```python
import torch

def _softmax(x, axis=-1):
    return torch.softmax(x, dim=axis)
def _gelu(x):
    return torch.nn.functional.gelu(x, approximate="tanh")
def _silu(x):
    return torch.nn.functional.silu(x)
def _sigmoid(x):
    return torch.sigmoid(x)
def _layernorm(x, axis=-1, eps=1e-5):
    m = x.mean(dim=axis, keepdim=True)
    v = x.var(dim=axis, keepdim=True, unbiased=False)
    return (x - m) / torch.sqrt(v + eps)
def _scatter_add(tgt, idx, src, axis=0):
    return tgt.clone().index_add_(axis, idx, src)
def _segment_sum(src, seg, n):
    out = torch.zeros((n,) + src.shape[1:], dtype=src.dtype)
    return out.index_add_(0, seg, src)
def _pad(x, pw):
    flat = tuple(v for pair in reversed(pw) for v in pair)
    return torch.nn.functional.pad(x, flat)

kernel_name = 'sequential_preLN__compressed_kv_cla__mixer_token_mlp__prompt'

def setup_inputs():

    _w = (lambda a: (lambda t: t.to(torch.bfloat16) if t.is_floating_point() else t)(torch.as_tensor(a)))
    def _A_setup():
        B, H, Sq, Sk, D, M = 1, 32, 2048, 2048, 128, 640
        Dc = 4 * D
        return {
            "x": _w((lambda *s: torch.randn(*s, dtype=torch.bfloat16) * 0.05)(B, Sq, M)),
            "c_kv": _w((lambda *s: torch.randn(*s, dtype=torch.bfloat16) * 0.2)(B, Sk, Dc)),
            "w_q": _w((lambda *s: torch.randn(*s, dtype=torch.bfloat16) * 3.2)(M, H, D) * (M ** -0.5)),
            "w_uk": _w((lambda *s: torch.randn(*s, dtype=torch.bfloat16) * 6.4)(Dc, H, D) * (Dc ** -0.5)),
            "w_uv": _w((lambda *s: torch.randn(*s, dtype=torch.bfloat16) * 0.2)(Dc, H, D) * (Dc ** -0.5)),
            "w_o": _w((lambda *s: torch.randn(*s, dtype=torch.bfloat16) * 0.2)(H, D, M) * ((H * D) ** -0.5)),
        }
    _A_in = _A_setup()

    def _B_setup():
        B, S, D, F = 1, 2048, 640, 1728
        return {
            "x": _w((lambda *s: torch.randn(*s, dtype=torch.bfloat16) * 0.05)(B, S, D)),
            "w1": _w((lambda *s: torch.randn(*s, dtype=torch.bfloat16) * 0.4)(S, F) * (S ** -0.5)),
            "b1": _w((lambda *s: torch.randn(*s, dtype=torch.bfloat16) * 3.2)(F) * 0.02),
            "w2": _w((lambda *s: torch.randn(*s, dtype=torch.bfloat16) * 0.2)(F, S) * (F ** -0.5)),
            "b2": _w((lambda *s: torch.randn(*s, dtype=torch.bfloat16) * 0.8)(S) * 0.02),
        }
    _B_in = _B_setup()

    return {
        "A_x": _A_in["x"],
        "A_c_kv": _A_in["c_kv"],
        "A_w_q": _A_in["w_q"],
        "A_w_uk": _A_in["w_uk"],
        "A_w_uv": _A_in["w_uv"],
        "A_w_o": _A_in["w_o"],
        "B_x": _B_in["x"],
        "B_w1": _B_in["w1"],
        "B_b1": _B_in["b1"],
        "B_w2": _B_in["w2"],
        "B_b2": _B_in["b2"],
    }

def reference(A_x, A_c_kv, A_w_q, A_w_uk, A_w_uv, A_w_o, B_x, B_w1, B_b1, B_w2, B_b2):
    def _A_ref(x, c_kv, w_q, w_uk, w_uv, w_o):
        B, Sq, M = x.shape[0], x.shape[1], x.shape[2]
        Sk = c_kv.shape[1]
        H, D = w_q.shape[1], w_q.shape[2]
        q = torch.einsum("bqm,mhd->bhqd", x, w_q)
        k = torch.einsum("bkc,chd->bhkd", c_kv, w_uk)
        v = torch.einsum("bkc,chd->bhkd", c_kv, w_uv)
        scores = torch.einsum("bhqd,bhkd->bhqk", q, k) * (D ** -0.5)
        off = Sk - Sq
        qi = torch.arange(Sq)[:, None]
        kj = torch.arange(Sk)[None, :]
        cmask = kj <= (qi + off)
        scores = torch.where(cmask[None, None], scores, -1e9)
        p = _softmax(scores, axis=-1)
        ctx = torch.einsum("bhqk,bhkd->bhqd", p, v)
        return torch.einsum("bhqd,hdm->bqm", ctx, w_o)

    def _B_ref(x, w1, b1, w2, b2):
        B, S, D = x.shape
        h = _layernorm(x, axis=-1)
        u = torch.einsum("bsd,sf->bdf", h, w1) + b1
        u = _gelu(u)
        y = torch.einsum("bdf,fs->bds", u, w2) + b2
        return (lambda x, *d: x.permute(*d))(y, 0, 2, 1)

    x = A_x
    h = x + _A_ref(_layernorm(x, axis=-1), A_c_kv, A_w_q, A_w_uk, A_w_uv, A_w_o)
    h2 = h + _B_ref(_layernorm(h, axis=-1), B_w1, B_b1, B_w2, B_b2)
    return h2
```

```asm
; @launch kernel=k1_kernel grid=(256,1,1) block=(512,1,1) lds=163840
; @launch kernel=k2_kernel grid=(256,1,1) block=(512,1,1) lds=163840
; @launch kernel=k3_kernel grid=(256,1,1) block=(512,1,1) lds=163840
; @launch kernel=k4_kernel grid=(256,1,1) block=(320,1,1) lds=16384
; @launch kernel=k5_kernel grid=(216,1,1) block=(512,1,1) lds=163840
; @launch kernel=k6_kernel grid=(256,1,1) block=(512,1,1) lds=163840
.amdgcn_target "amdgcn-amd-amdhsa--gfx950"
.text
.globl k1_kernel
.p2align 8
.type k1_kernel,@function
k1_kernel:
    s_cmp_ge_u32 s2, 256
    s_cbranch_scc1 K1_END
    s_load_dwordx4 s[4:7], s[0:1], 0
    s_load_dwordx4 s[8:11], s[0:1], 24
    s_load_dwordx2 s[12:13], s[0:1], 104
    s_load_dwordx2 s[60:61], s[0:1], 16
    v_and_b32 v1, 63, v0
    v_lshrrev_b32 v2, 6, v0
    s_nop 0
    v_readfirstlane_b32 s14, v2
    s_and_b32 s15, s2, 7
    s_lshr_b32 s16, s2, 3
    s_and_b32 s17, s16, 7
    s_lshr_b32 s18, s16, 3
    s_lshl_b32 s19, s15, 2
    s_add_u32 s18, s18, s19
    s_and_b32 s19, s18, 15
    s_waitcnt lgkmcnt(0)
    s_mov_b32 s20, s4
    s_and_b32 s21, s5, 0xffff
    s_mov_b32 s22, 2621440
    s_mov_b32 s23, 0x00020000
    s_mov_b32 s24, s6
    s_and_b32 s25, s7, 0xffff
    s_mov_b32 s26, 2097152
    s_mov_b32 s27, 0x00020000
    s_cmp_lt_u32 s18, 16
    s_cselect_b32 s8, s8, s10
    s_cselect_b32 s9, s9, s11
    s_cselect_b32 s3, 0, 16777216
    s_or_b32 s3, s3, 4194304
    s_mov_b32 s28, s8
    s_and_b32 s29, s9, 0xffff
    s_mov_b32 s30, 4194304
    s_mov_b32 s31, 0x00020000
    s_mov_b32 s60, s60
    s_and_b32 s61, s61, 0xffff
    s_mov_b32 s62, 5242880
    s_mov_b32 s63, 0x00020000
    s_lshl_b32 s64, s2, 3
    s_add_u32 s64, s64, s14
    s_mul_i32 s64, s64, 3072
    s_mov_b32 s32, s12
    s_and_b32 s33, s13, 0xffff
    s_mov_b32 s34, 2621440
    s_mov_b32 s35, 0x00020000
    s_add_u32 s36, s12, s3
    s_addc_u32 s37, s13, 0
    s_and_b32 s37, s37, 0xffff
    s_mov_b32 s38, 16777216
    s_mov_b32 s39, 0x00020000
    s_lshl_b32 s40, s2, 3
    s_add_u32 s40, s40, s14
    s_mul_i32 s41, s40, 1280
    v_lshlrev_b32 v3, 5, v1
    v_add_u32 v3, s41, v3
    v_cmp_gt_u32 vcc, 40, v1
    v_mov_b32 v4, 0x80000000
    s_nop 0
    v_cndmask_b32 v3, v4, v3, vcc
    buffer_load_dwordx4 v[8:11], v3, s[20:23], 0 offen
    buffer_load_dwordx4 v[12:15], v3, s[20:23], 0 offen offset:16
    v_lshrrev_b32 v5, 3, v1
    s_lshl_b32 s42, s17, 8
    s_lshl_b32 s43, s14, 5
    s_add_u32 s42, s42, s43
    v_add_u32 v5, s42, v5
    v_lshlrev_b32 v5, 10, v5
    v_lshrrev_b32 v6, 4, v1
    v_and_b32 v7, 7, v1
    v_xor_b32 v16, 0, v6
    v_xor_b32 v16, v16, v7
    v_lshl_add_u32 v16, v16, 4, v5
    v_add_u32 v200, 0, v16
    v_xor_b32 v16, 4, v6
    v_xor_b32 v16, v16, v7
    v_lshl_add_u32 v16, v16, 4, v5
    v_add_u32 v201, 7168, v16
    v_xor_b32 v16, 0, v6
    v_xor_b32 v16, v16, v7
    v_lshl_add_u32 v16, v16, 4, v5
    v_add_u32 v202, 14336, v16
    v_xor_b32 v16, 4, v6
    v_xor_b32 v16, v16, v7
    v_lshl_add_u32 v16, v16, 4, v5
    v_add_u32 v203, 21504, v16
    v_lshrrev_b32 v5, 5, v1
    v_and_b32 v6, 31, v1
    s_lshl_b32 s43, s14, 2
    s_lshl_b32 s44, s19, 9
    v_add_u32 v7, 0, v5
    v_lshlrev_b32 v16, 2, v7
    v_xor_b32 v16, v16, v6
    v_add_u32 v7, s43, v7
    v_lshlrev_b32 v7, 13, v7
    v_lshl_add_u32 v16, v16, 4, v7
    v_add_u32 v16, s44, v16
    v_add_u32 v204, 0, v16
    v_add_u32 v7, 2, v5
    v_lshlrev_b32 v16, 2, v7
    v_xor_b32 v16, v16, v6
    v_add_u32 v7, s43, v7
    v_lshlrev_b32 v7, 13, v7
    v_lshl_add_u32 v16, v16, 4, v7
    v_add_u32 v16, s44, v16
    v_add_u32 v205, 4294966272, v16
    s_lshl_b32 s45, s14, 12
    s_lshl_b32 s46, s14, 11
    s_add_u32 m0, s45, 0
    s_mov_b32 s47, 0
    buffer_load_dwordx4 v200, s[24:27], s47 offen offset:0 lds
    buffer_load_dwordx4 v201, s[24:27], s47 offen offset:1024 lds
    buffer_load_dwordx4 v202, s[24:27], s47 offen offset:2048 lds
    buffer_load_dwordx4 v203, s[24:27], s47 offen offset:3072 lds
    s_add_u32 m0, s46, 98304
    s_mov_b32 s48, 0
    buffer_load_dwordx4 v204, s[28:31], s48 offen offset:0 lds
    buffer_load_dwordx4 v205, s[28:31], s48 offen offset:1024 lds
    s_add_u32 m0, s46, 114688
    s_mov_b32 s48, 262144
    buffer_load_dwordx4 v204, s[28:31], s48 offen offset:0 lds
    buffer_load_dwordx4 v205, s[28:31], s48 offen offset:1024 lds
    v_and_b32 v5, 31, v1
    v_lshrrev_b32 v6, 5, v1
    v_bfe_u32 v7, v1, 1, 3
    v_xor_b32 v7, v7, v6
    s_lshr_b32 s49, s14, 2
    s_and_b32 s50, s14, 3
    s_lshl_b32 s51, s49, 14
    v_lshlrev_b32 v5, 7, v5
    v_add_u32 v5, s51, v5
    v_xor_b32 v16, 0, v7
    v_lshl_add_u32 v206, v16, 4, v5
    v_xor_b32 v16, 2, v7
    v_lshl_add_u32 v207, v16, 4, v5
    v_xor_b32 v16, 4, v7
    v_lshl_add_u32 v208, v16, 4, v5
    v_xor_b32 v16, 6, v7
    v_lshl_add_u32 v209, v16, 4, v5
    v_bfe_u32 v5, v1, 2, 2
    v_lshrrev_b32 v6, 5, v1
    v_lshl_add_u32 v6, v6, 3, v5
    v_lshlrev_b32 v6, 9, v6
    v_bfe_u32 v7, v1, 4, 1
    v_lshl_add_u32 v6, v7, 5, v6
    v_and_b32 v7, 3, v1
    v_lshl_add_u32 v6, v7, 3, v6
    s_lshr_b32 s51, s50, 1
    s_lshl_b32 s51, s51, 8
    s_add_u32 s51, s51, 98304
    v_add_u32 v6, s51, v6
    s_and_b32 s51, s50, 1
    s_lshl_b32 s51, s51, 1
    s_add_u32 s52, s51, 0
    v_xor_b32 v7, s52, v5
    v_lshl_add_u32 v210, v7, 6, v6
    s_add_u32 s52, s51, 1
    v_xor_b32 v7, s52, v5
    v_lshl_add_u32 v211, v7, 6, v6
    v_lshlrev_b32 v212, 4, v1
    s_lshl_b32 s66, s16, 3
    s_add_u32 s66, s66, s14
    s_lshl_b32 s66, s66, 14
    s_and_b32 s67, s15, 3
    s_lshl_b32 s67, s67, 11
    s_add_u32 s66, s66, s67
    s_add_u32 s67, s66, 8192
    s_lshl_b32 s68, s2, 3
    s_add_u32 s68, s68, s14
    s_lshl_b32 s68, s68, 10
    s_cmp_lt_u32 s18, 16
    s_cbranch_scc0 K1_V
    v_add_u32 v213, 0x10000, v206
    v_add_u32 v214, 0x10000, v207
    v_add_u32 v215, 0x10000, v208
    v_add_u32 v216, 0x10000, v209
    s_lshl_b32 s53, s19, 1
    s_lshr_b32 s54, s50, 1
    s_add_u32 s53, s53, s54
    s_lshl_b32 s53, s53, 19
    s_lshl_b32 s54, s17, 16
    s_add_u32 s53, s53, s54
    s_lshl_b32 s54, s49, 15
    s_add_u32 s53, s53, s54
    s_and_b32 s54, s50, 1
    s_lshl_b32 s54, s54, 12
    s_add_u32 s53, s53, s54
    s_mov_b32 s65, 0x3e0293ee
    s_waitcnt vmcnt(2) lgkmcnt(0)
    s_barrier
    ds_read_b64_tr_b16 v[32:33], v210 offset:0
    ds_read_b64_tr_b16 v[34:35], v210 offset:2048
    ds_read_b64_tr_b16 v[36:37], v211 offset:0
    ds_read_b64_tr_b16 v[38:39], v211 offset:2048
    ds_read_b128 v[16:19], v206 offset:0
    ds_read_b128 v[20:23], v206 offset:4096
    ds_read_b128 v[24:27], v206 offset:8192
    ds_read_b128 v[28:31], v206 offset:12288
    s_add_u32 m0, s45, 32768
    s_mov_b32 s47, 128
    buffer_load_dwordx4 v200, s[24:27], s47 offen offset:0 lds
    buffer_load_dwordx4 v201, s[24:27], s47 offen offset:1024 lds
    buffer_load_dwordx4 v202, s[24:27], s47 offen offset:2048 lds
    buffer_load_dwordx4 v203, s[24:27], s47 offen offset:3072 lds
    s_waitcnt lgkmcnt(0)
    v_mfma_f32_32x32x16_bf16 v[64:79], v[32:35], v[16:19], 0
    ds_read_b64_tr_b16 v[56:57], v210 offset:8192
    ds_read_b64_tr_b16 v[58:59], v210 offset:10240
    v_mfma_f32_32x32x16_bf16 v[80:95], v[36:39], v[16:19], 0
    ds_read_b64_tr_b16 v[60:61], v211 offset:8192
    ds_read_b64_tr_b16 v[62:63], v211 offset:10240
    v_mfma_f32_32x32x16_bf16 v[96:111], v[32:35], v[20:23], 0
    ds_read_b128 v[40:43], v207 offset:0
    ds_read_b128 v[44:47], v207 offset:4096
    v_mfma_f32_32x32x16_bf16 v[112:127], v[36:39], v[20:23], 0
    ds_read_b128 v[48:51], v207 offset:8192
    ds_read_b128 v[52:55], v207 offset:12288
    v_mfma_f32_32x32x16_bf16 v[128:143], v[32:35], v[24:27], 0
    s_add_u32 m0, s46, 131072
    s_mov_b32 s48, 524288
    buffer_load_dwordx4 v204, s[28:31], s48 offen offset:0 lds
    buffer_load_dwordx4 v205, s[28:31], s48 offen offset:1024 lds
    s_add_u32 m0, s46, 147456
    s_mov_b32 s48, 786432
    buffer_load_dwordx4 v204, s[28:31], s48 offen offset:0 lds
    buffer_load_dwordx4 v205, s[28:31], s48 offen offset:1024 lds
    v_mfma_f32_32x32x16_bf16 v[144:159], v[36:39], v[24:27], 0
    v_mfma_f32_32x32x16_bf16 v[160:175], v[32:35], v[28:31], 0
    v_mfma_f32_32x32x16_bf16 v[176:191], v[36:39], v[28:31], 0
    s_waitcnt vmcnt(8) lgkmcnt(0)
    s_barrier
    v_mfma_f32_32x32x16_bf16 v[64:79], v[56:59], v[40:43], v[64:79]
    ds_read_b64_tr_b16 v[32:33], v210 offset:16384
    ds_read_b64_tr_b16 v[34:35], v210 offset:18432
    v_mfma_f32_32x32x16_bf16 v[80:95], v[60:63], v[40:43], v[80:95]
    ds_read_b64_tr_b16 v[36:37], v211 offset:16384
    ds_read_b64_tr_b16 v[38:39], v211 offset:18432
    v_mfma_f32_32x32x16_bf16 v[96:111], v[56:59], v[44:47], v[96:111]
    ds_read_b128 v[16:19], v208 offset:0
    ds_read_b128 v[20:23], v208 offset:4096
    v_mfma_f32_32x32x16_bf16 v[112:127], v[60:63], v[44:47], v[112:127]
    ds_read_b128 v[24:27], v208 offset:8192
    ds_read_b128 v[28:31], v208 offset:12288
    v_mfma_f32_32x32x16_bf16 v[128:143], v[56:59], v[48:51], v[128:143]
    s_add_u32 m0, s46, 98304
    s_mov_b32 s48, 1048576
    buffer_load_dwordx4 v204, s[28:31], s48 offen offset:0 lds
    buffer_load_dwordx4 v205, s[28:31], s48 offen offset:1024 lds
    v_mfma_f32_32x32x16_bf16 v[144:159], v[60:63], v[48:51], v[144:159]
    v_mfma_f32_32x32x16_bf16 v[160:175], v[56:59], v[52:55], v[160:175]
    v_mfma_f32_32x32x16_bf16 v[176:191], v[60:63], v[52:55], v[176:191]
    s_waitcnt lgkmcnt(0)
    v_mfma_f32_32x32x16_bf16 v[64:79], v[32:35], v[16:19], v[64:79]
    ds_read_b64_tr_b16 v[56:57], v210 offset:24576
    ds_read_b64_tr_b16 v[58:59], v210 offset:26624
    v_mfma_f32_32x32x16_bf16 v[80:95], v[36:39], v[16:19], v[80:95]
    ds_read_b64_tr_b16 v[60:61], v211 offset:24576
    ds_read_b64_tr_b16 v[62:63], v211 offset:26624
    v_mfma_f32_32x32x16_bf16 v[96:111], v[32:35], v[20:23], v[96:111]
    ds_read_b128 v[40:43], v209 offset:0
    ds_read_b128 v[44:47], v209 offset:4096
    v_mfma_f32_32x32x16_bf16 v[112:127], v[36:39], v[20:23], v[112:127]
    ds_read_b128 v[48:51], v209 offset:8192
    ds_read_b128 v[52:55], v209 offset:12288
    v_mfma_f32_32x32x16_bf16 v[128:143], v[32:35], v[24:27], v[128:143]
    s_add_u32 m0, s45, 65536
    s_mov_b32 s47, 256
    buffer_load_dwordx4 v200, s[24:27], s47 offen offset:0 lds
    buffer_load_dwordx4 v201, s[24:27], s47 offen offset:1024 lds
    buffer_load_dwordx4 v202, s[24:27], s47 offen offset:2048 lds
    buffer_load_dwordx4 v203, s[24:27], s47 offen offset:3072 lds
    v_mfma_f32_32x32x16_bf16 v[144:159], v[36:39], v[24:27], v[144:159]
    v_mfma_f32_32x32x16_bf16 v[160:175], v[32:35], v[28:31], v[160:175]
    v_mfma_f32_32x32x16_bf16 v[176:191], v[36:39], v[28:31], v[176:191]
    s_waitcnt vmcnt(8) lgkmcnt(0)
    s_barrier
    v_mfma_f32_32x32x16_bf16 v[64:79], v[56:59], v[40:43], v[64:79]
    ds_read_b64_tr_b16 v[32:33], v210 offset:32768
    ds_read_b64_tr_b16 v[34:35], v210 offset:34816
    v_mfma_f32_32x32x16_bf16 v[80:95], v[60:63], v[40:43], v[80:95]
    ds_read_b64_tr_b16 v[36:37], v211 offset:32768
    ds_read_b64_tr_b16 v[38:39], v211 offset:34816
    v_mfma_f32_32x32x16_bf16 v[96:111], v[56:59], v[44:47], v[96:111]
    ds_read_b128 v[16:19], v206 offset:32768
    ds_read_b128 v[20:23], v206 offset:36864
    v_mfma_f32_32x32x16_bf16 v[112:127], v[60:63], v[44:47], v[112:127]
    ds_read_b128 v[24:27], v206 offset:40960
    ds_read_b128 v[28:31], v206 offset:45056
    v_mfma_f32_32x32x16_bf16 v[128:143], v[56:59], v[48:51], v[128:143]
    s_add_u32 m0, s46, 114688
    s_mov_b32 s48, 1310720
    buffer_load_dwordx4 v204, s[28:31], s48 offen offset:0 lds
    buffer_load_dwordx4 v205, s[28:31], s48 offen offset:1024 lds
    s_add_u32 m0, s45, 0
    s_mov_b32 s47, 384
    buffer_load_dwordx4 v200, s[24:27], s47 offen offset:0 lds
    buffer_load_dwordx4 v201, s[24:27], s47 offen offset:1024 lds
    buffer_load_dwordx4 v202, s[24:27], s47 offen offset:2048 lds
    buffer_load_dwordx4 v203, s[24:27], s47 offen offset:3072 lds
    v_mfma_f32_32x32x16_bf16 v[144:159], v[60:63], v[48:51], v[144:159]
    v_mfma_f32_32x32x16_bf16 v[160:175], v[56:59], v[52:55], v[160:175]
    v_mfma_f32_32x32x16_bf16 v[176:191], v[60:63], v[52:55], v[176:191]
    s_waitcnt lgkmcnt(0)
    v_mfma_f32_32x32x16_bf16 v[64:79], v[32:35], v[16:19], v[64:79]
    ds_read_b64_tr_b16 v[56:57], v210 offset:40960
    ds_read_b64_tr_b16 v[58:59], v210 offset:43008
    v_mfma_f32_32x32x16_bf16 v[80:95], v[36:39], v[16:19], v[80:95]
    ds_read_b64_tr_b16 v[60:61], v211 offset:40960
    ds_read_b64_tr_b16 v[62:63], v211 offset:43008
    v_mfma_f32_32x32x16_bf16 v[96:111], v[32:35], v[20:23], v[96:111]
    ds_read_b128 v[40:43], v207 offset:32768
    ds_read_b128 v[44:47], v207 offset:36864
    v_mfma_f32_32x32x16_bf16 v[112:127], v[36:39], v[20:23], v[112:127]
    ds_read_b128 v[48:51], v207 offset:40960
    ds_read_b128 v[52:55], v207 offset:45056
    v_mfma_f32_32x32x16_bf16 v[128:143], v[32:35], v[24:27], v[128:143]
    v_mfma_f32_32x32x16_bf16 v[144:159], v[36:39], v[24:27], v[144:159]
    v_mfma_f32_32x32x16_bf16 v[160:175], v[32:35], v[28:31], v[160:175]
    v_mfma_f32_32x32x16_bf16 v[176:191], v[36:39], v[28:31], v[176:191]
    s_waitcnt vmcnt(12) lgkmcnt(0)
    s_barrier
    v_mfma_f32_32x32x16_bf16 v[64:79], v[56:59], v[40:43], v[64:79]
    ds_read_b64_tr_b16 v[32:33], v210 offset:49152
    ds_read_b64_tr_b16 v[34:35], v210 offset:51200
    v_mfma_f32_32x32x16_bf16 v[80:95], v[60:63], v[40:43], v[80:95]
    ds_read_b64_tr_b16 v[36:37], v211 offset:49152
    ds_read_b64_tr_b16 v[38:39], v211 offset:51200
    v_mfma_f32_32x32x16_bf16 v[96:111], v[56:59], v[44:47], v[96:111]
    ds_read_b128 v[16:19], v208 offset:32768
    ds_read_b128 v[20:23], v208 offset:36864
    v_mfma_f32_32x32x16_bf16 v[112:127], v[60:63], v[44:47], v[112:127]
    ds_read_b128 v[24:27], v208 offset:40960
    ds_read_b128 v[28:31], v208 offset:45056
    v_mfma_f32_32x32x16_bf16 v[128:143], v[56:59], v[48:51], v[128:143]
    s_add_u32 m0, s46, 131072
    s_mov_b32 s48, 1572864
    buffer_load_dwordx4 v204, s[28:31], s48 offen offset:0 lds
    buffer_load_dwordx4 v205, s[28:31], s48 offen offset:1024 lds
    v_lshlrev_b32 v220, 16, v8
    v_mfma_f32_32x32x16_bf16 v[144:159], v[60:63], v[48:51], v[144:159]
    v_and_b32 v221, 0xffff0000, v8
    v_lshlrev_b32 v222, 16, v9
    v_mfma_f32_32x32x16_bf16 v[160:175], v[56:59], v[52:55], v[160:175]
    v_and_b32 v223, 0xffff0000, v9
    v_lshlrev_b32 v224, 16, v10
    v_mfma_f32_32x32x16_bf16 v[176:191], v[60:63], v[52:55], v[176:191]
    v_and_b32 v225, 0xffff0000, v10
    v_lshlrev_b32 v226, 16, v11
    v_and_b32 v227, 0xffff0000, v11
    s_waitcnt lgkmcnt(0)
    v_mfma_f32_32x32x16_bf16 v[64:79], v[32:35], v[16:19], v[64:79]
    ds_read_b64_tr_b16 v[56:57], v210 offset:57344
    ds_read_b64_tr_b16 v[58:59], v210 offset:59392
    v_mfma_f32_32x32x16_bf16 v[80:95], v[36:39], v[16:19], v[80:95]
    ds_read_b64_tr_b16 v[60:61], v211 offset:57344
    ds_read_b64_tr_b16 v[62:63], v211 offset:59392
    v_mfma_f32_32x32x16_bf16 v[96:111], v[32:35], v[20:23], v[96:111]
    ds_read_b128 v[40:43], v209 offset:32768
    ds_read_b128 v[44:47], v209 offset:36864
    v_mfma_f32_32x32x16_bf16 v[112:127], v[36:39], v[20:23], v[112:127]
    ds_read_b128 v[48:51], v209 offset:40960
    ds_read_b128 v[52:55], v209 offset:45056
    v_mfma_f32_32x32x16_bf16 v[128:143], v[32:35], v[24:27], v[128:143]
    v_lshlrev_b32 v228, 16, v12
    v_and_b32 v229, 0xffff0000, v12
    v_mfma_f32_32x32x16_bf16 v[144:159], v[36:39], v[24:27], v[144:159]
    v_lshlrev_b32 v230, 16, v13
    v_and_b32 v231, 0xffff0000, v13
    v_mfma_f32_32x32x16_bf16 v[160:175], v[32:35], v[28:31], v[160:175]
    v_lshlrev_b32 v232, 16, v14
    v_and_b32 v233, 0xffff0000, v14
    v_mfma_f32_32x32x16_bf16 v[176:191], v[36:39], v[28:31], v[176:191]
    v_lshlrev_b32 v234, 16, v15
    v_and_b32 v235, 0xffff0000, v15
    s_waitcnt vmcnt(8) lgkmcnt(0)
    s_barrier
    v_mfma_f32_32x32x16_bf16 v[64:79], v[56:59], v[40:43], v[64:79]
    ds_read_b64_tr_b16 v[32:33], v210 offset:0
    ds_read_b64_tr_b16 v[34:35], v210 offset:2048
    v_mfma_f32_32x32x16_bf16 v[80:95], v[60:63], v[40:43], v[80:95]
    ds_read_b64_tr_b16 v[36:37], v211 offset:0
    ds_read_b64_tr_b16 v[38:39], v211 offset:2048
    v_mfma_f32_32x32x16_bf16 v[96:111], v[56:59], v[44:47], v[96:111]
    ds_read_b128 v[16:19], v213 offset:0
    ds_read_b128 v[20:23], v213 offset:4096
    v_mfma_f32_32x32x16_bf16 v[112:127], v[60:63], v[44:47], v[112:127]
    ds_read_b128 v[24:27], v213 offset:8192
    ds_read_b128 v[28:31], v213 offset:12288
    v_mfma_f32_32x32x16_bf16 v[128:143], v[56:59], v[48:51], v[128:143]
    s_add_u32 m0, s46, 147456
    s_mov_b32 s48, 1835008
    buffer_load_dwordx4 v204, s[28:31], s48 offen offset:0 lds
    buffer_load_dwordx4 v205, s[28:31], s48 offen offset:1024 lds
    s_add_u32 m0, s45, 32768
    s_mov_b32 s47, 512
    buffer_load_dwordx4 v200, s[24:27], s47 offen offset:0 lds
    buffer_load_dwordx4 v201, s[24:27], s47 offen offset:1024 lds
    buffer_load_dwordx4 v202, s[24:27], s47 offen offset:2048 lds
    buffer_load_dwordx4 v203, s[24:27], s47 offen offset:3072 lds
    v_mfma_f32_32x32x16_bf16 v[144:159], v[60:63], v[48:51], v[144:159]
    v_add_f32 v236, v220, v221
    v_add_f32 v236, v236, v222
    v_mfma_f32_32x32x16_bf16 v[160:175], v[56:59], v[52:55], v[160:175]
    v_add_f32 v236, v236, v223
    v_add_f32 v236, v236, v224
    v_mfma_f32_32x32x16_bf16 v[176:191], v[60:63], v[52:55], v[176:191]
    v_add_f32 v236, v236, v225
    v_add_f32 v236, v236, v226
    v_add_f32 v236, v236, v227
    v_add_f32 v236, v236, v228
    s_waitcnt lgkmcnt(0)
    v_mfma_f32_32x32x16_bf16 v[64:79], v[32:35], v[16:19], v[64:79]
    ds_read_b64_tr_b16 v[56:57], v210 offset:8192
    ds_read_b64_tr_b16 v[58:59], v210 offset:10240
    v_mfma_f32_32x32x16_bf16 v[80:95], v[36:39], v[16:19], v[80:95]
    ds_read_b64_tr_b16 v[60:61], v211 offset:8192
    ds_read_b64_tr_b16 v[62:63], v211 offset:10240
    v_mfma_f32_32x32x16_bf16 v[96:111], v[32:35], v[20:23], v[96:111]
    ds_read_b128 v[40:43], v214 offset:0
    ds_read_b128 v[44:47], v214 offset:4096
    v_mfma_f32_32x32x16_bf16 v[112:127], v[36:39], v[20:23], v[112:127]
    ds_read_b128 v[48:51], v214 offset:8192
    ds_read_b128 v[52:55], v214 offset:12288
    v_mfma_f32_32x32x16_bf16 v[128:143], v[32:35], v[24:27], v[128:143]
    v_add_f32 v236, v236, v229
    v_add_f32 v236, v236, v230
    v_mfma_f32_32x32x16_bf16 v[144:159], v[36:39], v[24:27], v[144:159]
    v_add_f32 v236, v236, v231
    v_add_f32 v236, v236, v232
    v_mfma_f32_32x32x16_bf16 v[160:175], v[32:35], v[28:31], v[160:175]
    v_add_f32 v236, v236, v233
    v_add_f32 v236, v236, v234
    v_mfma_f32_32x32x16_bf16 v[176:191], v[36:39], v[28:31], v[176:191]
    v_add_f32 v236, v236, v235
    s_nop 1
    s_waitcnt vmcnt(12) lgkmcnt(0)
    s_barrier
    v_mfma_f32_32x32x16_bf16 v[64:79], v[56:59], v[40:43], v[64:79]
    ds_read_b64_tr_b16 v[32:33], v210 offset:16384
    ds_read_b64_tr_b16 v[34:35], v210 offset:18432
    v_mfma_f32_32x32x16_bf16 v[80:95], v[60:63], v[40:43], v[80:95]
    ds_read_b64_tr_b16 v[36:37], v211 offset:16384
    ds_read_b64_tr_b16 v[38:39], v211 offset:18432
    v_mfma_f32_32x32x16_bf16 v[96:111], v[56:59], v[44:47], v[96:111]
    ds_read_b128 v[16:19], v215 offset:0
    ds_read_b128 v[20:23], v215 offset:4096
    v_mfma_f32_32x32x16_bf16 v[112:127], v[60:63], v[44:47], v[112:127]
    ds_read_b128 v[24:27], v215 offset:8192
    ds_read_b128 v[28:31], v215 offset:12288
    v_mfma_f32_32x32x16_bf16 v[128:143], v[56:59], v[48:51], v[128:143]
    s_add_u32 m0, s46, 98304
    s_mov_b32 s48, 2097152
    buffer_load_dwordx4 v204, s[28:31], s48 offen offset:0 lds
    buffer_load_dwordx4 v205, s[28:31], s48 offen offset:1024 lds
    v_add_f32_dpp v236, v236, v236 quad_perm:[1,0,3,2] row_mask:0xf bank_mask:0xf
    v_mfma_f32_32x32x16_bf16 v[144:159], v[60:63], v[48:51], v[144:159]
    s_nop 1
    v_add_f32_dpp v236, v236, v236 quad_perm:[2,3,0,1] row_mask:0xf bank_mask:0xf
    v_mfma_f32_32x32x16_bf16 v[160:175], v[56:59], v[52:55], v[160:175]
    s_nop 1
    v_add_f32_dpp v236, v236, v236 row_half_mirror row_mask:0xf bank_mask:0xf
    v_mfma_f32_32x32x16_bf16 v[176:191], v[60:63], v[52:55], v[176:191]
    s_nop 1
    v_add_f32_dpp v236, v236, v236 row_mirror row_mask:0xf bank_mask:0xf
    s_nop 1
    s_waitcnt lgkmcnt(0)
    v_mfma_f32_32x32x16_bf16 v[64:79], v[32:35], v[16:19], v[64:79]
    ds_read_b64_tr_b16 v[56:57], v210 offset:24576
    ds_read_b64_tr_b16 v[58:59], v210 offset:26624
    v_mfma_f32_32x32x16_bf16 v[80:95], v[36:39], v[16:19], v[80:95]
    ds_read_b64_tr_b16 v[60:61], v211 offset:24576
    ds_read_b64_tr_b16 v[62:63], v211 offset:26624
    v_mfma_f32_32x32x16_bf16 v[96:111], v[32:35], v[20:23], v[96:111]
    ds_read_b128 v[40:43], v216 offset:0
    ds_read_b128 v[44:47], v216 offset:4096
    v_mfma_f32_32x32x16_bf16 v[112:127], v[36:39], v[20:23], v[112:127]
    ds_read_b128 v[48:51], v216 offset:8192
    ds_read_b128 v[52:55], v216 offset:12288
    v_mfma_f32_32x32x16_bf16 v[128:143], v[32:35], v[24:27], v[128:143]
    v_readlane_b32 s56, v236, 0
    v_readlane_b32 s57, v236, 16
    v_mfma_f32_32x32x16_bf16 v[144:159], v[36:39], v[24:27], v[144:159]
    v_readlane_b32 s58, v236, 32
    v_readlane_b32 s59, v236, 48
    v_mfma_f32_32x32x16_bf16 v[160:175], v[32:35], v[28:31], v[160:175]
    s_nop 1
    v_mov_b32 v236, s56
    v_mfma_f32_32x32x16_bf16 v[176:191], v[36:39], v[28:31], v[176:191]
    v_add_f32 v236, s57, v236
    v_add_f32 v236, s58, v236
    s_waitcnt vmcnt(8) lgkmcnt(0)
    s_barrier
    v_mfma_f32_32x32x16_bf16 v[64:79], v[56:59], v[40:43], v[64:79]
    ds_read_b64_tr_b16 v[32:33], v210 offset:32768
    ds_read_b64_tr_b16 v[34:35], v210 offset:34816
    v_mfma_f32_32x32x16_bf16 v[80:95], v[60:63], v[40:43], v[80:95]
    ds_read_b64_tr_b16 v[36:37], v211 offset:32768
    ds_read_b64_tr_b16 v[38:39], v211 offset:34816
    v_mfma_f32_32x32x16_bf16 v[96:111], v[56:59], v[44:47], v[96:111]
    ds_read_b128 v[16:19], v206 offset:0
    ds_read_b128 v[20:23], v206 offset:4096
    v_mfma_f32_32x32x16_bf16 v[112:127], v[60:63], v[44:47], v[112:127]
    ds_read_b128 v[24:27], v206 offset:8192
    ds_read_b128 v[28:31], v206 offset:12288
    v_mfma_f32_32x32x16_bf16 v[128:143], v[56:59], v[48:51], v[128:143]
    s_add_u32 m0, s46, 114688
    s_mov_b32 s48, 2359296
    buffer_load_dwordx4 v204, s[28:31], s48 offen offset:0 lds
    buffer_load_dwordx4 v205, s[28:31], s48 offen offset:1024 lds
    s_add_u32 m0, s45, 65536
    s_mov_b32 s47, 640
    buffer_load_dwordx4 v200, s[24:27], s47 offen offset:0 lds
    buffer_load_dwordx4 v201, s[24:27], s47 offen offset:1024 lds
    buffer_load_dwordx4 v202, s[24:27], s47 offen offset:2048 lds
    buffer_load_dwordx4 v203, s[24:27], s47 offen offset:3072 lds
    v_mfma_f32_32x32x16_bf16 v[144:159], v[60:63], v[48:51], v[144:159]
    v_add_f32 v236, s59, v236
    v_mul_f32 v236, 0.0015625, v236
    v_mfma_f32_32x32x16_bf16 v[160:175], v[56:59], v[52:55], v[160:175]
    v_sub_f32 v237, v220, v236
    v_mul_f32 v238, v237, v237
    v_mfma_f32_32x32x16_bf16 v[176:191], v[60:63], v[52:55], v[176:191]
    v_sub_f32 v237, v221, v236
    v_fmac_f32 v238, v237, v237
    v_sub_f32 v237, v222, v236
    v_fmac_f32 v238, v237, v237
    s_waitcnt lgkmcnt(0)
    v_mfma_f32_32x32x16_bf16 v[64:79], v[32:35], v[16:19], v[64:79]
    ds_read_b64_tr_b16 v[56:57], v210 offset:40960
    ds_read_b64_tr_b16 v[58:59], v210 offset:43008
    v_mfma_f32_32x32x16_bf16 v[80:95], v[36:39], v[16:19], v[80:95]
    ds_read_b64_tr_b16 v[60:61], v211 offset:40960
    ds_read_b64_tr_b16 v[62:63], v211 offset:43008
    v_mfma_f32_32x32x16_bf16 v[96:111], v[32:35], v[20:23], v[96:111]
    ds_read_b128 v[40:43], v207 offset:0
    ds_read_b128 v[44:47], v207 offset:4096
    v_mfma_f32_32x32x16_bf16 v[112:127], v[36:39], v[20:23], v[112:127]
    ds_read_b128 v[48:51], v207 offset:8192
    ds_read_b128 v[52:55], v207 offset:12288
    v_mfma_f32_32x32x16_bf16 v[128:143], v[32:35], v[24:27], v[128:143]
    v_sub_f32 v237, v223, v236
    v_fmac_f32 v238, v237, v237
    v_mfma_f32_32x32x16_bf16 v[144:159], v[36:39], v[24:27], v[144:159]
    v_sub_f32 v237, v224, v236
    v_fmac_f32 v238, v237, v237
    v_mfma_f32_32x32x16_bf16 v[160:175], v[32:35], v[28:31], v[160:175]
    v_sub_f32 v237, v225, v236
    v_fmac_f32 v238, v237, v237
    v_mfma_f32_32x32x16_bf16 v[176:191], v[36:39], v[28:31], v[176:191]
    v_sub_f32 v237, v226, v236
    v_fmac_f32 v238, v237, v237
    s_waitcnt vmcnt(12) lgkmcnt(0)
    s_barrier
    v_mfma_f32_32x32x16_bf16 v[64:79], v[56:59], v[40:43], v[64:79]
    ds_read_b64_tr_b16 v[32:33], v210 offset:49152
    ds_read_b64_tr_b16 v[34:35], v210 offset:51200
    v_mfma_f32_32x32x16_bf16 v[80:95], v[60:63], v[40:43], v[80:95]
    ds_read_b64_tr_b16 v[36:37], v211 offset:49152
    ds_read_b64_tr_b16 v[38:39], v211 offset:51200
    v_mfma_f32_32x32x16_bf16 v[96:111], v[56:59], v[44:47], v[96:111]
    ds_read_b128 v[16:19], v208 offset:0
    ds_read_b128 v[20:23], v208 offset:4096
    v_mfma_f32_32x32x16_bf16 v[112:127], v[60:63], v[44:47], v[112:127]
    ds_read_b128 v[24:27], v208 offset:8192
    ds_read_b128 v[28:31], v208 offset:12288
    v_mfma_f32_32x32x16_bf16 v[128:143], v[56:59], v[48:51], v[128:143]
    s_add_u32 m0, s46, 131072
    s_mov_b32 s48, 2621440
    buffer_load_dwordx4 v204, s[28:31], s48 offen offset:0 lds
    buffer_load_dwordx4 v205, s[28:31], s48 offen offset:1024 lds
    v_sub_f32 v237, v227, v236
    v_mfma_f32_32x32x16_bf16 v[144:159], v[60:63], v[48:51], v[144:159]
    v_fmac_f32 v238, v237, v237
    v_sub_f32 v237, v228, v236
    v_mfma_f32_32x32x16_bf16 v[160:175], v[56:59], v[52:55], v[160:175]
    v_fmac_f32 v238, v237, v237
    v_sub_f32 v237, v229, v236
    v_mfma_f32_32x32x16_bf16 v[176:191], v[60:63], v[52:55], v[176:191]
    v_fmac_f32 v238, v237, v237
    v_sub_f32 v237, v230, v236
    v_fmac_f32 v238, v237, v237
    s_waitcnt lgkmcnt(0)
    v_mfma_f32_32x32x16_bf16 v[64:79], v[32:35], v[16:19], v[64:79]
    ds_read_b64_tr_b16 v[56:57], v210 offset:57344
    ds_read_b64_tr_b16 v[58:59], v210 offset:59392
    v_mfma_f32_32x32x16_bf16 v[80:95], v[36:39], v[16:19], v[80:95]
    ds_read_b64_tr_b16 v[60:61], v211 offset:57344
    ds_read_b64_tr_b16 v[62:63], v211 offset:59392
    v_mfma_f32_32x32x16_bf16 v[96:111], v[32:35], v[20:23], v[96:111]
    ds_read_b128 v[40:43], v209 offset:0
    ds_read_b128 v[44:47], v209 offset:4096
    v_mfma_f32_32x32x16_bf16 v[112:127], v[36:39], v[20:23], v[112:127]
    ds_read_b128 v[48:51], v209 offset:8192
    ds_read_b128 v[52:55], v209 offset:12288
    v_mfma_f32_32x32x16_bf16 v[128:143], v[32:35], v[24:27], v[128:143]
    v_sub_f32 v237, v231, v236
    v_fmac_f32 v238, v237, v237
    v_mfma_f32_32x32x16_bf16 v[144:159], v[36:39], v[24:27], v[144:159]
    v_sub_f32 v237, v232, v236
    v_fmac_f32 v238, v237, v237
    v_mfma_f32_32x32x16_bf16 v[160:175], v[32:35], v[28:31], v[160:175]
    v_sub_f32 v237, v233, v236
    v_fmac_f32 v238, v237, v237
    v_mfma_f32_32x32x16_bf16 v[176:191], v[36:39], v[28:31], v[176:191]
    v_sub_f32 v237, v234, v236
    v_fmac_f32 v238, v237, v237
    s_waitcnt vmcnt(8) lgkmcnt(0)
    s_barrier
    v_mfma_f32_32x32x16_bf16 v[64:79], v[56:59], v[40:43], v[64:79]
    ds_read_b64_tr_b16 v[32:33], v210 offset:0
    ds_read_b64_tr_b16 v[34:35], v210 offset:2048
    v_mfma_f32_32x32x16_bf16 v[80:95], v[60:63], v[40:43], v[80:95]
    ds_read_b64_tr_b16 v[36:37], v211 offset:0
    ds_read_b64_tr_b16 v[38:39], v211 offset:2048
    v_mfma_f32_32x32x16_bf16 v[96:111], v[56:59], v[44:47], v[96:111]
    ds_read_b128 v[16:19], v206 offset:32768
    ds_read_b128 v[20:23], v206 offset:36864
    v_mfma_f32_32x32x16_bf16 v[112:127], v[60:63], v[44:47], v[112:127]
    ds_read_b128 v[24:27], v206 offset:40960
    ds_read_b128 v[28:31], v206 offset:45056
    v_mfma_f32_32x32x16_bf16 v[128:143], v[56:59], v[48:51], v[128:143]
    s_add_u32 m0, s46, 147456
    s_mov_b32 s48, 2883584
    buffer_load_dwordx4 v204, s[28:31], s48 offen offset:0 lds
    buffer_load_dwordx4 v205, s[28:31], s48 offen offset:1024 lds
    s_add_u32 m0, s45, 0
    s_mov_b32 s47, 768
    buffer_load_dwordx4 v200, s[24:27], s47 offen offset:0 lds
    buffer_load_dwordx4 v201, s[24:27], s47 offen offset:1024 lds
    buffer_load_dwordx4 v202, s[24:27], s47 offen offset:2048 lds
    buffer_load_dwordx4 v203, s[24:27], s47 offen offset:3072 lds
    v_mfma_f32_32x32x16_bf16 v[144:159], v[60:63], v[48:51], v[144:159]
    v_sub_f32 v237, v235, v236
    v_fmac_f32 v238, v237, v237
    v_mfma_f32_32x32x16_bf16 v[160:175], v[56:59], v[52:55], v[160:175]
    v_cndmask_b32 v238, 0, v238, vcc
    s_nop 1
    v_mfma_f32_32x32x16_bf16 v[176:191], v[60:63], v[52:55], v[176:191]
    v_add_f32_dpp v238, v238, v238 quad_perm:[1,0,3,2] row_mask:0xf bank_mask:0xf
    s_nop 1
    v_add_f32_dpp v238, v238, v238 quad_perm:[2,3,0,1] row_mask:0xf bank_mask:0xf
    s_nop 1
    s_waitcnt lgkmcnt(0)
    v_mfma_f32_32x32x16_bf16 v[64:79], v[32:35], v[16:19], v[64:79]
    ds_read_b64_tr_b16 v[56:57], v210 offset:8192
    ds_read_b64_tr_b16 v[58:59], v210 offset:10240
    v_mfma_f32_32x32x16_bf16 v[80:95], v[36:39], v[16:19], v[80:95]
    ds_read_b64_tr_b16 v[60:61], v211 offset:8192
    ds_read_b64_tr_b16 v[62:63], v211 offset:10240
    v_mfma_f32_32x32x16_bf16 v[96:111], v[32:35], v[20:23], v[96:111]
    ds_read_b128 v[40:43], v207 offset:32768
    ds_read_b128 v[44:47], v207 offset:36864
    v_mfma_f32_32x32x16_bf16 v[112:127], v[36:39], v[20:23], v[112:127]
    ds_read_b128 v[48:51], v207 offset:40960
    ds_read_b128 v[52:55], v207 offset:45056
    v_mfma_f32_32x32x16_bf16 v[128:143], v[32:35], v[24:27], v[128:143]
    v_add_f32_dpp v238, v238, v238 row_half_mirror row_mask:0xf bank_mask:0xf
    s_nop 1
    v_mfma_f32_32x32x16_bf16 v[144:159], v[36:39], v[24:27], v[144:159]
    v_add_f32_dpp v238, v238, v238 row_mirror row_mask:0xf bank_mask:0xf
    s_nop 1
    v_mfma_f32_32x32x16_bf16 v[160:175], v[32:35], v[28:31], v[160:175]
    v_readlane_b32 s56, v238, 0
    v_readlane_b32 s57, v238, 16
    v_mfma_f32_32x32x16_bf16 v[176:191], v[36:39], v[28:31], v[176:191]
    v_readlane_b32 s58, v238, 32
    v_readlane_b32 s59, v238, 48
    s_waitcnt vmcnt(12) lgkmcnt(0)
    s_barrier
    v_mfma_f32_32x32x16_bf16 v[64:79], v[56:59], v[40:43], v[64:79]
    ds_read_b64_tr_b16 v[32:33], v210 offset:16384
    ds_read_b64_tr_b16 v[34:35], v210 offset:18432
    v_mfma_f32_32x32x16_bf16 v[80:95], v[60:63], v[40:43], v[80:95]
    ds_read_b64_tr_b16 v[36:37], v211 offset:16384
    ds_read_b64_tr_b16 v[38:39], v211 offset:18432
    v_mfma_f32_32x32x16_bf16 v[96:111], v[56:59], v[44:47], v[96:111]
    ds_read_b128 v[16:19], v208 offset:32768
    ds_read_b128 v[20:23], v208 offset:36864
    v_mfma_f32_32x32x16_bf16 v[112:127], v[60:63], v[44:47], v[112:127]
    ds_read_b128 v[24:27], v208 offset:40960
    ds_read_b128 v[28:31], v208 offset:45056
    v_mfma_f32_32x32x16_bf16 v[128:143], v[56:59], v[48:51], v[128:143]
    s_add_u32 m0, s46, 98304
    s_mov_b32 s48, 3145728
    buffer_load_dwordx4 v204, s[28:31], s48 offen offset:0 lds
    buffer_load_dwordx4 v205, s[28:31], s48 offen offset:1024 lds
    s_nop 1
    v_mfma_f32_32x32x16_bf16 v[144:159], v[60:63], v[48:51], v[144:159]
    v_mov_b32 v238, s56
    v_add_f32 v238, s57, v238
    v_mfma_f32_32x32x16_bf16 v[160:175], v[56:59], v[52:55], v[160:175]
    v_add_f32 v238, s58, v238
    v_add_f32 v238, s59, v238
    v_mfma_f32_32x32x16_bf16 v[176:191], v[60:63], v[52:55], v[176:191]
    v_mul_f32 v238, 0.0015625, v238
    v_cvt_pk_bf16_f32 v238, v238, v238
    v_and_b32 v238, 0xffff0000, v238
    s_waitcnt lgkmcnt(0)
    v_mfma_f32_32x32x16_bf16 v[64:79], v[32:35], v[16:19], v[64:79]
    ds_read_b64_tr_b16 v[56:57], v210 offset:24576
    ds_read_b64_tr_b16 v[58:59], v210 offset:26624
    v_mfma_f32_32x32x16_bf16 v[80:95], v[36:39], v[16:19], v[80:95]
    ds_read_b64_tr_b16 v[60:61], v211 offset:24576
    ds_read_b64_tr_b16 v[62:63], v211 offset:26624
    v_mfma_f32_32x32x16_bf16 v[96:111], v[32:35], v[20:23], v[96:111]
    ds_read_b128 v[40:43], v209 offset:32768
    ds_read_b128 v[44:47], v209 offset:36864
    v_mfma_f32_32x32x16_bf16 v[112:127], v[36:39], v[20:23], v[112:127]
    ds_read_b128 v[48:51], v209 offset:40960
    ds_read_b128 v[52:55], v209 offset:45056
    v_mfma_f32_32x32x16_bf16 v[128:143], v[32:35], v[24:27], v[128:143]
    v_add_f32 v238, 0x3727c5ac, v238
    v_cvt_pk_bf16_f32 v238, v238, v238
    v_mfma_f32_32x32x16_bf16 v[144:159], v[36:39], v[24:27], v[144:159]
    v_and_b32 v238, 0xffff0000, v238
    v_sqrt_f32 v238, v238
    v_mfma_f32_32x32x16_bf16 v[160:175], v[32:35], v[28:31], v[160:175]
    s_nop 0
    v_cvt_pk_bf16_f32 v238, v238, v238
    v_mfma_f32_32x32x16_bf16 v[176:191], v[36:39], v[28:31], v[176:191]
    v_and_b32 v238, 0xffff0000, v238
    v_rcp_f32 v238, v238
    s_waitcnt vmcnt(8) lgkmcnt(0)
    s_barrier
    v_mfma_f32_32x32x16_bf16 v[64:79], v[56:59], v[40:43], v[64:79]
    ds_read_b64_tr_b16 v[32:33], v210 offset:32768
    ds_read_b64_tr_b16 v[34:35], v210 offset:34816
    v_mfma_f32_32x32x16_bf16 v[80:95], v[60:63], v[40:43], v[80:95]
    ds_read_b64_tr_b16 v[36:37], v211 offset:32768
    ds_read_b64_tr_b16 v[38:39], v211 offset:34816
    v_mfma_f32_32x32x16_bf16 v[96:111], v[56:59], v[44:47], v[96:111]
    ds_read_b128 v[16:19], v213 offset:0
    ds_read_b128 v[20:23], v213 offset:4096
    v_mfma_f32_32x32x16_bf16 v[112:127], v[60:63], v[44:47], v[112:127]
    ds_read_b128 v[24:27], v213 offset:8192
    ds_read_b128 v[28:31], v213 offset:12288
    v_mfma_f32_32x32x16_bf16 v[128:143], v[56:59], v[48:51], v[128:143]
    s_add_u32 m0, s46, 114688
    s_mov_b32 s48, 3407872
    buffer_load_dwordx4 v204, s[28:31], s48 offen offset:0 lds
    buffer_load_dwordx4 v205, s[28:31], s48 offen offset:1024 lds
    s_add_u32 m0, s45, 32768
    s_mov_b32 s47, 896
    buffer_load_dwordx4 v200, s[24:27], s47 offen offset:0 lds
    buffer_load_dwordx4 v201, s[24:27], s47 offen offset:1024 lds
    buffer_load_dwordx4 v202, s[24:27], s47 offen offset:2048 lds
    buffer_load_dwordx4 v203, s[24:27], s47 offen offset:3072 lds
    v_mfma_f32_32x32x16_bf16 v[144:159], v[60:63], v[48:51], v[144:159]
    v_cvt_pk_bf16_f32 v236, v236, v236
    v_and_b32 v236, 0xffff0000, v236
    v_mfma_f32_32x32x16_bf16 v[160:175], v[56:59], v[52:55], v[160:175]
    v_sub_f32 v220, v220, v236
    v_sub_f32 v221, v221, v236
    v_mfma_f32_32x32x16_bf16 v[176:191], v[60:63], v[52:55], v[176:191]
    v_cvt_pk_bf16_f32 v237, v220, v221
    v_lshlrev_b32 v220, 16, v237
    v_and_b32 v221, 0xffff0000, v237
    v_mul_f32 v220, v220, v238
    s_waitcnt lgkmcnt(0)
    v_mfma_f32_32x32x16_bf16 v[64:79], v[32:35], v[16:19], v[64:79]
    ds_read_b64_tr_b16 v[56:57], v210 offset:40960
    ds_read_b64_tr_b16 v[58:59], v210 offset:43008
    v_mfma_f32_32x32x16_bf16 v[80:95], v[36:39], v[16:19], v[80:95]
    ds_read_b64_tr_b16 v[60:61], v211 offset:40960
    ds_read_b64_tr_b16 v[62:63], v211 offset:43008
    v_mfma_f32_32x32x16_bf16 v[96:111], v[32:35], v[20:23], v[96:111]
    ds_read_b128 v[40:43], v214 offset:0
    ds_read_b128 v[44:47], v214 offset:4096
    v_mfma_f32_32x32x16_bf16 v[112:127], v[36:39], v[20:23], v[112:127]
    ds_read_b128 v[48:51], v214 offset:8192
    ds_read_b128 v[52:55], v214 offset:12288
    v_mfma_f32_32x32x16_bf16 v[128:143], v[32:35], v[24:27], v[128:143]
    v_mul_f32 v221, v221, v238
    v_cvt_pk_bf16_f32 v8, v220, v221
    v_mfma_f32_32x32x16_bf16 v[144:159], v[36:39], v[24:27], v[144:159]
    v_sub_f32 v222, v222, v236
    v_sub_f32 v223, v223, v236
    v_mfma_f32_32x32x16_bf16 v[160:175], v[32:35], v[28:31], v[160:175]
    v_cvt_pk_bf16_f32 v237, v222, v223
    v_lshlrev_b32 v222, 16, v237
    v_mfma_f32_32x32x16_bf16 v[176:191], v[36:39], v[28:31], v[176:191]
    v_and_b32 v223, 0xffff0000, v237
    v_mul_f32 v222, v222, v238
    s_waitcnt vmcnt(12) lgkmcnt(0)
    s_barrier
    v_mfma_f32_32x32x16_bf16 v[64:79], v[56:59], v[40:43], v[64:79]
    ds_read_b64_tr_b16 v[32:33], v210 offset:49152
    ds_read_b64_tr_b16 v[34:35], v210 offset:51200
    v_mfma_f32_32x32x16_bf16 v[80:95], v[60:63], v[40:43], v[80:95]
    ds_read_b64_tr_b16 v[36:37], v211 offset:49152
    ds_read_b64_tr_b16 v[38:39], v211 offset:51200
    v_mfma_f32_32x32x16_bf16 v[96:111], v[56:59], v[44:47], v[96:111]
    ds_read_b128 v[16:19], v215 offset:0
    ds_read_b128 v[20:23], v215 offset:4096
    v_mfma_f32_32x32x16_bf16 v[112:127], v[60:63], v[44:47], v[112:127]
    ds_read_b128 v[24:27], v215 offset:8192
    ds_read_b128 v[28:31], v215 offset:12288
    v_mfma_f32_32x32x16_bf16 v[128:143], v[56:59], v[48:51], v[128:143]
    s_add_u32 m0, s46, 131072
    s_mov_b32 s48, 3670016
    buffer_load_dwordx4 v204, s[28:31], s48 offen offset:0 lds
    buffer_load_dwordx4 v205, s[28:31], s48 offen offset:1024 lds
    v_mul_f32 v223, v223, v238
    v_mfma_f32_32x32x16_bf16 v[144:159], v[60:63], v[48:51], v[144:159]
    v_cvt_pk_bf16_f32 v9, v222, v223
    v_sub_f32 v224, v224, v236
    v_mfma_f32_32x32x16_bf16 v[160:175], v[56:59], v[52:55], v[160:175]
    v_sub_f32 v225, v225, v236
    v_cvt_pk_bf16_f32 v237, v224, v225
    v_mfma_f32_32x32x16_bf16 v[176:191], v[60:63], v[52:55], v[176:191]
    v_lshlrev_b32 v224, 16, v237
    v_and_b32 v225, 0xffff0000, v237
    v_mul_f32 v224, v224, v238
    s_waitcnt lgkmcnt(0)
    v_mfma_f32_32x32x16_bf16 v[64:79], v[32:35], v[16:19], v[64:79]
    ds_read_b64_tr_b16 v[56:57], v210 offset:57344
    ds_read_b64_tr_b16 v[58:59], v210 offset:59392
    v_mfma_f32_32x32x16_bf16 v[80:95], v[36:39], v[16:19], v[80:95]
    ds_read_b64_tr_b16 v[60:61], v211 offset:57344
    ds_read_b64_tr_b16 v[62:63], v211 offset:59392
    v_mfma_f32_32x32x16_bf16 v[96:111], v[32:35], v[20:23], v[96:111]
    ds_read_b128 v[40:43], v216 offset:0
    ds_read_b128 v[44:47], v216 offset:4096
    v_mfma_f32_32x32x16_bf16 v[112:127], v[36:39], v[20:23], v[112:127]
    ds_read_b128 v[48:51], v216 offset:8192
    ds_read_b128 v[52:55], v216 offset:12288
    v_mfma_f32_32x32x16_bf16 v[128:143], v[32:35], v[24:27], v[128:143]
    v_mul_f32 v225, v225, v238
    v_cvt_pk_bf16_f32 v10, v224, v225
    v_mfma_f32_32x32x16_bf16 v[144:159], v[36:39], v[24:27], v[144:159]
    v_sub_f32 v226, v226, v236
    v_sub_f32 v227, v227, v236
    v_mfma_f32_32x32x16_bf16 v[160:175], v[32:35], v[28:31], v[160:175]
    v_cvt_pk_bf16_f32 v237, v226, v227
    v_lshlrev_b32 v226, 16, v237
    v_mfma_f32_32x32x16_bf16 v[176:191], v[36:39], v[28:31], v[176:191]
    v_and_b32 v227, 0xffff0000, v237
    v_mul_f32 v226, v226, v238
    s_waitcnt vmcnt(8) lgkmcnt(0)
    s_barrier
    v_mfma_f32_32x32x16_bf16 v[64:79], v[56:59], v[40:43], v[64:79]
    ds_read_b64_tr_b16 v[32:33], v210 offset:0
    ds_read_b64_tr_b16 v[34:35], v210 offset:2048
    v_mfma_f32_32x32x16_bf16 v[80:95], v[60:63], v[40:43], v[80:95]
    ds_read_b64_tr_b16 v[36:37], v211 offset:0
    ds_read_b64_tr_b16 v[38:39], v211 offset:2048
    v_mfma_f32_32x32x16_bf16 v[96:111], v[56:59], v[44:47], v[96:111]
    ds_read_b128 v[16:19], v206 offset:0
    ds_read_b128 v[20:23], v206 offset:4096
    v_mfma_f32_32x32x16_bf16 v[112:127], v[60:63], v[44:47], v[112:127]
    s_add_u32 m0, s46, 147456
    s_mov_b32 s48, 3932160
    buffer_load_dwordx4 v204, s[28:31], s48 offen offset:0 lds
    buffer_load_dwordx4 v205, s[28:31], s48 offen offset:1024 lds
    v_mul_f32 v227, v227, v238
    v_mfma_f32_32x32x16_bf16 v[128:143], v[56:59], v[48:51], v[128:143]
    v_cvt_pk_bf16_f32 v11, v226, v227
    v_sub_f32 v228, v228, v236
    v_mfma_f32_32x32x16_bf16 v[144:159], v[60:63], v[48:51], v[144:159]
    v_sub_f32 v229, v229, v236
    v_cvt_pk_bf16_f32 v237, v228, v229
    v_mfma_f32_32x32x16_bf16 v[160:175], v[56:59], v[52:55], v[160:175]
    v_lshlrev_b32 v228, 16, v237
    v_and_b32 v229, 0xffff0000, v237
    v_mfma_f32_32x32x16_bf16 v[176:191], v[60:63], v[52:55], v[176:191]
    v_mul_f32 v228, v228, v238
    s_waitcnt lgkmcnt(0)
    v_mfma_f32_32x32x16_bf16 v[64:79], v[32:35], v[16:19], v[64:79]
    ds_read_b64_tr_b16 v[56:57], v210 offset:8192
    ds_read_b64_tr_b16 v[58:59], v210 offset:10240
    v_mfma_f32_32x32x16_bf16 v[80:95], v[36:39], v[16:19], v[80:95]
    ds_read_b64_tr_b16 v[60:61], v211 offset:8192
    ds_read_b64_tr_b16 v[62:63], v211 offset:10240
    v_mfma_f32_32x32x16_bf16 v[96:111], v[32:35], v[20:23], v[96:111]
    ds_read_b128 v[40:43], v207 offset:0
    ds_read_b128 v[44:47], v207 offset:4096
    v_mfma_f32_32x32x16_bf16 v[112:127], v[36:39], v[20:23], v[112:127]
    buffer_load_dwordx4 v[240:243], v212, s[60:63], s64 offen offset:0
    v_mul_f32 v229, v229, v238
    v_cvt_pk_bf16_f32 v12, v228, v229
    v_sub_f32 v230, v230, v236
    v_sub_f32 v231, v231, v236
    v_cvt_pk_bf16_f32 v237, v230, v231
    v_lshlrev_b32 v230, 16, v237
    v_and_b32 v231, 0xffff0000, v237
    v_mul_f32 v230, v230, v238
    s_waitcnt vmcnt(9) lgkmcnt(0)
    s_barrier
    v_mfma_f32_32x32x16_bf16 v[64:79], v[56:59], v[40:43], v[64:79]
    ds_read_b64_tr_b16 v[32:33], v210 offset:16384
    ds_read_b64_tr_b16 v[34:35], v210 offset:18432
    v_mfma_f32_32x32x16_bf16 v[80:95], v[60:63], v[40:43], v[80:95]
    ds_read_b64_tr_b16 v[36:37], v211 offset:16384
    ds_read_b64_tr_b16 v[38:39], v211 offset:18432
    v_mfma_f32_32x32x16_bf16 v[96:111], v[56:59], v[44:47], v[96:111]
    ds_read_b128 v[16:19], v208 offset:0
    ds_read_b128 v[20:23], v208 offset:4096
    v_mfma_f32_32x32x16_bf16 v[112:127], v[60:63], v[44:47], v[112:127]
    buffer_load_dwordx4 v[244:247], v212, s[60:63], s64 offen offset:1024
    v_mul_f32 v231, v231, v238
    v_cvt_pk_bf16_f32 v13, v230, v231
    v_sub_f32 v232, v232, v236
    v_sub_f32 v233, v233, v236
    v_cvt_pk_bf16_f32 v237, v232, v233
    v_lshlrev_b32 v232, 16, v237
    v_and_b32 v233, 0xffff0000, v237
    v_mul_f32 v232, v232, v238
    s_waitcnt lgkmcnt(0)
    v_mfma_f32_32x32x16_bf16 v[64:79], v[32:35], v[16:19], v[64:79]
    ds_read_b64_tr_b16 v[56:57], v210 offset:24576
    ds_read_b64_tr_b16 v[58:59], v210 offset:26624
    v_mfma_f32_32x32x16_bf16 v[80:95], v[36:39], v[16:19], v[80:95]
    ds_read_b64_tr_b16 v[60:61], v211 offset:24576
    ds_read_b64_tr_b16 v[62:63], v211 offset:26624
    v_mfma_f32_32x32x16_bf16 v[96:111], v[32:35], v[20:23], v[96:111]
    ds_read_b128 v[40:43], v209 offset:0
    ds_read_b128 v[44:47], v209 offset:4096
    v_mfma_f32_32x32x16_bf16 v[112:127], v[36:39], v[20:23], v[112:127]
    buffer_load_dwordx4 v[248:251], v212, s[60:63], s64 offen offset:2048
    v_mul_f32 v233, v233, v238
    v_cvt_pk_bf16_f32 v14, v232, v233
    v_sub_f32 v234, v234, v236
    v_sub_f32 v235, v235, v236
    v_cvt_pk_bf16_f32 v237, v234, v235
    v_lshlrev_b32 v234, 16, v237
    v_and_b32 v235, 0xffff0000, v237
    v_mul_f32 v234, v234, v238
    s_waitcnt vmcnt(5) lgkmcnt(0)
    s_barrier
    v_mfma_f32_32x32x16_bf16 v[64:79], v[56:59], v[40:43], v[64:79]
    ds_read_b64_tr_b16 v[32:33], v210 offset:32768
    ds_read_b64_tr_b16 v[34:35], v210 offset:34816
    v_mfma_f32_32x32x16_bf16 v[80:95], v[60:63], v[40:43], v[80:95]
    ds_read_b64_tr_b16 v[36:37], v211 offset:32768
    ds_read_b64_tr_b16 v[38:39], v211 offset:34816
    v_mfma_f32_32x32x16_bf16 v[96:111], v[56:59], v[44:47], v[96:111]
    ds_read_b128 v[16:19], v206 offset:32768
    ds_read_b128 v[20:23], v206 offset:36864
    v_mfma_f32_32x32x16_bf16 v[112:127], v[60:63], v[44:47], v[112:127]
    v_mul_f32 v235, v235, v238
    v_cvt_pk_bf16_f32 v15, v234, v235
    s_lshr_b32 s41, s40, 5
    s_mul_i32 s41, s41, 40960
    s_and_b32 s42, s40, 31
    s_lshl_b32 s42, s42, 4
    s_add_u32 s41, s41, s42
    v_lshlrev_b32 v3, 10, v1
    s_waitcnt lgkmcnt(0)
    v_mfma_f32_32x32x16_bf16 v[64:79], v[32:35], v[16:19], v[64:79]
    ds_read_b64_tr_b16 v[56:57], v210 offset:40960
    ds_read_b64_tr_b16 v[58:59], v210 offset:43008
    v_mfma_f32_32x32x16_bf16 v[80:95], v[36:39], v[16:19], v[80:95]
    ds_read_b64_tr_b16 v[60:61], v211 offset:40960
    ds_read_b64_tr_b16 v[62:63], v211 offset:43008
    v_mfma_f32_32x32x16_bf16 v[96:111], v[32:35], v[20:23], v[96:111]
    ds_read_b128 v[40:43], v207 offset:32768
    ds_read_b128 v[44:47], v207 offset:36864
    v_mfma_f32_32x32x16_bf16 v[112:127], v[36:39], v[20:23], v[112:127]
    v_add_u32 v3, s41, v3
    v_cndmask_b32 v3, v4, v3, vcc
    buffer_store_dwordx4 v[8:11], v3, s[32:35], 0 offen
    buffer_store_dwordx4 v[12:15], v3, s[32:35], 0 offen offset:512
    s_waitcnt vmcnt(5) lgkmcnt(0)
    s_barrier
    v_mfma_f32_32x32x16_bf16 v[64:79], v[56:59], v[40:43], v[64:79]
    ds_read_b64_tr_b16 v[32:33], v210 offset:49152
    ds_read_b64_tr_b16 v[34:35], v210 offset:51200
    v_mfma_f32_32x32x16_bf16 v[80:95], v[60:63], v[40:43], v[80:95]
    ds_read_b64_tr_b16 v[36:37], v211 offset:49152
    ds_read_b64_tr_b16 v[38:39], v211 offset:51200
    v_mfma_f32_32x32x16_bf16 v[96:111], v[56:59], v[44:47], v[96:111]
    ds_read_b128 v[16:19], v208 offset:32768
    ds_read_b128 v[20:23], v208 offset:36864
    v_mfma_f32_32x32x16_bf16 v[112:127], v[60:63], v[44:47], v[112:127]
    s_waitcnt lgkmcnt(0)
    v_mfma_f32_32x32x16_bf16 v[64:79], v[32:35], v[16:19], v[64:79]
    ds_read_b64_tr_b16 v[56:57], v210 offset:57344
    ds_read_b64_tr_b16 v[58:59], v210 offset:59392
    v_mfma_f32_32x32x16_bf16 v[80:95], v[36:39], v[16:19], v[80:95]
    ds_read_b64_tr_b16 v[60:61], v211 offset:57344
    ds_read_b64_tr_b16 v[62:63], v211 offset:59392
    v_mfma_f32_32x32x16_bf16 v[96:111], v[32:35], v[20:23], v[96:111]
    ds_read_b128 v[40:43], v209 offset:32768
    ds_read_b128 v[44:47], v209 offset:36864
    v_mfma_f32_32x32x16_bf16 v[112:127], v[36:39], v[20:23], v[112:127]
    s_waitcnt lgkmcnt(0)
    v_mfma_f32_32x32x16_bf16 v[64:79], v[56:59], v[40:43], v[64:79]
    ds_read_b64_tr_b16 v[32:33], v210 offset:0
    ds_read_b64_tr_b16 v[34:35], v210 offset:2048
    v_mfma_f32_32x32x16_bf16 v[80:95], v[60:63], v[40:43], v[80:95]
    ds_read_b64_tr_b16 v[36:37], v211 offset:0
    ds_read_b64_tr_b16 v[38:39], v211 offset:2048
    v_mfma_f32_32x32x16_bf16 v[96:111], v[56:59], v[44:47], v[96:111]
    ds_read_b128 v[24:27], v206 offset:8192
    ds_read_b128 v[28:31], v206 offset:12288
    v_mfma_f32_32x32x16_bf16 v[112:127], v[60:63], v[44:47], v[112:127]
    s_waitcnt lgkmcnt(0)
    v_mfma_f32_32x32x16_bf16 v[128:143], v[32:35], v[24:27], v[128:143]
    ds_read_b64_tr_b16 v[56:57], v210 offset:8192
    ds_read_b64_tr_b16 v[58:59], v210 offset:10240
    ds_read_b64_tr_b16 v[60:61], v211 offset:8192
    ds_read_b64_tr_b16 v[62:63], v211 offset:10240
    ds_read_b128 v[48:51], v207 offset:8192
    ds_read_b128 v[52:55], v207 offset:12288
    v_mul_f32 v64, s65, v64
    v_mul_f32 v65, s65, v65
    v_cvt_pk_bf16_f32 v192, v64, v65
    v_mul_f32 v66, s65, v66
    v_mul_f32 v67, s65, v67
    v_cvt_pk_bf16_f32 v193, v66, v67
    v_mul_f32 v68, s65, v68
    v_mul_f32 v69, s65, v69
    v_cvt_pk_bf16_f32 v194, v68, v69
    v_mul_f32 v70, s65, v70
    v_mfma_f32_32x32x16_bf16 v[144:159], v[36:39], v[24:27], v[144:159]
    v_mul_f32 v71, s65, v71
    v_cvt_pk_bf16_f32 v195, v70, v71
    s_add_u32 s55, s53, 0
    buffer_store_dwordx4 v[192:195], v212, s[36:39], s55 offen sc1
    v_mul_f32 v72, s65, v72
    v_mul_f32 v73, s65, v73
    v_cvt_pk_bf16_f32 v196, v72, v73
    v_mul_f32 v74, s65, v74
    v_mul_f32 v75, s65, v75
    v_cvt_pk_bf16_f32 v197, v74, v75
    v_mul_f32 v76, s65, v76
    v_mul_f32 v77, s65, v77
    v_cvt_pk_bf16_f32 v198, v76, v77
    v_mul_f32 v78, s65, v78
    v_mul_f32 v79, s65, v79
    v_cvt_pk_bf16_f32 v199, v78, v79
    v_mfma_f32_32x32x16_bf16 v[160:175], v[32:35], v[28:31], v[160:175]
    s_add_u32 s55, s53, 1024
    buffer_store_dwordx4 v[196:199], v212, s[36:39], s55 offen sc1
    v_mul_f32 v80, s65, v80
    v_mul_f32 v81, s65, v81
    v_cvt_pk_bf16_f32 v252, v80, v81
    v_mul_f32 v82, s65, v82
    v_mul_f32 v83, s65, v83
    v_cvt_pk_bf16_f32 v253, v82, v83
    v_mul_f32 v84, s65, v84
    v_mul_f32 v85, s65, v85
    v_cvt_pk_bf16_f32 v254, v84, v85
    v_mul_f32 v86, s65, v86
    v_mul_f32 v87, s65, v87
    v_cvt_pk_bf16_f32 v255, v86, v87
    s_add_u32 s55, s53, 2048
    buffer_store_dwordx4 v[252:255], v212, s[36:39], s55 offen sc1
    v_mfma_f32_32x32x16_bf16 v[176:191], v[36:39], v[28:31], v[176:191]
    v_mul_f32 v88, s65, v88
    v_mul_f32 v89, s65, v89
    v_cvt_pk_bf16_f32 v192, v88, v89
    v_mul_f32 v90, s65, v90
    v_mul_f32 v91, s65, v91
    v_cvt_pk_bf16_f32 v193, v90, v91
    v_mul_f32 v92, s65, v92
    v_mul_f32 v93, s65, v93
    v_cvt_pk_bf16_f32 v194, v92, v93
    v_mul_f32 v94, s65, v94
    v_mul_f32 v95, s65, v95
    v_cvt_pk_bf16_f32 v195, v94, v95
    s_add_u32 s55, s53, 3072
    buffer_store_dwordx4 v[192:195], v212, s[36:39], s55 offen sc1
    s_waitcnt lgkmcnt(0)
    v_mfma_f32_32x32x16_bf16 v[128:143], v[56:59], v[48:51], v[128:143]
    ds_read_b64_tr_b16 v[32:33], v210 offset:16384
    ds_read_b64_tr_b16 v[34:35], v210 offset:18432
    ds_read_b64_tr_b16 v[36:37], v211 offset:16384
    ds_read_b64_tr_b16 v[38:39], v211 offset:18432
    ds_read_b128 v[24:27], v208 offset:8192
    ds_read_b128 v[28:31], v208 offset:12288
    v_mul_f32 v96, s65, v96
    v_mul_f32 v97, s65, v97
    v_cvt_pk_bf16_f32 v196, v96, v97
    v_mul_f32 v98, s65, v98
    v_mul_f32 v99, s65, v99
    v_cvt_pk_bf16_f32 v197, v98, v99
    v_mul_f32 v100, s65, v100
    v_mul_f32 v101, s65, v101
    v_cvt_pk_bf16_f32 v198, v100, v101
    v_mul_f32 v102, s65, v102
    v_mfma_f32_32x32x16_bf16 v[144:159], v[60:63], v[48:51], v[144:159]
    v_mul_f32 v103, s65, v103
    v_cvt_pk_bf16_f32 v199, v102, v103
    s_add_u32 s55, s53, 8192
    buffer_store_dwordx4 v[196:199], v212, s[36:39], s55 offen sc1
    v_mul_f32 v104, s65, v104
    v_mul_f32 v105, s65, v105
    v_cvt_pk_bf16_f32 v252, v104, v105
    v_mul_f32 v106, s65, v106
    v_mul_f32 v107, s65, v107
    v_cvt_pk_bf16_f32 v253, v106, v107
    v_mul_f32 v108, s65, v108
    v_mul_f32 v109, s65, v109
    v_cvt_pk_bf16_f32 v254, v108, v109
    v_mul_f32 v110, s65, v110
    v_mul_f32 v111, s65, v111
    v_cvt_pk_bf16_f32 v255, v110, v111
    v_mfma_f32_32x32x16_bf16 v[160:175], v[56:59], v[52:55], v[160:175]
    s_add_u32 s55, s53, 9216
    buffer_store_dwordx4 v[252:255], v212, s[36:39], s55 offen sc1
    v_mul_f32 v112, s65, v112
    v_mul_f32 v113, s65, v113
    v_cvt_pk_bf16_f32 v192, v112, v113
    v_mul_f32 v114, s65, v114
    v_mul_f32 v115, s65, v115
    v_cvt_pk_bf16_f32 v193, v114, v115
    v_mul_f32 v116, s65, v116
    v_mul_f32 v117, s65, v117
    v_cvt_pk_bf16_f32 v194, v116, v117
    v_mul_f32 v118, s65, v118
    v_mul_f32 v119, s65, v119
    v_cvt_pk_bf16_f32 v195, v118, v119
    s_add_u32 s55, s53, 10240
    buffer_store_dwordx4 v[192:195], v212, s[36:39], s55 offen sc1
    v_mfma_f32_32x32x16_bf16 v[176:191], v[60:63], v[52:55], v[176:191]
    v_mul_f32 v120, s65, v120
    v_mul_f32 v121, s65, v121
    v_cvt_pk_bf16_f32 v196, v120, v121
    v_mul_f32 v122, s65, v122
    v_mul_f32 v123, s65, v123
    v_cvt_pk_bf16_f32 v197, v122, v123
    v_mul_f32 v124, s65, v124
    v_mul_f32 v125, s65, v125
    v_cvt_pk_bf16_f32 v198, v124, v125
    v_mul_f32 v126, s65, v126
    v_mul_f32 v127, s65, v127
    v_cvt_pk_bf16_f32 v199, v126, v127
    s_add_u32 s55, s53, 11264
    buffer_store_dwordx4 v[196:199], v212, s[36:39], s55 offen sc1
    s_waitcnt lgkmcnt(0)
    v_mfma_f32_32x32x16_bf16 v[128:143], v[32:35], v[24:27], v[128:143]
    ds_read_b64_tr_b16 v[56:57], v210 offset:24576
    ds_read_b64_tr_b16 v[58:59], v210 offset:26624
    v_mfma_f32_32x32x16_bf16 v[144:159], v[36:39], v[24:27], v[144:159]
    ds_read_b64_tr_b16 v[60:61], v211 offset:24576
    ds_read_b64_tr_b16 v[62:63], v211 offset:26624
    v_mfma_f32_32x32x16_bf16 v[160:175], v[32:35], v[28:31], v[160:175]
    ds_read_b128 v[48:51], v209 offset:8192
    ds_read_b128 v[52:55], v209 offset:12288
    v_mfma_f32_32x32x16_bf16 v[176:191], v[36:39], v[28:31], v[176:191]
    s_waitcnt lgkmcnt(0)
    v_mfma_f32_32x32x16_bf16 v[128:143], v[56:59], v[48:51], v[128:143]
    ds_read_b64_tr_b16 v[32:33], v210 offset:32768
    ds_read_b64_tr_b16 v[34:35], v210 offset:34816
    v_mfma_f32_32x32x16_bf16 v[144:159], v[60:63], v[48:51], v[144:159]
    ds_read_b64_tr_b16 v[36:37], v211 offset:32768
    ds_read_b64_tr_b16 v[38:39], v211 offset:34816
    v_mfma_f32_32x32x16_bf16 v[160:175], v[56:59], v[52:55], v[160:175]
    ds_read_b128 v[24:27], v206 offset:40960
    ds_read_b128 v[28:31], v206 offset:45056
    v_mfma_f32_32x32x16_bf16 v[176:191], v[60:63], v[52:55], v[176:191]
    s_waitcnt lgkmcnt(0)
    v_mfma_f32_32x32x16_bf16 v[128:143], v[32:35], v[24:27], v[128:143]
    ds_read_b64_tr_b16 v[56:57], v210 offset:40960
    ds_read_b64_tr_b16 v[58:59], v210 offset:43008
    v_mfma_f32_32x32x16_bf16 v[144:159], v[36:39], v[24:27], v[144:159]
    ds_read_b64_tr_b16 v[60:61], v211 offset:40960
    ds_read_b64_tr_b16 v[62:63], v211 offset:43008
    v_mfma_f32_32x32x16_bf16 v[160:175], v[32:35], v[28:31], v[160:175]
    ds_read_b128 v[48:51], v207 offset:40960
    ds_read_b128 v[52:55], v207 offset:45056
    v_mfma_f32_32x32x16_bf16 v[176:191], v[36:39], v[28:31], v[176:191]
    s_waitcnt lgkmcnt(0)
    v_mfma_f32_32x32x16_bf16 v[128:143], v[56:59], v[48:51], v[128:143]
    ds_read_b64_tr_b16 v[32:33], v210 offset:49152
    ds_read_b64_tr_b16 v[34:35], v210 offset:51200
    v_mfma_f32_32x32x16_bf16 v[144:159], v[60:63], v[48:51], v[144:159]
    ds_read_b64_tr_b16 v[36:37], v211 offset:49152
    ds_read_b64_tr_b16 v[38:39], v211 offset:51200
    v_mfma_f32_32x32x16_bf16 v[160:175], v[56:59], v[52:55], v[160:175]
    ds_read_b128 v[24:27], v208 offset:40960
    ds_read_b128 v[28:31], v208 offset:45056
    v_mfma_f32_32x32x16_bf16 v[176:191], v[60:63], v[52:55], v[176:191]
    s_waitcnt lgkmcnt(0)
    v_mfma_f32_32x32x16_bf16 v[128:143], v[32:35], v[24:27], v[128:143]
    ds_read_b64_tr_b16 v[56:57], v210 offset:57344
    ds_read_b64_tr_b16 v[58:59], v210 offset:59392
    v_mfma_f32_32x32x16_bf16 v[144:159], v[36:39], v[24:27], v[144:159]
    ds_read_b64_tr_b16 v[60:61], v211 offset:57344
    ds_read_b64_tr_b16 v[62:63], v211 offset:59392
    v_mfma_f32_32x32x16_bf16 v[160:175], v[32:35], v[28:31], v[160:175]
    ds_read_b128 v[48:51], v209 offset:40960
    ds_read_b128 v[52:55], v209 offset:45056
    v_mfma_f32_32x32x16_bf16 v[176:191], v[36:39], v[28:31], v[176:191]
    s_waitcnt lgkmcnt(0)
    v_mfma_f32_32x32x16_bf16 v[128:143], v[56:59], v[48:51], v[128:143]
    v_mfma_f32_32x32x16_bf16 v[144:159], v[60:63], v[48:51], v[144:159]
    v_mfma_f32_32x32x16_bf16 v[160:175], v[56:59], v[52:55], v[160:175]
    v_mfma_f32_32x32x16_bf16 v[176:191], v[60:63], v[52:55], v[176:191]
    s_nop 7
    s_nop 7
    v_mul_f32 v128, s65, v128
    v_mul_f32 v129, s65, v129
    v_cvt_pk_bf16_f32 v16, v128, v129
    v_mul_f32 v130, s65, v130
    v_mul_f32 v131, s65, v131
    v_cvt_pk_bf16_f32 v17, v130, v131
    v_mul_f32 v132, s65, v132
    v_mul_f32 v133, s65, v133
    v_cvt_pk_bf16_f32 v18, v132, v133
    v_mul_f32 v134, s65, v134
    v_mul_f32 v135, s65, v135
    v_cvt_pk_bf16_f32 v19, v134, v135
    s_add_u32 s55, s53, 16384
    buffer_store_dwordx4 v[16:19], v212, s[36:39], s55 offen sc1
    v_mul_f32 v136, s65, v136
    v_mul_f32 v137, s65, v137
    v_cvt_pk_bf16_f32 v20, v136, v137
    v_mul_f32 v138, s65, v138
    v_mul_f32 v139, s65, v139
    v_cvt_pk_bf16_f32 v21, v138, v139
    v_mul_f32 v140, s65, v140
    v_mul_f32 v141, s65, v141
    v_cvt_pk_bf16_f32 v22, v140, v141
    v_mul_f32 v142, s65, v142
    v_mul_f32 v143, s65, v143
    v_cvt_pk_bf16_f32 v23, v142, v143
    s_add_u32 s55, s53, 17408
    buffer_store_dwordx4 v[20:23], v212, s[36:39], s55 offen sc1
    v_mul_f32 v144, s65, v144
    v_mul_f32 v145, s65, v145
    v_cvt_pk_bf16_f32 v24, v144, v145
    v_mul_f32 v146, s65, v146
    v_mul_f32 v147, s65, v147
    v_cvt_pk_bf16_f32 v25, v146, v147
    v_mul_f32 v148, s65, v148
    v_mul_f32 v149, s65, v149
    v_cvt_pk_bf16_f32 v26, v148, v149
    v_mul_f32 v150, s65, v150
    v_mul_f32 v151, s65, v151
    v_cvt_pk_bf16_f32 v27, v150, v151
    s_add_u32 s55, s53, 18432
    buffer_store_dwordx4 v[24:27], v212, s[36:39], s55 offen sc1
    v_mul_f32 v152, s65, v152
    v_mul_f32 v153, s65, v153
    v_cvt_pk_bf16_f32 v28, v152, v153
    v_mul_f32 v154, s65, v154
    v_mul_f32 v155, s65, v155
    v_cvt_pk_bf16_f32 v29, v154, v155
    v_mul_f32 v156, s65, v156
    v_mul_f32 v157, s65, v157
    v_cvt_pk_bf16_f32 v30, v156, v157
    v_mul_f32 v158, s65, v158
    v_mul_f32 v159, s65, v159
    v_cvt_pk_bf16_f32 v31, v158, v159
    s_add_u32 s55, s53, 19456
    buffer_store_dwordx4 v[28:31], v212, s[36:39], s55 offen sc1
    v_mul_f32 v160, s65, v160
    v_mul_f32 v161, s65, v161
    v_cvt_pk_bf16_f32 v32, v160, v161
    v_mul_f32 v162, s65, v162
    v_mul_f32 v163, s65, v163
    v_cvt_pk_bf16_f32 v33, v162, v163
    v_mul_f32 v164, s65, v164
    v_mul_f32 v165, s65, v165
    v_cvt_pk_bf16_f32 v34, v164, v165
    v_mul_f32 v166, s65, v166
    v_mul_f32 v167, s65, v167
    v_cvt_pk_bf16_f32 v35, v166, v167
    s_add_u32 s55, s53, 24576
    buffer_store_dwordx4 v[32:35], v212, s[36:39], s55 offen sc1
    v_mul_f32 v168, s65, v168
    v_mul_f32 v169, s65, v169
    v_cvt_pk_bf16_f32 v36, v168, v169
    v_mul_f32 v170, s65, v170
    v_mul_f32 v171, s65, v171
    v_cvt_pk_bf16_f32 v37, v170, v171
    v_mul_f32 v172, s65, v172
    v_mul_f32 v173, s65, v173
    v_cvt_pk_bf16_f32 v38, v172, v173
    v_mul_f32 v174, s65, v174
    v_mul_f32 v175, s65, v175
    v_cvt_pk_bf16_f32 v39, v174, v175
    s_add_u32 s55, s53, 25600
    buffer_store_dwordx4 v[36:39], v212, s[36:39], s55 offen sc1
    v_mul_f32 v176, s65, v176
    v_mul_f32 v177, s65, v177
    v_cvt_pk_bf16_f32 v40, v176, v177
    v_mul_f32 v178, s65, v178
    v_mul_f32 v179, s65, v179
    v_cvt_pk_bf16_f32 v41, v178, v179
    v_mul_f32 v180, s65, v180
    v_mul_f32 v181, s65, v181
    v_cvt_pk_bf16_f32 v42, v180, v181
    v_mul_f32 v182, s65, v182
    v_mul_f32 v183, s65, v183
    v_cvt_pk_bf16_f32 v43, v182, v183
    s_add_u32 s55, s53, 26624
    buffer_store_dwordx4 v[40:43], v212, s[36:39], s55 offen sc1
    v_mul_f32 v184, s65, v184
    v_mul_f32 v185, s65, v185
    v_cvt_pk_bf16_f32 v44, v184, v185
    v_mul_f32 v186, s65, v186
    v_mul_f32 v187, s65, v187
    v_cvt_pk_bf16_f32 v45, v186, v187
    v_mul_f32 v188, s65, v188
    v_mul_f32 v189, s65, v189
    v_cvt_pk_bf16_f32 v46, v188, v189
    v_mul_f32 v190, s65, v190
    v_mul_f32 v191, s65, v191
    v_cvt_pk_bf16_f32 v47, v190, v191
    s_add_u32 s55, s53, 27648
    buffer_store_dwordx4 v[44:47], v212, s[36:39], s55 offen sc1
    s_endpgm
K1_V:
    v_add_u32 v213, 0x10000, v206
    v_add_u32 v214, 0x10000, v207
    v_add_u32 v215, 0x10000, v208
    v_add_u32 v216, 0x10000, v209
    s_lshl_b32 s53, s19, 1
    s_lshr_b32 s54, s50, 1
    s_add_u32 s53, s53, s54
    s_lshl_b32 s53, s53, 19
    s_lshl_b32 s54, s17, 16
    s_add_u32 s53, s53, s54
    s_lshl_b32 s54, s49, 15
    s_add_u32 s53, s53, s54
    s_and_b32 s54, s50, 1
    s_lshl_b32 s54, s54, 11
    s_add_u32 s53, s53, s54
    s_mov_b32 s65, 0x3e0293ee
    s_waitcnt vmcnt(2) lgkmcnt(0)
    s_barrier
    ds_read_b64_tr_b16 v[32:33], v210 offset:0
    ds_read_b64_tr_b16 v[34:35], v210 offset:2048
    ds_read_b64_tr_b16 v[36:37], v211 offset:0
    ds_read_b64_tr_b16 v[38:39], v211 offset:2048
    ds_read_b128 v[16:19], v206 offset:0
    ds_read_b128 v[20:23], v206 offset:4096
    ds_read_b128 v[24:27], v206 offset:8192
    ds_read_b128 v[28:31], v206 offset:12288
    s_add_u32 m0, s45, 32768
    s_mov_b32 s47, 128
    buffer_load_dwordx4 v200, s[24:27], s47 offen offset:0 lds
    buffer_load_dwordx4 v201, s[24:27], s47 offen offset:1024 lds
    buffer_load_dwordx4 v202, s[24:27], s47 offen offset:2048 lds
    buffer_load_dwordx4 v203, s[24:27], s47 offen offset:3072 lds
    s_waitcnt lgkmcnt(0)
    v_mfma_f32_32x32x16_bf16 v[64:79], v[16:19], v[32:35], 0
    ds_read_b64_tr_b16 v[56:57], v210 offset:8192
    ds_read_b64_tr_b16 v[58:59], v210 offset:10240
    v_mfma_f32_32x32x16_bf16 v[80:95], v[16:19], v[36:39], 0
    ds_read_b64_tr_b16 v[60:61], v211 offset:8192
    ds_read_b64_tr_b16 v[62:63], v211 offset:10240
    v_mfma_f32_32x32x16_bf16 v[96:111], v[20:23], v[32:35], 0
    ds_read_b128 v[40:43], v207 offset:0
    ds_read_b128 v[44:47], v207 offset:4096
    v_mfma_f32_32x32x16_bf16 v[112:127], v[20:23], v[36:39], 0
    ds_read_b128 v[48:51], v207 offset:8192
    ds_read_b128 v[52:55], v207 offset:12288
    v_mfma_f32_32x32x16_bf16 v[128:143], v[24:27], v[32:35], 0
    s_add_u32 m0, s46, 131072
    s_mov_b32 s48, 524288
    buffer_load_dwordx4 v204, s[28:31], s48 offen offset:0 lds
    buffer_load_dwordx4 v205, s[28:31], s48 offen offset:1024 lds
    s_add_u32 m0, s46, 147456
    s_mov_b32 s48, 786432
    buffer_load_dwordx4 v204, s[28:31], s48 offen offset:0 lds
    buffer_load_dwordx4 v205, s[28:31], s48 offen offset:1024 lds
    v_mfma_f32_32x32x16_bf16 v[144:159], v[24:27], v[36:39], 0
    v_mfma_f32_32x32x16_bf16 v[160:175], v[28:31], v[32:35], 0
    v_mfma_f32_32x32x16_bf16 v[176:191], v[28:31], v[36:39], 0
    s_waitcnt vmcnt(8) lgkmcnt(0)
    s_barrier
    v_mfma_f32_32x32x16_bf16 v[64:79], v[40:43], v[56:59], v[64:79]
    ds_read_b64_tr_b16 v[32:33], v210 offset:16384
    ds_read_b64_tr_b16 v[34:35], v210 offset:18432
    v_mfma_f32_32x32x16_bf16 v[80:95], v[40:43], v[60:63], v[80:95]
    ds_read_b64_tr_b16 v[36:37], v211 offset:16384
    ds_read_b64_tr_b16 v[38:39], v211 offset:18432
    v_mfma_f32_32x32x16_bf16 v[96:111], v[44:47], v[56:59], v[96:111]
    ds_read_b128 v[16:19], v208 offset:0
    ds_read_b128 v[20:23], v208 offset:4096
    v_mfma_f32_32x32x16_bf16 v[112:127], v[44:47], v[60:63], v[112:127]
    ds_read_b128 v[24:27], v208 offset:8192
    ds_read_b128 v[28:31], v208 offset:12288
    v_mfma_f32_32x32x16_bf16 v[128:143], v[48:51], v[56:59], v[128:143]
    s_add_u32 m0, s46, 98304
    s_mov_b32 s48, 1048576
    buffer_load_dwordx4 v204, s[28:31], s48 offen offset:0 lds
    buffer_load_dwordx4 v205, s[28:31], s48 offen offset:1024 lds
    v_mfma_f32_32x32x16_bf16 v[144:159], v[48:51], v[60:63], v[144:159]
    v_mfma_f32_32x32x16_bf16 v[160:175], v[52:55], v[56:59], v[160:175]
    v_mfma_f32_32x32x16_bf16 v[176:191], v[52:55], v[60:63], v[176:191]
    s_waitcnt lgkmcnt(0)
    v_mfma_f32_32x32x16_bf16 v[64:79], v[16:19], v[32:35], v[64:79]
    ds_read_b64_tr_b16 v[56:57], v210 offset:24576
    ds_read_b64_tr_b16 v[58:59], v210 offset:26624
    v_mfma_f32_32x32x16_bf16 v[80:95], v[16:19], v[36:39], v[80:95]
    ds_read_b64_tr_b16 v[60:61], v211 offset:24576
    ds_read_b64_tr_b16 v[62:63], v211 offset:26624
    v_mfma_f32_32x32x16_bf16 v[96:111], v[20:23], v[32:35], v[96:111]
    ds_read_b128 v[40:43], v209 offset:0
    ds_read_b128 v[44:47], v209 offset:4096
    v_mfma_f32_32x32x16_bf16 v[112:127], v[20:23], v[36:39], v[112:127]
    ds_read_b128 v[48:51], v209 offset:8192
    ds_read_b128 v[52:55], v209 offset:12288
    v_mfma_f32_32x32x16_bf16 v[128:143], v[24:27], v[32:35], v[128:143]
    s_add_u32 m0, s45, 65536
    s_mov_b32 s47, 256
    buffer_load_dwordx4 v200, s[24:27], s47 offen offset:0 lds
    buffer_load_dwordx4 v201, s[24:27], s47 offen offset:1024 lds
    buffer_load_dwordx4 v202, s[24:27], s47 offen offset:2048 lds
    buffer_load_dwordx4 v203, s[24:27], s47 offen offset:3072 lds
    v_mfma_f32_32x32x16_bf16 v[144:159], v[24:27], v[36:39], v[144:159]
    v_mfma_f32_32x32x16_bf16 v[160:175], v[28:31], v[32:35], v[160:175]
    v_mfma_f32_32x32x16_bf16 v[176:191], v[28:31], v[36:39], v[176:191]
    s_waitcnt vmcnt(8) lgkmcnt(0)
    s_barrier
    v_mfma_f32_32x32x16_bf16 v[64:79], v[40:43], v[56:59], v[64:79]
    ds_read_b64_tr_b16 v[32:33], v210 offset:32768
    ds_read_b64_tr_b16 v[34:35], v210 offset:34816
    v_mfma_f32_32x32x16_bf16 v[80:95], v[40:43], v[60:63], v[80:95]
    ds_read_b64_tr_b16 v[36:37], v211 offset:32768
    ds_read_b64_tr_b16 v[38:39], v211 offset:34816
    v_mfma_f32_32x32x16_bf16 v[96:111], v[44:47], v[56:59], v[96:111]
    ds_read_b128 v[16:19], v206 offset:32768
    ds_read_b128 v[20:23], v206 offset:36864
    v_mfma_f32_32x32x16_bf16 v[112:127], v[44:47], v[60:63], v[112:127]
    ds_read_b128 v[24:27], v206 offset:40960
    ds_read_b128 v[28:31], v206 offset:45056
    v_mfma_f32_32x32x16_bf16 v[128:143], v[48:51], v[56:59], v[128:143]
    s_add_u32 m0, s46, 114688
    s_mov_b32 s48, 1310720
    buffer_load_dwordx4 v204, s[28:31], s48 offen offset:0 lds
    buffer_load_dwordx4 v205, s[28:31], s48 offen offset:1024 lds
    s_add_u32 m0, s45, 0
    s_mov_b32 s47, 384
    buffer_load_dwordx4 v200, s[24:27], s47 offen offset:0 lds
    buffer_load_dwordx4 v201, s[24:27], s47 offen offset:1024 lds
    buffer_load_dwordx4 v202, s[24:27], s47 offen offset:2048 lds
    buffer_load_dwordx4 v203, s[24:27], s47 offen offset:3072 lds
    v_mfma_f32_32x32x16_bf16 v[144:159], v[48:51], v[60:63], v[144:159]
    v_mfma_f32_32x32x16_bf16 v[160:175], v[52:55], v[56:59], v[160:175]
    v_mfma_f32_32x32x16_bf16 v[176:191], v[52:55], v[60:63], v[176:191]
    s_waitcnt lgkmcnt(0)
    v_mfma_f32_32x32x16_bf16 v[64:79], v[16:19], v[32:35], v[64:79]
    ds_read_b64_tr_b16 v[56:57], v210 offset:40960
    ds_read_b64_tr_b16 v[58:59], v210 offset:43008
    v_mfma_f32_32x32x16_bf16 v[80:95], v[16:19], v[36:39], v[80:95]
    ds_read_b64_tr_b16 v[60:61], v211 offset:40960
    ds_read_b64_tr_b16 v[62:63], v211 offset:43008
    v_mfma_f32_32x32x16_bf16 v[96:111], v[20:23], v[32:35], v[96:111]
    ds_read_b128 v[40:43], v207 offset:32768
    ds_read_b128 v[44:47], v207 offset:36864
    v_mfma_f32_32x32x16_bf16 v[112:127], v[20:23], v[36:39], v[112:127]
    ds_read_b128 v[48:51], v207 offset:40960
    ds_read_b128 v[52:55], v207 offset:45056
    v_mfma_f32_32x32x16_bf16 v[128:143], v[24:27], v[32:35], v[128:143]
    v_mfma_f32_32x32x16_bf16 v[144:159], v[24:27], v[36:39], v[144:159]
    v_mfma_f32_32x32x16_bf16 v[160:175], v[28:31], v[32:35], v[160:175]
    v_mfma_f32_32x32x16_bf16 v[176:191], v[28:31], v[36:39], v[176:191]
    s_waitcnt vmcnt(12) lgkmcnt(0)
    s_barrier
    v_mfma_f32_32x32x16_bf16 v[64:79], v[40:43], v[56:59], v[64:79]
    ds_read_b64_tr_b16 v[32:33], v210 offset:49152
    ds_read_b64_tr_b16 v[34:35], v210 offset:51200
    v_mfma_f32_32x32x16_bf16 v[80:95], v[40:43], v[60:63], v[80:95]
    ds_read_b64_tr_b16 v[36:37], v211 offset:49152
    ds_read_b64_tr_b16 v[38:39], v211 offset:51200
    v_mfma_f32_32x32x16_bf16 v[96:111], v[44:47], v[56:59], v[96:111]
    ds_read_b128 v[16:19], v208 offset:32768
    ds_read_b128 v[20:23], v208 offset:36864
    v_mfma_f32_32x32x16_bf16 v[112:127], v[44:47], v[60:63], v[112:127]
    ds_read_b128 v[24:27], v208 offset:40960
    ds_read_b128 v[28:31], v208 offset:45056
    v_mfma_f32_32x32x16_bf16 v[128:143], v[48:51], v[56:59], v[128:143]
    s_add_u32 m0, s46, 131072
    s_mov_b32 s48, 1572864
    buffer_load_dwordx4 v204, s[28:31], s48 offen offset:0 lds
    buffer_load_dwordx4 v205, s[28:31], s48 offen offset:1024 lds
    v_lshlrev_b32 v220, 16, v8
    v_mfma_f32_32x32x16_bf16 v[144:159], v[48:51], v[60:63], v[144:159]
    v_and_b32 v221, 0xffff0000, v8
    v_lshlrev_b32 v222, 16, v9
    v_mfma_f32_32x32x16_bf16 v[160:175], v[52:55], v[56:59], v[160:175]
    v_and_b32 v223, 0xffff0000, v9
    v_lshlrev_b32 v224, 16, v10
    v_mfma_f32_32x32x16_bf16 v[176:191], v[52:55], v[60:63], v[176:191]
    v_and_b32 v225, 0xffff0000, v10
    v_lshlrev_b32 v226, 16, v11
    v_and_b32 v227, 0xffff0000, v11
    s_waitcnt lgkmcnt(0)
    v_mfma_f32_32x32x16_bf16 v[64:79], v[16:19], v[32:35], v[64:79]
    ds_read_b64_tr_b16 v[56:57], v210 offset:57344
    ds_read_b64_tr_b16 v[58:59], v210 offset:59392
    v_mfma_f32_32x32x16_bf16 v[80:95], v[16:19], v[36:39], v[80:95]
    ds_read_b64_tr_b16 v[60:61], v211 offset:57344
    ds_read_b64_tr_b16 v[62:63], v211 offset:59392
    v_mfma_f32_32x32x16_bf16 v[96:111], v[20:23], v[32:35], v[96:111]
    ds_read_b128 v[40:43], v209 offset:32768
    ds_read_b128 v[44:47], v209 offset:36864
    v_mfma_f32_32x32x16_bf16 v[112:127], v[20:23], v[36:39], v[112:127]
    ds_read_b128 v[48:51], v209 offset:40960
    ds_read_b128 v[52:55], v209 offset:45056
    v_mfma_f32_32x32x16_bf16 v[128:143], v[24:27], v[32:35], v[128:143]
    v_lshlrev_b32 v228, 16, v12
    v_and_b32 v229, 0xffff0000, v12
    v_mfma_f32_32x32x16_bf16 v[144:159], v[24:27], v[36:39], v[144:159]
    v_lshlrev_b32 v230, 16, v13
    v_and_b32 v231, 0xffff0000, v13
    v_mfma_f32_32x32x16_bf16 v[160:175], v[28:31], v[32:35], v[160:175]
    v_lshlrev_b32 v232, 16, v14
    v_and_b32 v233, 0xffff0000, v14
    v_mfma_f32_32x32x16_bf16 v[176:191], v[28:31], v[36:39], v[176:191]
    v_lshlrev_b32 v234, 16, v15
    v_and_b32 v235, 0xffff0000, v15
    s_waitcnt vmcnt(8) lgkmcnt(0)
    s_barrier
    v_mfma_f32_32x32x16_bf16 v[64:79], v[40:43], v[56:59], v[64:79]
    ds_read_b64_tr_b16 v[32:33], v210 offset:0
    ds_read_b64_tr_b16 v[34:35], v210 offset:2048
    v_mfma_f32_32x32x16_bf16 v[80:95], v[40:43], v[60:63], v[80:95]
    ds_read_b64_tr_b16 v[36:37], v211 offset:0
    ds_read_b64_tr_b16 v[38:39], v211 offset:2048
    v_mfma_f32_32x32x16_bf16 v[96:111], v[44:47], v[56:59], v[96:111]
    ds_read_b128 v[16:19], v213 offset:0
    ds_read_b128 v[20:23], v213 offset:4096
    v_mfma_f32_32x32x16_bf16 v[112:127], v[44:47], v[60:63], v[112:127]
    ds_read_b128 v[24:27], v213 offset:8192
    ds_read_b128 v[28:31], v213 offset:12288
    v_mfma_f32_32x32x16_bf16 v[128:143], v[48:51], v[56:59], v[128:143]
    s_add_u32 m0, s46, 147456
    s_mov_b32 s48, 1835008
    buffer_load_dwordx4 v204, s[28:31], s48 offen offset:0 lds
    buffer_load_dwordx4 v205, s[28:31], s48 offen offset:1024 lds
    s_add_u32 m0, s45, 32768
    s_mov_b32 s47, 512
    buffer_load_dwordx4 v200, s[24:27], s47 offen offset:0 lds
    buffer_load_dwordx4 v201, s[24:27], s47 offen offset:1024 lds
    buffer_load_dwordx4 v202, s[24:27], s47 offen offset:2048 lds
    buffer_load_dwordx4 v203, s[24:27], s47 offen offset:3072 lds
    v_mfma_f32_32x32x16_bf16 v[144:159], v[48:51], v[60:63], v[144:159]
    v_add_f32 v236, v220, v221
    v_add_f32 v236, v236, v222
    v_mfma_f32_32x32x16_bf16 v[160:175], v[52:55], v[56:59], v[160:175]
    v_add_f32 v236, v236, v223
    v_add_f32 v236, v236, v224
    v_mfma_f32_32x32x16_bf16 v[176:191], v[52:55], v[60:63], v[176:191]
    v_add_f32 v236, v236, v225
    v_add_f32 v236, v236, v226
    v_add_f32 v236, v236, v227
    v_add_f32 v236, v236, v228
    s_waitcnt lgkmcnt(0)
    v_mfma_f32_32x32x16_bf16 v[64:79], v[16:19], v[32:35], v[64:79]
    ds_read_b64_tr_b16 v[56:57], v210 offset:8192
    ds_read_b64_tr_b16 v[58:59], v210 offset:10240
    v_mfma_f32_32x32x16_bf16 v[80:95], v[16:19], v[36:39], v[80:95]
    ds_read_b64_tr_b16 v[60:61], v211 offset:8192
    ds_read_b64_tr_b16 v[62:63], v211 offset:10240
    v_mfma_f32_32x32x16_bf16 v[96:111], v[20:23], v[32:35], v[96:111]
    ds_read_b128 v[40:43], v214 offset:0
    ds_read_b128 v[44:47], v214 offset:4096
    v_mfma_f32_32x32x16_bf16 v[112:127], v[20:23], v[36:39], v[112:127]
    ds_read_b128 v[48:51], v214 offset:8192
    ds_read_b128 v[52:55], v214 offset:12288
    v_mfma_f32_32x32x16_bf16 v[128:143], v[24:27], v[32:35], v[128:143]
    v_add_f32 v236, v236, v229
    v_add_f32 v236, v236, v230
    v_mfma_f32_32x32x16_bf16 v[144:159], v[24:27], v[36:39], v[144:159]
    v_add_f32 v236, v236, v231
    v_add_f32 v236, v236, v232
    v_mfma_f32_32x32x16_bf16 v[160:175], v[28:31], v[32:35], v[160:175]
    v_add_f32 v236, v236, v233
    v_add_f32 v236, v236, v234
    v_mfma_f32_32x32x16_bf16 v[176:191], v[28:31], v[36:39], v[176:191]
    v_add_f32 v236, v236, v235
    s_nop 1
    s_waitcnt vmcnt(12) lgkmcnt(0)
    s_barrier
    v_mfma_f32_32x32x16_bf16 v[64:79], v[40:43], v[56:59], v[64:79]
    ds_read_b64_tr_b16 v[32:33], v210 offset:16384
    ds_read_b64_tr_b16 v[34:35], v210 offset:18432
    v_mfma_f32_32x32x16_bf16 v[80:95], v[40:43], v[60:63], v[80:95]
    ds_read_b64_tr_b16 v[36:37], v211 offset:16384
    ds_read_b64_tr_b16 v[38:39], v211 offset:18432
    v_mfma_f32_32x32x16_bf16 v[96:111], v[44:47], v[56:59], v[96:111]
    ds_read_b128 v[16:19], v215 offset:0
    ds_read_b128 v[20:23], v215 offset:4096
    v_mfma_f32_32x32x16_bf16 v[112:127], v[44:47], v[60:63], v[112:127]
    ds_read_b128 v[24:27], v215 offset:8192
    ds_read_b128 v[28:31], v215 offset:12288
    v_mfma_f32_32x32x16_bf16 v[128:143], v[48:51], v[56:59], v[128:143]
    s_add_u32 m0, s46, 98304
    s_mov_b32 s48, 2097152
    buffer_load_dwordx4 v204, s[28:31], s48 offen offset:0 lds
    buffer_load_dwordx4 v205, s[28:31], s48 offen offset:1024 lds
    v_add_f32_dpp v236, v236, v236 quad_perm:[1,0,3,2] row_mask:0xf bank_mask:0xf
    v_mfma_f32_32x32x16_bf16 v[144:159], v[48:51], v[60:63], v[144:159]
    s_nop 1
    v_add_f32_dpp v236, v236, v236 quad_perm:[2,3,0,1] row_mask:0xf bank_mask:0xf
    v_mfma_f32_32x32x16_bf16 v[160:175], v[52:55], v[56:59], v[160:175]
    s_nop 1
    v_add_f32_dpp v236, v236, v236 row_half_mirror row_mask:0xf bank_mask:0xf
    v_mfma_f32_32x32x16_bf16 v[176:191], v[52:55], v[60:63], v[176:191]
    s_nop 1
    v_add_f32_dpp v236, v236, v236 row_mirror row_mask:0xf bank_mask:0xf
    s_nop 1
    s_waitcnt lgkmcnt(0)
    v_mfma_f32_32x32x16_bf16 v[64:79], v[16:19], v[32:35], v[64:79]
    ds_read_b64_tr_b16 v[56:57], v210 offset:24576
    ds_read_b64_tr_b16 v[58:59], v210 offset:26624
    v_mfma_f32_32x32x16_bf16 v[80:95], v[16:19], v[36:39], v[80:95]
    ds_read_b64_tr_b16 v[60:61], v211 offset:24576
    ds_read_b64_tr_b16 v[62:63], v211 offset:26624
    v_mfma_f32_32x32x16_bf16 v[96:111], v[20:23], v[32:35], v[96:111]
    ds_read_b128 v[40:43], v216 offset:0
    ds_read_b128 v[44:47], v216 offset:4096
    v_mfma_f32_32x32x16_bf16 v[112:127], v[20:23], v[36:39], v[112:127]
    ds_read_b128 v[48:51], v216 offset:8192
    ds_read_b128 v[52:55], v216 offset:12288
    v_mfma_f32_32x32x16_bf16 v[128:143], v[24:27], v[32:35], v[128:143]
    v_readlane_b32 s56, v236, 0
    v_readlane_b32 s57, v236, 16
    v_mfma_f32_32x32x16_bf16 v[144:159], v[24:27], v[36:39], v[144:159]
    v_readlane_b32 s58, v236, 32
    v_readlane_b32 s59, v236, 48
    v_mfma_f32_32x32x16_bf16 v[160:175], v[28:31], v[32:35], v[160:175]
    s_nop 1
    v_mov_b32 v236, s56
    v_mfma_f32_32x32x16_bf16 v[176:191], v[28:31], v[36:39], v[176:191]
    v_add_f32 v236, s57, v236
    v_add_f32 v236, s58, v236
    s_waitcnt vmcnt(8) lgkmcnt(0)
    s_barrier
    v_mfma_f32_32x32x16_bf16 v[64:79], v[40:43], v[56:59], v[64:79]
    ds_read_b64_tr_b16 v[32:33], v210 offset:32768
    ds_read_b64_tr_b16 v[34:35], v210 offset:34816
    v_mfma_f32_32x32x16_bf16 v[80:95], v[40:43], v[60:63], v[80:95]
    ds_read_b64_tr_b16 v[36:37], v211 offset:32768
    ds_read_b64_tr_b16 v[38:39], v211 offset:34816
    v_mfma_f32_32x32x16_bf16 v[96:111], v[44:47], v[56:59], v[96:111]
    ds_read_b128 v[16:19], v206 offset:0
    ds_read_b128 v[20:23], v206 offset:4096
    v_mfma_f32_32x32x16_bf16 v[112:127], v[44:47], v[60:63], v[112:127]
    ds_read_b128 v[24:27], v206 offset:8192
    ds_read_b128 v[28:31], v206 offset:12288
    v_mfma_f32_32x32x16_bf16 v[128:143], v[48:51], v[56:59], v[128:143]
    s_add_u32 m0, s46, 114688
    s_mov_b32 s48, 2359296
    buffer_load_dwordx4 v204, s[28:31], s48 offen offset:0 lds
    buffer_load_dwordx4 v205, s[28:31], s48 offen offset:1024 lds
    s_add_u32 m0, s45, 65536
    s_mov_b32 s47, 640
    buffer_load_dwordx4 v200, s[24:27], s47 offen offset:0 lds
    buffer_load_dwordx4 v201, s[24:27], s47 offen offset:1024 lds
    buffer_load_dwordx4 v202, s[24:27], s47 offen offset:2048 lds
    buffer_load_dwordx4 v203, s[24:27], s47 offen offset:3072 lds
    v_mfma_f32_32x32x16_bf16 v[144:159], v[48:51], v[60:63], v[144:159]
    v_add_f32 v236, s59, v236
    v_mul_f32 v236, 0.0015625, v236
    v_mfma_f32_32x32x16_bf16 v[160:175], v[52:55], v[56:59], v[160:175]
    v_sub_f32 v237, v220, v236
    v_mul_f32 v238, v237, v237
    v_mfma_f32_32x32x16_bf16 v[176:191], v[52:55], v[60:63], v[176:191]
    v_sub_f32 v237, v221, v236
    v_fmac_f32 v238, v237, v237
    v_sub_f32 v237, v222, v236
    v_fmac_f32 v238, v237, v237
    s_waitcnt lgkmcnt(0)
    v_mfma_f32_32x32x16_bf16 v[64:79], v[16:19], v[32:35], v[64:79]
    ds_read_b64_tr_b16 v[56:57], v210 offset:40960
    ds_read_b64_tr_b16 v[58:59], v210 offset:43008
    v_mfma_f32_32x32x16_bf16 v[80:95], v[16:19], v[36:39], v[80:95]
    ds_read_b64_tr_b16 v[60:61], v211 offset:40960
    ds_read_b64_tr_b16 v[62:63], v211 offset:43008
    v_mfma_f32_32x32x16_bf16 v[96:111], v[20:23], v[32:35], v[96:111]
    ds_read_b128 v[40:43], v207 offset:0
    ds_read_b128 v[44:47], v207 offset:4096
    v_mfma_f32_32x32x16_bf16 v[112:127], v[20:23], v[36:39], v[112:127]
    ds_read_b128 v[48:51], v207 offset:8192
    ds_read_b128 v[52:55], v207 offset:12288
    v_mfma_f32_32x32x16_bf16 v[128:143], v[24:27], v[32:35], v[128:143]
    v_sub_f32 v237, v223, v236
    v_fmac_f32 v238, v237, v237
    v_mfma_f32_32x32x16_bf16 v[144:159], v[24:27], v[36:39], v[144:159]
    v_sub_f32 v237, v224, v236
    v_fmac_f32 v238, v237, v237
    v_mfma_f32_32x32x16_bf16 v[160:175], v[28:31], v[32:35], v[160:175]
    v_sub_f32 v237, v225, v236
    v_fmac_f32 v238, v237, v237
    v_mfma_f32_32x32x16_bf16 v[176:191], v[28:31], v[36:39], v[176:191]
    v_sub_f32 v237, v226, v236
    v_fmac_f32 v238, v237, v237
    s_waitcnt vmcnt(12) lgkmcnt(0)
    s_barrier
    v_mfma_f32_32x32x16_bf16 v[64:79], v[40:43], v[56:59], v[64:79]
    ds_read_b64_tr_b16 v[32:33], v210 offset:49152
    ds_read_b64_tr_b16 v[34:35], v210 offset:51200
    v_mfma_f32_32x32x16_bf16 v[80:95], v[40:43], v[60:63], v[80:95]
    ds_read_b64_tr_b16 v[36:37], v211 offset:49152
    ds_read_b64_tr_b16 v[38:39], v211 offset:51200
    v_mfma_f32_32x32x16_bf16 v[96:111], v[44:47], v[56:59], v[96:111]
    ds_read_b128 v[16:19], v208 offset:0
    ds_read_b128 v[20:23], v208 offset:4096
    v_mfma_f32_32x32x16_bf16 v[112:127], v[44:47], v[60:63], v[112:127]
    ds_read_b128 v[24:27], v208 offset:8192
    ds_read_b128 v[28:31], v208 offset:12288
    v_mfma_f32_32x32x16_bf16 v[128:143], v[48:51], v[56:59], v[128:143]
    s_add_u32 m0, s46, 131072
    s_mov_b32 s48, 2621440
    buffer_load_dwordx4 v204, s[28:31], s48 offen offset:0 lds
    buffer_load_dwordx4 v205, s[28:31], s48 offen offset:1024 lds
    v_sub_f32 v237, v227, v236
    v_mfma_f32_32x32x16_bf16 v[144:159], v[48:51], v[60:63], v[144:159]
    v_fmac_f32 v238, v237, v237
    v_sub_f32 v237, v228, v236
    v_mfma_f32_32x32x16_bf16 v[160:175], v[52:55], v[56:59], v[160:175]
    v_fmac_f32 v238, v237, v237
    v_sub_f32 v237, v229, v236
    v_mfma_f32_32x32x16_bf16 v[176:191], v[52:55], v[60:63], v[176:191]
    v_fmac_f32 v238, v237, v237
    v_sub_f32 v237, v230, v236
    v_fmac_f32 v238, v237, v237
    s_waitcnt lgkmcnt(0)
    v_mfma_f32_32x32x16_bf16 v[64:79], v[16:19], v[32:35], v[64:79]
    ds_read_b64_tr_b16 v[56:57], v210 offset:57344
    ds_read_b64_tr_b16 v[58:59], v210 offset:59392
    v_mfma_f32_32x32x16_bf16 v[80:95], v[16:19], v[36:39], v[80:95]
    ds_read_b64_tr_b16 v[60:61], v211 offset:57344
    ds_read_b64_tr_b16 v[62:63], v211 offset:59392
    v_mfma_f32_32x32x16_bf16 v[96:111], v[20:23], v[32:35], v[96:111]
    ds_read_b128 v[40:43], v209 offset:0
    ds_read_b128 v[44:47], v209 offset:4096
    v_mfma_f32_32x32x16_bf16 v[112:127], v[20:23], v[36:39], v[112:127]
    ds_read_b128 v[48:51], v209 offset:8192
    ds_read_b128 v[52:55], v209 offset:12288
    v_mfma_f32_32x32x16_bf16 v[128:143], v[24:27], v[32:35], v[128:143]
    v_sub_f32 v237, v231, v236
    v_fmac_f32 v238, v237, v237
    v_mfma_f32_32x32x16_bf16 v[144:159], v[24:27], v[36:39], v[144:159]
    v_sub_f32 v237, v232, v236
    v_fmac_f32 v238, v237, v237
    v_mfma_f32_32x32x16_bf16 v[160:175], v[28:31], v[32:35], v[160:175]
    v_sub_f32 v237, v233, v236
    v_fmac_f32 v238, v237, v237
    v_mfma_f32_32x32x16_bf16 v[176:191], v[28:31], v[36:39], v[176:191]
    v_sub_f32 v237, v234, v236
    v_fmac_f32 v238, v237, v237
    s_waitcnt vmcnt(8) lgkmcnt(0)
    s_barrier
    v_mfma_f32_32x32x16_bf16 v[64:79], v[40:43], v[56:59], v[64:79]
    ds_read_b64_tr_b16 v[32:33], v210 offset:0
    ds_read_b64_tr_b16 v[34:35], v210 offset:2048
    v_mfma_f32_32x32x16_bf16 v[80:95], v[40:43], v[60:63], v[80:95]
    ds_read_b64_tr_b16 v[36:37], v211 offset:0
    ds_read_b64_tr_b16 v[38:39], v211 offset:2048
    v_mfma_f32_32x32x16_bf16 v[96:111], v[44:47], v[56:59], v[96:111]
    ds_read_b128 v[16:19], v206 offset:32768
    ds_read_b128 v[20:23], v206 offset:36864
    v_mfma_f32_32x32x16_bf16 v[112:127], v[44:47], v[60:63], v[112:127]
    ds_read_b128 v[24:27], v206 offset:40960
    ds_read_b128 v[28:31], v206 offset:45056
    v_mfma_f32_32x32x16_bf16 v[128:143], v[48:51], v[56:59], v[128:143]
    s_add_u32 m0, s46, 147456
    s_mov_b32 s48, 2883584
    buffer_load_dwordx4 v204, s[28:31], s48 offen offset:0 lds
    buffer_load_dwordx4 v205, s[28:31], s48 offen offset:1024 lds
    s_add_u32 m0, s45, 0
    s_mov_b32 s47, 768
    buffer_load_dwordx4 v200, s[24:27], s47 offen offset:0 lds
    buffer_load_dwordx4 v201, s[24:27], s47 offen offset:1024 lds
    buffer_load_dwordx4 v202, s[24:27], s47 offen offset:2048 lds
    buffer_load_dwordx4 v203, s[24:27], s47 offen offset:3072 lds
    v_mfma_f32_32x32x16_bf16 v[144:159], v[48:51], v[60:63], v[144:159]
    v_sub_f32 v237, v235, v236
    v_fmac_f32 v238, v237, v237
    v_mfma_f32_32x32x16_bf16 v[160:175], v[52:55], v[56:59], v[160:175]
    v_cndmask_b32 v238, 0, v238, vcc
    s_nop 1
    v_mfma_f32_32x32x16_bf16 v[176:191], v[52:55], v[60:63], v[176:191]
    v_add_f32_dpp v238, v238, v238 quad_perm:[1,0,3,2] row_mask:0xf bank_mask:0xf
    s_nop 1
    v_add_f32_dpp v238, v238, v238 quad_perm:[2,3,0,1] row_mask:0xf bank_mask:0xf
    s_nop 1
    s_waitcnt lgkmcnt(0)
    v_mfma_f32_32x32x16_bf16 v[64:79], v[16:19], v[32:35], v[64:79]
    ds_read_b64_tr_b16 v[56:57], v210 offset:8192
    ds_read_b64_tr_b16 v[58:59], v210 offset:10240
    v_mfma_f32_32x32x16_bf16 v[80:95], v[16:19], v[36:39], v[80:95]
    ds_read_b64_tr_b16 v[60:61], v211 offset:8192
    ds_read_b64_tr_b16 v[62:63], v211 offset:10240
    v_mfma_f32_32x32x16_bf16 v[96:111], v[20:23], v[32:35], v[96:111]
    ds_read_b128 v[40:43], v207 offset:32768
    ds_read_b128 v[44:47], v207 offset:36864
    v_mfma_f32_32x32x16_bf16 v[112:127], v[20:23], v[36:39], v[112:127]
    ds_read_b128 v[48:51], v207 offset:40960
    ds_read_b128 v[52:55], v207 offset:45056
    v_mfma_f32_32x32x16_bf16 v[128:143], v[24:27], v[32:35], v[128:143]
    v_add_f32_dpp v238, v238, v238 row_half_mirror row_mask:0xf bank_mask:0xf
    s_nop 1
    v_mfma_f32_32x32x16_bf16 v[144:159], v[24:27], v[36:39], v[144:159]
    v_add_f32_dpp v238, v238, v238 row_mirror row_mask:0xf bank_mask:0xf
    s_nop 1
    v_mfma_f32_32x32x16_bf16 v[160:175], v[28:31], v[32:35], v[160:175]
    v_readlane_b32 s56, v238, 0
    v_readlane_b32 s57, v238, 16
    v_mfma_f32_32x32x16_bf16 v[176:191], v[28:31], v[36:39], v[176:191]
    v_readlane_b32 s58, v238, 32
    v_readlane_b32 s59, v238, 48
    s_waitcnt vmcnt(12) lgkmcnt(0)
    s_barrier
    v_mfma_f32_32x32x16_bf16 v[64:79], v[40:43], v[56:59], v[64:79]
    ds_read_b64_tr_b16 v[32:33], v210 offset:16384
    ds_read_b64_tr_b16 v[34:35], v210 offset:18432
    v_mfma_f32_32x32x16_bf16 v[80:95], v[40:43], v[60:63], v[80:95]
    ds_read_b64_tr_b16 v[36:37], v211 offset:16384
    ds_read_b64_tr_b16 v[38:39], v211 offset:18432
    v_mfma_f32_32x32x16_bf16 v[96:111], v[44:47], v[56:59], v[96:111]
    ds_read_b128 v[16:19], v208 offset:32768
    ds_read_b128 v[20:23], v208 offset:36864
    v_mfma_f32_32x32x16_bf16 v[112:127], v[44:47], v[60:63], v[112:127]
    ds_read_b128 v[24:27], v208 offset:40960
    ds_read_b128 v[28:31], v208 offset:45056
    v_mfma_f32_32x32x16_bf16 v[128:143], v[48:51], v[56:59], v[128:143]
    s_add_u32 m0, s46, 98304
    s_mov_b32 s48, 3145728
    buffer_load_dwordx4 v204, s[28:31], s48 offen offset:0 lds
    buffer_load_dwordx4 v205, s[28:31], s48 offen offset:1024 lds
    s_nop 1
    v_mfma_f32_32x32x16_bf16 v[144:159], v[48:51], v[60:63], v[144:159]
    v_mov_b32 v238, s56
    v_add_f32 v238, s57, v238
    v_mfma_f32_32x32x16_bf16 v[160:175], v[52:55], v[56:59], v[160:175]
    v_add_f32 v238, s58, v238
    v_add_f32 v238, s59, v238
    v_mfma_f32_32x32x16_bf16 v[176:191], v[52:55], v[60:63], v[176:191]
    v_mul_f32 v238, 0.0015625, v238
    v_cvt_pk_bf16_f32 v238, v238, v238
    v_and_b32 v238, 0xffff0000, v238
    s_waitcnt lgkmcnt(0)
    v_mfma_f32_32x32x16_bf16 v[64:79], v[16:19], v[32:35], v[64:79]
    ds_read_b64_tr_b16 v[56:57], v210 offset:24576
    ds_read_b64_tr_b16 v[58:59], v210 offset:26624
    v_mfma_f32_32x32x16_bf16 v[80:95], v[16:19], v[36:39], v[80:95]
    ds_read_b64_tr_b16 v[60:61], v211 offset:24576
    ds_read_b64_tr_b16 v[62:63], v211 offset:26624
    v_mfma_f32_32x32x16_bf16 v[96:111], v[20:23], v[32:35], v[96:111]
    ds_read_b128 v[40:43], v209 offset:32768
    ds_read_b128 v[44:47], v209 offset:36864
    v_mfma_f32_32x32x16_bf16 v[112:127], v[20:23], v[36:39], v[112:127]
    ds_read_b128 v[48:51], v209 offset:40960
    ds_read_b128 v[52:55], v209 offset:45056
    v_mfma_f32_32x32x16_bf16 v[128:143], v[24:27], v[32:35], v[128:143]
    v_add_f32 v238, 0x3727c5ac, v238
    v_cvt_pk_bf16_f32 v238, v238, v238
    v_mfma_f32_32x32x16_bf16 v[144:159], v[24:27], v[36:39], v[144:159]
    v_and_b32 v238, 0xffff0000, v238
    v_sqrt_f32 v238, v238
    v_mfma_f32_32x32x16_bf16 v[160:175], v[28:31], v[32:35], v[160:175]
    s_nop 0
    v_cvt_pk_bf16_f32 v238, v238, v238
    v_mfma_f32_32x32x16_bf16 v[176:191], v[28:31], v[36:39], v[176:191]
    v_and_b32 v238, 0xffff0000, v238
    v_rcp_f32 v238, v238
    s_waitcnt vmcnt(8) lgkmcnt(0)
    s_barrier
    v_mfma_f32_32x32x16_bf16 v[64:79], v[40:43], v[56:59], v[64:79]
    ds_read_b64_tr_b16 v[32:33], v210 offset:32768
    ds_read_b64_tr_b16 v[34:35], v210 offset:34816
    v_mfma_f32_32x32x16_bf16 v[80:95], v[40:43], v[60:63], v[80:95]
    ds_read_b64_tr_b16 v[36:37], v211 offset:32768
    ds_read_b64_tr_b16 v[38:39], v211 offset:34816
    v_mfma_f32_32x32x16_bf16 v[96:111], v[44:47], v[56:59], v[96:111]
    ds_read_b128 v[16:19], v213 offset:0
    ds_read_b128 v[20:23], v213 offset:4096
    v_mfma_f32_32x32x16_bf16 v[112:127], v[44:47], v[60:63], v[112:127]
    ds_read_b128 v[24:27], v213 offset:8192
    ds_read_b128 v[28:31], v213 offset:12288
    v_mfma_f32_32x32x16_bf16 v[128:143], v[48:51], v[56:59], v[128:143]
    s_add_u32 m0, s46, 114688
    s_mov_b32 s48, 3407872
    buffer_load_dwordx4 v204, s[28:31], s48 offen offset:0 lds
    buffer_load_dwordx4 v205, s[28:31], s48 offen offset:1024 lds
    s_add_u32 m0, s45, 32768
    s_mov_b32 s47, 896
    buffer_load_dwordx4 v200, s[24:27], s47 offen offset:0 lds
    buffer_load_dwordx4 v201, s[24:27], s47 offen offset:1024 lds
    buffer_load_dwordx4 v202, s[24:27], s47 offen offset:2048 lds
    buffer_load_dwordx4 v203, s[24:27], s47 offen offset:3072 lds
    v_mfma_f32_32x32x16_bf16 v[144:159], v[48:51], v[60:63], v[144:159]
    v_cvt_pk_bf16_f32 v236, v236, v236
    v_and_b32 v236, 0xffff0000, v236
    v_mfma_f32_32x32x16_bf16 v[160:175], v[52:55], v[56:59], v[160:175]
    v_sub_f32 v220, v220, v236
    v_sub_f32 v221, v221, v236
    v_mfma_f32_32x32x16_bf16 v[176:191], v[52:55], v[60:63], v[176:191]
    v_cvt_pk_bf16_f32 v237, v220, v221
    v_lshlrev_b32 v220, 16, v237
    v_and_b32 v221, 0xffff0000, v237
    v_mul_f32 v220, v220, v238
    s_waitcnt lgkmcnt(0)
    v_mfma_f32_32x32x16_bf16 v[64:79], v[16:19], v[32:35], v[64:79]
    ds_read_b64_tr_b16 v[56:57], v210 offset:40960
    ds_read_b64_tr_b16 v[58:59], v210 offset:43008
    v_mfma_f32_32x32x16_bf16 v[80:95], v[16:19], v[36:39], v[80:95]
    ds_read_b64_tr_b16 v[60:61], v211 offset:40960
    ds_read_b64_tr_b16 v[62:63], v211 offset:43008
    v_mfma_f32_32x32x16_bf16 v[96:111], v[20:23], v[32:35], v[96:111]
    ds_read_b128 v[40:43], v214 offset:0
    ds_read_b128 v[44:47], v214 offset:4096
    v_mfma_f32_32x32x16_bf16 v[112:127], v[20:23], v[36:39], v[112:127]
    ds_read_b128 v[48:51], v214 offset:8192
    ds_read_b128 v[52:55], v214 offset:12288
    v_mfma_f32_32x32x16_bf16 v[128:143], v[24:27], v[32:35], v[128:143]
    v_mul_f32 v221, v221, v238
    v_cvt_pk_bf16_f32 v8, v220, v221
    v_mfma_f32_32x32x16_bf16 v[144:159], v[24:27], v[36:39], v[144:159]
    v_sub_f32 v222, v222, v236
    v_sub_f32 v223, v223, v236
    v_mfma_f32_32x32x16_bf16 v[160:175], v[28:31], v[32:35], v[160:175]
    v_cvt_pk_bf16_f32 v237, v222, v223
    v_lshlrev_b32 v222, 16, v237
    v_mfma_f32_32x32x16_bf16 v[176:191], v[28:31], v[36:39], v[176:191]
    v_and_b32 v223, 0xffff0000, v237
    v_mul_f32 v222, v222, v238
    s_waitcnt vmcnt(12) lgkmcnt(0)
    s_barrier
    v_mfma_f32_32x32x16_bf16 v[64:79], v[40:43], v[56:59], v[64:79]
    ds_read_b64_tr_b16 v[32:33], v210 offset:49152
    ds_read_b64_tr_b16 v[34:35], v210 offset:51200
    v_mfma_f32_32x32x16_bf16 v[80:95], v[40:43], v[60:63], v[80:95]
    ds_read_b64_tr_b16 v[36:37], v211 offset:49152
    ds_read_b64_tr_b16 v[38:39], v211 offset:51200
    v_mfma_f32_32x32x16_bf16 v[96:111], v[44:47], v[56:59], v[96:111]
    ds_read_b128 v[16:19], v215 offset:0
    ds_read_b128 v[20:23], v215 offset:4096
    v_mfma_f32_32x32x16_bf16 v[112:127], v[44:47], v[60:63], v[112:127]
    ds_read_b128 v[24:27], v215 offset:8192
    ds_read_b128 v[28:31], v215 offset:12288
    v_mfma_f32_32x32x16_bf16 v[128:143], v[48:51], v[56:59], v[128:143]
    s_add_u32 m0, s46, 131072
    s_mov_b32 s48, 3670016
    buffer_load_dwordx4 v204, s[28:31], s48 offen offset:0 lds
    buffer_load_dwordx4 v205, s[28:31], s48 offen offset:1024 lds
    v_mul_f32 v223, v223, v238
    v_mfma_f32_32x32x16_bf16 v[144:159], v[48:51], v[60:63], v[144:159]
    v_cvt_pk_bf16_f32 v9, v222, v223
    v_sub_f32 v224, v224, v236
    v_mfma_f32_32x32x16_bf16 v[160:175], v[52:55], v[56:59], v[160:175]
    v_sub_f32 v225, v225, v236
    v_cvt_pk_bf16_f32 v237, v224, v225
    v_mfma_f32_32x32x16_bf16 v[176:191], v[52:55], v[60:63], v[176:191]
    v_lshlrev_b32 v224, 16, v237
    v_and_b32 v225, 0xffff0000, v237
    v_mul_f32 v224, v224, v238
    s_waitcnt lgkmcnt(0)
    v_mfma_f32_32x32x16_bf16 v[64:79], v[16:19], v[32:35], v[64:79]
    ds_read_b64_tr_b16 v[56:57], v210 offset:57344
    ds_read_b64_tr_b16 v[58:59], v210 offset:59392
    v_mfma_f32_32x32x16_bf16 v[80:95], v[16:19], v[36:39], v[80:95]
    ds_read_b64_tr_b16 v[60:61], v211 offset:57344
    ds_read_b64_tr_b16 v[62:63], v211 offset:59392
    v_mfma_f32_32x32x16_bf16 v[96:111], v[20:23], v[32:35], v[96:111]
    ds_read_b128 v[40:43], v216 offset:0
    ds_read_b128 v[44:47], v216 offset:4096
    v_mfma_f32_32x32x16_bf16 v[112:127], v[20:23], v[36:39], v[112:127]
    ds_read_b128 v[48:51], v216 offset:8192
    ds_read_b128 v[52:55], v216 offset:12288
    v_mfma_f32_32x32x16_bf16 v[128:143], v[24:27], v[32:35], v[128:143]
    v_mul_f32 v225, v225, v238
    v_cvt_pk_bf16_f32 v10, v224, v225
    v_mfma_f32_32x32x16_bf16 v[144:159], v[24:27], v[36:39], v[144:159]
    v_sub_f32 v226, v226, v236
    v_sub_f32 v227, v227, v236
    v_mfma_f32_32x32x16_bf16 v[160:175], v[28:31], v[32:35], v[160:175]
    v_cvt_pk_bf16_f32 v237, v226, v227
    v_lshlrev_b32 v226, 16, v237
    v_mfma_f32_32x32x16_bf16 v[176:191], v[28:31], v[36:39], v[176:191]
    v_and_b32 v227, 0xffff0000, v237
    v_mul_f32 v226, v226, v238
    s_waitcnt vmcnt(8) lgkmcnt(0)
    s_barrier
    v_mfma_f32_32x32x16_bf16 v[64:79], v[40:43], v[56:59], v[64:79]
    ds_read_b64_tr_b16 v[32:33], v210 offset:0
    ds_read_b64_tr_b16 v[34:35], v210 offset:2048
    v_mfma_f32_32x32x16_bf16 v[80:95], v[40:43], v[60:63], v[80:95]
    ds_read_b64_tr_b16 v[36:37], v211 offset:0
    ds_read_b64_tr_b16 v[38:39], v211 offset:2048
    v_mfma_f32_32x32x16_bf16 v[96:111], v[44:47], v[56:59], v[96:111]
    ds_read_b128 v[16:19], v206 offset:0
    ds_read_b128 v[20:23], v206 offset:4096
    v_mfma_f32_32x32x16_bf16 v[112:127], v[44:47], v[60:63], v[112:127]
    s_add_u32 m0, s46, 147456
    s_mov_b32 s48, 3932160
    buffer_load_dwordx4 v204, s[28:31], s48 offen offset:0 lds
    buffer_load_dwordx4 v205, s[28:31], s48 offen offset:1024 lds
    v_mul_f32 v227, v227, v238
    v_mfma_f32_32x32x16_bf16 v[128:143], v[48:51], v[56:59], v[128:143]
    v_cvt_pk_bf16_f32 v11, v226, v227
    v_sub_f32 v228, v228, v236
    v_mfma_f32_32x32x16_bf16 v[144:159], v[48:51], v[60:63], v[144:159]
    v_sub_f32 v229, v229, v236
    v_cvt_pk_bf16_f32 v237, v228, v229
    v_mfma_f32_32x32x16_bf16 v[160:175], v[52:55], v[56:59], v[160:175]
    v_lshlrev_b32 v228, 16, v237
    v_and_b32 v229, 0xffff0000, v237
    v_mfma_f32_32x32x16_bf16 v[176:191], v[52:55], v[60:63], v[176:191]
    v_mul_f32 v228, v228, v238
    s_waitcnt lgkmcnt(0)
    v_mfma_f32_32x32x16_bf16 v[64:79], v[16:19], v[32:35], v[64:79]
    ds_read_b64_tr_b16 v[56:57], v210 offset:8192
    ds_read_b64_tr_b16 v[58:59], v210 offset:10240
    v_mfma_f32_32x32x16_bf16 v[80:95], v[16:19], v[36:39], v[80:95]
    ds_read_b64_tr_b16 v[60:61], v211 offset:8192
    ds_read_b64_tr_b16 v[62:63], v211 offset:10240
    v_mfma_f32_32x32x16_bf16 v[96:111], v[20:23], v[32:35], v[96:111]
    ds_read_b128 v[40:43], v207 offset:0
    ds_read_b128 v[44:47], v207 offset:4096
    v_mfma_f32_32x32x16_bf16 v[112:127], v[20:23], v[36:39], v[112:127]
    buffer_load_dwordx4 v[240:243], v212, s[60:63], s64 offen offset:0
    v_mul_f32 v229, v229, v238
    v_cvt_pk_bf16_f32 v12, v228, v229
    v_sub_f32 v230, v230, v236
    v_sub_f32 v231, v231, v236
    v_cvt_pk_bf16_f32 v237, v230, v231
    v_lshlrev_b32 v230, 16, v237
    v_and_b32 v231, 0xffff0000, v237
    v_mul_f32 v230, v230, v238
    s_waitcnt vmcnt(9) lgkmcnt(0)
    s_barrier
    v_mfma_f32_32x32x16_bf16 v[64:79], v[40:43], v[56:59], v[64:79]
    ds_read_b64_tr_b16 v[32:33], v210 offset:16384
    ds_read_b64_tr_b16 v[34:35], v210 offset:18432
    v_mfma_f32_32x32x16_bf16 v[80:95], v[40:43], v[60:63], v[80:95]
    ds_read_b64_tr_b16 v[36:37], v211 offset:16384
    ds_read_b64_tr_b16 v[38:39], v211 offset:18432
    v_mfma_f32_32x32x16_bf16 v[96:111], v[44:47], v[56:59], v[96:111]
    ds_read_b128 v[16:19], v208 offset:0
    ds_read_b128 v[20:23], v208 offset:4096
    v_mfma_f32_32x32x16_bf16 v[112:127], v[44:47], v[60:63], v[112:127]
    buffer_load_dwordx4 v[244:247], v212, s[60:63], s64 offen offset:1024
    v_mul_f32 v231, v231, v238
    v_cvt_pk_bf16_f32 v13, v230, v231
    v_sub_f32 v232, v232, v236
    v_sub_f32 v233, v233, v236
    v_cvt_pk_bf16_f32 v237, v232, v233
    v_lshlrev_b32 v232, 16, v237
    v_and_b32 v233, 0xffff0000, v237
    v_mul_f32 v232, v232, v238
    s_waitcnt lgkmcnt(0)
    v_mfma_f32_32x32x16_bf16 v[64:79], v[16:19], v[32:35], v[64:79]
    ds_read_b64_tr_b16 v[56:57], v210 offset:24576
    ds_read_b64_tr_b16 v[58:59], v210 offset:26624
    v_mfma_f32_32x32x16_bf16 v[80:95], v[16:19], v[36:39], v[80:95]
    ds_read_b64_tr_b16 v[60:61], v211 offset:24576
    ds_read_b64_tr_b16 v[62:63], v211 offset:26624
    v_mfma_f32_32x32x16_bf16 v[96:111], v[20:23], v[32:35], v[96:111]
    ds_read_b128 v[40:43], v209 offset:0
    ds_read_b128 v[44:47], v209 offset:4096
    v_mfma_f32_32x32x16_bf16 v[112:127], v[20:23], v[36:39], v[112:127]
    buffer_load_dwordx4 v[248:251], v212, s[60:63], s64 offen offset:2048
    v_mul_f32 v233, v233, v238
    v_cvt_pk_bf16_f32 v14, v232, v233
    v_sub_f32 v234, v234, v236
    v_sub_f32 v235, v235, v236
    v_cvt_pk_bf16_f32 v237, v234, v235
    v_lshlrev_b32 v234, 16, v237
    v_and_b32 v235, 0xffff0000, v237
    v_mul_f32 v234, v234, v238
    s_waitcnt vmcnt(5) lgkmcnt(0)
    s_barrier
    v_mfma_f32_32x32x16_bf16 v[64:79], v[40:43], v[56:59], v[64:79]
    ds_read_b64_tr_b16 v[32:33], v210 offset:32768
    ds_read_b64_tr_b16 v[34:35], v210 offset:34816
    v_mfma_f32_32x32x16_bf16 v[80:95], v[40:43], v[60:63], v[80:95]
    ds_read_b64_tr_b16 v[36:37], v211 offset:32768
    ds_read_b64_tr_b16 v[38:39], v211 offset:34816
    v_mfma_f32_32x32x16_bf16 v[96:111], v[44:47], v[56:59], v[96:111]
    ds_read_b128 v[16:19], v206 offset:32768
    ds_read_b128 v[20:23], v206 offset:36864
    v_mfma_f32_32x32x16_bf16 v[112:127], v[44:47], v[60:63], v[112:127]
    v_mul_f32 v235, v235, v238
    v_cvt_pk_bf16_f32 v15, v234, v235
    s_lshr_b32 s41, s40, 5
    s_mul_i32 s41, s41, 40960
    s_and_b32 s42, s40, 31
    s_lshl_b32 s42, s42, 4
    s_add_u32 s41, s41, s42
    v_lshlrev_b32 v3, 10, v1
    s_waitcnt lgkmcnt(0)
    v_mfma_f32_32x32x16_bf16 v[64:79], v[16:19], v[32:35], v[64:79]
    ds_read_b64_tr_b16 v[56:57], v210 offset:40960
    ds_read_b64_tr_b16 v[58:59], v210 offset:43008
    v_mfma_f32_32x32x16_bf16 v[80:95], v[16:19], v[36:39], v[80:95]
    ds_read_b64_tr_b16 v[60:61], v211 offset:40960
    ds_read_b64_tr_b16 v[62:63], v211 offset:43008
    v_mfma_f32_32x32x16_bf16 v[96:111], v[20:23], v[32:35], v[96:111]
    ds_read_b128 v[40:43], v207 offset:32768
    ds_read_b128 v[44:47], v207 offset:36864
    v_mfma_f32_32x32x16_bf16 v[112:127], v[20:23], v[36:39], v[112:127]
    v_add_u32 v3, s41, v3
    v_cndmask_b32 v3, v4, v3, vcc
    buffer_store_dwordx4 v[8:11], v3, s[32:35], 0 offen
    buffer_store_dwordx4 v[12:15], v3, s[32:35], 0 offen offset:512
    s_waitcnt vmcnt(5) lgkmcnt(0)
    s_barrier
    v_mfma_f32_32x32x16_bf16 v[64:79], v[40:43], v[56:59], v[64:79]
    ds_read_b64_tr_b16 v[32:33], v210 offset:49152
    ds_read_b64_tr_b16 v[34:35], v210 offset:51200
    v_mfma_f32_32x32x16_bf16 v[80:95], v[40:43], v[60:63], v[80:95]
    ds_read_b64_tr_b16 v[36:37], v211 offset:49152
    ds_read_b64_tr_b16 v[38:39], v211 offset:51200
    v_mfma_f32_32x32x16_bf16 v[96:111], v[44:47], v[56:59], v[96:111]
    ds_read_b128 v[16:19], v208 offset:32768
    ds_read_b128 v[20:23], v208 offset:36864
    v_mfma_f32_32x32x16_bf16 v[112:127], v[44:47], v[60:63], v[112:127]
    s_waitcnt lgkmcnt(0)
    v_mfma_f32_32x32x16_bf16 v[64:79], v[16:19], v[32:35], v[64:79]
    ds_read_b64_tr_b16 v[56:57], v210 offset:57344
    ds_read_b64_tr_b16 v[58:59], v210 offset:59392
    v_mfma_f32_32x32x16_bf16 v[80:95], v[16:19], v[36:39], v[80:95]
    ds_read_b64_tr_b16 v[60:61], v211 offset:57344
    ds_read_b64_tr_b16 v[62:63], v211 offset:59392
    v_mfma_f32_32x32x16_bf16 v[96:111], v[20:23], v[32:35], v[96:111]
    ds_read_b128 v[40:43], v209 offset:32768
    ds_read_b128 v[44:47], v209 offset:36864
    v_mfma_f32_32x32x16_bf16 v[112:127], v[20:23], v[36:39], v[112:127]
    s_waitcnt lgkmcnt(0)
    v_mfma_f32_32x32x16_bf16 v[64:79], v[40:43], v[56:59], v[64:79]
    ds_read_b64_tr_b16 v[32:33], v210 offset:0
    ds_read_b64_tr_b16 v[34:35], v210 offset:2048
    v_mfma_f32_32x32x16_bf16 v[80:95], v[40:43], v[60:63], v[80:95]
    ds_read_b64_tr_b16 v[36:37], v211 offset:0
    ds_read_b64_tr_b16 v[38:39], v211 offset:2048
    v_mfma_f32_32x32x16_bf16 v[96:111], v[44:47], v[56:59], v[96:111]
    ds_read_b128 v[24:27], v206 offset:8192
    ds_read_b128 v[28:31], v206 offset:12288
    v_mfma_f32_32x32x16_bf16 v[112:127], v[44:47], v[60:63], v[112:127]
    s_waitcnt lgkmcnt(0)
    v_mfma_f32_32x32x16_bf16 v[128:143], v[24:27], v[32:35], v[128:143]
    ds_read_b64_tr_b16 v[56:57], v210 offset:8192
    ds_read_b64_tr_b16 v[58:59], v210 offset:10240
    ds_read_b64_tr_b16 v[60:61], v211 offset:8192
    ds_read_b64_tr_b16 v[62:63], v211 offset:10240
    ds_read_b128 v[48:51], v207 offset:8192
    ds_read_b128 v[52:55], v207 offset:12288
    v_cvt_pk_bf16_f32 v192, v64, v65
    v_cvt_pk_bf16_f32 v193, v66, v67
    v_mfma_f32_32x32x16_bf16 v[144:159], v[24:27], v[36:39], v[144:159]
    v_cvt_pk_bf16_f32 v194, v68, v69
    v_cvt_pk_bf16_f32 v195, v70, v71
    s_add_u32 s55, s53, 0
    buffer_store_dwordx4 v[192:195], v212, s[36:39], s55 offen sc1
    v_cvt_pk_bf16_f32 v196, v72, v73
    v_cvt_pk_bf16_f32 v197, v74, v75
    v_cvt_pk_bf16_f32 v198, v76, v77
    v_cvt_pk_bf16_f32 v199, v78, v79
    v_mfma_f32_32x32x16_bf16 v[160:175], v[28:31], v[32:35], v[160:175]
    s_add_u32 s55, s53, 4096
    buffer_store_dwordx4 v[196:199], v212, s[36:39], s55 offen sc1
    v_cvt_pk_bf16_f32 v252, v80, v81
    v_cvt_pk_bf16_f32 v253, v82, v83
    v_cvt_pk_bf16_f32 v254, v84, v85
    v_cvt_pk_bf16_f32 v255, v86, v87
    s_add_u32 s55, s53, 1024
    buffer_store_dwordx4 v[252:255], v212, s[36:39], s55 offen sc1
    v_mfma_f32_32x32x16_bf16 v[176:191], v[28:31], v[36:39], v[176:191]
    v_cvt_pk_bf16_f32 v192, v88, v89
    v_cvt_pk_bf16_f32 v193, v90, v91
    v_cvt_pk_bf16_f32 v194, v92, v93
    v_cvt_pk_bf16_f32 v195, v94, v95
    s_add_u32 s55, s53, 5120
    buffer_store_dwordx4 v[192:195], v212, s[36:39], s55 offen sc1
    s_waitcnt lgkmcnt(0)
    v_mfma_f32_32x32x16_bf16 v[128:143], v[48:51], v[56:59], v[128:143]
    ds_read_b64_tr_b16 v[32:33], v210 offset:16384
    ds_read_b64_tr_b16 v[34:35], v210 offset:18432
    ds_read_b64_tr_b16 v[36:37], v211 offset:16384
    ds_read_b64_tr_b16 v[38:39], v211 offset:18432
    ds_read_b128 v[24:27], v208 offset:8192
    ds_read_b128 v[28:31], v208 offset:12288
    v_cvt_pk_bf16_f32 v196, v96, v97
    v_cvt_pk_bf16_f32 v197, v98, v99
    v_mfma_f32_32x32x16_bf16 v[144:159], v[48:51], v[60:63], v[144:159]
    v_cvt_pk_bf16_f32 v198, v100, v101
    v_cvt_pk_bf16_f32 v199, v102, v103
    s_add_u32 s55, s53, 8192
    buffer_store_dwordx4 v[196:199], v212, s[36:39], s55 offen sc1
    v_cvt_pk_bf16_f32 v252, v104, v105
    v_cvt_pk_bf16_f32 v253, v106, v107
    v_cvt_pk_bf16_f32 v254, v108, v109
    v_cvt_pk_bf16_f32 v255, v110, v111
    v_mfma_f32_32x32x16_bf16 v[160:175], v[52:55], v[56:59], v[160:175]
    s_add_u32 s55, s53, 12288
    buffer_store_dwordx4 v[252:255], v212, s[36:39], s55 offen sc1
    v_cvt_pk_bf16_f32 v192, v112, v113
    v_cvt_pk_bf16_f32 v193, v114, v115
    v_cvt_pk_bf16_f32 v194, v116, v117
    v_cvt_pk_bf16_f32 v195, v118, v119
    s_add_u32 s55, s53, 9216
    buffer_store_dwordx4 v[192:195], v212, s[36:39], s55 offen sc1
    v_mfma_f32_32x32x16_bf16 v[176:191], v[52:55], v[60:63], v[176:191]
    v_cvt_pk_bf16_f32 v196, v120, v121
    v_cvt_pk_bf16_f32 v197, v122, v123
    v_cvt_pk_bf16_f32 v198, v124, v125
    v_cvt_pk_bf16_f32 v199, v126, v127
    s_add_u32 s55, s53, 13312
    buffer_store_dwordx4 v[196:199], v212, s[36:39], s55 offen sc1
    s_waitcnt lgkmcnt(0)
    v_mfma_f32_32x32x16_bf16 v[128:143], v[24:27], v[32:35], v[128:143]
    ds_read_b64_tr_b16 v[56:57], v210 offset:24576
    ds_read_b64_tr_b16 v[58:59], v210 offset:26624
    v_mfma_f32_32x32x16_bf16 v[144:159], v[24:27], v[36:39], v[144:159]
    ds_read_b64_tr_b16 v[60:61], v211 offset:24576
    ds_read_b64_tr_b16 v[62:63], v211 offset:26624
    v_mfma_f32_32x32x16_bf16 v[160:175], v[28:31], v[32:35], v[160:175]
    ds_read_b128 v[48:51], v209 offset:8192
    ds_read_b128 v[52:55], v209 offset:12288
    v_mfma_f32_32x32x16_bf16 v[176:191], v[28:31], v[36:39], v[176:191]
    s_waitcnt lgkmcnt(0)
    v_mfma_f32_32x32x16_bf16 v[128:143], v[48:51], v[56:59], v[128:143]
    ds_read_b64_tr_b16 v[32:33], v210 offset:32768
    ds_read_b64_tr_b16 v[34:35], v210 offset:34816
    v_mfma_f32_32x32x16_bf16 v[144:159], v[48:51], v[60:63], v[144:159]
    ds_read_b64_tr_b16 v[36:37], v211 offset:32768
    ds_read_b64_tr_b16 v[38:39], v211 offset:34816
    v_mfma_f32_32x32x16_bf16 v[160:175], v[52:55], v[56:59], v[160:175]
    ds_read_b128 v[24:27], v206 offset:40960
    ds_read_b128 v[28:31], v206 offset:45056
    v_mfma_f32_32x32x16_bf16 v[176:191], v[52:55], v[60:63], v[176:191]
    s_waitcnt lgkmcnt(0)
    v_mfma_f32_32x32x16_bf16 v[128:143], v[24:27], v[32:35], v[128:143]
    ds_read_b64_tr_b16 v[56:57], v210 offset:40960
    ds_read_b64_tr_b16 v[58:59], v210 offset:43008
    v_mfma_f32_32x32x16_bf16 v[144:159], v[24:27], v[36:39], v[144:159]
    ds_read_b64_tr_b16 v[60:61], v211 offset:40960
    ds_read_b64_tr_b16 v[62:63], v211 offset:43008
    v_mfma_f32_32x32x16_bf16 v[160:175], v[28:31], v[32:35], v[160:175]
    ds_read_b128 v[48:51], v207 offset:40960
    ds_read_b128 v[52:55], v207 offset:45056
    v_mfma_f32_32x32x16_bf16 v[176:191], v[28:31], v[36:39], v[176:191]
    s_waitcnt lgkmcnt(0)
    v_mfma_f32_32x32x16_bf16 v[128:143], v[48:51], v[56:59], v[128:143]
    ds_read_b64_tr_b16 v[32:33], v210 offset:49152
    ds_read_b64_tr_b16 v[34:35], v210 offset:51200
    v_mfma_f32_32x32x16_bf16 v[144:159], v[48:51], v[60:63], v[144:159]
    ds_read_b64_tr_b16 v[36:37], v211 offset:49152
    ds_read_b64_tr_b16 v[38:39], v211 offset:51200
    v_mfma_f32_32x32x16_bf16 v[160:175], v[52:55], v[56:59], v[160:175]
    ds_read_b128 v[24:27], v208 offset:40960
    ds_read_b128 v[28:31], v208 offset:45056
    v_mfma_f32_32x32x16_bf16 v[176:191], v[52:55], v[60:63], v[176:191]
    s_waitcnt lgkmcnt(0)
    v_mfma_f32_32x32x16_bf16 v[128:143], v[24:27], v[32:35], v[128:143]
    ds_read_b64_tr_b16 v[56:57], v210 offset:57344
    ds_read_b64_tr_b16 v[58:59], v210 offset:59392
    v_mfma_f32_32x32x16_bf16 v[144:159], v[24:27], v[36:39], v[144:159]
    ds_read_b64_tr_b16 v[60:61], v211 offset:57344
    ds_read_b64_tr_b16 v[62:63], v211 offset:59392
    v_mfma_f32_32x32x16_bf16 v[160:175], v[28:31], v[32:35], v[160:175]
    ds_read_b128 v[48:51], v209 offset:40960
    ds_read_b128 v[52:55], v209 offset:45056
    v_mfma_f32_32x32x16_bf16 v[176:191], v[28:31], v[36:39], v[176:191]
    s_waitcnt lgkmcnt(0)
    v_mfma_f32_32x32x16_bf16 v[128:143], v[48:51], v[56:59], v[128:143]
    v_mfma_f32_32x32x16_bf16 v[144:159], v[48:51], v[60:63], v[144:159]
    v_mfma_f32_32x32x16_bf16 v[160:175], v[52:55], v[56:59], v[160:175]
    v_mfma_f32_32x32x16_bf16 v[176:191], v[52:55], v[60:63], v[176:191]
    s_nop 7
    s_nop 7
    v_cvt_pk_bf16_f32 v16, v128, v129
    v_cvt_pk_bf16_f32 v17, v130, v131
    v_cvt_pk_bf16_f32 v18, v132, v133
    v_cvt_pk_bf16_f32 v19, v134, v135
    s_add_u32 s55, s53, 16384
    buffer_store_dwordx4 v[16:19], v212, s[36:39], s55 offen sc1
    v_cvt_pk_bf16_f32 v20, v136, v137
    v_cvt_pk_bf16_f32 v21, v138, v139
    v_cvt_pk_bf16_f32 v22, v140, v141
    v_cvt_pk_bf16_f32 v23, v142, v143
    s_add_u32 s55, s53, 20480
    buffer_store_dwordx4 v[20:23], v212, s[36:39], s55 offen sc1
    v_cvt_pk_bf16_f32 v24, v144, v145
    v_cvt_pk_bf16_f32 v25, v146, v147
    v_cvt_pk_bf16_f32 v26, v148, v149
    v_cvt_pk_bf16_f32 v27, v150, v151
    s_add_u32 s55, s53, 17408
    buffer_store_dwordx4 v[24:27], v212, s[36:39], s55 offen sc1
    v_cvt_pk_bf16_f32 v28, v152, v153
    v_cvt_pk_bf16_f32 v29, v154, v155
    v_cvt_pk_bf16_f32 v30, v156, v157
    v_cvt_pk_bf16_f32 v31, v158, v159
    s_add_u32 s55, s53, 21504
    buffer_store_dwordx4 v[28:31], v212, s[36:39], s55 offen sc1
    v_cvt_pk_bf16_f32 v32, v160, v161
    v_cvt_pk_bf16_f32 v33, v162, v163
    v_cvt_pk_bf16_f32 v34, v164, v165
    v_cvt_pk_bf16_f32 v35, v166, v167
    s_add_u32 s55, s53, 24576
    buffer_store_dwordx4 v[32:35], v212, s[36:39], s55 offen sc1
    v_cvt_pk_bf16_f32 v36, v168, v169
    v_cvt_pk_bf16_f32 v37, v170, v171
    v_cvt_pk_bf16_f32 v38, v172, v173
    v_cvt_pk_bf16_f32 v39, v174, v175
    s_add_u32 s55, s53, 28672
    buffer_store_dwordx4 v[36:39], v212, s[36:39], s55 offen sc1
    v_cvt_pk_bf16_f32 v40, v176, v177
    v_cvt_pk_bf16_f32 v41, v178, v179
    v_cvt_pk_bf16_f32 v42, v180, v181
    v_cvt_pk_bf16_f32 v43, v182, v183
    s_add_u32 s55, s53, 25600
    buffer_store_dwordx4 v[40:43], v212, s[36:39], s55 offen sc1
    v_cvt_pk_bf16_f32 v44, v184, v185
    v_cvt_pk_bf16_f32 v45, v186, v187
    v_cvt_pk_bf16_f32 v46, v188, v189
    v_cvt_pk_bf16_f32 v47, v190, v191
    s_add_u32 s55, s53, 29696
    buffer_store_dwordx4 v[44:47], v212, s[36:39], s55 offen sc1
    s_endpgm
K1_END:
    s_endpgm
k1_kernel_end:
.globl k2_kernel
.p2align 8
.type k2_kernel,@function
k2_kernel:
    s_cmp_ge_u32 s2, 256
    s_cbranch_scc1 K2_END
    s_load_dwordx2 s[4:5], s[0:1], 16
    s_load_dwordx2 s[6:7], s[0:1], 104
    s_load_dwordx2 s[8:9], s[0:1], 40
    s_load_dwordx2 s[10:11], s[0:1], 56
    s_load_dwordx2 s[12:13], s[0:1], 72
    v_and_b32 v248, 63, v0
    v_lshrrev_b32 v249, 6, v0
    s_nop 0
    v_readfirstlane_b32 s14, v249
    s_and_b32 s15, s2, 7
    s_lshl_b32 s15, s15, 2
    s_bfe_u32 s16, s2, 0x20003
    s_add_u32 s15, s15, s16
    s_lshr_b32 s16, s2, 5
    s_sub_u32 s17, 15, s16
    s_lshl_b32 s18, s17, 1
    s_add_u32 s18, s18, 2
    s_cmp_ge_u32 s14, 4
    s_cselect_b32 s19, s16, s17
    s_cselect_b32 s60, 1, 0
    s_lshl_b32 s61, s19, 1
    s_add_u32 s61, s61, 2
    s_and_b32 s62, s14, 3
    s_lshl_b32 s63, s19, 2
    s_add_u32 s63, s63, s62
    v_lshlrev_b32 v230, 4, v248
    v_lshrrev_b32 v249, 4, v248
    v_lshlrev_b32 v250, 2, v249
    v_and_b32 v251, 15, v248
    v_xor_b32 v250, v250, v251
    s_lshl_b32 s40, s14, 3
    v_add_u32 v249, s40, v249
    v_lshlrev_b32 v249, 13, v249
    v_lshl_add_u32 v249, v250, 4, v249
    s_lshl_b32 s40, s15, 8
    v_add_u32 v240, s40, v249
    v_add_u32 v241, 31744, v240
    s_lshl_b32 s41, s14, 11
    s_mul_i32 s42, s63, 40960
    s_lshl_b32 s43, s15, 19
    s_add_u32 s44, s43, s41
    s_lshl_b32 s45, s62, 12
    s_add_u32 s46, s43, s45
    s_waitcnt lgkmcnt(0)
    s_mov_b32 s20, s4
    s_and_b32 s21, s5, 0xffff
    s_mov_b32 s22, 5242880
    s_mov_b32 s23, 0x00020000
    s_mov_b32 s24, s6
    s_and_b32 s25, s7, 0xffff
    s_mov_b32 s26, 2621440
    s_mov_b32 s27, 0x00020000
    s_add_u32 s28, s6, 4194304
    s_addc_u32 s29, s7, 0
    s_and_b32 s29, s29, 0xffff
    s_mov_b32 s30, 16777216
    s_mov_b32 s31, 0x00020000
    s_add_u32 s32, s6, 20971520
    s_addc_u32 s33, s7, 0
    s_and_b32 s33, s33, 0xffff
    s_mov_b32 s34, 16777216
    s_mov_b32 s35, 0x00020000
    s_add_u32 s36, s6, 37748736
    s_addc_u32 s37, s7, 0
    s_and_b32 s37, s37, 0xffff
    s_mov_b32 s38, 16777216
    s_mov_b32 s39, 0x00020000
    s_add_u32 m0, s41, 49152
    s_mov_b32 s47, 0
    buffer_load_dwordx4 v240, s[20:23], s47 offen offset:0 lds
    buffer_load_dwordx4 v241, s[20:23], s47 offen offset:1024 lds
    s_add_u32 s48, s42, 0
    buffer_load_dwordx4 v[0:3], v230, s[24:27], s48 offen
    s_add_u32 s48, s42, 1024
    buffer_load_dwordx4 v[4:7], v230, s[24:27], s48 offen
    s_add_u32 s48, s42, 2048
    buffer_load_dwordx4 v[8:11], v230, s[24:27], s48 offen
    s_add_u32 s48, s42, 3072
    buffer_load_dwordx4 v[12:15], v230, s[24:27], s48 offen
    s_add_u32 m0, s41, 65536
    s_mov_b32 s47, 524288
    buffer_load_dwordx4 v240, s[20:23], s47 offen offset:0 lds
    buffer_load_dwordx4 v241, s[20:23], s47 offen offset:1024 lds
    s_add_u32 s48, s42, 4096
    buffer_load_dwordx4 v[16:19], v230, s[24:27], s48 offen
    s_add_u32 s48, s42, 5120
    buffer_load_dwordx4 v[20:23], v230, s[24:27], s48 offen
    v_bfe_u32 v249, v248, 2, 2
    v_lshrrev_b32 v250, 5, v248
    v_lshl_add_u32 v250, v250, 3, v249
    v_lshlrev_b32 v250, 8, v250
    v_bfe_u32 v251, v248, 4, 1
    v_lshl_add_u32 v250, v251, 5, v250
    v_and_b32 v251, 3, v248
    v_lshl_add_u32 v250, v251, 3, v250
    v_add_u32 v250, 49152, v250
    v_xor_b32 v251, 0, v249
    v_lshl_add_u32 v242, v251, 6, v250
    v_xor_b32 v251, 1, v249
    v_lshl_add_u32 v243, v251, 6, v250
    v_xor_b32 v251, 2, v249
    v_lshl_add_u32 v244, v251, 6, v250
    v_xor_b32 v251, 3, v249
    v_lshl_add_u32 v245, v251, 6, v250
    v_and_b32 v249, 31, v248
    v_lshrrev_b32 v250, 5, v248
    v_lshlrev_b32 v250, 2, v250
    v_sub_u32 v249, v249, v250
    s_lshl_b32 s40, s63, 5
    v_add_u32 v231, s40, v249
    s_waitcnt vmcnt(8) lgkmcnt(0)
    s_barrier
    ds_read_b64_tr_b16 v[176:177], v242 offset:0
    ds_read_b64_tr_b16 v[178:179], v242 offset:1024
    ds_read_b64_tr_b16 v[180:181], v243 offset:0
    ds_read_b64_tr_b16 v[182:183], v243 offset:1024
    ds_read_b64_tr_b16 v[184:185], v244 offset:0
    ds_read_b64_tr_b16 v[186:187], v244 offset:1024
    ds_read_b64_tr_b16 v[188:189], v245 offset:0
    ds_read_b64_tr_b16 v[190:191], v245 offset:1024
    s_add_u32 s48, s42, 6144
    buffer_load_dwordx4 v[24:27], v230, s[24:27], s48 offen
    s_add_u32 s48, s42, 7168
    buffer_load_dwordx4 v[28:31], v230, s[24:27], s48 offen
    s_add_u32 m0, s41, 81920
    s_mov_b32 s47, 1048576
    buffer_load_dwordx4 v240, s[20:23], s47 offen offset:0 lds
    buffer_load_dwordx4 v241, s[20:23], s47 offen offset:1024 lds
    s_add_u32 s48, s42, 8192
    buffer_load_dwordx4 v[32:35], v230, s[24:27], s48 offen
    s_add_u32 s48, s42, 9216
    buffer_load_dwordx4 v[36:39], v230, s[24:27], s48 offen
    s_waitcnt vmcnt(13) lgkmcnt(0)
    v_mfma_f32_32x32x16_bf16 v[96:111], v[176:179], v[0:3], 0
    ds_read_b64_tr_b16 v[192:193], v242 offset:4096
    ds_read_b64_tr_b16 v[194:195], v242 offset:5120
    ds_read_b64_tr_b16 v[196:197], v243 offset:4096
    v_mfma_f32_32x32x16_bf16 v[112:127], v[180:183], v[0:3], 0
    ds_read_b64_tr_b16 v[198:199], v243 offset:5120
    ds_read_b64_tr_b16 v[200:201], v244 offset:4096
    ds_read_b64_tr_b16 v[202:203], v244 offset:5120
    v_mfma_f32_32x32x16_bf16 v[128:143], v[184:187], v[0:3], 0
    ds_read_b64_tr_b16 v[204:205], v245 offset:4096
    ds_read_b64_tr_b16 v[206:207], v245 offset:5120
    s_add_u32 s48, s42, 10240
    buffer_load_dwordx4 v[40:43], v230, s[24:27], s48 offen
    v_mfma_f32_32x32x16_bf16 v[144:159], v[188:191], v[0:3], 0
    s_add_u32 s48, s42, 11264
    buffer_load_dwordx4 v[44:47], v230, s[24:27], s48 offen
    s_add_u32 m0, s41, 98304
    s_mov_b32 s47, 1572864
    buffer_load_dwordx4 v240, s[20:23], s47 offen offset:0 lds
    buffer_load_dwordx4 v241, s[20:23], s47 offen offset:1024 lds
    s_waitcnt vmcnt(16) lgkmcnt(0)
    v_mfma_f32_32x32x16_bf16 v[96:111], v[192:195], v[4:7], v[96:111]
    ds_read_b64_tr_b16 v[176:177], v242 offset:8192
    ds_read_b64_tr_b16 v[178:179], v242 offset:9216
    ds_read_b64_tr_b16 v[180:181], v243 offset:8192
    v_mfma_f32_32x32x16_bf16 v[112:127], v[196:199], v[4:7], v[112:127]
    ds_read_b64_tr_b16 v[182:183], v243 offset:9216
    ds_read_b64_tr_b16 v[184:185], v244 offset:8192
    ds_read_b64_tr_b16 v[186:187], v244 offset:9216
    v_mfma_f32_32x32x16_bf16 v[128:143], v[200:203], v[4:7], v[128:143]
    ds_read_b64_tr_b16 v[188:189], v245 offset:8192
    ds_read_b64_tr_b16 v[190:191], v245 offset:9216
    s_add_u32 s48, s42, 12288
    buffer_load_dwordx4 v[48:51], v230, s[24:27], s48 offen
    v_mfma_f32_32x32x16_bf16 v[144:159], v[204:207], v[4:7], v[144:159]
    s_add_u32 s48, s42, 13312
    buffer_load_dwordx4 v[52:55], v230, s[24:27], s48 offen
    s_add_u32 s48, s42, 16384
    buffer_load_dwordx4 v[0:3], v230, s[24:27], s48 offen
    s_waitcnt vmcnt(18) lgkmcnt(0)
    v_mfma_f32_32x32x16_bf16 v[96:111], v[176:179], v[8:11], v[96:111]
    ds_read_b64_tr_b16 v[192:193], v242 offset:12288
    ds_read_b64_tr_b16 v[194:195], v242 offset:13312
    ds_read_b64_tr_b16 v[196:197], v243 offset:12288
    v_mfma_f32_32x32x16_bf16 v[112:127], v[180:183], v[8:11], v[112:127]
    ds_read_b64_tr_b16 v[198:199], v243 offset:13312
    ds_read_b64_tr_b16 v[200:201], v244 offset:12288
    ds_read_b64_tr_b16 v[202:203], v244 offset:13312
    v_mfma_f32_32x32x16_bf16 v[128:143], v[184:187], v[8:11], v[128:143]
    ds_read_b64_tr_b16 v[204:205], v245 offset:12288
    ds_read_b64_tr_b16 v[206:207], v245 offset:13312
    s_add_u32 s48, s42, 14336
    buffer_load_dwordx4 v[56:59], v230, s[24:27], s48 offen
    v_mfma_f32_32x32x16_bf16 v[144:159], v[188:191], v[8:11], v[144:159]
    s_add_u32 s48, s42, 15360
    buffer_load_dwordx4 v[60:63], v230, s[24:27], s48 offen
    s_add_u32 s48, s42, 17408
    buffer_load_dwordx4 v[4:7], v230, s[24:27], s48 offen
    s_waitcnt vmcnt(18) lgkmcnt(0)
    s_barrier
    v_mfma_f32_32x32x16_bf16 v[96:111], v[192:195], v[12:15], v[96:111]
    ds_read_b64_tr_b16 v[176:177], v242 offset:16384
    ds_read_b64_tr_b16 v[178:179], v242 offset:17408
    ds_read_b64_tr_b16 v[180:181], v243 offset:16384
    v_mfma_f32_32x32x16_bf16 v[112:127], v[196:199], v[12:15], v[112:127]
    ds_read_b64_tr_b16 v[182:183], v243 offset:17408
    ds_read_b64_tr_b16 v[184:185], v244 offset:16384
    ds_read_b64_tr_b16 v[186:187], v244 offset:17408
    v_mfma_f32_32x32x16_bf16 v[128:143], v[200:203], v[12:15], v[128:143]
    ds_read_b64_tr_b16 v[188:189], v245 offset:16384
    ds_read_b64_tr_b16 v[190:191], v245 offset:17408
    s_add_u32 m0, s41, 49152
    s_mov_b32 s47, 2097152
    buffer_load_dwordx4 v240, s[20:23], s47 offen offset:0 lds
    buffer_load_dwordx4 v241, s[20:23], s47 offen offset:1024 lds
    v_mfma_f32_32x32x16_bf16 v[144:159], v[204:207], v[12:15], v[144:159]
    s_add_u32 s48, s42, 18432
    buffer_load_dwordx4 v[8:11], v230, s[24:27], s48 offen
    s_waitcnt vmcnt(20) lgkmcnt(0)
    v_mfma_f32_32x32x16_bf16 v[96:111], v[176:179], v[16:19], v[96:111]
    ds_read_b64_tr_b16 v[192:193], v242 offset:20480
    ds_read_b64_tr_b16 v[194:195], v242 offset:21504
    ds_read_b64_tr_b16 v[196:197], v243 offset:20480
    v_mfma_f32_32x32x16_bf16 v[112:127], v[180:183], v[16:19], v[112:127]
    ds_read_b64_tr_b16 v[198:199], v243 offset:21504
    ds_read_b64_tr_b16 v[200:201], v244 offset:20480
    ds_read_b64_tr_b16 v[202:203], v244 offset:21504
    v_mfma_f32_32x32x16_bf16 v[128:143], v[184:187], v[16:19], v[128:143]
    ds_read_b64_tr_b16 v[204:205], v245 offset:20480
    ds_read_b64_tr_b16 v[206:207], v245 offset:21504
    s_add_u32 s48, s42, 19456
    buffer_load_dwordx4 v[12:15], v230, s[24:27], s48 offen
    v_mfma_f32_32x32x16_bf16 v[144:159], v[188:191], v[16:19], v[144:159]
    s_waitcnt vmcnt(20) lgkmcnt(0)
    v_mfma_f32_32x32x16_bf16 v[96:111], v[192:195], v[20:23], v[96:111]
    ds_read_b64_tr_b16 v[176:177], v242 offset:24576
    ds_read_b64_tr_b16 v[178:179], v242 offset:25600
    ds_read_b64_tr_b16 v[180:181], v243 offset:24576
    v_mfma_f32_32x32x16_bf16 v[112:127], v[196:199], v[20:23], v[112:127]
    ds_read_b64_tr_b16 v[182:183], v243 offset:25600
    ds_read_b64_tr_b16 v[184:185], v244 offset:24576
    ds_read_b64_tr_b16 v[186:187], v244 offset:25600
    v_mfma_f32_32x32x16_bf16 v[128:143], v[200:203], v[20:23], v[128:143]
    ds_read_b64_tr_b16 v[188:189], v245 offset:24576
    ds_read_b64_tr_b16 v[190:191], v245 offset:25600
    s_add_u32 s48, s42, 20480
    buffer_load_dwordx4 v[16:19], v230, s[24:27], s48 offen
    v_mfma_f32_32x32x16_bf16 v[144:159], v[204:207], v[20:23], v[144:159]
    s_waitcnt vmcnt(20) lgkmcnt(0)
    v_mfma_f32_32x32x16_bf16 v[96:111], v[176:179], v[24:27], v[96:111]
    ds_read_b64_tr_b16 v[192:193], v242 offset:28672
    ds_read_b64_tr_b16 v[194:195], v242 offset:29696
    ds_read_b64_tr_b16 v[196:197], v243 offset:28672
    v_mfma_f32_32x32x16_bf16 v[112:127], v[180:183], v[24:27], v[112:127]
    ds_read_b64_tr_b16 v[198:199], v243 offset:29696
    ds_read_b64_tr_b16 v[200:201], v244 offset:28672
    ds_read_b64_tr_b16 v[202:203], v244 offset:29696
    v_mfma_f32_32x32x16_bf16 v[128:143], v[184:187], v[24:27], v[128:143]
    ds_read_b64_tr_b16 v[204:205], v245 offset:28672
    ds_read_b64_tr_b16 v[206:207], v245 offset:29696
    s_add_u32 s48, s42, 21504
    buffer_load_dwordx4 v[20:23], v230, s[24:27], s48 offen
    v_mfma_f32_32x32x16_bf16 v[144:159], v[188:191], v[24:27], v[144:159]
    s_waitcnt vmcnt(18) lgkmcnt(0)
    s_barrier
    v_mfma_f32_32x32x16_bf16 v[96:111], v[192:195], v[28:31], v[96:111]
    ds_read_b64_tr_b16 v[176:177], v242 offset:32768
    ds_read_b64_tr_b16 v[178:179], v242 offset:33792
    ds_read_b64_tr_b16 v[180:181], v243 offset:32768
    v_mfma_f32_32x32x16_bf16 v[112:127], v[196:199], v[28:31], v[112:127]
    ds_read_b64_tr_b16 v[182:183], v243 offset:33792
    ds_read_b64_tr_b16 v[184:185], v244 offset:32768
    ds_read_b64_tr_b16 v[186:187], v244 offset:33792
    v_mfma_f32_32x32x16_bf16 v[128:143], v[200:203], v[28:31], v[128:143]
    ds_read_b64_tr_b16 v[188:189], v245 offset:32768
    ds_read_b64_tr_b16 v[190:191], v245 offset:33792
    s_add_u32 m0, s41, 65536
    s_mov_b32 s47, 2621440
    buffer_load_dwordx4 v240, s[20:23], s47 offen offset:0 lds
    buffer_load_dwordx4 v241, s[20:23], s47 offen offset:1024 lds
    v_mfma_f32_32x32x16_bf16 v[144:159], v[204:207], v[28:31], v[144:159]
    s_add_u32 s48, s42, 22528
    buffer_load_dwordx4 v[24:27], v230, s[24:27], s48 offen
    s_waitcnt vmcnt(20) lgkmcnt(0)
    v_mfma_f32_32x32x16_bf16 v[96:111], v[176:179], v[32:35], v[96:111]
    ds_read_b64_tr_b16 v[192:193], v242 offset:36864
    ds_read_b64_tr_b16 v[194:195], v242 offset:37888
    ds_read_b64_tr_b16 v[196:197], v243 offset:36864
    v_mfma_f32_32x32x16_bf16 v[112:127], v[180:183], v[32:35], v[112:127]
    ds_read_b64_tr_b16 v[198:199], v243 offset:37888
    ds_read_b64_tr_b16 v[200:201], v244 offset:36864
    ds_read_b64_tr_b16 v[202:203], v244 offset:37888
    v_mfma_f32_32x32x16_bf16 v[128:143], v[184:187], v[32:35], v[128:143]
    ds_read_b64_tr_b16 v[204:205], v245 offset:36864
    ds_read_b64_tr_b16 v[206:207], v245 offset:37888
    s_add_u32 s48, s42, 23552
    buffer_load_dwordx4 v[28:31], v230, s[24:27], s48 offen
    v_mfma_f32_32x32x16_bf16 v[144:159], v[188:191], v[32:35], v[144:159]
    s_waitcnt vmcnt(20) lgkmcnt(0)
    v_mfma_f32_32x32x16_bf16 v[96:111], v[192:195], v[36:39], v[96:111]
    ds_read_b64_tr_b16 v[176:177], v242 offset:40960
    ds_read_b64_tr_b16 v[178:179], v242 offset:41984
    ds_read_b64_tr_b16 v[180:181], v243 offset:40960
    v_mfma_f32_32x32x16_bf16 v[112:127], v[196:199], v[36:39], v[112:127]
    ds_read_b64_tr_b16 v[182:183], v243 offset:41984
    ds_read_b64_tr_b16 v[184:185], v244 offset:40960
    ds_read_b64_tr_b16 v[186:187], v244 offset:41984
    v_mfma_f32_32x32x16_bf16 v[128:143], v[200:203], v[36:39], v[128:143]
    ds_read_b64_tr_b16 v[188:189], v245 offset:40960
    ds_read_b64_tr_b16 v[190:191], v245 offset:41984
    s_add_u32 s48, s42, 24576
    buffer_load_dwordx4 v[32:35], v230, s[24:27], s48 offen
    v_mfma_f32_32x32x16_bf16 v[144:159], v[204:207], v[36:39], v[144:159]
    s_waitcnt vmcnt(20) lgkmcnt(0)
    v_mfma_f32_32x32x16_bf16 v[96:111], v[176:179], v[40:43], v[96:111]
    ds_read_b64_tr_b16 v[192:193], v242 offset:45056
    ds_read_b64_tr_b16 v[194:195], v242 offset:46080
    ds_read_b64_tr_b16 v[196:197], v243 offset:45056
    v_mfma_f32_32x32x16_bf16 v[112:127], v[180:183], v[40:43], v[112:127]
    ds_read_b64_tr_b16 v[198:199], v243 offset:46080
    ds_read_b64_tr_b16 v[200:201], v244 offset:45056
    ds_read_b64_tr_b16 v[202:203], v244 offset:46080
    v_mfma_f32_32x32x16_bf16 v[128:143], v[184:187], v[40:43], v[128:143]
    ds_read_b64_tr_b16 v[204:205], v245 offset:45056
    ds_read_b64_tr_b16 v[206:207], v245 offset:46080
    s_add_u32 s48, s42, 25600
    buffer_load_dwordx4 v[36:39], v230, s[24:27], s48 offen
    v_mfma_f32_32x32x16_bf16 v[144:159], v[188:191], v[40:43], v[144:159]
    s_waitcnt vmcnt(18) lgkmcnt(0)
    s_barrier
    v_mfma_f32_32x32x16_bf16 v[96:111], v[192:195], v[44:47], v[96:111]
    ds_read_b64_tr_b16 v[176:177], v242 offset:49152
    ds_read_b64_tr_b16 v[178:179], v242 offset:50176
    ds_read_b64_tr_b16 v[180:181], v243 offset:49152
    v_mfma_f32_32x32x16_bf16 v[112:127], v[196:199], v[44:47], v[112:127]
    ds_read_b64_tr_b16 v[182:183], v243 offset:50176
    ds_read_b64_tr_b16 v[184:185], v244 offset:49152
    ds_read_b64_tr_b16 v[186:187], v244 offset:50176
    v_mfma_f32_32x32x16_bf16 v[128:143], v[200:203], v[44:47], v[128:143]
    ds_read_b64_tr_b16 v[188:189], v245 offset:49152
    ds_read_b64_tr_b16 v[190:191], v245 offset:50176
    s_add_u32 m0, s41, 81920
    s_mov_b32 s47, 3145728
    buffer_load_dwordx4 v240, s[20:23], s47 offen offset:0 lds
    buffer_load_dwordx4 v241, s[20:23], s47 offen offset:1024 lds
    v_mfma_f32_32x32x16_bf16 v[144:159], v[204:207], v[44:47], v[144:159]
    s_add_u32 s48, s42, 26624
    buffer_load_dwordx4 v[40:43], v230, s[24:27], s48 offen
    s_waitcnt vmcnt(20) lgkmcnt(0)
    v_mfma_f32_32x32x16_bf16 v[96:111], v[176:179], v[48:51], v[96:111]
    ds_read_b64_tr_b16 v[192:193], v242 offset:53248
    ds_read_b64_tr_b16 v[194:195], v242 offset:54272
    ds_read_b64_tr_b16 v[196:197], v243 offset:53248
    v_mfma_f32_32x32x16_bf16 v[112:127], v[180:183], v[48:51], v[112:127]
    ds_read_b64_tr_b16 v[198:199], v243 offset:54272
    ds_read_b64_tr_b16 v[200:201], v244 offset:53248
    ds_read_b64_tr_b16 v[202:203], v244 offset:54272
    v_mfma_f32_32x32x16_bf16 v[128:143], v[184:187], v[48:51], v[128:143]
    ds_read_b64_tr_b16 v[204:205], v245 offset:53248
    ds_read_b64_tr_b16 v[206:207], v245 offset:54272
    s_add_u32 s48, s42, 27648
    buffer_load_dwordx4 v[44:47], v230, s[24:27], s48 offen
    v_mfma_f32_32x32x16_bf16 v[144:159], v[188:191], v[48:51], v[144:159]
    s_waitcnt vmcnt(20) lgkmcnt(0)
    v_mfma_f32_32x32x16_bf16 v[96:111], v[192:195], v[52:55], v[96:111]
    ds_read_b64_tr_b16 v[176:177], v242 offset:57344
    ds_read_b64_tr_b16 v[178:179], v242 offset:58368
    ds_read_b64_tr_b16 v[180:181], v243 offset:57344
    v_mfma_f32_32x32x16_bf16 v[112:127], v[196:199], v[52:55], v[112:127]
    ds_read_b64_tr_b16 v[182:183], v243 offset:58368
    ds_read_b64_tr_b16 v[184:185], v244 offset:57344
    ds_read_b64_tr_b16 v[186:187], v244 offset:58368
    v_mfma_f32_32x32x16_bf16 v[128:143], v[200:203], v[52:55], v[128:143]
    ds_read_b64_tr_b16 v[188:189], v245 offset:57344
    ds_read_b64_tr_b16 v[190:191], v245 offset:58368
    s_add_u32 s48, s42, 28672
    buffer_load_dwordx4 v[48:51], v230, s[24:27], s48 offen
    v_mfma_f32_32x32x16_bf16 v[144:159], v[204:207], v[52:55], v[144:159]
    s_waitcnt vmcnt(19) lgkmcnt(0)
    v_mfma_f32_32x32x16_bf16 v[96:111], v[176:179], v[56:59], v[96:111]
    ds_read_b64_tr_b16 v[192:193], v242 offset:61440
    ds_read_b64_tr_b16 v[194:195], v242 offset:62464
    ds_read_b64_tr_b16 v[196:197], v243 offset:61440
    v_mfma_f32_32x32x16_bf16 v[112:127], v[180:183], v[56:59], v[112:127]
    ds_read_b64_tr_b16 v[198:199], v243 offset:62464
    ds_read_b64_tr_b16 v[200:201], v244 offset:61440
    ds_read_b64_tr_b16 v[202:203], v244 offset:62464
    v_mfma_f32_32x32x16_bf16 v[128:143], v[184:187], v[56:59], v[128:143]
    ds_read_b64_tr_b16 v[204:205], v245 offset:61440
    ds_read_b64_tr_b16 v[206:207], v245 offset:62464
    s_add_u32 s48, s42, 29696
    buffer_load_dwordx4 v[52:55], v230, s[24:27], s48 offen
    v_mfma_f32_32x32x16_bf16 v[144:159], v[188:191], v[56:59], v[144:159]
    s_waitcnt vmcnt(16) lgkmcnt(0)
    s_barrier
    v_mfma_f32_32x32x16_bf16 v[96:111], v[192:195], v[60:63], v[96:111]
    ds_read_b64_tr_b16 v[176:177], v242 offset:0
    ds_read_b64_tr_b16 v[178:179], v242 offset:1024
    ds_read_b64_tr_b16 v[180:181], v243 offset:0
    v_mfma_f32_32x32x16_bf16 v[112:127], v[196:199], v[60:63], v[112:127]
    ds_read_b64_tr_b16 v[182:183], v243 offset:1024
    ds_read_b64_tr_b16 v[184:185], v244 offset:0
    ds_read_b64_tr_b16 v[186:187], v244 offset:1024
    v_mfma_f32_32x32x16_bf16 v[128:143], v[200:203], v[60:63], v[128:143]
    ds_read_b64_tr_b16 v[188:189], v245 offset:0
    ds_read_b64_tr_b16 v[190:191], v245 offset:1024
    s_add_u32 m0, s41, 98304
    s_mov_b32 s47, 3670016
    buffer_load_dwordx4 v240, s[20:23], s47 offen offset:0 lds
    buffer_load_dwordx4 v241, s[20:23], s47 offen offset:1024 lds
    v_mfma_f32_32x32x16_bf16 v[144:159], v[204:207], v[60:63], v[144:159]
    s_add_u32 s48, s42, 30720
    buffer_load_dwordx4 v[56:59], v230, s[24:27], s48 offen
    s_waitcnt lgkmcnt(0)
    v_mfma_f32_32x32x16_bf16 v[96:111], v[176:179], v[0:3], v[96:111]
    ds_read_b64_tr_b16 v[192:193], v242 offset:4096
    ds_read_b64_tr_b16 v[194:195], v242 offset:5120
    ds_read_b64_tr_b16 v[196:197], v243 offset:4096
    v_mfma_f32_32x32x16_bf16 v[112:127], v[180:183], v[0:3], v[112:127]
    ds_read_b64_tr_b16 v[198:199], v243 offset:5120
    ds_read_b64_tr_b16 v[200:201], v244 offset:4096
    ds_read_b64_tr_b16 v[202:203], v244 offset:5120
    v_mfma_f32_32x32x16_bf16 v[128:143], v[184:187], v[0:3], v[128:143]
    ds_read_b64_tr_b16 v[204:205], v245 offset:4096
    ds_read_b64_tr_b16 v[206:207], v245 offset:5120
    s_add_u32 s48, s42, 31744
    buffer_load_dwordx4 v[60:63], v230, s[24:27], s48 offen
    v_mfma_f32_32x32x16_bf16 v[144:159], v[188:191], v[0:3], v[144:159]
    s_waitcnt lgkmcnt(0)
    v_mfma_f32_32x32x16_bf16 v[96:111], v[192:195], v[4:7], v[96:111]
    ds_read_b64_tr_b16 v[176:177], v242 offset:8192
    ds_read_b64_tr_b16 v[178:179], v242 offset:9216
    ds_read_b64_tr_b16 v[180:181], v243 offset:8192
    v_mfma_f32_32x32x16_bf16 v[112:127], v[196:199], v[4:7], v[112:127]
    ds_read_b64_tr_b16 v[182:183], v243 offset:9216
    ds_read_b64_tr_b16 v[184:185], v244 offset:8192
    ds_read_b64_tr_b16 v[186:187], v244 offset:9216
    v_mfma_f32_32x32x16_bf16 v[128:143], v[200:203], v[4:7], v[128:143]
    ds_read_b64_tr_b16 v[188:189], v245 offset:8192
    ds_read_b64_tr_b16 v[190:191], v245 offset:9216
    s_add_u32 s48, s42, 32768
    buffer_load_dwordx4 v[0:3], v230, s[24:27], s48 offen
    v_mfma_f32_32x32x16_bf16 v[144:159], v[204:207], v[4:7], v[144:159]
    s_waitcnt vmcnt(20) lgkmcnt(0)
    v_mfma_f32_32x32x16_bf16 v[96:111], v[176:179], v[8:11], v[96:111]
    ds_read_b64_tr_b16 v[192:193], v242 offset:12288
    ds_read_b64_tr_b16 v[194:195], v242 offset:13312
    ds_read_b64_tr_b16 v[196:197], v243 offset:12288
    v_mfma_f32_32x32x16_bf16 v[112:127], v[180:183], v[8:11], v[112:127]
    ds_read_b64_tr_b16 v[198:199], v243 offset:13312
    ds_read_b64_tr_b16 v[200:201], v244 offset:12288
    ds_read_b64_tr_b16 v[202:203], v244 offset:13312
    v_mfma_f32_32x32x16_bf16 v[128:143], v[184:187], v[8:11], v[128:143]
    ds_read_b64_tr_b16 v[204:205], v245 offset:12288
    ds_read_b64_tr_b16 v[206:207], v245 offset:13312
    s_add_u32 s48, s42, 33792
    buffer_load_dwordx4 v[4:7], v230, s[24:27], s48 offen
    v_mfma_f32_32x32x16_bf16 v[144:159], v[188:191], v[8:11], v[144:159]
    s_waitcnt vmcnt(16) lgkmcnt(0)
    s_barrier
    v_mfma_f32_32x32x16_bf16 v[96:111], v[192:195], v[12:15], v[96:111]
    ds_read_b64_tr_b16 v[176:177], v242 offset:16384
    ds_read_b64_tr_b16 v[178:179], v242 offset:17408
    ds_read_b64_tr_b16 v[180:181], v243 offset:16384
    v_mfma_f32_32x32x16_bf16 v[112:127], v[196:199], v[12:15], v[112:127]
    ds_read_b64_tr_b16 v[182:183], v243 offset:17408
    ds_read_b64_tr_b16 v[184:185], v244 offset:16384
    ds_read_b64_tr_b16 v[186:187], v244 offset:17408
    v_mfma_f32_32x32x16_bf16 v[128:143], v[200:203], v[12:15], v[128:143]
    ds_read_b64_tr_b16 v[188:189], v245 offset:16384
    ds_read_b64_tr_b16 v[190:191], v245 offset:17408
    s_add_u32 m0, s41, 49152
    s_mov_b32 s47, 4194304
    buffer_load_dwordx4 v240, s[20:23], s47 offen offset:0 lds
    buffer_load_dwordx4 v241, s[20:23], s47 offen offset:1024 lds
    v_mfma_f32_32x32x16_bf16 v[144:159], v[204:207], v[12:15], v[144:159]
    s_add_u32 s48, s42, 34816
    buffer_load_dwordx4 v[8:11], v230, s[24:27], s48 offen
    s_waitcnt lgkmcnt(0)
    v_mfma_f32_32x32x16_bf16 v[96:111], v[176:179], v[16:19], v[96:111]
    ds_read_b64_tr_b16 v[192:193], v242 offset:20480
    ds_read_b64_tr_b16 v[194:195], v242 offset:21504
    ds_read_b64_tr_b16 v[196:197], v243 offset:20480
    v_mfma_f32_32x32x16_bf16 v[112:127], v[180:183], v[16:19], v[112:127]
    ds_read_b64_tr_b16 v[198:199], v243 offset:21504
    ds_read_b64_tr_b16 v[200:201], v244 offset:20480
    ds_read_b64_tr_b16 v[202:203], v244 offset:21504
    v_mfma_f32_32x32x16_bf16 v[128:143], v[184:187], v[16:19], v[128:143]
    ds_read_b64_tr_b16 v[204:205], v245 offset:20480
    ds_read_b64_tr_b16 v[206:207], v245 offset:21504
    s_add_u32 s48, s42, 35840
    buffer_load_dwordx4 v[12:15], v230, s[24:27], s48 offen
    v_mfma_f32_32x32x16_bf16 v[144:159], v[188:191], v[16:19], v[144:159]
    s_waitcnt lgkmcnt(0)
    v_mfma_f32_32x32x16_bf16 v[96:111], v[192:195], v[20:23], v[96:111]
    ds_read_b64_tr_b16 v[176:177], v242 offset:24576
    ds_read_b64_tr_b16 v[178:179], v242 offset:25600
    ds_read_b64_tr_b16 v[180:181], v243 offset:24576
    v_mfma_f32_32x32x16_bf16 v[112:127], v[196:199], v[20:23], v[112:127]
    ds_read_b64_tr_b16 v[182:183], v243 offset:25600
    ds_read_b64_tr_b16 v[184:185], v244 offset:24576
    ds_read_b64_tr_b16 v[186:187], v244 offset:25600
    v_mfma_f32_32x32x16_bf16 v[128:143], v[200:203], v[20:23], v[128:143]
    ds_read_b64_tr_b16 v[188:189], v245 offset:24576
    ds_read_b64_tr_b16 v[190:191], v245 offset:25600
    s_add_u32 s48, s42, 36864
    buffer_load_dwordx4 v[16:19], v230, s[24:27], s48 offen
    v_mfma_f32_32x32x16_bf16 v[144:159], v[204:207], v[20:23], v[144:159]
    s_waitcnt vmcnt(20) lgkmcnt(0)
    v_mfma_f32_32x32x16_bf16 v[96:111], v[176:179], v[24:27], v[96:111]
    ds_read_b64_tr_b16 v[192:193], v242 offset:28672
    ds_read_b64_tr_b16 v[194:195], v242 offset:29696
    ds_read_b64_tr_b16 v[196:197], v243 offset:28672
    v_mfma_f32_32x32x16_bf16 v[112:127], v[180:183], v[24:27], v[112:127]
    ds_read_b64_tr_b16 v[198:199], v243 offset:29696
    ds_read_b64_tr_b16 v[200:201], v244 offset:28672
    ds_read_b64_tr_b16 v[202:203], v244 offset:29696
    v_mfma_f32_32x32x16_bf16 v[128:143], v[184:187], v[24:27], v[128:143]
    ds_read_b64_tr_b16 v[204:205], v245 offset:28672
    ds_read_b64_tr_b16 v[206:207], v245 offset:29696
    s_add_u32 s48, s42, 37888
    buffer_load_dwordx4 v[20:23], v230, s[24:27], s48 offen
    v_mfma_f32_32x32x16_bf16 v[144:159], v[188:191], v[24:27], v[144:159]
    s_waitcnt vmcnt(16) lgkmcnt(0)
    s_barrier
    v_mfma_f32_32x32x16_bf16 v[96:111], v[192:195], v[28:31], v[96:111]
    ds_read_b64_tr_b16 v[176:177], v242 offset:32768
    ds_read_b64_tr_b16 v[178:179], v242 offset:33792
    ds_read_b64_tr_b16 v[180:181], v243 offset:32768
    v_mfma_f32_32x32x16_bf16 v[112:127], v[196:199], v[28:31], v[112:127]
    ds_read_b64_tr_b16 v[182:183], v243 offset:33792
    ds_read_b64_tr_b16 v[184:185], v244 offset:32768
    ds_read_b64_tr_b16 v[186:187], v244 offset:33792
    v_mfma_f32_32x32x16_bf16 v[128:143], v[200:203], v[28:31], v[128:143]
    ds_read_b64_tr_b16 v[188:189], v245 offset:32768
    ds_read_b64_tr_b16 v[190:191], v245 offset:33792
    s_add_u32 m0, s41, 65536
    s_mov_b32 s47, 4718592
    buffer_load_dwordx4 v240, s[20:23], s47 offen offset:0 lds
    buffer_load_dwordx4 v241, s[20:23], s47 offen offset:1024 lds
    v_mfma_f32_32x32x16_bf16 v[144:159], v[204:207], v[28:31], v[144:159]
    s_add_u32 s48, s42, 38912
    buffer_load_dwordx4 v[24:27], v230, s[24:27], s48 offen
    s_add_u32 m0, s41, 0
    s_add_u32 s47, s44, 0
    buffer_load_dwordx4 v230, s[28:31], s47 offen offset:0 lds
    buffer_load_dwordx4 v230, s[28:31], s47 offen offset:1024 lds
    s_waitcnt lgkmcnt(0)
    v_mfma_f32_32x32x16_bf16 v[96:111], v[176:179], v[32:35], v[96:111]
    ds_read_b64_tr_b16 v[192:193], v242 offset:36864
    ds_read_b64_tr_b16 v[194:195], v242 offset:37888
    ds_read_b64_tr_b16 v[196:197], v243 offset:36864
    v_mfma_f32_32x32x16_bf16 v[112:127], v[180:183], v[32:35], v[112:127]
    ds_read_b64_tr_b16 v[198:199], v243 offset:37888
    ds_read_b64_tr_b16 v[200:201], v244 offset:36864
    ds_read_b64_tr_b16 v[202:203], v244 offset:37888
    v_mfma_f32_32x32x16_bf16 v[128:143], v[184:187], v[32:35], v[128:143]
    ds_read_b64_tr_b16 v[204:205], v245 offset:36864
    ds_read_b64_tr_b16 v[206:207], v245 offset:37888
    s_add_u32 s48, s42, 39936
    buffer_load_dwordx4 v[28:31], v230, s[24:27], s48 offen
    v_mfma_f32_32x32x16_bf16 v[144:159], v[188:191], v[32:35], v[144:159]
    s_waitcnt lgkmcnt(0)
    v_mfma_f32_32x32x16_bf16 v[96:111], v[192:195], v[36:39], v[96:111]
    ds_read_b64_tr_b16 v[176:177], v242 offset:40960
    ds_read_b64_tr_b16 v[178:179], v242 offset:41984
    ds_read_b64_tr_b16 v[180:181], v243 offset:40960
    v_mfma_f32_32x32x16_bf16 v[112:127], v[196:199], v[36:39], v[112:127]
    ds_read_b64_tr_b16 v[182:183], v243 offset:41984
    ds_read_b64_tr_b16 v[184:185], v244 offset:40960
    ds_read_b64_tr_b16 v[186:187], v244 offset:41984
    v_mfma_f32_32x32x16_bf16 v[128:143], v[200:203], v[36:39], v[128:143]
    ds_read_b64_tr_b16 v[188:189], v245 offset:40960
    ds_read_b64_tr_b16 v[190:191], v245 offset:41984
    s_add_u32 m0, s41, 16384
    s_add_u32 s47, s44, 16384
    buffer_load_dwordx4 v230, s[28:31], s47 offen offset:0 lds
    buffer_load_dwordx4 v230, s[28:31], s47 offen offset:1024 lds
    v_mfma_f32_32x32x16_bf16 v[144:159], v[204:207], v[36:39], v[144:159]
    s_waitcnt vmcnt(23) lgkmcnt(0)
    v_mfma_f32_32x32x16_bf16 v[96:111], v[176:179], v[40:43], v[96:111]
    ds_read_b64_tr_b16 v[192:193], v242 offset:45056
    ds_read_b64_tr_b16 v[194:195], v242 offset:46080
    ds_read_b64_tr_b16 v[196:197], v243 offset:45056
    v_mfma_f32_32x32x16_bf16 v[112:127], v[180:183], v[40:43], v[112:127]
    ds_read_b64_tr_b16 v[198:199], v243 offset:46080
    ds_read_b64_tr_b16 v[200:201], v244 offset:45056
    ds_read_b64_tr_b16 v[202:203], v244 offset:46080
    v_mfma_f32_32x32x16_bf16 v[128:143], v[184:187], v[40:43], v[128:143]
    ds_read_b64_tr_b16 v[204:205], v245 offset:45056
    ds_read_b64_tr_b16 v[206:207], v245 offset:46080
    v_mfma_f32_32x32x16_bf16 v[144:159], v[188:191], v[40:43], v[144:159]
    s_waitcnt vmcnt(18) lgkmcnt(0)
    s_barrier
    v_mfma_f32_32x32x16_bf16 v[96:111], v[192:195], v[44:47], v[96:111]
    ds_read_b64_tr_b16 v[176:177], v242 offset:49152
    ds_read_b64_tr_b16 v[178:179], v242 offset:50176
    ds_read_b64_tr_b16 v[180:181], v243 offset:49152
    v_mfma_f32_32x32x16_bf16 v[112:127], v[196:199], v[44:47], v[112:127]
    ds_read_b64_tr_b16 v[182:183], v243 offset:50176
    ds_read_b64_tr_b16 v[184:185], v244 offset:49152
    ds_read_b64_tr_b16 v[186:187], v244 offset:50176
    v_mfma_f32_32x32x16_bf16 v[128:143], v[200:203], v[44:47], v[128:143]
    ds_read_b64_tr_b16 v[188:189], v245 offset:49152
    ds_read_b64_tr_b16 v[190:191], v245 offset:50176
    s_add_u32 m0, s41, 131072
    s_add_u32 s47, s44, 0
    buffer_load_dwordx4 v230, s[32:35], s47 offen offset:0 lds
    buffer_load_dwordx4 v230, s[32:35], s47 offen offset:1024 lds
    v_mfma_f32_32x32x16_bf16 v[144:159], v[204:207], v[44:47], v[144:159]
    s_waitcnt lgkmcnt(0)
    v_mfma_f32_32x32x16_bf16 v[96:111], v[176:179], v[48:51], v[96:111]
    ds_read_b64_tr_b16 v[192:193], v242 offset:53248
    ds_read_b64_tr_b16 v[194:195], v242 offset:54272
    ds_read_b64_tr_b16 v[196:197], v243 offset:53248
    v_mfma_f32_32x32x16_bf16 v[112:127], v[180:183], v[48:51], v[112:127]
    ds_read_b64_tr_b16 v[198:199], v243 offset:54272
    ds_read_b64_tr_b16 v[200:201], v244 offset:53248
    ds_read_b64_tr_b16 v[202:203], v244 offset:54272
    v_mfma_f32_32x32x16_bf16 v[128:143], v[184:187], v[48:51], v[128:143]
    ds_read_b64_tr_b16 v[204:205], v245 offset:53248
    ds_read_b64_tr_b16 v[206:207], v245 offset:54272
    v_mfma_f32_32x32x16_bf16 v[144:159], v[188:191], v[48:51], v[144:159]
    s_waitcnt lgkmcnt(0)
    v_mfma_f32_32x32x16_bf16 v[96:111], v[192:195], v[52:55], v[96:111]
    ds_read_b64_tr_b16 v[176:177], v242 offset:57344
    ds_read_b64_tr_b16 v[178:179], v242 offset:58368
    ds_read_b64_tr_b16 v[180:181], v243 offset:57344
    v_mfma_f32_32x32x16_bf16 v[112:127], v[196:199], v[52:55], v[112:127]
    ds_read_b64_tr_b16 v[182:183], v243 offset:58368
    ds_read_b64_tr_b16 v[184:185], v244 offset:57344
    ds_read_b64_tr_b16 v[186:187], v244 offset:58368
    v_mfma_f32_32x32x16_bf16 v[128:143], v[200:203], v[52:55], v[128:143]
    ds_read_b64_tr_b16 v[188:189], v245 offset:57344
    ds_read_b64_tr_b16 v[190:191], v245 offset:58368
    s_add_u32 m0, s41, 32768
    s_add_u32 s47, s44, 32768
    buffer_load_dwordx4 v230, s[28:31], s47 offen offset:0 lds
    buffer_load_dwordx4 v230, s[28:31], s47 offen offset:1024 lds
    v_mfma_f32_32x32x16_bf16 v[144:159], v[204:207], v[52:55], v[144:159]
    s_waitcnt vmcnt(21) lgkmcnt(0)
    v_mfma_f32_32x32x16_bf16 v[96:111], v[176:179], v[56:59], v[96:111]
    ds_read_b64_tr_b16 v[192:193], v242 offset:61440
    ds_read_b64_tr_b16 v[194:195], v242 offset:62464
    ds_read_b64_tr_b16 v[196:197], v243 offset:61440
    v_mfma_f32_32x32x16_bf16 v[112:127], v[180:183], v[56:59], v[112:127]
    ds_read_b64_tr_b16 v[198:199], v243 offset:62464
    ds_read_b64_tr_b16 v[200:201], v244 offset:61440
    ds_read_b64_tr_b16 v[202:203], v244 offset:62464
    v_mfma_f32_32x32x16_bf16 v[128:143], v[184:187], v[56:59], v[128:143]
    ds_read_b64_tr_b16 v[204:205], v245 offset:61440
    ds_read_b64_tr_b16 v[206:207], v245 offset:62464
    v_mfma_f32_32x32x16_bf16 v[144:159], v[188:191], v[56:59], v[144:159]
    s_waitcnt vmcnt(16) lgkmcnt(0)
    s_barrier
    v_mfma_f32_32x32x16_bf16 v[96:111], v[192:195], v[60:63], v[96:111]
    ds_read_b64_tr_b16 v[176:177], v242 offset:0
    ds_read_b64_tr_b16 v[178:179], v242 offset:1024
    ds_read_b64_tr_b16 v[180:181], v243 offset:0
    v_mfma_f32_32x32x16_bf16 v[112:127], v[196:199], v[60:63], v[112:127]
    ds_read_b64_tr_b16 v[182:183], v243 offset:1024
    ds_read_b64_tr_b16 v[184:185], v244 offset:0
    ds_read_b64_tr_b16 v[186:187], v244 offset:1024
    v_mfma_f32_32x32x16_bf16 v[128:143], v[200:203], v[60:63], v[128:143]
    ds_read_b64_tr_b16 v[188:189], v245 offset:0
    ds_read_b64_tr_b16 v[190:191], v245 offset:1024
    s_add_u32 m0, s41, 147456
    s_add_u32 s47, s44, 16384
    buffer_load_dwordx4 v230, s[32:35], s47 offen offset:0 lds
    buffer_load_dwordx4 v230, s[32:35], s47 offen offset:1024 lds
    v_mfma_f32_32x32x16_bf16 v[144:159], v[204:207], v[60:63], v[144:159]
    s_waitcnt lgkmcnt(0)
    v_mfma_f32_32x32x16_bf16 v[96:111], v[176:179], v[0:3], v[96:111]
    ds_read_b64_tr_b16 v[192:193], v242 offset:4096
    ds_read_b64_tr_b16 v[194:195], v242 offset:5120
    ds_read_b64_tr_b16 v[196:197], v243 offset:4096
    v_mfma_f32_32x32x16_bf16 v[112:127], v[180:183], v[0:3], v[112:127]
    ds_read_b64_tr_b16 v[198:199], v243 offset:5120
    ds_read_b64_tr_b16 v[200:201], v244 offset:4096
    ds_read_b64_tr_b16 v[202:203], v244 offset:5120
    v_mfma_f32_32x32x16_bf16 v[128:143], v[184:187], v[0:3], v[128:143]
    ds_read_b64_tr_b16 v[204:205], v245 offset:4096
    ds_read_b64_tr_b16 v[206:207], v245 offset:5120
    v_mfma_f32_32x32x16_bf16 v[144:159], v[188:191], v[0:3], v[144:159]
    s_waitcnt lgkmcnt(0)
    v_mfma_f32_32x32x16_bf16 v[96:111], v[192:195], v[4:7], v[96:111]
    ds_read_b64_tr_b16 v[176:177], v242 offset:8192
    ds_read_b64_tr_b16 v[178:179], v242 offset:9216
    ds_read_b64_tr_b16 v[180:181], v243 offset:8192
    v_mfma_f32_32x32x16_bf16 v[112:127], v[196:199], v[4:7], v[112:127]
    ds_read_b64_tr_b16 v[182:183], v243 offset:9216
    ds_read_b64_tr_b16 v[184:185], v244 offset:8192
    ds_read_b64_tr_b16 v[186:187], v244 offset:9216
    v_mfma_f32_32x32x16_bf16 v[128:143], v[200:203], v[4:7], v[128:143]
    ds_read_b64_tr_b16 v[188:189], v245 offset:8192
    ds_read_b64_tr_b16 v[190:191], v245 offset:9216
    v_mfma_f32_32x32x16_bf16 v[144:159], v[204:207], v[4:7], v[144:159]
    s_waitcnt vmcnt(17) lgkmcnt(0)
    v_mfma_f32_32x32x16_bf16 v[96:111], v[176:179], v[8:11], v[96:111]
    ds_read_b64_tr_b16 v[192:193], v242 offset:12288
    ds_read_b64_tr_b16 v[194:195], v242 offset:13312
    ds_read_b64_tr_b16 v[196:197], v243 offset:12288
    v_mfma_f32_32x32x16_bf16 v[112:127], v[180:183], v[8:11], v[112:127]
    ds_read_b64_tr_b16 v[198:199], v243 offset:13312
    ds_read_b64_tr_b16 v[200:201], v244 offset:12288
    ds_read_b64_tr_b16 v[202:203], v244 offset:13312
    v_mfma_f32_32x32x16_bf16 v[128:143], v[184:187], v[8:11], v[128:143]
    ds_read_b64_tr_b16 v[204:205], v245 offset:12288
    ds_read_b64_tr_b16 v[206:207], v245 offset:13312
    v_mfma_f32_32x32x16_bf16 v[144:159], v[188:191], v[8:11], v[144:159]
    s_waitcnt vmcnt(12) lgkmcnt(0)
    s_barrier
    v_mfma_f32_32x32x16_bf16 v[96:111], v[192:195], v[12:15], v[96:111]
    ds_read_b64_tr_b16 v[176:177], v242 offset:16384
    ds_read_b64_tr_b16 v[178:179], v242 offset:17408
    ds_read_b64_tr_b16 v[180:181], v243 offset:16384
    v_mfma_f32_32x32x16_bf16 v[112:127], v[196:199], v[12:15], v[112:127]
    ds_read_b64_tr_b16 v[182:183], v243 offset:17408
    ds_read_b64_tr_b16 v[184:185], v244 offset:16384
    ds_read_b64_tr_b16 v[186:187], v244 offset:17408
    v_mfma_f32_32x32x16_bf16 v[128:143], v[200:203], v[12:15], v[128:143]
    ds_read_b64_tr_b16 v[188:189], v245 offset:16384
    ds_read_b64_tr_b16 v[190:191], v245 offset:17408
    v_mfma_f32_32x32x16_bf16 v[144:159], v[204:207], v[12:15], v[144:159]
    s_waitcnt lgkmcnt(0)
    v_mfma_f32_32x32x16_bf16 v[96:111], v[176:179], v[16:19], v[96:111]
    ds_read_b64_tr_b16 v[192:193], v242 offset:20480
    ds_read_b64_tr_b16 v[194:195], v242 offset:21504
    ds_read_b64_tr_b16 v[196:197], v243 offset:20480
    v_mfma_f32_32x32x16_bf16 v[112:127], v[180:183], v[16:19], v[112:127]
    ds_read_b64_tr_b16 v[198:199], v243 offset:21504
    ds_read_b64_tr_b16 v[200:201], v244 offset:20480
    ds_read_b64_tr_b16 v[202:203], v244 offset:21504
    v_mfma_f32_32x32x16_bf16 v[128:143], v[184:187], v[16:19], v[128:143]
    ds_read_b64_tr_b16 v[204:205], v245 offset:20480
    ds_read_b64_tr_b16 v[206:207], v245 offset:21504
    v_mfma_f32_32x32x16_bf16 v[144:159], v[188:191], v[16:19], v[144:159]
    s_waitcnt lgkmcnt(0)
    v_mfma_f32_32x32x16_bf16 v[96:111], v[192:195], v[20:23], v[96:111]
    ds_read_b64_tr_b16 v[176:177], v242 offset:24576
    ds_read_b64_tr_b16 v[178:179], v242 offset:25600
    ds_read_b64_tr_b16 v[180:181], v243 offset:24576
    v_mfma_f32_32x32x16_bf16 v[112:127], v[196:199], v[20:23], v[112:127]
    ds_read_b64_tr_b16 v[182:183], v243 offset:25600
    ds_read_b64_tr_b16 v[184:185], v244 offset:24576
    ds_read_b64_tr_b16 v[186:187], v244 offset:25600
    v_mfma_f32_32x32x16_bf16 v[128:143], v[200:203], v[20:23], v[128:143]
    ds_read_b64_tr_b16 v[188:189], v245 offset:24576
    ds_read_b64_tr_b16 v[190:191], v245 offset:25600
    v_mfma_f32_32x32x16_bf16 v[144:159], v[204:207], v[20:23], v[144:159]
    s_waitcnt vmcnt(11) lgkmcnt(0)
    v_mfma_f32_32x32x16_bf16 v[96:111], v[176:179], v[24:27], v[96:111]
    ds_read_b64_tr_b16 v[192:193], v242 offset:28672
    ds_read_b64_tr_b16 v[194:195], v242 offset:29696
    ds_read_b64_tr_b16 v[196:197], v243 offset:28672
    v_mfma_f32_32x32x16_bf16 v[112:127], v[180:183], v[24:27], v[112:127]
    ds_read_b64_tr_b16 v[198:199], v243 offset:29696
    ds_read_b64_tr_b16 v[200:201], v244 offset:28672
    ds_read_b64_tr_b16 v[202:203], v244 offset:29696
    v_mfma_f32_32x32x16_bf16 v[128:143], v[184:187], v[24:27], v[128:143]
    ds_read_b64_tr_b16 v[204:205], v245 offset:28672
    ds_read_b64_tr_b16 v[206:207], v245 offset:29696
    v_mfma_f32_32x32x16_bf16 v[144:159], v[188:191], v[24:27], v[144:159]
    s_waitcnt vmcnt(8) lgkmcnt(0)
    v_mfma_f32_32x32x16_bf16 v[96:111], v[192:195], v[28:31], v[96:111]
    v_mfma_f32_32x32x16_bf16 v[112:127], v[196:199], v[28:31], v[112:127]
    v_mfma_f32_32x32x16_bf16 v[128:143], v[200:203], v[28:31], v[128:143]
    v_mfma_f32_32x32x16_bf16 v[144:159], v[204:207], v[28:31], v[144:159]
    s_waitcnt vmcnt(0)
    s_barrier
    s_waitcnt lgkmcnt(0)
    s_cmp_eq_u32 s60, 0
    s_cbranch_scc1 K2F_NOS2
    s_mov_b32 s64, 2
    s_add_u32 s65, s64, 1
    s_and_b32 s66, s65, 3
    s_lshl_b32 s66, s66, 14
    s_add_u32 m0, s66, s45
    s_lshl_b32 s65, s65, 14
    s_add_u32 s65, s65, s46
    buffer_load_dwordx4 v230, s[28:31], s65 offen offset:0 lds
    buffer_load_dwordx4 v230, s[28:31], s65 offen offset:1024 lds
    buffer_load_dwordx4 v230, s[28:31], s65 offen offset:2048 lds
    buffer_load_dwordx4 v230, s[28:31], s65 offen offset:3072 lds
    s_add_u32 s66, s64, 2
    s_and_b32 s66, s66, 3
    s_lshl_b32 s66, s66, 14
    s_add_u32 s66, s66, s45
    s_add_u32 m0, s66, 98304
    s_sub_u32 s65, s65, 16384
    buffer_load_dwordx4 v230, s[32:35], s65 offen offset:0 lds
    buffer_load_dwordx4 v230, s[32:35], s65 offen offset:1024 lds
    buffer_load_dwordx4 v230, s[32:35], s65 offen offset:2048 lds
    buffer_load_dwordx4 v230, s[32:35], s65 offen offset:3072 lds
K2F_NOS2:
    ds_read_b128 v[176:179], v230 offset:0
    ds_read_b128 v[180:183], v230 offset:1024
    ds_read_b128 v[184:187], v230 offset:2048
    ds_read_b128 v[188:191], v230 offset:3072
    ds_read_b128 v[192:195], v230 offset:4096
    ds_read_b128 v[196:199], v230 offset:5120
    ds_read_b128 v[200:203], v230 offset:6144
    ds_read_b128 v[204:207], v230 offset:7168
    v_cvt_pk_bf16_f32 v64, v96, v97
    v_cvt_pk_bf16_f32 v65, v98, v99
    v_cvt_pk_bf16_f32 v66, v100, v101
    v_cvt_pk_bf16_f32 v67, v102, v103
    v_cvt_pk_bf16_f32 v68, v104, v105
    v_cvt_pk_bf16_f32 v69, v106, v107
    v_cvt_pk_bf16_f32 v70, v108, v109
    v_cvt_pk_bf16_f32 v71, v110, v111
    v_cvt_pk_bf16_f32 v72, v112, v113
    v_cvt_pk_bf16_f32 v73, v114, v115
    v_cvt_pk_bf16_f32 v74, v116, v117
    v_cvt_pk_bf16_f32 v75, v118, v119
    v_cvt_pk_bf16_f32 v76, v120, v121
    v_cvt_pk_bf16_f32 v77, v122, v123
    v_cvt_pk_bf16_f32 v78, v124, v125
    v_cvt_pk_bf16_f32 v79, v126, v127
    v_cvt_pk_bf16_f32 v80, v128, v129
    v_cvt_pk_bf16_f32 v81, v130, v131
    v_cvt_pk_bf16_f32 v82, v132, v133
    v_cvt_pk_bf16_f32 v83, v134, v135
    v_cvt_pk_bf16_f32 v84, v136, v137
    v_cvt_pk_bf16_f32 v85, v138, v139
    v_cvt_pk_bf16_f32 v86, v140, v141
    v_cvt_pk_bf16_f32 v87, v142, v143
    v_cvt_pk_bf16_f32 v88, v144, v145
    v_cvt_pk_bf16_f32 v89, v146, v147
    v_cvt_pk_bf16_f32 v90, v148, v149
    v_cvt_pk_bf16_f32 v91, v150, v151
    v_cvt_pk_bf16_f32 v92, v152, v153
    v_cvt_pk_bf16_f32 v93, v154, v155
    v_cvt_pk_bf16_f32 v94, v156, v157
    v_cvt_pk_bf16_f32 v95, v158, v159
    v_mov_b32 v226, 0
    v_mov_b32 v227, 81920
    ds_write_b32 v227, v226
    v_add_u32 v228, 16384, v230
    v_add_u32 v229, 131072, v230
    s_mov_b32 s51, 0
    s_mov_b32 s52, 0xf149f2ca
    s_mov_b32 s53, 0x41000000
    s_waitcnt lgkmcnt(0)
    v_mfma_f32_32x32x16_bf16 v[96:111], v[176:179], v[64:67], 0
    ds_read_b128 v[176:179], v230 offset:8192
    v_mov_b32 v0, 0
    v_mov_b32 v1, 0
    v_mov_b32 v2, 0
    v_mov_b32 v3, 0
    v_mfma_f32_32x32x16_bf16 v[96:111], v[180:183], v[68:71], v[96:111]
    ds_read_b128 v[180:183], v230 offset:9216
    v_mov_b32 v4, 0
    v_mov_b32 v5, 0
    v_mov_b32 v6, 0
    v_mov_b32 v7, 0
    v_mfma_f32_32x32x16_bf16 v[96:111], v[184:187], v[72:75], v[96:111]
    ds_read_b128 v[184:187], v230 offset:10240
    v_mov_b32 v8, 0
    v_mov_b32 v9, 0
    v_mov_b32 v10, 0
    v_mov_b32 v11, 0
    v_mfma_f32_32x32x16_bf16 v[96:111], v[188:191], v[76:79], v[96:111]
    ds_read_b128 v[188:191], v230 offset:11264
    v_mov_b32 v12, 0
    v_mov_b32 v13, 0
    v_mov_b32 v14, 0
    v_mov_b32 v15, 0
    v_mfma_f32_32x32x16_bf16 v[96:111], v[192:195], v[80:83], v[96:111]
    ds_read_b128 v[192:195], v230 offset:12288
    v_mov_b32 v16, 0
    v_mov_b32 v17, 0
    v_mov_b32 v18, 0
    v_mov_b32 v19, 0
    v_mfma_f32_32x32x16_bf16 v[96:111], v[196:199], v[84:87], v[96:111]
    ds_read_b128 v[196:199], v230 offset:13312
    v_mov_b32 v20, 0
    v_mov_b32 v21, 0
    v_mov_b32 v22, 0
    v_mov_b32 v23, 0
    v_mfma_f32_32x32x16_bf16 v[96:111], v[200:203], v[88:91], v[96:111]
    ds_read_b128 v[200:203], v230 offset:14336
    v_mov_b32 v24, 0
    v_mov_b32 v25, 0
    v_mov_b32 v26, 0
    v_mov_b32 v27, 0
    v_mfma_f32_32x32x16_bf16 v[96:111], v[204:207], v[92:95], v[96:111]
    ds_read_b128 v[204:207], v230 offset:15360
    v_mov_b32 v28, 0
    v_mov_b32 v29, 0
    v_mov_b32 v30, 0
    v_mov_b32 v31, 0
    s_waitcnt lgkmcnt(7)
    v_mfma_f32_32x32x16_bf16 v[112:127], v[176:179], v[64:67], 0
    ds_read_b128 v[176:179], v228 offset:0
    v_mov_b32 v32, 0
    v_mov_b32 v33, 0
    v_mov_b32 v34, 0
    v_mov_b32 v35, 0
    s_waitcnt lgkmcnt(7)
    v_mfma_f32_32x32x16_bf16 v[112:127], v[180:183], v[68:71], v[112:127]
    ds_read_b128 v[180:183], v228 offset:1024
    v_mov_b32 v36, 0
    v_mov_b32 v37, 0
    v_mov_b32 v38, 0
    v_mov_b32 v39, 0
    s_waitcnt lgkmcnt(7)
    v_mfma_f32_32x32x16_bf16 v[112:127], v[184:187], v[72:75], v[112:127]
    ds_read_b128 v[184:187], v228 offset:2048
    v_mov_b32 v40, 0
    v_mov_b32 v41, 0
    v_mov_b32 v42, 0
    v_mov_b32 v43, 0
    s_waitcnt lgkmcnt(7)
    v_mfma_f32_32x32x16_bf16 v[112:127], v[188:191], v[76:79], v[112:127]
    ds_read_b128 v[188:191], v228 offset:3072
    v_mov_b32 v44, 0
    v_mov_b32 v45, 0
    v_mov_b32 v46, 0
    v_mov_b32 v47, 0
    s_waitcnt lgkmcnt(7)
    v_mfma_f32_32x32x16_bf16 v[112:127], v[192:195], v[80:83], v[112:127]
    ds_read_b128 v[192:195], v228 offset:4096
    v_mov_b32 v48, 0
    v_mov_b32 v49, 0
    v_mov_b32 v50, 0
    v_mov_b32 v51, 0
    s_waitcnt lgkmcnt(7)
    v_mfma_f32_32x32x16_bf16 v[112:127], v[196:199], v[84:87], v[112:127]
    ds_read_b128 v[196:199], v228 offset:5120
    v_mov_b32 v52, 0
    v_mov_b32 v53, 0
    v_mov_b32 v54, 0
    v_mov_b32 v55, 0
    s_waitcnt lgkmcnt(7)
    v_mfma_f32_32x32x16_bf16 v[112:127], v[200:203], v[88:91], v[112:127]
    ds_read_b128 v[200:203], v228 offset:6144
    v_mov_b32 v56, 0
    v_mov_b32 v57, 0
    v_mov_b32 v58, 0
    v_mov_b32 v59, 0
    s_waitcnt lgkmcnt(7)
    v_mfma_f32_32x32x16_bf16 v[112:127], v[204:207], v[92:95], v[112:127]
    ds_read_b128 v[204:207], v228 offset:7168
    v_mov_b32 v60, 0
    v_mov_b32 v61, 0
    v_mov_b32 v62, 0
    v_mov_b32 v63, 0
    v_mov_b32 v224, 0
    v_mov_b32 v225, 0
    s_mov_b32 s54, 0
    s_nop 7
    s_nop 3
    s_cmp_eq_u32 s61, 2
    s_cbranch_scc0 K2F_NOM
    s_lshl_b32 s67, s54, 6
    v_subrev_u32 v227, s67, v231
    v_mov_b32 v226, s52
    v_cmp_le_i32 s[56:57], 0, v227
    v_cmp_le_i32 s[58:59], 1, v227
    v_cmp_le_i32 s[92:93], 2, v227
    v_cmp_le_i32 s[94:95], 3, v227
    v_cndmask_b32 v96, v226, v96, s[56:57]
    v_cndmask_b32 v97, v226, v97, s[58:59]
    v_cndmask_b32 v98, v226, v98, s[92:93]
    v_cndmask_b32 v99, v226, v99, s[94:95]
    v_cmp_le_i32 s[56:57], 8, v227
    v_cmp_le_i32 s[58:59], 9, v227
    v_cmp_le_i32 s[92:93], 10, v227
    v_cmp_le_i32 s[94:95], 11, v227
    v_cndmask_b32 v100, v226, v100, s[56:57]
    v_cndmask_b32 v101, v226, v101, s[58:59]
    v_cndmask_b32 v102, v226, v102, s[92:93]
    v_cndmask_b32 v103, v226, v103, s[94:95]
    v_cmp_le_i32 s[56:57], 16, v227
    v_cmp_le_i32 s[58:59], 17, v227
    v_cmp_le_i32 s[92:93], 18, v227
    v_cmp_le_i32 s[94:95], 19, v227
    v_cndmask_b32 v104, v226, v104, s[56:57]
    v_cndmask_b32 v105, v226, v105, s[58:59]
    v_cndmask_b32 v106, v226, v106, s[92:93]
    v_cndmask_b32 v107, v226, v107, s[94:95]
    v_cmp_le_i32 s[56:57], 24, v227
    v_cmp_le_i32 s[58:59], 25, v227
    v_cmp_le_i32 s[92:93], 26, v227
    v_cmp_le_i32 s[94:95], 27, v227
    v_cndmask_b32 v108, v226, v108, s[56:57]
    v_cndmask_b32 v109, v226, v109, s[58:59]
    v_cndmask_b32 v110, v226, v110, s[92:93]
    v_cndmask_b32 v111, v226, v111, s[94:95]
    v_cmp_le_i32 s[56:57], 32, v227
    v_cmp_le_i32 s[58:59], 33, v227
    v_cmp_le_i32 s[92:93], 34, v227
    v_cmp_le_i32 s[94:95], 35, v227
    v_cndmask_b32 v112, v226, v112, s[56:57]
    v_cndmask_b32 v113, v226, v113, s[58:59]
    v_cndmask_b32 v114, v226, v114, s[92:93]
    v_cndmask_b32 v115, v226, v115, s[94:95]
    v_cmp_le_i32 s[56:57], 40, v227
    v_cmp_le_i32 s[58:59], 41, v227
    v_cmp_le_i32 s[92:93], 42, v227
    v_cmp_le_i32 s[94:95], 43, v227
    v_cndmask_b32 v116, v226, v116, s[56:57]
    v_cndmask_b32 v117, v226, v117, s[58:59]
    v_cndmask_b32 v118, v226, v118, s[92:93]
    v_cndmask_b32 v119, v226, v119, s[94:95]
    v_cmp_le_i32 s[56:57], 48, v227
    v_cmp_le_i32 s[58:59], 49, v227
    v_cmp_le_i32 s[92:93], 50, v227
    v_cmp_le_i32 s[94:95], 51, v227
    v_cndmask_b32 v120, v226, v120, s[56:57]
    v_cndmask_b32 v121, v226, v121, s[58:59]
    v_cndmask_b32 v122, v226, v122, s[92:93]
    v_cndmask_b32 v123, v226, v123, s[94:95]
    v_cmp_le_i32 s[56:57], 56, v227
    v_cmp_le_i32 s[58:59], 57, v227
    v_cmp_le_i32 s[92:93], 58, v227
    v_cmp_le_i32 s[94:95], 59, v227
    v_cndmask_b32 v124, v226, v124, s[56:57]
    v_cndmask_b32 v125, v226, v125, s[58:59]
    v_cndmask_b32 v126, v226, v126, s[92:93]
    v_cndmask_b32 v127, v226, v127, s[94:95]
K2F_NOM:
    v_max3_f32 v246, v96, v97, v98
    v_max3_f32 v226, v99, v100, v101
    v_max3_f32 v246, v246, v102, v103
    v_max3_f32 v226, v226, v104, v105
    v_max3_f32 v246, v246, v106, v107
    v_max3_f32 v226, v226, v108, v109
    v_max3_f32 v246, v246, v110, v111
    v_max3_f32 v226, v226, v112, v113
    v_max3_f32 v246, v246, v114, v115
    v_max3_f32 v226, v226, v116, v117
    v_max3_f32 v246, v246, v118, v119
    v_max3_f32 v226, v226, v120, v121
    v_max3_f32 v246, v246, v122, v123
    v_max3_f32 v226, v226, v124, v125
    v_max3_f32 v246, v246, v126, v127
    v_max_f32 v246, v246, v226
    v_mov_b32 v226, v246
    s_nop 1
    v_permlane32_swap_b32 v246, v226
    v_max_f32 v246, v246, v226
    v_sub_f32 v208, 0, v246
    v_sub_f32 v209, 0, v246
    v_sub_f32 v210, 0, v246
    v_sub_f32 v211, 0, v246
    v_sub_f32 v212, 0, v246
    v_sub_f32 v213, 0, v246
    v_sub_f32 v214, 0, v246
    v_sub_f32 v215, 0, v246
    v_sub_f32 v216, 0, v246
    v_sub_f32 v217, 0, v246
    v_sub_f32 v218, 0, v246
    v_sub_f32 v219, 0, v246
    v_sub_f32 v220, 0, v246
    v_sub_f32 v221, 0, v246
    v_sub_f32 v222, 0, v246
    v_sub_f32 v223, 0, v246
    v_sub_f32 v96, v96, v246
    v_sub_f32 v97, v97, v246
    v_sub_f32 v98, v98, v246
    v_sub_f32 v99, v99, v246
    v_sub_f32 v100, v100, v246
    v_sub_f32 v101, v101, v246
    v_sub_f32 v102, v102, v246
    v_sub_f32 v103, v103, v246
    v_sub_f32 v104, v104, v246
    v_sub_f32 v105, v105, v246
    v_sub_f32 v106, v106, v246
    v_sub_f32 v107, v107, v246
    v_sub_f32 v108, v108, v246
    v_sub_f32 v109, v109, v246
    v_sub_f32 v110, v110, v246
    v_sub_f32 v111, v111, v246
    v_sub_f32 v112, v112, v246
    v_sub_f32 v113, v113, v246
    v_sub_f32 v114, v114, v246
    v_sub_f32 v115, v115, v246
    v_sub_f32 v116, v116, v246
    v_sub_f32 v117, v117, v246
    v_sub_f32 v118, v118, v246
    v_sub_f32 v119, v119, v246
    v_sub_f32 v120, v120, v246
    v_sub_f32 v121, v121, v246
    v_sub_f32 v122, v122, v246
    v_sub_f32 v123, v123, v246
    v_sub_f32 v124, v124, v246
    v_sub_f32 v125, v125, v246
    v_sub_f32 v126, v126, v246
    v_sub_f32 v127, v127, v246
    s_sub_u32 s49, s61, 3
    v_add_u32 v229, 98304, v230
    s_add_u32 s96, s46, 65536
    s_add_u32 s97, s46, 49152
    s_cmp_eq_u32 s60, 0
    s_cbranch_scc1 K2FH_PRE
    s_cmp_eq_u32 s61, 2
    s_cbranch_scc1 K2FL_M0b
K2FL_U0:
    s_waitcnt lgkmcnt(4)
    v_mfma_f32_32x32x16_bf16 v[128:143], v[176:179], v[64:67], v[208:223]
    ds_read_b128 v[176:179], v230 offset:24576
    v_exp_f32 v232, v96
    v_exp_f32 v233, v97
    v_mfma_f32_32x32x16_bf16 v[128:143], v[180:183], v[68:71], v[128:143]
    ds_read_b128 v[180:183], v230 offset:25600
    v_exp_f32 v234, v98
    v_exp_f32 v235, v99
    v_mfma_f32_32x32x16_bf16 v[128:143], v[184:187], v[72:75], v[128:143]
    ds_read_b128 v[184:187], v230 offset:26624
    v_add_f32 v224, v224, v232
    v_cvt_pk_bf16_f32 v160, v232, v233
    v_add_f32 v225, v225, v233
    v_exp_f32 v236, v100
    v_mfma_f32_32x32x16_bf16 v[128:143], v[188:191], v[76:79], v[128:143]
    ds_read_b128 v[188:191], v230 offset:27648
    v_exp_f32 v237, v101
    v_add_f32 v224, v224, v234
    v_cvt_pk_bf16_f32 v161, v234, v235
    s_waitcnt lgkmcnt(4)
    v_mfma_f32_32x32x16_bf16 v[128:143], v[192:195], v[80:83], v[128:143]
    ds_read_b128 v[192:195], v230 offset:28672
    v_add_f32 v225, v225, v235
    v_exp_f32 v238, v102
    v_mfma_f32_32x32x16_bf16 v[128:143], v[196:199], v[84:87], v[128:143]
    ds_read_b128 v[196:199], v230 offset:29696
    v_exp_f32 v239, v103
    v_add_f32 v224, v224, v236
    v_cvt_pk_bf16_f32 v162, v236, v237
    v_add_f32 v225, v225, v237
    v_mfma_f32_32x32x16_bf16 v[128:143], v[200:203], v[88:91], v[128:143]
    ds_read_b128 v[200:203], v230 offset:30720
    v_add_f32 v224, v224, v238
    v_cvt_pk_bf16_f32 v163, v238, v239
    v_add_f32 v225, v225, v239
    v_exp_f32 v232, v104
    v_mfma_f32_32x32x16_bf16 v[128:143], v[204:207], v[92:95], v[128:143]
    ds_read_b128 v[204:207], v230 offset:31744
    v_exp_f32 v233, v105
    v_exp_f32 v234, v106
    s_waitcnt lgkmcnt(4)
    v_mfma_f32_32x32x16_bf16 v[144:159], v[176:179], v[64:67], v[208:223]
    ds_read_b128 v[176:179], v229 offset:32768
    v_exp_f32 v235, v107
    v_add_f32 v224, v224, v232
    v_mfma_f32_32x32x16_bf16 v[144:159], v[180:183], v[68:71], v[144:159]
    ds_read_b128 v[180:183], v229 offset:33792
    v_cvt_pk_bf16_f32 v164, v232, v233
    v_add_f32 v225, v225, v233
    v_exp_f32 v236, v108
    v_mfma_f32_32x32x16_bf16 v[144:159], v[184:187], v[72:75], v[144:159]
    ds_read_b128 v[184:187], v229 offset:34816
    v_exp_f32 v237, v109
    v_add_f32 v224, v224, v234
    v_cvt_pk_bf16_f32 v165, v234, v235
    v_add_f32 v225, v225, v235
    v_mfma_f32_32x32x16_bf16 v[144:159], v[188:191], v[76:79], v[144:159]
    ds_read_b128 v[188:191], v229 offset:35840
    v_exp_f32 v238, v110
    v_exp_f32 v239, v111
    s_waitcnt lgkmcnt(4)
    v_mfma_f32_32x32x16_bf16 v[144:159], v[192:195], v[80:83], v[144:159]
    ds_read_b128 v[192:195], v229 offset:36864
    v_add_f32 v224, v224, v236
    v_cvt_pk_bf16_f32 v166, v236, v237
    v_add_f32 v225, v225, v237
    v_add_f32 v224, v224, v238
    v_mfma_f32_32x32x16_bf16 v[144:159], v[196:199], v[84:87], v[144:159]
    ds_read_b128 v[196:199], v229 offset:37888
    v_cvt_pk_bf16_f32 v167, v238, v239
    v_add_f32 v225, v225, v239
    v_exp_f32 v232, v112
    v_mfma_f32_32x32x16_bf16 v[144:159], v[200:203], v[88:91], v[144:159]
    ds_read_b128 v[200:203], v229 offset:38912
    v_exp_f32 v233, v113
    v_exp_f32 v234, v114
    v_mfma_f32_32x32x16_bf16 v[144:159], v[204:207], v[92:95], v[144:159]
    ds_read_b128 v[204:207], v229 offset:39936
    v_exp_f32 v235, v115
    v_add_f32 v224, v224, v232
    v_cvt_pk_bf16_f32 v168, v232, v233
    s_waitcnt lgkmcnt(4)
    v_mfma_f32_32x32x16_bf16 v[0:15], v[176:179], v[160:163], v[0:15]
    ds_read_b128 v[176:179], v229 offset:40960
    v_add_f32 v225, v225, v233
    v_exp_f32 v236, v116
    v_exp_f32 v237, v117
    v_mfma_f32_32x32x16_bf16 v[16:31], v[180:183], v[160:163], v[16:31]
    ds_read_b128 v[180:183], v229 offset:41984
    v_add_f32 v224, v224, v234
    v_cvt_pk_bf16_f32 v169, v234, v235
    v_add_f32 v225, v225, v235
    v_mfma_f32_32x32x16_bf16 v[32:47], v[184:187], v[160:163], v[32:47]
    ds_read_b128 v[184:187], v229 offset:43008
    v_exp_f32 v238, v118
    v_exp_f32 v239, v119
    v_add_f32 v224, v224, v236
    v_mfma_f32_32x32x16_bf16 v[48:63], v[188:191], v[160:163], v[48:63]
    ds_read_b128 v[188:191], v229 offset:44032
    v_cvt_pk_bf16_f32 v170, v236, v237
    v_add_f32 v225, v225, v237
    v_add_f32 v224, v224, v238
    v_cvt_pk_bf16_f32 v171, v238, v239
    s_waitcnt lgkmcnt(4)
    v_mfma_f32_32x32x16_bf16 v[0:15], v[192:195], v[164:167], v[0:15]
    ds_read_b128 v[192:195], v229 offset:45056
    v_add_f32 v225, v225, v239
    v_exp_f32 v232, v120
    v_exp_f32 v233, v121
    v_mfma_f32_32x32x16_bf16 v[16:31], v[196:199], v[164:167], v[16:31]
    ds_read_b128 v[196:199], v229 offset:46080
    v_exp_f32 v234, v122
    v_exp_f32 v235, v123
    v_mfma_f32_32x32x16_bf16 v[32:47], v[200:203], v[164:167], v[32:47]
    ds_read_b128 v[200:203], v229 offset:47104
    v_add_f32 v224, v224, v232
    v_cvt_pk_bf16_f32 v172, v232, v233
    v_add_f32 v225, v225, v233
    v_mfma_f32_32x32x16_bf16 v[48:63], v[204:207], v[164:167], v[48:63]
    ds_read_b128 v[204:207], v229 offset:48128
    v_exp_f32 v236, v124
    v_exp_f32 v237, v125
    v_add_f32 v224, v224, v234
    s_waitcnt lgkmcnt(4)
    s_waitcnt vmcnt(8)
    s_barrier
    v_mfma_f32_32x32x16_bf16 v[0:15], v[176:179], v[168:171], v[0:15]
    ds_read_b128 v[176:179], v230 offset:32768
    s_add_u32 m0, s45, 0
    s_nop 0
    buffer_load_dwordx4 v230, s[28:31], s96 offen offset:0 lds
    v_cvt_pk_bf16_f32 v173, v234, v235
    v_add_f32 v225, v225, v235
    v_exp_f32 v238, v126
    v_mfma_f32_32x32x16_bf16 v[16:31], v[180:183], v[168:171], v[16:31]
    ds_read_b128 v[180:183], v230 offset:33792
    buffer_load_dwordx4 v230, s[28:31], s96 offen offset:1024 lds
    v_exp_f32 v239, v127
    v_add_f32 v224, v224, v236
    v_cvt_pk_bf16_f32 v174, v236, v237
    v_mfma_f32_32x32x16_bf16 v[32:47], v[184:187], v[168:171], v[32:47]
    ds_read_b128 v[184:187], v230 offset:34816
    buffer_load_dwordx4 v230, s[28:31], s96 offen offset:2048 lds
    v_add_f32 v225, v225, v237
    v_add_f32 v224, v224, v238
    v_cvt_pk_bf16_f32 v175, v238, v239
    v_add_f32 v225, v225, v239
    v_mfma_f32_32x32x16_bf16 v[48:63], v[188:191], v[168:171], v[48:63]
    ds_read_b128 v[188:191], v230 offset:35840
    buffer_load_dwordx4 v230, s[28:31], s96 offen offset:3072 lds
    s_add_u32 m0, s45, 114688
    s_waitcnt lgkmcnt(4)
    v_mfma_f32_32x32x16_bf16 v[0:15], v[192:195], v[172:175], v[0:15]
    ds_read_b128 v[192:195], v230 offset:36864
    buffer_load_dwordx4 v230, s[32:35], s97 offen offset:0 lds
    v_mfma_f32_32x32x16_bf16 v[16:31], v[196:199], v[172:175], v[16:31]
    ds_read_b128 v[196:199], v230 offset:37888
    buffer_load_dwordx4 v230, s[32:35], s97 offen offset:1024 lds
    v_mfma_f32_32x32x16_bf16 v[32:47], v[200:203], v[172:175], v[32:47]
    ds_read_b128 v[200:203], v230 offset:38912
    buffer_load_dwordx4 v230, s[32:35], s97 offen offset:2048 lds
    v_mfma_f32_32x32x16_bf16 v[48:63], v[204:207], v[172:175], v[48:63]
    ds_read_b128 v[204:207], v230 offset:39936
    buffer_load_dwordx4 v230, s[32:35], s97 offen offset:3072 lds
    s_mov_b32 s97, s96
    s_add_u32 s96, s96, 16384
    s_add_u32 s51, s51, 1
    s_cmp_ge_u32 s51, s49
    s_cbranch_scc1 K2FL_M1a
K2FL_U1:
    s_waitcnt lgkmcnt(4)
    v_mfma_f32_32x32x16_bf16 v[96:111], v[176:179], v[64:67], v[208:223]
    ds_read_b128 v[176:179], v230 offset:40960
    v_exp_f32 v232, v128
    v_exp_f32 v233, v129
    v_mfma_f32_32x32x16_bf16 v[96:111], v[180:183], v[68:71], v[96:111]
    ds_read_b128 v[180:183], v230 offset:41984
    v_exp_f32 v234, v130
    v_exp_f32 v235, v131
    v_mfma_f32_32x32x16_bf16 v[96:111], v[184:187], v[72:75], v[96:111]
    ds_read_b128 v[184:187], v230 offset:43008
    v_add_f32 v224, v224, v232
    v_cvt_pk_bf16_f32 v160, v232, v233
    v_add_f32 v225, v225, v233
    v_exp_f32 v236, v132
    v_mfma_f32_32x32x16_bf16 v[96:111], v[188:191], v[76:79], v[96:111]
    ds_read_b128 v[188:191], v230 offset:44032
    v_exp_f32 v237, v133
    v_add_f32 v224, v224, v234
    v_cvt_pk_bf16_f32 v161, v234, v235
    s_waitcnt lgkmcnt(4)
    v_mfma_f32_32x32x16_bf16 v[96:111], v[192:195], v[80:83], v[96:111]
    ds_read_b128 v[192:195], v230 offset:45056
    v_add_f32 v225, v225, v235
    v_exp_f32 v238, v134
    v_mfma_f32_32x32x16_bf16 v[96:111], v[196:199], v[84:87], v[96:111]
    ds_read_b128 v[196:199], v230 offset:46080
    v_exp_f32 v239, v135
    v_add_f32 v224, v224, v236
    v_cvt_pk_bf16_f32 v162, v236, v237
    v_add_f32 v225, v225, v237
    v_mfma_f32_32x32x16_bf16 v[96:111], v[200:203], v[88:91], v[96:111]
    ds_read_b128 v[200:203], v230 offset:47104
    v_add_f32 v224, v224, v238
    v_cvt_pk_bf16_f32 v163, v238, v239
    v_add_f32 v225, v225, v239
    v_exp_f32 v232, v136
    v_mfma_f32_32x32x16_bf16 v[96:111], v[204:207], v[92:95], v[96:111]
    ds_read_b128 v[204:207], v230 offset:48128
    v_exp_f32 v233, v137
    v_exp_f32 v234, v138
    s_waitcnt lgkmcnt(4)
    v_mfma_f32_32x32x16_bf16 v[112:127], v[176:179], v[64:67], v[208:223]
    ds_read_b128 v[176:179], v229 offset:49152
    v_exp_f32 v235, v139
    v_add_f32 v224, v224, v232
    v_mfma_f32_32x32x16_bf16 v[112:127], v[180:183], v[68:71], v[112:127]
    ds_read_b128 v[180:183], v229 offset:50176
    v_cvt_pk_bf16_f32 v164, v232, v233
    v_add_f32 v225, v225, v233
    v_exp_f32 v236, v140
    v_mfma_f32_32x32x16_bf16 v[112:127], v[184:187], v[72:75], v[112:127]
    ds_read_b128 v[184:187], v229 offset:51200
    v_exp_f32 v237, v141
    v_add_f32 v224, v224, v234
    v_cvt_pk_bf16_f32 v165, v234, v235
    v_add_f32 v225, v225, v235
    v_mfma_f32_32x32x16_bf16 v[112:127], v[188:191], v[76:79], v[112:127]
    ds_read_b128 v[188:191], v229 offset:52224
    v_exp_f32 v238, v142
    v_exp_f32 v239, v143
    s_waitcnt lgkmcnt(4)
    v_mfma_f32_32x32x16_bf16 v[112:127], v[192:195], v[80:83], v[112:127]
    ds_read_b128 v[192:195], v229 offset:53248
    v_add_f32 v224, v224, v236
    v_cvt_pk_bf16_f32 v166, v236, v237
    v_add_f32 v225, v225, v237
    v_add_f32 v224, v224, v238
    v_mfma_f32_32x32x16_bf16 v[112:127], v[196:199], v[84:87], v[112:127]
    ds_read_b128 v[196:199], v229 offset:54272
    v_cvt_pk_bf16_f32 v167, v238, v239
    v_add_f32 v225, v225, v239
    v_exp_f32 v232, v144
    v_mfma_f32_32x32x16_bf16 v[112:127], v[200:203], v[88:91], v[112:127]
    ds_read_b128 v[200:203], v229 offset:55296
    v_exp_f32 v233, v145
    v_exp_f32 v234, v146
    v_mfma_f32_32x32x16_bf16 v[112:127], v[204:207], v[92:95], v[112:127]
    ds_read_b128 v[204:207], v229 offset:56320
    v_exp_f32 v235, v147
    v_add_f32 v224, v224, v232
    v_cvt_pk_bf16_f32 v168, v232, v233
    s_waitcnt lgkmcnt(4)
    v_mfma_f32_32x32x16_bf16 v[0:15], v[176:179], v[160:163], v[0:15]
    ds_read_b128 v[176:179], v229 offset:57344
    v_add_f32 v225, v225, v233
    v_exp_f32 v236, v148
    v_exp_f32 v237, v149
    v_mfma_f32_32x32x16_bf16 v[16:31], v[180:183], v[160:163], v[16:31]
    ds_read_b128 v[180:183], v229 offset:58368
    v_add_f32 v224, v224, v234
    v_cvt_pk_bf16_f32 v169, v234, v235
    v_add_f32 v225, v225, v235
    v_mfma_f32_32x32x16_bf16 v[32:47], v[184:187], v[160:163], v[32:47]
    ds_read_b128 v[184:187], v229 offset:59392
    v_exp_f32 v238, v150
    v_exp_f32 v239, v151
    v_add_f32 v224, v224, v236
    v_mfma_f32_32x32x16_bf16 v[48:63], v[188:191], v[160:163], v[48:63]
    ds_read_b128 v[188:191], v229 offset:60416
    v_cvt_pk_bf16_f32 v170, v236, v237
    v_add_f32 v225, v225, v237
    v_add_f32 v224, v224, v238
    v_cvt_pk_bf16_f32 v171, v238, v239
    s_waitcnt lgkmcnt(4)
    v_mfma_f32_32x32x16_bf16 v[0:15], v[192:195], v[164:167], v[0:15]
    ds_read_b128 v[192:195], v229 offset:61440
    v_add_f32 v225, v225, v239
    v_exp_f32 v232, v152
    v_exp_f32 v233, v153
    v_mfma_f32_32x32x16_bf16 v[16:31], v[196:199], v[164:167], v[16:31]
    ds_read_b128 v[196:199], v229 offset:62464
    v_exp_f32 v234, v154
    v_exp_f32 v235, v155
    v_mfma_f32_32x32x16_bf16 v[32:47], v[200:203], v[164:167], v[32:47]
    ds_read_b128 v[200:203], v229 offset:63488
    v_add_f32 v224, v224, v232
    v_cvt_pk_bf16_f32 v172, v232, v233
    v_add_f32 v225, v225, v233
    v_mfma_f32_32x32x16_bf16 v[48:63], v[204:207], v[164:167], v[48:63]
    ds_read_b128 v[204:207], v229 offset:64512
    v_exp_f32 v236, v156
    v_exp_f32 v237, v157
    v_add_f32 v224, v224, v234
    s_waitcnt lgkmcnt(4)
    s_waitcnt vmcnt(8)
    s_barrier
    v_mfma_f32_32x32x16_bf16 v[0:15], v[176:179], v[168:171], v[0:15]
    ds_read_b128 v[176:179], v230 offset:49152
    s_add_u32 m0, s45, 16384
    s_nop 0
    buffer_load_dwordx4 v230, s[28:31], s96 offen offset:0 lds
    v_cvt_pk_bf16_f32 v173, v234, v235
    v_add_f32 v225, v225, v235
    v_exp_f32 v238, v158
    v_mfma_f32_32x32x16_bf16 v[16:31], v[180:183], v[168:171], v[16:31]
    ds_read_b128 v[180:183], v230 offset:50176
    buffer_load_dwordx4 v230, s[28:31], s96 offen offset:1024 lds
    v_exp_f32 v239, v159
    v_add_f32 v224, v224, v236
    v_cvt_pk_bf16_f32 v174, v236, v237
    v_mfma_f32_32x32x16_bf16 v[32:47], v[184:187], v[168:171], v[32:47]
    ds_read_b128 v[184:187], v230 offset:51200
    buffer_load_dwordx4 v230, s[28:31], s96 offen offset:2048 lds
    v_add_f32 v225, v225, v237
    v_add_f32 v224, v224, v238
    v_cvt_pk_bf16_f32 v175, v238, v239
    v_add_f32 v225, v225, v239
    v_mfma_f32_32x32x16_bf16 v[48:63], v[188:191], v[168:171], v[48:63]
    ds_read_b128 v[188:191], v230 offset:52224
    buffer_load_dwordx4 v230, s[28:31], s96 offen offset:3072 lds
    s_add_u32 m0, s45, 131072
    s_waitcnt lgkmcnt(4)
    v_mfma_f32_32x32x16_bf16 v[0:15], v[192:195], v[172:175], v[0:15]
    ds_read_b128 v[192:195], v230 offset:53248
    buffer_load_dwordx4 v230, s[32:35], s97 offen offset:0 lds
    v_mfma_f32_32x32x16_bf16 v[16:31], v[196:199], v[172:175], v[16:31]
    ds_read_b128 v[196:199], v230 offset:54272
    buffer_load_dwordx4 v230, s[32:35], s97 offen offset:1024 lds
    v_mfma_f32_32x32x16_bf16 v[32:47], v[200:203], v[172:175], v[32:47]
    ds_read_b128 v[200:203], v230 offset:55296
    buffer_load_dwordx4 v230, s[32:35], s97 offen offset:2048 lds
    v_mfma_f32_32x32x16_bf16 v[48:63], v[204:207], v[172:175], v[48:63]
    ds_read_b128 v[204:207], v230 offset:56320
    buffer_load_dwordx4 v230, s[32:35], s97 offen offset:3072 lds
    s_mov_b32 s97, s96
    s_add_u32 s96, s96, 16384
    s_add_u32 s51, s51, 1
K2FL_U2:
    s_waitcnt lgkmcnt(4)
    v_mfma_f32_32x32x16_bf16 v[128:143], v[176:179], v[64:67], v[208:223]
    ds_read_b128 v[176:179], v230 offset:57344
    v_exp_f32 v232, v96
    v_exp_f32 v233, v97
    v_mfma_f32_32x32x16_bf16 v[128:143], v[180:183], v[68:71], v[128:143]
    ds_read_b128 v[180:183], v230 offset:58368
    v_exp_f32 v234, v98
    v_exp_f32 v235, v99
    v_mfma_f32_32x32x16_bf16 v[128:143], v[184:187], v[72:75], v[128:143]
    ds_read_b128 v[184:187], v230 offset:59392
    v_add_f32 v224, v224, v232
    v_cvt_pk_bf16_f32 v160, v232, v233
    v_add_f32 v225, v225, v233
    v_exp_f32 v236, v100
    v_mfma_f32_32x32x16_bf16 v[128:143], v[188:191], v[76:79], v[128:143]
    ds_read_b128 v[188:191], v230 offset:60416
    v_exp_f32 v237, v101
    v_add_f32 v224, v224, v234
    v_cvt_pk_bf16_f32 v161, v234, v235
    s_waitcnt lgkmcnt(4)
    v_mfma_f32_32x32x16_bf16 v[128:143], v[192:195], v[80:83], v[128:143]
    ds_read_b128 v[192:195], v230 offset:61440
    v_add_f32 v225, v225, v235
    v_exp_f32 v238, v102
    v_mfma_f32_32x32x16_bf16 v[128:143], v[196:199], v[84:87], v[128:143]
    ds_read_b128 v[196:199], v230 offset:62464
    v_exp_f32 v239, v103
    v_add_f32 v224, v224, v236
    v_cvt_pk_bf16_f32 v162, v236, v237
    v_add_f32 v225, v225, v237
    v_mfma_f32_32x32x16_bf16 v[128:143], v[200:203], v[88:91], v[128:143]
    ds_read_b128 v[200:203], v230 offset:63488
    v_add_f32 v224, v224, v238
    v_cvt_pk_bf16_f32 v163, v238, v239
    v_add_f32 v225, v225, v239
    v_exp_f32 v232, v104
    v_mfma_f32_32x32x16_bf16 v[128:143], v[204:207], v[92:95], v[128:143]
    ds_read_b128 v[204:207], v230 offset:64512
    v_exp_f32 v233, v105
    v_exp_f32 v234, v106
    s_waitcnt lgkmcnt(4)
    v_mfma_f32_32x32x16_bf16 v[144:159], v[176:179], v[64:67], v[208:223]
    ds_read_b128 v[176:179], v229 offset:0
    v_exp_f32 v235, v107
    v_add_f32 v224, v224, v232
    v_mfma_f32_32x32x16_bf16 v[144:159], v[180:183], v[68:71], v[144:159]
    ds_read_b128 v[180:183], v229 offset:1024
    v_cvt_pk_bf16_f32 v164, v232, v233
    v_add_f32 v225, v225, v233
    v_exp_f32 v236, v108
    v_mfma_f32_32x32x16_bf16 v[144:159], v[184:187], v[72:75], v[144:159]
    ds_read_b128 v[184:187], v229 offset:2048
    v_exp_f32 v237, v109
    v_add_f32 v224, v224, v234
    v_cvt_pk_bf16_f32 v165, v234, v235
    v_add_f32 v225, v225, v235
    v_mfma_f32_32x32x16_bf16 v[144:159], v[188:191], v[76:79], v[144:159]
    ds_read_b128 v[188:191], v229 offset:3072
    v_exp_f32 v238, v110
    v_exp_f32 v239, v111
    s_waitcnt lgkmcnt(4)
    v_mfma_f32_32x32x16_bf16 v[144:159], v[192:195], v[80:83], v[144:159]
    ds_read_b128 v[192:195], v229 offset:4096
    v_add_f32 v224, v224, v236
    v_cvt_pk_bf16_f32 v166, v236, v237
    v_add_f32 v225, v225, v237
    v_add_f32 v224, v224, v238
    v_mfma_f32_32x32x16_bf16 v[144:159], v[196:199], v[84:87], v[144:159]
    ds_read_b128 v[196:199], v229 offset:5120
    v_cvt_pk_bf16_f32 v167, v238, v239
    v_add_f32 v225, v225, v239
    v_exp_f32 v232, v112
    v_mfma_f32_32x32x16_bf16 v[144:159], v[200:203], v[88:91], v[144:159]
    ds_read_b128 v[200:203], v229 offset:6144
    v_exp_f32 v233, v113
    v_exp_f32 v234, v114
    v_mfma_f32_32x32x16_bf16 v[144:159], v[204:207], v[92:95], v[144:159]
    ds_read_b128 v[204:207], v229 offset:7168
    v_exp_f32 v235, v115
    v_add_f32 v224, v224, v232
    v_cvt_pk_bf16_f32 v168, v232, v233
    s_waitcnt lgkmcnt(4)
    v_mfma_f32_32x32x16_bf16 v[0:15], v[176:179], v[160:163], v[0:15]
    ds_read_b128 v[176:179], v229 offset:8192
    v_add_f32 v225, v225, v233
    v_exp_f32 v236, v116
    v_exp_f32 v237, v117
    v_mfma_f32_32x32x16_bf16 v[16:31], v[180:183], v[160:163], v[16:31]
    ds_read_b128 v[180:183], v229 offset:9216
    v_add_f32 v224, v224, v234
    v_cvt_pk_bf16_f32 v169, v234, v235
    v_add_f32 v225, v225, v235
    v_mfma_f32_32x32x16_bf16 v[32:47], v[184:187], v[160:163], v[32:47]
    ds_read_b128 v[184:187], v229 offset:10240
    v_exp_f32 v238, v118
    v_exp_f32 v239, v119
    v_add_f32 v224, v224, v236
    v_mfma_f32_32x32x16_bf16 v[48:63], v[188:191], v[160:163], v[48:63]
    ds_read_b128 v[188:191], v229 offset:11264
    v_cvt_pk_bf16_f32 v170, v236, v237
    v_add_f32 v225, v225, v237
    v_add_f32 v224, v224, v238
    v_cvt_pk_bf16_f32 v171, v238, v239
    s_waitcnt lgkmcnt(4)
    v_mfma_f32_32x32x16_bf16 v[0:15], v[192:195], v[164:167], v[0:15]
    ds_read_b128 v[192:195], v229 offset:12288
    v_add_f32 v225, v225, v239
    v_exp_f32 v232, v120
    v_exp_f32 v233, v121
    v_mfma_f32_32x32x16_bf16 v[16:31], v[196:199], v[164:167], v[16:31]
    ds_read_b128 v[196:199], v229 offset:13312
    v_exp_f32 v234, v122
    v_exp_f32 v235, v123
    v_mfma_f32_32x32x16_bf16 v[32:47], v[200:203], v[164:167], v[32:47]
    ds_read_b128 v[200:203], v229 offset:14336
    v_add_f32 v224, v224, v232
    v_cvt_pk_bf16_f32 v172, v232, v233
    v_add_f32 v225, v225, v233
    v_mfma_f32_32x32x16_bf16 v[48:63], v[204:207], v[164:167], v[48:63]
    ds_read_b128 v[204:207], v229 offset:15360
    v_exp_f32 v236, v124
    v_exp_f32 v237, v125
    v_add_f32 v224, v224, v234
    s_waitcnt lgkmcnt(4)
    s_waitcnt vmcnt(8)
    s_barrier
    v_mfma_f32_32x32x16_bf16 v[0:15], v[176:179], v[168:171], v[0:15]
    ds_read_b128 v[176:179], v230 offset:0
    s_add_u32 m0, s45, 32768
    s_nop 0
    buffer_load_dwordx4 v230, s[28:31], s96 offen offset:0 lds
    v_cvt_pk_bf16_f32 v173, v234, v235
    v_add_f32 v225, v225, v235
    v_exp_f32 v238, v126
    v_mfma_f32_32x32x16_bf16 v[16:31], v[180:183], v[168:171], v[16:31]
    ds_read_b128 v[180:183], v230 offset:1024
    buffer_load_dwordx4 v230, s[28:31], s96 offen offset:1024 lds
    v_exp_f32 v239, v127
    v_add_f32 v224, v224, v236
    v_cvt_pk_bf16_f32 v174, v236, v237
    v_mfma_f32_32x32x16_bf16 v[32:47], v[184:187], v[168:171], v[32:47]
    ds_read_b128 v[184:187], v230 offset:2048
    buffer_load_dwordx4 v230, s[28:31], s96 offen offset:2048 lds
    v_add_f32 v225, v225, v237
    v_add_f32 v224, v224, v238
    v_cvt_pk_bf16_f32 v175, v238, v239
    v_add_f32 v225, v225, v239
    v_mfma_f32_32x32x16_bf16 v[48:63], v[188:191], v[168:171], v[48:63]
    ds_read_b128 v[188:191], v230 offset:3072
    buffer_load_dwordx4 v230, s[28:31], s96 offen offset:3072 lds
    s_add_u32 m0, s45, 147456
    s_waitcnt lgkmcnt(4)
    v_mfma_f32_32x32x16_bf16 v[0:15], v[192:195], v[172:175], v[0:15]
    ds_read_b128 v[192:195], v230 offset:4096
    buffer_load_dwordx4 v230, s[32:35], s97 offen offset:0 lds
    v_mfma_f32_32x32x16_bf16 v[16:31], v[196:199], v[172:175], v[16:31]
    ds_read_b128 v[196:199], v230 offset:5120
    buffer_load_dwordx4 v230, s[32:35], s97 offen offset:1024 lds
    v_mfma_f32_32x32x16_bf16 v[32:47], v[200:203], v[172:175], v[32:47]
    ds_read_b128 v[200:203], v230 offset:6144
    buffer_load_dwordx4 v230, s[32:35], s97 offen offset:2048 lds
    v_mfma_f32_32x32x16_bf16 v[48:63], v[204:207], v[172:175], v[48:63]
    ds_read_b128 v[204:207], v230 offset:7168
    buffer_load_dwordx4 v230, s[32:35], s97 offen offset:3072 lds
    s_mov_b32 s97, s96
    s_add_u32 s96, s96, 16384
    s_add_u32 s51, s51, 1
    s_cmp_ge_u32 s51, s49
    s_cbranch_scc1 K2FL_M1b
K2FL_U3:
    s_waitcnt lgkmcnt(4)
    v_mfma_f32_32x32x16_bf16 v[96:111], v[176:179], v[64:67], v[208:223]
    ds_read_b128 v[176:179], v230 offset:8192
    v_exp_f32 v232, v128
    v_exp_f32 v233, v129
    v_mfma_f32_32x32x16_bf16 v[96:111], v[180:183], v[68:71], v[96:111]
    ds_read_b128 v[180:183], v230 offset:9216
    v_exp_f32 v234, v130
    v_exp_f32 v235, v131
    v_mfma_f32_32x32x16_bf16 v[96:111], v[184:187], v[72:75], v[96:111]
    ds_read_b128 v[184:187], v230 offset:10240
    v_add_f32 v224, v224, v232
    v_cvt_pk_bf16_f32 v160, v232, v233
    v_add_f32 v225, v225, v233
    v_exp_f32 v236, v132
    v_mfma_f32_32x32x16_bf16 v[96:111], v[188:191], v[76:79], v[96:111]
    ds_read_b128 v[188:191], v230 offset:11264
    v_exp_f32 v237, v133
    v_add_f32 v224, v224, v234
    v_cvt_pk_bf16_f32 v161, v234, v235
    s_waitcnt lgkmcnt(4)
    v_mfma_f32_32x32x16_bf16 v[96:111], v[192:195], v[80:83], v[96:111]
    ds_read_b128 v[192:195], v230 offset:12288
    v_add_f32 v225, v225, v235
    v_exp_f32 v238, v134
    v_mfma_f32_32x32x16_bf16 v[96:111], v[196:199], v[84:87], v[96:111]
    ds_read_b128 v[196:199], v230 offset:13312
    v_exp_f32 v239, v135
    v_add_f32 v224, v224, v236
    v_cvt_pk_bf16_f32 v162, v236, v237
    v_add_f32 v225, v225, v237
    v_mfma_f32_32x32x16_bf16 v[96:111], v[200:203], v[88:91], v[96:111]
    ds_read_b128 v[200:203], v230 offset:14336
    v_add_f32 v224, v224, v238
    v_cvt_pk_bf16_f32 v163, v238, v239
    v_add_f32 v225, v225, v239
    v_exp_f32 v232, v136
    v_mfma_f32_32x32x16_bf16 v[96:111], v[204:207], v[92:95], v[96:111]
    ds_read_b128 v[204:207], v230 offset:15360
    v_exp_f32 v233, v137
    v_exp_f32 v234, v138
    s_waitcnt lgkmcnt(4)
    v_mfma_f32_32x32x16_bf16 v[112:127], v[176:179], v[64:67], v[208:223]
    ds_read_b128 v[176:179], v229 offset:16384
    v_exp_f32 v235, v139
    v_add_f32 v224, v224, v232
    v_mfma_f32_32x32x16_bf16 v[112:127], v[180:183], v[68:71], v[112:127]
    ds_read_b128 v[180:183], v229 offset:17408
    v_cvt_pk_bf16_f32 v164, v232, v233
    v_add_f32 v225, v225, v233
    v_exp_f32 v236, v140
    v_mfma_f32_32x32x16_bf16 v[112:127], v[184:187], v[72:75], v[112:127]
    ds_read_b128 v[184:187], v229 offset:18432
    v_exp_f32 v237, v141
    v_add_f32 v224, v224, v234
    v_cvt_pk_bf16_f32 v165, v234, v235
    v_add_f32 v225, v225, v235
    v_mfma_f32_32x32x16_bf16 v[112:127], v[188:191], v[76:79], v[112:127]
    ds_read_b128 v[188:191], v229 offset:19456
    v_exp_f32 v238, v142
    v_exp_f32 v239, v143
    s_waitcnt lgkmcnt(4)
    v_mfma_f32_32x32x16_bf16 v[112:127], v[192:195], v[80:83], v[112:127]
    ds_read_b128 v[192:195], v229 offset:20480
    v_add_f32 v224, v224, v236
    v_cvt_pk_bf16_f32 v166, v236, v237
    v_add_f32 v225, v225, v237
    v_add_f32 v224, v224, v238
    v_mfma_f32_32x32x16_bf16 v[112:127], v[196:199], v[84:87], v[112:127]
    ds_read_b128 v[196:199], v229 offset:21504
    v_cvt_pk_bf16_f32 v167, v238, v239
    v_add_f32 v225, v225, v239
    v_exp_f32 v232, v144
    v_mfma_f32_32x32x16_bf16 v[112:127], v[200:203], v[88:91], v[112:127]
    ds_read_b128 v[200:203], v229 offset:22528
    v_exp_f32 v233, v145
    v_exp_f32 v234, v146
    v_mfma_f32_32x32x16_bf16 v[112:127], v[204:207], v[92:95], v[112:127]
    ds_read_b128 v[204:207], v229 offset:23552
    v_exp_f32 v235, v147
    v_add_f32 v224, v224, v232
    v_cvt_pk_bf16_f32 v168, v232, v233
    s_waitcnt lgkmcnt(4)
    v_mfma_f32_32x32x16_bf16 v[0:15], v[176:179], v[160:163], v[0:15]
    ds_read_b128 v[176:179], v229 offset:24576
    v_add_f32 v225, v225, v233
    v_exp_f32 v236, v148
    v_exp_f32 v237, v149
    v_mfma_f32_32x32x16_bf16 v[16:31], v[180:183], v[160:163], v[16:31]
    ds_read_b128 v[180:183], v229 offset:25600
    v_add_f32 v224, v224, v234
    v_cvt_pk_bf16_f32 v169, v234, v235
    v_add_f32 v225, v225, v235
    v_mfma_f32_32x32x16_bf16 v[32:47], v[184:187], v[160:163], v[32:47]
    ds_read_b128 v[184:187], v229 offset:26624
    v_exp_f32 v238, v150
    v_exp_f32 v239, v151
    v_add_f32 v224, v224, v236
    v_mfma_f32_32x32x16_bf16 v[48:63], v[188:191], v[160:163], v[48:63]
    ds_read_b128 v[188:191], v229 offset:27648
    v_cvt_pk_bf16_f32 v170, v236, v237
    v_add_f32 v225, v225, v237
    v_add_f32 v224, v224, v238
    v_cvt_pk_bf16_f32 v171, v238, v239
    s_waitcnt lgkmcnt(4)
    v_mfma_f32_32x32x16_bf16 v[0:15], v[192:195], v[164:167], v[0:15]
    ds_read_b128 v[192:195], v229 offset:28672
    v_add_f32 v225, v225, v239
    v_exp_f32 v232, v152
    v_exp_f32 v233, v153
    v_mfma_f32_32x32x16_bf16 v[16:31], v[196:199], v[164:167], v[16:31]
    ds_read_b128 v[196:199], v229 offset:29696
    v_exp_f32 v234, v154
    v_exp_f32 v235, v155
    v_mfma_f32_32x32x16_bf16 v[32:47], v[200:203], v[164:167], v[32:47]
    ds_read_b128 v[200:203], v229 offset:30720
    v_add_f32 v224, v224, v232
    v_cvt_pk_bf16_f32 v172, v232, v233
    v_add_f32 v225, v225, v233
    v_mfma_f32_32x32x16_bf16 v[48:63], v[204:207], v[164:167], v[48:63]
    ds_read_b128 v[204:207], v229 offset:31744
    v_exp_f32 v236, v156
    v_exp_f32 v237, v157
    v_add_f32 v224, v224, v234
    s_waitcnt lgkmcnt(4)
    s_waitcnt vmcnt(8)
    s_barrier
    v_mfma_f32_32x32x16_bf16 v[0:15], v[176:179], v[168:171], v[0:15]
    ds_read_b128 v[176:179], v230 offset:16384
    s_add_u32 m0, s45, 49152
    s_nop 0
    buffer_load_dwordx4 v230, s[28:31], s96 offen offset:0 lds
    v_cvt_pk_bf16_f32 v173, v234, v235
    v_add_f32 v225, v225, v235
    v_exp_f32 v238, v158
    v_mfma_f32_32x32x16_bf16 v[16:31], v[180:183], v[168:171], v[16:31]
    ds_read_b128 v[180:183], v230 offset:17408
    buffer_load_dwordx4 v230, s[28:31], s96 offen offset:1024 lds
    v_exp_f32 v239, v159
    v_add_f32 v224, v224, v236
    v_cvt_pk_bf16_f32 v174, v236, v237
    v_mfma_f32_32x32x16_bf16 v[32:47], v[184:187], v[168:171], v[32:47]
    ds_read_b128 v[184:187], v230 offset:18432
    buffer_load_dwordx4 v230, s[28:31], s96 offen offset:2048 lds
    v_add_f32 v225, v225, v237
    v_add_f32 v224, v224, v238
    v_cvt_pk_bf16_f32 v175, v238, v239
    v_add_f32 v225, v225, v239
    v_mfma_f32_32x32x16_bf16 v[48:63], v[188:191], v[168:171], v[48:63]
    ds_read_b128 v[188:191], v230 offset:19456
    buffer_load_dwordx4 v230, s[28:31], s96 offen offset:3072 lds
    s_add_u32 m0, s45, 98304
    s_waitcnt lgkmcnt(4)
    v_mfma_f32_32x32x16_bf16 v[0:15], v[192:195], v[172:175], v[0:15]
    ds_read_b128 v[192:195], v230 offset:20480
    buffer_load_dwordx4 v230, s[32:35], s97 offen offset:0 lds
    v_mfma_f32_32x32x16_bf16 v[16:31], v[196:199], v[172:175], v[16:31]
    ds_read_b128 v[196:199], v230 offset:21504
    buffer_load_dwordx4 v230, s[32:35], s97 offen offset:1024 lds
    v_mfma_f32_32x32x16_bf16 v[32:47], v[200:203], v[172:175], v[32:47]
    ds_read_b128 v[200:203], v230 offset:22528
    buffer_load_dwordx4 v230, s[32:35], s97 offen offset:2048 lds
    v_mfma_f32_32x32x16_bf16 v[48:63], v[204:207], v[172:175], v[48:63]
    ds_read_b128 v[204:207], v230 offset:23552
    buffer_load_dwordx4 v230, s[32:35], s97 offen offset:3072 lds
    s_mov_b32 s97, s96
    s_add_u32 s96, s96, 16384
    s_add_u32 s51, s51, 1
    s_branch K2FL_U0
K2FL_M1a:
    s_waitcnt lgkmcnt(4)
    v_mfma_f32_32x32x16_bf16 v[96:111], v[176:179], v[64:67], v[208:223]
    ds_read_b128 v[176:179], v230 offset:40960
    v_exp_f32 v232, v128
    v_exp_f32 v233, v129
    v_exp_f32 v234, v130
    v_mfma_f32_32x32x16_bf16 v[96:111], v[180:183], v[68:71], v[96:111]
    ds_read_b128 v[180:183], v230 offset:41984
    v_exp_f32 v235, v131
    v_add_f32 v224, v224, v232
    v_cvt_pk_bf16_f32 v160, v232, v233
    v_mfma_f32_32x32x16_bf16 v[96:111], v[184:187], v[72:75], v[96:111]
    ds_read_b128 v[184:187], v230 offset:43008
    v_add_f32 v225, v225, v233
    v_exp_f32 v236, v132
    v_exp_f32 v237, v133
    v_add_f32 v224, v224, v234
    v_mfma_f32_32x32x16_bf16 v[96:111], v[188:191], v[76:79], v[96:111]
    ds_read_b128 v[188:191], v230 offset:44032
    v_cvt_pk_bf16_f32 v161, v234, v235
    v_add_f32 v225, v225, v235
    v_exp_f32 v238, v134
    s_waitcnt lgkmcnt(4)
    v_mfma_f32_32x32x16_bf16 v[96:111], v[192:195], v[80:83], v[96:111]
    ds_read_b128 v[192:195], v230 offset:45056
    v_exp_f32 v239, v135
    v_add_f32 v224, v224, v236
    v_cvt_pk_bf16_f32 v162, v236, v237
    v_add_f32 v225, v225, v237
    v_add_f32 v224, v224, v238
    v_mfma_f32_32x32x16_bf16 v[96:111], v[196:199], v[84:87], v[96:111]
    ds_read_b128 v[196:199], v230 offset:46080
    v_cvt_pk_bf16_f32 v163, v238, v239
    v_add_f32 v225, v225, v239
    v_exp_f32 v232, v136
    v_exp_f32 v233, v137
    v_mfma_f32_32x32x16_bf16 v[96:111], v[200:203], v[88:91], v[96:111]
    ds_read_b128 v[200:203], v230 offset:47104
    v_exp_f32 v234, v138
    v_exp_f32 v235, v139
    v_add_f32 v224, v224, v232
    v_mfma_f32_32x32x16_bf16 v[96:111], v[204:207], v[92:95], v[96:111]
    ds_read_b128 v[204:207], v230 offset:48128
    v_cvt_pk_bf16_f32 v164, v232, v233
    v_add_f32 v225, v225, v233
    v_exp_f32 v236, v140
    s_waitcnt lgkmcnt(4)
    s_cmp_lt_u32 s62, 1
    s_cselect_b64 vcc, -1, 0
    s_cbranch_vccnz K2FL_M1a_qk8
    v_mfma_f32_32x32x16_bf16 v[112:127], v[176:179], v[64:67], v[208:223]
K2FL_M1a_qk8:
    ds_read_b128 v[176:179], v229 offset:49152
    v_exp_f32 v237, v141
    v_add_f32 v224, v224, v234
    v_cvt_pk_bf16_f32 v165, v234, v235
    v_add_f32 v225, v225, v235
    v_exp_f32 v238, v142
    s_cbranch_vccnz K2FL_M1a_qk9
    v_mfma_f32_32x32x16_bf16 v[112:127], v[180:183], v[68:71], v[112:127]
K2FL_M1a_qk9:
    ds_read_b128 v[180:183], v229 offset:50176
    v_exp_f32 v239, v143
    v_add_f32 v224, v224, v236
    v_cvt_pk_bf16_f32 v166, v236, v237
    s_cbranch_vccnz K2FL_M1a_qk10
    v_mfma_f32_32x32x16_bf16 v[112:127], v[184:187], v[72:75], v[112:127]
K2FL_M1a_qk10:
    ds_read_b128 v[184:187], v229 offset:51200
    v_add_f32 v225, v225, v237
    v_add_f32 v224, v224, v238
    v_cvt_pk_bf16_f32 v167, v238, v239
    v_add_f32 v225, v225, v239
    v_exp_f32 v232, v144
    s_cbranch_vccnz K2FL_M1a_qk11
    v_mfma_f32_32x32x16_bf16 v[112:127], v[188:191], v[76:79], v[112:127]
K2FL_M1a_qk11:
    ds_read_b128 v[188:191], v229 offset:52224
    v_exp_f32 v233, v145
    v_exp_f32 v234, v146
    s_waitcnt lgkmcnt(4)
    s_cbranch_vccnz K2FL_M1a_qk12
    v_mfma_f32_32x32x16_bf16 v[112:127], v[192:195], v[80:83], v[112:127]
K2FL_M1a_qk12:
    ds_read_b128 v[192:195], v229 offset:53248
    v_exp_f32 v235, v147
    v_add_f32 v224, v224, v232
    v_cvt_pk_bf16_f32 v168, v232, v233
    v_add_f32 v225, v225, v233
    v_exp_f32 v236, v148
    s_cbranch_vccnz K2FL_M1a_qk13
    v_mfma_f32_32x32x16_bf16 v[112:127], v[196:199], v[84:87], v[112:127]
K2FL_M1a_qk13:
    ds_read_b128 v[196:199], v229 offset:54272
    v_exp_f32 v237, v149
    v_add_f32 v224, v224, v234
    v_cvt_pk_bf16_f32 v169, v234, v235
    s_cbranch_vccnz K2FL_M1a_qk14
    v_mfma_f32_32x32x16_bf16 v[112:127], v[200:203], v[88:91], v[112:127]
K2FL_M1a_qk14:
    ds_read_b128 v[200:203], v229 offset:55296
    v_add_f32 v225, v225, v235
    v_exp_f32 v238, v150
    v_exp_f32 v239, v151
    v_add_f32 v224, v224, v236
    s_cbranch_vccnz K2FL_M1a_qk15
    v_mfma_f32_32x32x16_bf16 v[112:127], v[204:207], v[92:95], v[112:127]
K2FL_M1a_qk15:
    ds_read_b128 v[204:207], v229 offset:56320
    v_cvt_pk_bf16_f32 v170, v236, v237
    v_add_f32 v225, v225, v237
    v_add_f32 v224, v224, v238
    v_cvt_pk_bf16_f32 v171, v238, v239
    v_add_f32 v225, v225, v239
    s_waitcnt lgkmcnt(4)
    v_mfma_f32_32x32x16_bf16 v[0:15], v[176:179], v[160:163], v[0:15]
    ds_read_b128 v[176:179], v229 offset:57344
    v_exp_f32 v232, v152
    v_exp_f32 v233, v153
    v_mfma_f32_32x32x16_bf16 v[16:31], v[180:183], v[160:163], v[16:31]
    ds_read_b128 v[180:183], v229 offset:58368
    v_exp_f32 v234, v154
    v_exp_f32 v235, v155
    v_add_f32 v224, v224, v232
    v_mfma_f32_32x32x16_bf16 v[32:47], v[184:187], v[160:163], v[32:47]
    ds_read_b128 v[184:187], v229 offset:59392
    v_cvt_pk_bf16_f32 v172, v232, v233
    v_add_f32 v225, v225, v233
    v_exp_f32 v236, v156
    v_mfma_f32_32x32x16_bf16 v[48:63], v[188:191], v[160:163], v[48:63]
    ds_read_b128 v[188:191], v229 offset:60416
    v_exp_f32 v237, v157
    v_add_f32 v224, v224, v234
    v_cvt_pk_bf16_f32 v173, v234, v235
    v_add_f32 v225, v225, v235
    s_waitcnt lgkmcnt(4)
    v_mfma_f32_32x32x16_bf16 v[0:15], v[192:195], v[164:167], v[0:15]
    ds_read_b128 v[192:195], v229 offset:61440
    v_exp_f32 v238, v158
    v_exp_f32 v239, v159
    v_add_f32 v224, v224, v236
    v_mfma_f32_32x32x16_bf16 v[16:31], v[196:199], v[164:167], v[16:31]
    ds_read_b128 v[196:199], v229 offset:62464
    v_cvt_pk_bf16_f32 v174, v236, v237
    v_add_f32 v225, v225, v237
    v_add_f32 v224, v224, v238
    v_cvt_pk_bf16_f32 v175, v238, v239
    v_add_f32 v225, v225, v239
    v_mfma_f32_32x32x16_bf16 v[32:47], v[200:203], v[164:167], v[32:47]
    ds_read_b128 v[200:203], v229 offset:63488
    s_add_u32 s54, s51, 1
    s_lshl_b32 s67, s54, 6
    v_subrev_u32 v227, s67, v231
    v_mov_b32 v226, s52
    v_cmp_le_i32 s[56:57], 0, v227
    v_cmp_le_i32 s[58:59], 1, v227
    v_cmp_le_i32 s[92:93], 2, v227
    v_mfma_f32_32x32x16_bf16 v[48:63], v[204:207], v[164:167], v[48:63]
    ds_read_b128 v[204:207], v229 offset:64512
    v_cmp_le_i32 s[94:95], 3, v227
    v_cndmask_b32 v96, v226, v96, s[56:57]
    v_cndmask_b32 v97, v226, v97, s[58:59]
    v_cndmask_b32 v98, v226, v98, s[92:93]
    v_cndmask_b32 v99, v226, v99, s[94:95]
    v_cmp_le_i32 s[56:57], 8, v227
    v_cmp_le_i32 s[58:59], 9, v227
    s_waitcnt lgkmcnt(4)
    s_waitcnt vmcnt(8)
    s_barrier
    v_mfma_f32_32x32x16_bf16 v[0:15], v[176:179], v[168:171], v[0:15]
    ds_read_b128 v[176:179], v230 offset:49152
    s_add_u32 m0, s45, 16384
    s_nop 0
    buffer_load_dwordx4 v230, s[28:31], s96 offen offset:0 lds
    v_cmp_le_i32 s[92:93], 10, v227
    v_cmp_le_i32 s[94:95], 11, v227
    v_cndmask_b32 v100, v226, v100, s[56:57]
    v_cndmask_b32 v101, v226, v101, s[58:59]
    v_cndmask_b32 v102, v226, v102, s[92:93]
    v_cndmask_b32 v103, v226, v103, s[94:95]
    v_mfma_f32_32x32x16_bf16 v[16:31], v[180:183], v[168:171], v[16:31]
    ds_read_b128 v[180:183], v230 offset:50176
    buffer_load_dwordx4 v230, s[28:31], s96 offen offset:1024 lds
    v_cmp_le_i32 s[56:57], 16, v227
    v_cmp_le_i32 s[58:59], 17, v227
    v_cmp_le_i32 s[92:93], 18, v227
    v_cmp_le_i32 s[94:95], 19, v227
    v_cndmask_b32 v104, v226, v104, s[56:57]
    v_cndmask_b32 v105, v226, v105, s[58:59]
    v_cndmask_b32 v106, v226, v106, s[92:93]
    v_mfma_f32_32x32x16_bf16 v[32:47], v[184:187], v[168:171], v[32:47]
    ds_read_b128 v[184:187], v230 offset:51200
    buffer_load_dwordx4 v230, s[28:31], s96 offen offset:2048 lds
    v_cndmask_b32 v107, v226, v107, s[94:95]
    v_cmp_le_i32 s[56:57], 24, v227
    v_cmp_le_i32 s[58:59], 25, v227
    v_cmp_le_i32 s[92:93], 26, v227
    v_cmp_le_i32 s[94:95], 27, v227
    v_cndmask_b32 v108, v226, v108, s[56:57]
    v_cndmask_b32 v109, v226, v109, s[58:59]
    v_mfma_f32_32x32x16_bf16 v[48:63], v[188:191], v[168:171], v[48:63]
    ds_read_b128 v[188:191], v230 offset:52224
    buffer_load_dwordx4 v230, s[28:31], s96 offen offset:3072 lds
    s_add_u32 m0, s45, 131072
    v_cndmask_b32 v110, v226, v110, s[92:93]
    v_cndmask_b32 v111, v226, v111, s[94:95]
    v_cmp_le_i32 s[56:57], 32, v227
    v_cmp_le_i32 s[58:59], 33, v227
    v_cmp_le_i32 s[92:93], 34, v227
    v_cmp_le_i32 s[94:95], 35, v227
    v_cndmask_b32 v112, v226, v112, s[56:57]
    s_waitcnt lgkmcnt(4)
    v_mfma_f32_32x32x16_bf16 v[0:15], v[192:195], v[172:175], v[0:15]
    ds_read_b128 v[192:195], v230 offset:53248
    buffer_load_dwordx4 v230, s[32:35], s97 offen offset:0 lds
    v_cndmask_b32 v113, v226, v113, s[58:59]
    v_cndmask_b32 v114, v226, v114, s[92:93]
    v_cndmask_b32 v115, v226, v115, s[94:95]
    v_cmp_le_i32 s[56:57], 40, v227
    v_cmp_le_i32 s[58:59], 41, v227
    v_cmp_le_i32 s[92:93], 42, v227
    v_cmp_le_i32 s[94:95], 43, v227
    v_mfma_f32_32x32x16_bf16 v[16:31], v[196:199], v[172:175], v[16:31]
    ds_read_b128 v[196:199], v230 offset:54272
    buffer_load_dwordx4 v230, s[32:35], s97 offen offset:1024 lds
    v_cndmask_b32 v116, v226, v116, s[56:57]
    v_cndmask_b32 v117, v226, v117, s[58:59]
    v_cndmask_b32 v118, v226, v118, s[92:93]
    v_cndmask_b32 v119, v226, v119, s[94:95]
    v_cmp_le_i32 s[56:57], 48, v227
    v_cmp_le_i32 s[58:59], 49, v227
    v_mfma_f32_32x32x16_bf16 v[32:47], v[200:203], v[172:175], v[32:47]
    ds_read_b128 v[200:203], v230 offset:55296
    buffer_load_dwordx4 v230, s[32:35], s97 offen offset:2048 lds
    v_cmp_le_i32 s[92:93], 50, v227
    v_cmp_le_i32 s[94:95], 51, v227
    v_cndmask_b32 v120, v226, v120, s[56:57]
    v_cndmask_b32 v121, v226, v121, s[58:59]
    v_cndmask_b32 v122, v226, v122, s[92:93]
    v_cndmask_b32 v123, v226, v123, s[94:95]
    v_cmp_le_i32 s[56:57], 56, v227
    v_mfma_f32_32x32x16_bf16 v[48:63], v[204:207], v[172:175], v[48:63]
    ds_read_b128 v[204:207], v230 offset:56320
    buffer_load_dwordx4 v230, s[32:35], s97 offen offset:3072 lds
    s_mov_b32 s97, s96
    s_add_u32 s96, s96, 16384
    v_cmp_le_i32 s[58:59], 57, v227
    v_cmp_le_i32 s[92:93], 58, v227
    v_cmp_le_i32 s[94:95], 59, v227
    v_cndmask_b32 v124, v226, v124, s[56:57]
    v_cndmask_b32 v125, v226, v125, s[58:59]
    v_cndmask_b32 v126, v226, v126, s[92:93]
    v_cndmask_b32 v127, v226, v127, s[94:95]
    s_add_u32 s51, s51, 1
K2FL_M0a:
    s_waitcnt lgkmcnt(4)
    s_cmp_lt_u32 s62, 2
    s_cselect_b64 vcc, -1, 0
    s_cbranch_vccnz K2FL_M0a_qk0
    v_mfma_f32_32x32x16_bf16 v[128:143], v[176:179], v[64:67], v[208:223]
K2FL_M0a_qk0:
    ds_read_b128 v[176:179], v230 offset:57344
    v_exp_f32 v232, v96
    v_exp_f32 v233, v97
    v_exp_f32 v234, v98
    s_cbranch_vccnz K2FL_M0a_qk1
    v_mfma_f32_32x32x16_bf16 v[128:143], v[180:183], v[68:71], v[128:143]
K2FL_M0a_qk1:
    ds_read_b128 v[180:183], v230 offset:58368
    v_exp_f32 v235, v99
    v_add_f32 v224, v224, v232
    v_cvt_pk_bf16_f32 v160, v232, v233
    s_cbranch_vccnz K2FL_M0a_qk2
    v_mfma_f32_32x32x16_bf16 v[128:143], v[184:187], v[72:75], v[128:143]
K2FL_M0a_qk2:
    ds_read_b128 v[184:187], v230 offset:59392
    v_add_f32 v225, v225, v233
    v_exp_f32 v236, v100
    v_exp_f32 v237, v101
    v_add_f32 v224, v224, v234
    s_cbranch_vccnz K2FL_M0a_qk3
    v_mfma_f32_32x32x16_bf16 v[128:143], v[188:191], v[76:79], v[128:143]
K2FL_M0a_qk3:
    ds_read_b128 v[188:191], v230 offset:60416
    v_cvt_pk_bf16_f32 v161, v234, v235
    v_add_f32 v225, v225, v235
    v_exp_f32 v238, v102
    s_waitcnt lgkmcnt(4)
    s_cbranch_vccnz K2FL_M0a_qk4
    v_mfma_f32_32x32x16_bf16 v[128:143], v[192:195], v[80:83], v[128:143]
K2FL_M0a_qk4:
    ds_read_b128 v[192:195], v230 offset:61440
    v_exp_f32 v239, v103
    v_add_f32 v224, v224, v236
    v_cvt_pk_bf16_f32 v162, v236, v237
    v_add_f32 v225, v225, v237
    v_add_f32 v224, v224, v238
    s_cbranch_vccnz K2FL_M0a_qk5
    v_mfma_f32_32x32x16_bf16 v[128:143], v[196:199], v[84:87], v[128:143]
K2FL_M0a_qk5:
    ds_read_b128 v[196:199], v230 offset:62464
    v_cvt_pk_bf16_f32 v163, v238, v239
    v_add_f32 v225, v225, v239
    v_exp_f32 v232, v104
    v_exp_f32 v233, v105
    s_cbranch_vccnz K2FL_M0a_qk6
    v_mfma_f32_32x32x16_bf16 v[128:143], v[200:203], v[88:91], v[128:143]
K2FL_M0a_qk6:
    ds_read_b128 v[200:203], v230 offset:63488
    v_exp_f32 v234, v106
    v_exp_f32 v235, v107
    v_add_f32 v224, v224, v232
    s_cbranch_vccnz K2FL_M0a_qk7
    v_mfma_f32_32x32x16_bf16 v[128:143], v[204:207], v[92:95], v[128:143]
K2FL_M0a_qk7:
    ds_read_b128 v[204:207], v230 offset:64512
    v_cvt_pk_bf16_f32 v164, v232, v233
    v_add_f32 v225, v225, v233
    v_exp_f32 v236, v108
    s_waitcnt lgkmcnt(4)
    s_cmp_lt_u32 s62, 3
    s_cselect_b64 vcc, -1, 0
    s_cbranch_vccnz K2FL_M0a_qk8
    v_mfma_f32_32x32x16_bf16 v[144:159], v[176:179], v[64:67], v[208:223]
K2FL_M0a_qk8:
    ds_read_b128 v[176:179], v229 offset:0
    v_exp_f32 v237, v109
    v_add_f32 v224, v224, v234
    v_cvt_pk_bf16_f32 v165, v234, v235
    v_add_f32 v225, v225, v235
    v_exp_f32 v238, v110
    s_cbranch_vccnz K2FL_M0a_qk9
    v_mfma_f32_32x32x16_bf16 v[144:159], v[180:183], v[68:71], v[144:159]
K2FL_M0a_qk9:
    ds_read_b128 v[180:183], v229 offset:1024
    v_exp_f32 v239, v111
    v_add_f32 v224, v224, v236
    v_cvt_pk_bf16_f32 v166, v236, v237
    s_cbranch_vccnz K2FL_M0a_qk10
    v_mfma_f32_32x32x16_bf16 v[144:159], v[184:187], v[72:75], v[144:159]
K2FL_M0a_qk10:
    ds_read_b128 v[184:187], v229 offset:2048
    v_add_f32 v225, v225, v237
    v_add_f32 v224, v224, v238
    v_cvt_pk_bf16_f32 v167, v238, v239
    v_add_f32 v225, v225, v239
    v_exp_f32 v232, v112
    s_cbranch_vccnz K2FL_M0a_qk11
    v_mfma_f32_32x32x16_bf16 v[144:159], v[188:191], v[76:79], v[144:159]
K2FL_M0a_qk11:
    ds_read_b128 v[188:191], v229 offset:3072
    v_exp_f32 v233, v113
    v_exp_f32 v234, v114
    s_waitcnt lgkmcnt(4)
    s_cbranch_vccnz K2FL_M0a_qk12
    v_mfma_f32_32x32x16_bf16 v[144:159], v[192:195], v[80:83], v[144:159]
K2FL_M0a_qk12:
    ds_read_b128 v[192:195], v229 offset:4096
    v_exp_f32 v235, v115
    v_add_f32 v224, v224, v232
    v_cvt_pk_bf16_f32 v168, v232, v233
    v_add_f32 v225, v225, v233
    v_exp_f32 v236, v116
    s_cbranch_vccnz K2FL_M0a_qk13
    v_mfma_f32_32x32x16_bf16 v[144:159], v[196:199], v[84:87], v[144:159]
K2FL_M0a_qk13:
    ds_read_b128 v[196:199], v229 offset:5120
    v_exp_f32 v237, v117
    v_add_f32 v224, v224, v234
    v_cvt_pk_bf16_f32 v169, v234, v235
    s_cbranch_vccnz K2FL_M0a_qk14
    v_mfma_f32_32x32x16_bf16 v[144:159], v[200:203], v[88:91], v[144:159]
K2FL_M0a_qk14:
    ds_read_b128 v[200:203], v229 offset:6144
    v_add_f32 v225, v225, v235
    v_exp_f32 v238, v118
    v_exp_f32 v239, v119
    v_add_f32 v224, v224, v236
    s_cbranch_vccnz K2FL_M0a_qk15
    v_mfma_f32_32x32x16_bf16 v[144:159], v[204:207], v[92:95], v[144:159]
K2FL_M0a_qk15:
    ds_read_b128 v[204:207], v229 offset:7168
    v_cvt_pk_bf16_f32 v170, v236, v237
    v_add_f32 v225, v225, v237
    v_add_f32 v224, v224, v238
    v_cvt_pk_bf16_f32 v171, v238, v239
    v_add_f32 v225, v225, v239
    s_waitcnt lgkmcnt(4)
    v_mfma_f32_32x32x16_bf16 v[0:15], v[176:179], v[160:163], v[0:15]
    ds_read_b128 v[176:179], v229 offset:8192
    v_exp_f32 v232, v120
    v_exp_f32 v233, v121
    v_mfma_f32_32x32x16_bf16 v[16:31], v[180:183], v[160:163], v[16:31]
    ds_read_b128 v[180:183], v229 offset:9216
    v_exp_f32 v234, v122
    v_exp_f32 v235, v123
    v_add_f32 v224, v224, v232
    v_mfma_f32_32x32x16_bf16 v[32:47], v[184:187], v[160:163], v[32:47]
    ds_read_b128 v[184:187], v229 offset:10240
    v_cvt_pk_bf16_f32 v172, v232, v233
    v_add_f32 v225, v225, v233
    v_exp_f32 v236, v124
    v_mfma_f32_32x32x16_bf16 v[48:63], v[188:191], v[160:163], v[48:63]
    ds_read_b128 v[188:191], v229 offset:11264
    v_exp_f32 v237, v125
    v_add_f32 v224, v224, v234
    v_cvt_pk_bf16_f32 v173, v234, v235
    v_add_f32 v225, v225, v235
    s_waitcnt lgkmcnt(4)
    v_mfma_f32_32x32x16_bf16 v[0:15], v[192:195], v[164:167], v[0:15]
    ds_read_b128 v[192:195], v229 offset:12288
    v_exp_f32 v238, v126
    v_exp_f32 v239, v127
    v_add_f32 v224, v224, v236
    v_mfma_f32_32x32x16_bf16 v[16:31], v[196:199], v[164:167], v[16:31]
    ds_read_b128 v[196:199], v229 offset:13312
    v_cvt_pk_bf16_f32 v174, v236, v237
    v_add_f32 v225, v225, v237
    v_add_f32 v224, v224, v238
    v_cvt_pk_bf16_f32 v175, v238, v239
    v_add_f32 v225, v225, v239
    v_mfma_f32_32x32x16_bf16 v[32:47], v[200:203], v[164:167], v[32:47]
    ds_read_b128 v[200:203], v229 offset:14336
    s_add_u32 s54, s51, 1
    s_lshl_b32 s67, s54, 6
    v_subrev_u32 v227, s67, v231
    v_mov_b32 v226, s52
    v_cmp_le_i32 s[56:57], 0, v227
    v_cmp_le_i32 s[58:59], 1, v227
    v_cmp_le_i32 s[92:93], 2, v227
    v_mfma_f32_32x32x16_bf16 v[48:63], v[204:207], v[164:167], v[48:63]
    ds_read_b128 v[204:207], v229 offset:15360
    v_cmp_le_i32 s[94:95], 3, v227
    v_cndmask_b32 v128, v226, v128, s[56:57]
    v_cndmask_b32 v129, v226, v129, s[58:59]
    v_cndmask_b32 v130, v226, v130, s[92:93]
    v_cndmask_b32 v131, v226, v131, s[94:95]
    v_cmp_le_i32 s[56:57], 8, v227
    v_cmp_le_i32 s[58:59], 9, v227
    s_waitcnt lgkmcnt(4)
    s_waitcnt vmcnt(8)
    s_barrier
    s_cmp_lt_u32 s62, 1
    s_cselect_b64 vcc, -1, 0
    s_cbranch_vccnz K2FL_M0a_pv8
    v_mfma_f32_32x32x16_bf16 v[0:15], v[176:179], v[168:171], v[0:15]
K2FL_M0a_pv8:
    ds_read_b128 v[176:179], v229 offset:16384
    s_add_u32 m0, s45, 32768
    s_nop 0
    buffer_load_dwordx4 v230, s[28:31], s96 offen offset:0 lds
    v_cmp_le_i32 s[92:93], 10, v227
    v_cmp_le_i32 s[94:95], 11, v227
    v_cndmask_b32 v132, v226, v132, s[56:57]
    v_cndmask_b32 v133, v226, v133, s[58:59]
    v_cndmask_b32 v134, v226, v134, s[92:93]
    v_cndmask_b32 v135, v226, v135, s[94:95]
    s_cbranch_vccnz K2FL_M0a_pv9
    v_mfma_f32_32x32x16_bf16 v[16:31], v[180:183], v[168:171], v[16:31]
K2FL_M0a_pv9:
    ds_read_b128 v[180:183], v229 offset:17408
    buffer_load_dwordx4 v230, s[28:31], s96 offen offset:1024 lds
    v_cmp_le_i32 s[56:57], 16, v227
    v_cmp_le_i32 s[58:59], 17, v227
    v_cmp_le_i32 s[92:93], 18, v227
    v_cmp_le_i32 s[94:95], 19, v227
    v_cndmask_b32 v136, v226, v136, s[56:57]
    v_cndmask_b32 v137, v226, v137, s[58:59]
    v_cndmask_b32 v138, v226, v138, s[92:93]
    s_cbranch_vccnz K2FL_M0a_pv10
    v_mfma_f32_32x32x16_bf16 v[32:47], v[184:187], v[168:171], v[32:47]
K2FL_M0a_pv10:
    ds_read_b128 v[184:187], v229 offset:18432
    buffer_load_dwordx4 v230, s[28:31], s96 offen offset:2048 lds
    v_cndmask_b32 v139, v226, v139, s[94:95]
    v_cmp_le_i32 s[56:57], 24, v227
    v_cmp_le_i32 s[58:59], 25, v227
    v_cmp_le_i32 s[92:93], 26, v227
    v_cmp_le_i32 s[94:95], 27, v227
    v_cndmask_b32 v140, v226, v140, s[56:57]
    v_cndmask_b32 v141, v226, v141, s[58:59]
    s_cbranch_vccnz K2FL_M0a_pv11
    v_mfma_f32_32x32x16_bf16 v[48:63], v[188:191], v[168:171], v[48:63]
K2FL_M0a_pv11:
    ds_read_b128 v[188:191], v229 offset:19456
    buffer_load_dwordx4 v230, s[28:31], s96 offen offset:3072 lds
    s_add_u32 m0, s45, 147456
    v_cndmask_b32 v142, v226, v142, s[92:93]
    v_cndmask_b32 v143, v226, v143, s[94:95]
    v_cmp_le_i32 s[56:57], 32, v227
    v_cmp_le_i32 s[58:59], 33, v227
    v_cmp_le_i32 s[92:93], 34, v227
    v_cmp_le_i32 s[94:95], 35, v227
    v_cndmask_b32 v144, v226, v144, s[56:57]
    s_waitcnt lgkmcnt(4)
    s_cbranch_vccnz K2FL_M0a_pv12
    v_mfma_f32_32x32x16_bf16 v[0:15], v[192:195], v[172:175], v[0:15]
K2FL_M0a_pv12:
    ds_read_b128 v[192:195], v229 offset:20480
    buffer_load_dwordx4 v230, s[32:35], s97 offen offset:0 lds
    v_cndmask_b32 v145, v226, v145, s[58:59]
    v_cndmask_b32 v146, v226, v146, s[92:93]
    v_cndmask_b32 v147, v226, v147, s[94:95]
    v_cmp_le_i32 s[56:57], 40, v227
    v_cmp_le_i32 s[58:59], 41, v227
    v_cmp_le_i32 s[92:93], 42, v227
    v_cmp_le_i32 s[94:95], 43, v227
    s_cbranch_vccnz K2FL_M0a_pv13
    v_mfma_f32_32x32x16_bf16 v[16:31], v[196:199], v[172:175], v[16:31]
K2FL_M0a_pv13:
    ds_read_b128 v[196:199], v229 offset:21504
    buffer_load_dwordx4 v230, s[32:35], s97 offen offset:1024 lds
    v_cndmask_b32 v148, v226, v148, s[56:57]
    v_cndmask_b32 v149, v226, v149, s[58:59]
    v_cndmask_b32 v150, v226, v150, s[92:93]
    v_cndmask_b32 v151, v226, v151, s[94:95]
    v_cmp_le_i32 s[56:57], 48, v227
    v_cmp_le_i32 s[58:59], 49, v227
    s_cbranch_vccnz K2FL_M0a_pv14
    v_mfma_f32_32x32x16_bf16 v[32:47], v[200:203], v[172:175], v[32:47]
K2FL_M0a_pv14:
    ds_read_b128 v[200:203], v229 offset:22528
    buffer_load_dwordx4 v230, s[32:35], s97 offen offset:2048 lds
    v_cmp_le_i32 s[92:93], 50, v227
    v_cmp_le_i32 s[94:95], 51, v227
    v_cndmask_b32 v152, v226, v152, s[56:57]
    v_cndmask_b32 v153, v226, v153, s[58:59]
    v_cndmask_b32 v154, v226, v154, s[92:93]
    v_cndmask_b32 v155, v226, v155, s[94:95]
    v_cmp_le_i32 s[56:57], 56, v227
    s_cbranch_vccnz K2FL_M0a_pv15
    v_mfma_f32_32x32x16_bf16 v[48:63], v[204:207], v[172:175], v[48:63]
K2FL_M0a_pv15:
    ds_read_b128 v[204:207], v229 offset:23552
    buffer_load_dwordx4 v230, s[32:35], s97 offen offset:3072 lds
    s_mov_b32 s97, s96
    s_add_u32 s96, s96, 16384
    v_cmp_le_i32 s[58:59], 57, v227
    v_cmp_le_i32 s[92:93], 58, v227
    v_cmp_le_i32 s[94:95], 59, v227
    v_cndmask_b32 v156, v226, v156, s[56:57]
    v_cndmask_b32 v157, v226, v157, s[58:59]
    v_cndmask_b32 v158, v226, v158, s[92:93]
    v_cndmask_b32 v159, v226, v159, s[94:95]
    s_add_u32 s51, s51, 1
K2FL_L1a:
    v_exp_f32 v232, v128
    v_exp_f32 v233, v129
    v_exp_f32 v234, v130
    v_exp_f32 v235, v131
    v_add_f32 v224, v224, v232
    v_cvt_pk_bf16_f32 v160, v232, v233
    v_add_f32 v225, v225, v233
    v_exp_f32 v236, v132
    v_exp_f32 v237, v133
    v_add_f32 v224, v224, v234
    v_cvt_pk_bf16_f32 v161, v234, v235
    v_add_f32 v225, v225, v235
    v_exp_f32 v238, v134
    v_exp_f32 v239, v135
    v_add_f32 v224, v224, v236
    v_cvt_pk_bf16_f32 v162, v236, v237
    v_add_f32 v225, v225, v237
    v_add_f32 v224, v224, v238
    v_cvt_pk_bf16_f32 v163, v238, v239
    v_add_f32 v225, v225, v239
    s_nop 0
    s_waitcnt lgkmcnt(6)
    s_cmp_lt_u32 s62, 2
    s_cselect_b64 vcc, -1, 0
    s_cbranch_vccnz K2FL_L1a_pv0
    v_mfma_f32_32x32x16_bf16 v[0:15], v[176:179], v[160:163], v[0:15]
K2FL_L1a_pv0:
    ds_read_b128 v[176:179], v229 offset:24576
    v_exp_f32 v232, v136
    v_exp_f32 v233, v137
    v_exp_f32 v234, v138
    v_exp_f32 v235, v139
    v_add_f32 v224, v224, v232
    s_cbranch_vccnz K2FL_L1a_pv1
    v_mfma_f32_32x32x16_bf16 v[16:31], v[180:183], v[160:163], v[16:31]
K2FL_L1a_pv1:
    ds_read_b128 v[180:183], v229 offset:25600
    v_cvt_pk_bf16_f32 v164, v232, v233
    v_add_f32 v225, v225, v233
    v_exp_f32 v236, v140
    v_exp_f32 v237, v141
    v_add_f32 v224, v224, v234
    s_waitcnt lgkmcnt(6)
    s_cbranch_vccnz K2FL_L1a_pv2
    v_mfma_f32_32x32x16_bf16 v[32:47], v[184:187], v[160:163], v[32:47]
K2FL_L1a_pv2:
    ds_read_b128 v[184:187], v229 offset:26624
    v_cvt_pk_bf16_f32 v165, v234, v235
    v_add_f32 v225, v225, v235
    v_exp_f32 v238, v142
    v_exp_f32 v239, v143
    v_add_f32 v224, v224, v236
    s_cbranch_vccnz K2FL_L1a_pv3
    v_mfma_f32_32x32x16_bf16 v[48:63], v[188:191], v[160:163], v[48:63]
K2FL_L1a_pv3:
    ds_read_b128 v[188:191], v229 offset:27648
    v_cvt_pk_bf16_f32 v166, v236, v237
    v_add_f32 v225, v225, v237
    v_add_f32 v224, v224, v238
    v_cvt_pk_bf16_f32 v167, v238, v239
    v_add_f32 v225, v225, v239
    s_nop 1
    s_waitcnt lgkmcnt(6)
    s_cbranch_vccnz K2FL_L1a_pv4
    v_mfma_f32_32x32x16_bf16 v[0:15], v[192:195], v[164:167], v[0:15]
K2FL_L1a_pv4:
    ds_read_b128 v[192:195], v229 offset:28672
    v_exp_f32 v232, v144
    v_exp_f32 v233, v145
    v_exp_f32 v234, v146
    v_exp_f32 v235, v147
    v_add_f32 v224, v224, v232
    s_cbranch_vccnz K2FL_L1a_pv5
    v_mfma_f32_32x32x16_bf16 v[16:31], v[196:199], v[164:167], v[16:31]
K2FL_L1a_pv5:
    ds_read_b128 v[196:199], v229 offset:29696
    v_cvt_pk_bf16_f32 v168, v232, v233
    v_add_f32 v225, v225, v233
    v_exp_f32 v236, v148
    v_exp_f32 v237, v149
    v_add_f32 v224, v224, v234
    s_waitcnt lgkmcnt(6)
    s_cbranch_vccnz K2FL_L1a_pv6
    v_mfma_f32_32x32x16_bf16 v[32:47], v[200:203], v[164:167], v[32:47]
K2FL_L1a_pv6:
    ds_read_b128 v[200:203], v229 offset:30720
    v_cvt_pk_bf16_f32 v169, v234, v235
    v_add_f32 v225, v225, v235
    v_exp_f32 v238, v150
    v_exp_f32 v239, v151
    v_add_f32 v224, v224, v236
    s_cbranch_vccnz K2FL_L1a_pv7
    v_mfma_f32_32x32x16_bf16 v[48:63], v[204:207], v[164:167], v[48:63]
K2FL_L1a_pv7:
    ds_read_b128 v[204:207], v229 offset:31744
    v_cvt_pk_bf16_f32 v170, v236, v237
    v_add_f32 v225, v225, v237
    v_add_f32 v224, v224, v238
    v_cvt_pk_bf16_f32 v171, v238, v239
    v_add_f32 v225, v225, v239
    s_nop 1
    s_waitcnt lgkmcnt(7)
    s_waitcnt vmcnt(8)
    s_barrier
    s_cmp_lt_u32 s62, 3
    s_cselect_b64 vcc, -1, 0
    s_cbranch_vccnz K2FL_L1a_pv8
    v_mfma_f32_32x32x16_bf16 v[0:15], v[176:179], v[168:171], v[0:15]
K2FL_L1a_pv8:
    v_exp_f32 v232, v152
    v_exp_f32 v233, v153
    v_exp_f32 v234, v154
    v_exp_f32 v235, v155
    v_add_f32 v224, v224, v232
    s_waitcnt lgkmcnt(6)
    s_cbranch_vccnz K2FL_L1a_pv9
    v_mfma_f32_32x32x16_bf16 v[16:31], v[180:183], v[168:171], v[16:31]
K2FL_L1a_pv9:
    v_cvt_pk_bf16_f32 v172, v232, v233
    v_add_f32 v225, v225, v233
    v_exp_f32 v236, v156
    v_exp_f32 v237, v157
    v_add_f32 v224, v224, v234
    s_waitcnt lgkmcnt(5)
    s_cbranch_vccnz K2FL_L1a_pv10
    v_mfma_f32_32x32x16_bf16 v[32:47], v[184:187], v[168:171], v[32:47]
K2FL_L1a_pv10:
    v_cvt_pk_bf16_f32 v173, v234, v235
    v_add_f32 v225, v225, v235
    v_exp_f32 v238, v158
    v_exp_f32 v239, v159
    v_add_f32 v224, v224, v236
    s_waitcnt lgkmcnt(4)
    s_cbranch_vccnz K2FL_L1a_pv11
    v_mfma_f32_32x32x16_bf16 v[48:63], v[188:191], v[168:171], v[48:63]
K2FL_L1a_pv11:
    v_cvt_pk_bf16_f32 v174, v236, v237
    v_add_f32 v225, v225, v237
    v_add_f32 v224, v224, v238
    v_cvt_pk_bf16_f32 v175, v238, v239
    v_add_f32 v225, v225, v239
    s_nop 1
    s_waitcnt lgkmcnt(3)
    s_cbranch_vccnz K2FL_L1a_pv12
    v_mfma_f32_32x32x16_bf16 v[0:15], v[192:195], v[172:175], v[0:15]
K2FL_L1a_pv12:
    s_cmp_eq_u32 s60, 0
    s_cbranch_scc1 K2FL_L1a_nl
    s_add_u32 s64, s51, 3
    s_cmp_ge_u32 s64, s18
    s_cbranch_scc1 K2FL_L1a_nl
    s_add_u32 s65, s64, 1
    s_and_b32 s66, s65, 3
    s_lshl_b32 s66, s66, 14
    s_add_u32 m0, s66, s45
    s_lshl_b32 s65, s65, 14
    s_add_u32 s65, s65, s46
    buffer_load_dwordx4 v230, s[28:31], s65 offen offset:0 lds
    buffer_load_dwordx4 v230, s[28:31], s65 offen offset:1024 lds
    buffer_load_dwordx4 v230, s[28:31], s65 offen offset:2048 lds
    buffer_load_dwordx4 v230, s[28:31], s65 offen offset:3072 lds
    s_add_u32 s66, s64, 2
    s_and_b32 s66, s66, 3
    s_lshl_b32 s66, s66, 14
    s_add_u32 s66, s66, s45
    s_add_u32 m0, s66, 98304
    s_sub_u32 s65, s65, 16384
    buffer_load_dwordx4 v230, s[32:35], s65 offen offset:0 lds
    buffer_load_dwordx4 v230, s[32:35], s65 offen offset:1024 lds
    buffer_load_dwordx4 v230, s[32:35], s65 offen offset:2048 lds
    buffer_load_dwordx4 v230, s[32:35], s65 offen offset:3072 lds
K2FL_L1a_nl:
    s_waitcnt lgkmcnt(2)
    s_cbranch_vccnz K2FL_L1a_pv13
    v_mfma_f32_32x32x16_bf16 v[16:31], v[196:199], v[172:175], v[16:31]
K2FL_L1a_pv13:
    s_waitcnt lgkmcnt(1)
    s_cbranch_vccnz K2FL_L1a_pv14
    v_mfma_f32_32x32x16_bf16 v[32:47], v[200:203], v[172:175], v[32:47]
K2FL_L1a_pv14:
    s_waitcnt lgkmcnt(0)
    s_cbranch_vccnz K2FL_L1a_pv15
    v_mfma_f32_32x32x16_bf16 v[48:63], v[204:207], v[172:175], v[48:63]
K2FL_L1a_pv15:
    s_nop 1
    s_add_u32 s51, s51, 1
    s_branch K2F_EPI
K2FL_M1b:
    s_waitcnt lgkmcnt(4)
    v_mfma_f32_32x32x16_bf16 v[96:111], v[176:179], v[64:67], v[208:223]
    ds_read_b128 v[176:179], v230 offset:8192
    v_exp_f32 v232, v128
    v_exp_f32 v233, v129
    v_exp_f32 v234, v130
    v_mfma_f32_32x32x16_bf16 v[96:111], v[180:183], v[68:71], v[96:111]
    ds_read_b128 v[180:183], v230 offset:9216
    v_exp_f32 v235, v131
    v_add_f32 v224, v224, v232
    v_cvt_pk_bf16_f32 v160, v232, v233
    v_mfma_f32_32x32x16_bf16 v[96:111], v[184:187], v[72:75], v[96:111]
    ds_read_b128 v[184:187], v230 offset:10240
    v_add_f32 v225, v225, v233
    v_exp_f32 v236, v132
    v_exp_f32 v237, v133
    v_add_f32 v224, v224, v234
    v_mfma_f32_32x32x16_bf16 v[96:111], v[188:191], v[76:79], v[96:111]
    ds_read_b128 v[188:191], v230 offset:11264
    v_cvt_pk_bf16_f32 v161, v234, v235
    v_add_f32 v225, v225, v235
    v_exp_f32 v238, v134
    s_waitcnt lgkmcnt(4)
    v_mfma_f32_32x32x16_bf16 v[96:111], v[192:195], v[80:83], v[96:111]
    ds_read_b128 v[192:195], v230 offset:12288
    v_exp_f32 v239, v135
    v_add_f32 v224, v224, v236
    v_cvt_pk_bf16_f32 v162, v236, v237
    v_add_f32 v225, v225, v237
    v_add_f32 v224, v224, v238
    v_mfma_f32_32x32x16_bf16 v[96:111], v[196:199], v[84:87], v[96:111]
    ds_read_b128 v[196:199], v230 offset:13312
    v_cvt_pk_bf16_f32 v163, v238, v239
    v_add_f32 v225, v225, v239
    v_exp_f32 v232, v136
    v_exp_f32 v233, v137
    v_mfma_f32_32x32x16_bf16 v[96:111], v[200:203], v[88:91], v[96:111]
    ds_read_b128 v[200:203], v230 offset:14336
    v_exp_f32 v234, v138
    v_exp_f32 v235, v139
    v_add_f32 v224, v224, v232
    v_mfma_f32_32x32x16_bf16 v[96:111], v[204:207], v[92:95], v[96:111]
    ds_read_b128 v[204:207], v230 offset:15360
    v_cvt_pk_bf16_f32 v164, v232, v233
    v_add_f32 v225, v225, v233
    v_exp_f32 v236, v140
    s_waitcnt lgkmcnt(4)
    s_cmp_lt_u32 s62, 1
    s_cselect_b64 vcc, -1, 0
    s_cbranch_vccnz K2FL_M1b_qk8
    v_mfma_f32_32x32x16_bf16 v[112:127], v[176:179], v[64:67], v[208:223]
K2FL_M1b_qk8:
    ds_read_b128 v[176:179], v229 offset:16384
    v_exp_f32 v237, v141
    v_add_f32 v224, v224, v234
    v_cvt_pk_bf16_f32 v165, v234, v235
    v_add_f32 v225, v225, v235
    v_exp_f32 v238, v142
    s_cbranch_vccnz K2FL_M1b_qk9
    v_mfma_f32_32x32x16_bf16 v[112:127], v[180:183], v[68:71], v[112:127]
K2FL_M1b_qk9:
    ds_read_b128 v[180:183], v229 offset:17408
    v_exp_f32 v239, v143
    v_add_f32 v224, v224, v236
    v_cvt_pk_bf16_f32 v166, v236, v237
    s_cbranch_vccnz K2FL_M1b_qk10
    v_mfma_f32_32x32x16_bf16 v[112:127], v[184:187], v[72:75], v[112:127]
K2FL_M1b_qk10:
    ds_read_b128 v[184:187], v229 offset:18432
    v_add_f32 v225, v225, v237
    v_add_f32 v224, v224, v238
    v_cvt_pk_bf16_f32 v167, v238, v239
    v_add_f32 v225, v225, v239
    v_exp_f32 v232, v144
    s_cbranch_vccnz K2FL_M1b_qk11
    v_mfma_f32_32x32x16_bf16 v[112:127], v[188:191], v[76:79], v[112:127]
K2FL_M1b_qk11:
    ds_read_b128 v[188:191], v229 offset:19456
    v_exp_f32 v233, v145
    v_exp_f32 v234, v146
    s_waitcnt lgkmcnt(4)
    s_cbranch_vccnz K2FL_M1b_qk12
    v_mfma_f32_32x32x16_bf16 v[112:127], v[192:195], v[80:83], v[112:127]
K2FL_M1b_qk12:
    ds_read_b128 v[192:195], v229 offset:20480
    v_exp_f32 v235, v147
    v_add_f32 v224, v224, v232
    v_cvt_pk_bf16_f32 v168, v232, v233
    v_add_f32 v225, v225, v233
    v_exp_f32 v236, v148
    s_cbranch_vccnz K2FL_M1b_qk13
    v_mfma_f32_32x32x16_bf16 v[112:127], v[196:199], v[84:87], v[112:127]
K2FL_M1b_qk13:
    ds_read_b128 v[196:199], v229 offset:21504
    v_exp_f32 v237, v149
    v_add_f32 v224, v224, v234
    v_cvt_pk_bf16_f32 v169, v234, v235
    s_cbranch_vccnz K2FL_M1b_qk14
    v_mfma_f32_32x32x16_bf16 v[112:127], v[200:203], v[88:91], v[112:127]
K2FL_M1b_qk14:
    ds_read_b128 v[200:203], v229 offset:22528
    v_add_f32 v225, v225, v235
    v_exp_f32 v238, v150
    v_exp_f32 v239, v151
    v_add_f32 v224, v224, v236
    s_cbranch_vccnz K2FL_M1b_qk15
    v_mfma_f32_32x32x16_bf16 v[112:127], v[204:207], v[92:95], v[112:127]
K2FL_M1b_qk15:
    ds_read_b128 v[204:207], v229 offset:23552
    v_cvt_pk_bf16_f32 v170, v236, v237
    v_add_f32 v225, v225, v237
    v_add_f32 v224, v224, v238
    v_cvt_pk_bf16_f32 v171, v238, v239
    v_add_f32 v225, v225, v239
    s_waitcnt lgkmcnt(4)
    v_mfma_f32_32x32x16_bf16 v[0:15], v[176:179], v[160:163], v[0:15]
    ds_read_b128 v[176:179], v229 offset:24576
    v_exp_f32 v232, v152
    v_exp_f32 v233, v153
    v_mfma_f32_32x32x16_bf16 v[16:31], v[180:183], v[160:163], v[16:31]
    ds_read_b128 v[180:183], v229 offset:25600
    v_exp_f32 v234, v154
    v_exp_f32 v235, v155
    v_add_f32 v224, v224, v232
    v_mfma_f32_32x32x16_bf16 v[32:47], v[184:187], v[160:163], v[32:47]
    ds_read_b128 v[184:187], v229 offset:26624
    v_cvt_pk_bf16_f32 v172, v232, v233
    v_add_f32 v225, v225, v233
    v_exp_f32 v236, v156
    v_mfma_f32_32x32x16_bf16 v[48:63], v[188:191], v[160:163], v[48:63]
    ds_read_b128 v[188:191], v229 offset:27648
    v_exp_f32 v237, v157
    v_add_f32 v224, v224, v234
    v_cvt_pk_bf16_f32 v173, v234, v235
    v_add_f32 v225, v225, v235
    s_waitcnt lgkmcnt(4)
    v_mfma_f32_32x32x16_bf16 v[0:15], v[192:195], v[164:167], v[0:15]
    ds_read_b128 v[192:195], v229 offset:28672
    v_exp_f32 v238, v158
    v_exp_f32 v239, v159
    v_add_f32 v224, v224, v236
    v_mfma_f32_32x32x16_bf16 v[16:31], v[196:199], v[164:167], v[16:31]
    ds_read_b128 v[196:199], v229 offset:29696
    v_cvt_pk_bf16_f32 v174, v236, v237
    v_add_f32 v225, v225, v237
    v_add_f32 v224, v224, v238
    v_cvt_pk_bf16_f32 v175, v238, v239
    v_add_f32 v225, v225, v239
    v_mfma_f32_32x32x16_bf16 v[32:47], v[200:203], v[164:167], v[32:47]
    ds_read_b128 v[200:203], v229 offset:30720
    s_add_u32 s54, s51, 1
    s_lshl_b32 s67, s54, 6
    v_subrev_u32 v227, s67, v231
    v_mov_b32 v226, s52
    v_cmp_le_i32 s[56:57], 0, v227
    v_cmp_le_i32 s[58:59], 1, v227
    v_cmp_le_i32 s[92:93], 2, v227
    v_mfma_f32_32x32x16_bf16 v[48:63], v[204:207], v[164:167], v[48:63]
    ds_read_b128 v[204:207], v229 offset:31744
    v_cmp_le_i32 s[94:95], 3, v227
    v_cndmask_b32 v96, v226, v96, s[56:57]
    v_cndmask_b32 v97, v226, v97, s[58:59]
    v_cndmask_b32 v98, v226, v98, s[92:93]
    v_cndmask_b32 v99, v226, v99, s[94:95]
    v_cmp_le_i32 s[56:57], 8, v227
    v_cmp_le_i32 s[58:59], 9, v227
    s_waitcnt lgkmcnt(4)
    s_waitcnt vmcnt(8)
    s_barrier
    v_mfma_f32_32x32x16_bf16 v[0:15], v[176:179], v[168:171], v[0:15]
    ds_read_b128 v[176:179], v230 offset:16384
    s_add_u32 m0, s45, 49152
    s_nop 0
    buffer_load_dwordx4 v230, s[28:31], s96 offen offset:0 lds
    v_cmp_le_i32 s[92:93], 10, v227
    v_cmp_le_i32 s[94:95], 11, v227
    v_cndmask_b32 v100, v226, v100, s[56:57]
    v_cndmask_b32 v101, v226, v101, s[58:59]
    v_cndmask_b32 v102, v226, v102, s[92:93]
    v_cndmask_b32 v103, v226, v103, s[94:95]
    v_mfma_f32_32x32x16_bf16 v[16:31], v[180:183], v[168:171], v[16:31]
    ds_read_b128 v[180:183], v230 offset:17408
    buffer_load_dwordx4 v230, s[28:31], s96 offen offset:1024 lds
    v_cmp_le_i32 s[56:57], 16, v227
    v_cmp_le_i32 s[58:59], 17, v227
    v_cmp_le_i32 s[92:93], 18, v227
    v_cmp_le_i32 s[94:95], 19, v227
    v_cndmask_b32 v104, v226, v104, s[56:57]
    v_cndmask_b32 v105, v226, v105, s[58:59]
    v_cndmask_b32 v106, v226, v106, s[92:93]
    v_mfma_f32_32x32x16_bf16 v[32:47], v[184:187], v[168:171], v[32:47]
    ds_read_b128 v[184:187], v230 offset:18432
    buffer_load_dwordx4 v230, s[28:31], s96 offen offset:2048 lds
    v_cndmask_b32 v107, v226, v107, s[94:95]
    v_cmp_le_i32 s[56:57], 24, v227
    v_cmp_le_i32 s[58:59], 25, v227
    v_cmp_le_i32 s[92:93], 26, v227
    v_cmp_le_i32 s[94:95], 27, v227
    v_cndmask_b32 v108, v226, v108, s[56:57]
    v_cndmask_b32 v109, v226, v109, s[58:59]
    v_mfma_f32_32x32x16_bf16 v[48:63], v[188:191], v[168:171], v[48:63]
    ds_read_b128 v[188:191], v230 offset:19456
    buffer_load_dwordx4 v230, s[28:31], s96 offen offset:3072 lds
    s_add_u32 m0, s45, 98304
    v_cndmask_b32 v110, v226, v110, s[92:93]
    v_cndmask_b32 v111, v226, v111, s[94:95]
    v_cmp_le_i32 s[56:57], 32, v227
    v_cmp_le_i32 s[58:59], 33, v227
    v_cmp_le_i32 s[92:93], 34, v227
    v_cmp_le_i32 s[94:95], 35, v227
    v_cndmask_b32 v112, v226, v112, s[56:57]
    s_waitcnt lgkmcnt(4)
    v_mfma_f32_32x32x16_bf16 v[0:15], v[192:195], v[172:175], v[0:15]
    ds_read_b128 v[192:195], v230 offset:20480
    buffer_load_dwordx4 v230, s[32:35], s97 offen offset:0 lds
    v_cndmask_b32 v113, v226, v113, s[58:59]
    v_cndmask_b32 v114, v226, v114, s[92:93]
    v_cndmask_b32 v115, v226, v115, s[94:95]
    v_cmp_le_i32 s[56:57], 40, v227
    v_cmp_le_i32 s[58:59], 41, v227
    v_cmp_le_i32 s[92:93], 42, v227
    v_cmp_le_i32 s[94:95], 43, v227
    v_mfma_f32_32x32x16_bf16 v[16:31], v[196:199], v[172:175], v[16:31]
    ds_read_b128 v[196:199], v230 offset:21504
    buffer_load_dwordx4 v230, s[32:35], s97 offen offset:1024 lds
    v_cndmask_b32 v116, v226, v116, s[56:57]
    v_cndmask_b32 v117, v226, v117, s[58:59]
    v_cndmask_b32 v118, v226, v118, s[92:93]
    v_cndmask_b32 v119, v226, v119, s[94:95]
    v_cmp_le_i32 s[56:57], 48, v227
    v_cmp_le_i32 s[58:59], 49, v227
    v_mfma_f32_32x32x16_bf16 v[32:47], v[200:203], v[172:175], v[32:47]
    ds_read_b128 v[200:203], v230 offset:22528
    buffer_load_dwordx4 v230, s[32:35], s97 offen offset:2048 lds
    v_cmp_le_i32 s[92:93], 50, v227
    v_cmp_le_i32 s[94:95], 51, v227
    v_cndmask_b32 v120, v226, v120, s[56:57]
    v_cndmask_b32 v121, v226, v121, s[58:59]
    v_cndmask_b32 v122, v226, v122, s[92:93]
    v_cndmask_b32 v123, v226, v123, s[94:95]
    v_cmp_le_i32 s[56:57], 56, v227
    v_mfma_f32_32x32x16_bf16 v[48:63], v[204:207], v[172:175], v[48:63]
    ds_read_b128 v[204:207], v230 offset:23552
    buffer_load_dwordx4 v230, s[32:35], s97 offen offset:3072 lds
    s_mov_b32 s97, s96
    s_add_u32 s96, s96, 16384
    v_cmp_le_i32 s[58:59], 57, v227
    v_cmp_le_i32 s[92:93], 58, v227
    v_cmp_le_i32 s[94:95], 59, v227
    v_cndmask_b32 v124, v226, v124, s[56:57]
    v_cndmask_b32 v125, v226, v125, s[58:59]
    v_cndmask_b32 v126, v226, v126, s[92:93]
    v_cndmask_b32 v127, v226, v127, s[94:95]
    s_add_u32 s51, s51, 1
K2FL_M0b:
    s_waitcnt lgkmcnt(4)
    s_cmp_lt_u32 s62, 2
    s_cselect_b64 vcc, -1, 0
    s_cbranch_vccnz K2FL_M0b_qk0
    v_mfma_f32_32x32x16_bf16 v[128:143], v[176:179], v[64:67], v[208:223]
K2FL_M0b_qk0:
    ds_read_b128 v[176:179], v230 offset:24576
    v_exp_f32 v232, v96
    v_exp_f32 v233, v97
    v_exp_f32 v234, v98
    s_cbranch_vccnz K2FL_M0b_qk1
    v_mfma_f32_32x32x16_bf16 v[128:143], v[180:183], v[68:71], v[128:143]
K2FL_M0b_qk1:
    ds_read_b128 v[180:183], v230 offset:25600
    v_exp_f32 v235, v99
    v_add_f32 v224, v224, v232
    v_cvt_pk_bf16_f32 v160, v232, v233
    s_cbranch_vccnz K2FL_M0b_qk2
    v_mfma_f32_32x32x16_bf16 v[128:143], v[184:187], v[72:75], v[128:143]
K2FL_M0b_qk2:
    ds_read_b128 v[184:187], v230 offset:26624
    v_add_f32 v225, v225, v233
    v_exp_f32 v236, v100
    v_exp_f32 v237, v101
    v_add_f32 v224, v224, v234
    s_cbranch_vccnz K2FL_M0b_qk3
    v_mfma_f32_32x32x16_bf16 v[128:143], v[188:191], v[76:79], v[128:143]
K2FL_M0b_qk3:
    ds_read_b128 v[188:191], v230 offset:27648
    v_cvt_pk_bf16_f32 v161, v234, v235
    v_add_f32 v225, v225, v235
    v_exp_f32 v238, v102
    s_waitcnt lgkmcnt(4)
    s_cbranch_vccnz K2FL_M0b_qk4
    v_mfma_f32_32x32x16_bf16 v[128:143], v[192:195], v[80:83], v[128:143]
K2FL_M0b_qk4:
    ds_read_b128 v[192:195], v230 offset:28672
    v_exp_f32 v239, v103
    v_add_f32 v224, v224, v236
    v_cvt_pk_bf16_f32 v162, v236, v237
    v_add_f32 v225, v225, v237
    v_add_f32 v224, v224, v238
    s_cbranch_vccnz K2FL_M0b_qk5
    v_mfma_f32_32x32x16_bf16 v[128:143], v[196:199], v[84:87], v[128:143]
K2FL_M0b_qk5:
    ds_read_b128 v[196:199], v230 offset:29696
    v_cvt_pk_bf16_f32 v163, v238, v239
    v_add_f32 v225, v225, v239
    v_exp_f32 v232, v104
    v_exp_f32 v233, v105
    s_cbranch_vccnz K2FL_M0b_qk6
    v_mfma_f32_32x32x16_bf16 v[128:143], v[200:203], v[88:91], v[128:143]
K2FL_M0b_qk6:
    ds_read_b128 v[200:203], v230 offset:30720
    v_exp_f32 v234, v106
    v_exp_f32 v235, v107
    v_add_f32 v224, v224, v232
    s_cbranch_vccnz K2FL_M0b_qk7
    v_mfma_f32_32x32x16_bf16 v[128:143], v[204:207], v[92:95], v[128:143]
K2FL_M0b_qk7:
    ds_read_b128 v[204:207], v230 offset:31744
    v_cvt_pk_bf16_f32 v164, v232, v233
    v_add_f32 v225, v225, v233
    v_exp_f32 v236, v108
    s_waitcnt lgkmcnt(4)
    s_cmp_lt_u32 s62, 3
    s_cselect_b64 vcc, -1, 0
    s_cbranch_vccnz K2FL_M0b_qk8
    v_mfma_f32_32x32x16_bf16 v[144:159], v[176:179], v[64:67], v[208:223]
K2FL_M0b_qk8:
    ds_read_b128 v[176:179], v229 offset:32768
    v_exp_f32 v237, v109
    v_add_f32 v224, v224, v234
    v_cvt_pk_bf16_f32 v165, v234, v235
    v_add_f32 v225, v225, v235
    v_exp_f32 v238, v110
    s_cbranch_vccnz K2FL_M0b_qk9
    v_mfma_f32_32x32x16_bf16 v[144:159], v[180:183], v[68:71], v[144:159]
K2FL_M0b_qk9:
    ds_read_b128 v[180:183], v229 offset:33792
    v_exp_f32 v239, v111
    v_add_f32 v224, v224, v236
    v_cvt_pk_bf16_f32 v166, v236, v237
    s_cbranch_vccnz K2FL_M0b_qk10
    v_mfma_f32_32x32x16_bf16 v[144:159], v[184:187], v[72:75], v[144:159]
K2FL_M0b_qk10:
    ds_read_b128 v[184:187], v229 offset:34816
    v_add_f32 v225, v225, v237
    v_add_f32 v224, v224, v238
    v_cvt_pk_bf16_f32 v167, v238, v239
    v_add_f32 v225, v225, v239
    v_exp_f32 v232, v112
    s_cbranch_vccnz K2FL_M0b_qk11
    v_mfma_f32_32x32x16_bf16 v[144:159], v[188:191], v[76:79], v[144:159]
K2FL_M0b_qk11:
    ds_read_b128 v[188:191], v229 offset:35840
    v_exp_f32 v233, v113
    v_exp_f32 v234, v114
    s_waitcnt lgkmcnt(4)
    s_cbranch_vccnz K2FL_M0b_qk12
    v_mfma_f32_32x32x16_bf16 v[144:159], v[192:195], v[80:83], v[144:159]
K2FL_M0b_qk12:
    ds_read_b128 v[192:195], v229 offset:36864
    v_exp_f32 v235, v115
    v_add_f32 v224, v224, v232
    v_cvt_pk_bf16_f32 v168, v232, v233
    v_add_f32 v225, v225, v233
    v_exp_f32 v236, v116
    s_cbranch_vccnz K2FL_M0b_qk13
    v_mfma_f32_32x32x16_bf16 v[144:159], v[196:199], v[84:87], v[144:159]
K2FL_M0b_qk13:
    ds_read_b128 v[196:199], v229 offset:37888
    v_exp_f32 v237, v117
    v_add_f32 v224, v224, v234
    v_cvt_pk_bf16_f32 v169, v234, v235
    s_cbranch_vccnz K2FL_M0b_qk14
    v_mfma_f32_32x32x16_bf16 v[144:159], v[200:203], v[88:91], v[144:159]
K2FL_M0b_qk14:
    ds_read_b128 v[200:203], v229 offset:38912
    v_add_f32 v225, v225, v235
    v_exp_f32 v238, v118
    v_exp_f32 v239, v119
    v_add_f32 v224, v224, v236
    s_cbranch_vccnz K2FL_M0b_qk15
    v_mfma_f32_32x32x16_bf16 v[144:159], v[204:207], v[92:95], v[144:159]
K2FL_M0b_qk15:
    ds_read_b128 v[204:207], v229 offset:39936
    v_cvt_pk_bf16_f32 v170, v236, v237
    v_add_f32 v225, v225, v237
    v_add_f32 v224, v224, v238
    v_cvt_pk_bf16_f32 v171, v238, v239
    v_add_f32 v225, v225, v239
    s_waitcnt lgkmcnt(4)
    v_mfma_f32_32x32x16_bf16 v[0:15], v[176:179], v[160:163], v[0:15]
    ds_read_b128 v[176:179], v229 offset:40960
    v_exp_f32 v232, v120
    v_exp_f32 v233, v121
    v_mfma_f32_32x32x16_bf16 v[16:31], v[180:183], v[160:163], v[16:31]
    ds_read_b128 v[180:183], v229 offset:41984
    v_exp_f32 v234, v122
    v_exp_f32 v235, v123
    v_add_f32 v224, v224, v232
    v_mfma_f32_32x32x16_bf16 v[32:47], v[184:187], v[160:163], v[32:47]
    ds_read_b128 v[184:187], v229 offset:43008
    v_cvt_pk_bf16_f32 v172, v232, v233
    v_add_f32 v225, v225, v233
    v_exp_f32 v236, v124
    v_mfma_f32_32x32x16_bf16 v[48:63], v[188:191], v[160:163], v[48:63]
    ds_read_b128 v[188:191], v229 offset:44032
    v_exp_f32 v237, v125
    v_add_f32 v224, v224, v234
    v_cvt_pk_bf16_f32 v173, v234, v235
    v_add_f32 v225, v225, v235
    s_waitcnt lgkmcnt(4)
    v_mfma_f32_32x32x16_bf16 v[0:15], v[192:195], v[164:167], v[0:15]
    ds_read_b128 v[192:195], v229 offset:45056
    v_exp_f32 v238, v126
    v_exp_f32 v239, v127
    v_add_f32 v224, v224, v236
    v_mfma_f32_32x32x16_bf16 v[16:31], v[196:199], v[164:167], v[16:31]
    ds_read_b128 v[196:199], v229 offset:46080
    v_cvt_pk_bf16_f32 v174, v236, v237
    v_add_f32 v225, v225, v237
    v_add_f32 v224, v224, v238
    v_cvt_pk_bf16_f32 v175, v238, v239
    v_add_f32 v225, v225, v239
    v_mfma_f32_32x32x16_bf16 v[32:47], v[200:203], v[164:167], v[32:47]
    ds_read_b128 v[200:203], v229 offset:47104
    s_add_u32 s54, s51, 1
    s_lshl_b32 s67, s54, 6
    v_subrev_u32 v227, s67, v231
    v_mov_b32 v226, s52
    v_cmp_le_i32 s[56:57], 0, v227
    v_cmp_le_i32 s[58:59], 1, v227
    v_cmp_le_i32 s[92:93], 2, v227
    v_mfma_f32_32x32x16_bf16 v[48:63], v[204:207], v[164:167], v[48:63]
    ds_read_b128 v[204:207], v229 offset:48128
    v_cmp_le_i32 s[94:95], 3, v227
    v_cndmask_b32 v128, v226, v128, s[56:57]
    v_cndmask_b32 v129, v226, v129, s[58:59]
    v_cndmask_b32 v130, v226, v130, s[92:93]
    v_cndmask_b32 v131, v226, v131, s[94:95]
    v_cmp_le_i32 s[56:57], 8, v227
    v_cmp_le_i32 s[58:59], 9, v227
    s_waitcnt lgkmcnt(4)
    s_waitcnt vmcnt(8)
    s_barrier
    s_cmp_lt_u32 s62, 1
    s_cselect_b64 vcc, -1, 0
    s_cbranch_vccnz K2FL_M0b_pv8
    v_mfma_f32_32x32x16_bf16 v[0:15], v[176:179], v[168:171], v[0:15]
K2FL_M0b_pv8:
    ds_read_b128 v[176:179], v229 offset:49152
    s_add_u32 m0, s45, 0
    s_nop 0
    buffer_load_dwordx4 v230, s[28:31], s96 offen offset:0 lds
    v_cmp_le_i32 s[92:93], 10, v227
    v_cmp_le_i32 s[94:95], 11, v227
    v_cndmask_b32 v132, v226, v132, s[56:57]
    v_cndmask_b32 v133, v226, v133, s[58:59]
    v_cndmask_b32 v134, v226, v134, s[92:93]
    v_cndmask_b32 v135, v226, v135, s[94:95]
    s_cbranch_vccnz K2FL_M0b_pv9
    v_mfma_f32_32x32x16_bf16 v[16:31], v[180:183], v[168:171], v[16:31]
K2FL_M0b_pv9:
    ds_read_b128 v[180:183], v229 offset:50176
    buffer_load_dwordx4 v230, s[28:31], s96 offen offset:1024 lds
    v_cmp_le_i32 s[56:57], 16, v227
    v_cmp_le_i32 s[58:59], 17, v227
    v_cmp_le_i32 s[92:93], 18, v227
    v_cmp_le_i32 s[94:95], 19, v227
    v_cndmask_b32 v136, v226, v136, s[56:57]
    v_cndmask_b32 v137, v226, v137, s[58:59]
    v_cndmask_b32 v138, v226, v138, s[92:93]
    s_cbranch_vccnz K2FL_M0b_pv10
    v_mfma_f32_32x32x16_bf16 v[32:47], v[184:187], v[168:171], v[32:47]
K2FL_M0b_pv10:
    ds_read_b128 v[184:187], v229 offset:51200
    buffer_load_dwordx4 v230, s[28:31], s96 offen offset:2048 lds
    v_cndmask_b32 v139, v226, v139, s[94:95]
    v_cmp_le_i32 s[56:57], 24, v227
    v_cmp_le_i32 s[58:59], 25, v227
    v_cmp_le_i32 s[92:93], 26, v227
    v_cmp_le_i32 s[94:95], 27, v227
    v_cndmask_b32 v140, v226, v140, s[56:57]
    v_cndmask_b32 v141, v226, v141, s[58:59]
    s_cbranch_vccnz K2FL_M0b_pv11
    v_mfma_f32_32x32x16_bf16 v[48:63], v[188:191], v[168:171], v[48:63]
K2FL_M0b_pv11:
    ds_read_b128 v[188:191], v229 offset:52224
    buffer_load_dwordx4 v230, s[28:31], s96 offen offset:3072 lds
    s_add_u32 m0, s45, 114688
    v_cndmask_b32 v142, v226, v142, s[92:93]
    v_cndmask_b32 v143, v226, v143, s[94:95]
    v_cmp_le_i32 s[56:57], 32, v227
    v_cmp_le_i32 s[58:59], 33, v227
    v_cmp_le_i32 s[92:93], 34, v227
    v_cmp_le_i32 s[94:95], 35, v227
    v_cndmask_b32 v144, v226, v144, s[56:57]
    s_waitcnt lgkmcnt(4)
    s_cbranch_vccnz K2FL_M0b_pv12
    v_mfma_f32_32x32x16_bf16 v[0:15], v[192:195], v[172:175], v[0:15]
K2FL_M0b_pv12:
    ds_read_b128 v[192:195], v229 offset:53248
    buffer_load_dwordx4 v230, s[32:35], s97 offen offset:0 lds
    v_cndmask_b32 v145, v226, v145, s[58:59]
    v_cndmask_b32 v146, v226, v146, s[92:93]
    v_cndmask_b32 v147, v226, v147, s[94:95]
    v_cmp_le_i32 s[56:57], 40, v227
    v_cmp_le_i32 s[58:59], 41, v227
    v_cmp_le_i32 s[92:93], 42, v227
    v_cmp_le_i32 s[94:95], 43, v227
    s_cbranch_vccnz K2FL_M0b_pv13
    v_mfma_f32_32x32x16_bf16 v[16:31], v[196:199], v[172:175], v[16:31]
K2FL_M0b_pv13:
    ds_read_b128 v[196:199], v229 offset:54272
    buffer_load_dwordx4 v230, s[32:35], s97 offen offset:1024 lds
    v_cndmask_b32 v148, v226, v148, s[56:57]
    v_cndmask_b32 v149, v226, v149, s[58:59]
    v_cndmask_b32 v150, v226, v150, s[92:93]
    v_cndmask_b32 v151, v226, v151, s[94:95]
    v_cmp_le_i32 s[56:57], 48, v227
    v_cmp_le_i32 s[58:59], 49, v227
    s_cbranch_vccnz K2FL_M0b_pv14
    v_mfma_f32_32x32x16_bf16 v[32:47], v[200:203], v[172:175], v[32:47]
K2FL_M0b_pv14:
    ds_read_b128 v[200:203], v229 offset:55296
    buffer_load_dwordx4 v230, s[32:35], s97 offen offset:2048 lds
    v_cmp_le_i32 s[92:93], 50, v227
    v_cmp_le_i32 s[94:95], 51, v227
    v_cndmask_b32 v152, v226, v152, s[56:57]
    v_cndmask_b32 v153, v226, v153, s[58:59]
    v_cndmask_b32 v154, v226, v154, s[92:93]
    v_cndmask_b32 v155, v226, v155, s[94:95]
    v_cmp_le_i32 s[56:57], 56, v227
    s_cbranch_vccnz K2FL_M0b_pv15
    v_mfma_f32_32x32x16_bf16 v[48:63], v[204:207], v[172:175], v[48:63]
K2FL_M0b_pv15:
    ds_read_b128 v[204:207], v229 offset:56320
    buffer_load_dwordx4 v230, s[32:35], s97 offen offset:3072 lds
    s_mov_b32 s97, s96
    s_add_u32 s96, s96, 16384
    v_cmp_le_i32 s[58:59], 57, v227
    v_cmp_le_i32 s[92:93], 58, v227
    v_cmp_le_i32 s[94:95], 59, v227
    v_cndmask_b32 v156, v226, v156, s[56:57]
    v_cndmask_b32 v157, v226, v157, s[58:59]
    v_cndmask_b32 v158, v226, v158, s[92:93]
    v_cndmask_b32 v159, v226, v159, s[94:95]
    s_add_u32 s51, s51, 1
K2FL_L1b:
    v_exp_f32 v232, v128
    v_exp_f32 v233, v129
    v_exp_f32 v234, v130
    v_exp_f32 v235, v131
    v_add_f32 v224, v224, v232
    v_cvt_pk_bf16_f32 v160, v232, v233
    v_add_f32 v225, v225, v233
    v_exp_f32 v236, v132
    v_exp_f32 v237, v133
    v_add_f32 v224, v224, v234
    v_cvt_pk_bf16_f32 v161, v234, v235
    v_add_f32 v225, v225, v235
    v_exp_f32 v238, v134
    v_exp_f32 v239, v135
    v_add_f32 v224, v224, v236
    v_cvt_pk_bf16_f32 v162, v236, v237
    v_add_f32 v225, v225, v237
    v_add_f32 v224, v224, v238
    v_cvt_pk_bf16_f32 v163, v238, v239
    v_add_f32 v225, v225, v239
    s_nop 0
    s_waitcnt lgkmcnt(6)
    s_cmp_lt_u32 s62, 2
    s_cselect_b64 vcc, -1, 0
    s_cbranch_vccnz K2FL_L1b_pv0
    v_mfma_f32_32x32x16_bf16 v[0:15], v[176:179], v[160:163], v[0:15]
K2FL_L1b_pv0:
    ds_read_b128 v[176:179], v229 offset:57344
    v_exp_f32 v232, v136
    v_exp_f32 v233, v137
    v_exp_f32 v234, v138
    v_exp_f32 v235, v139
    v_add_f32 v224, v224, v232
    s_cbranch_vccnz K2FL_L1b_pv1
    v_mfma_f32_32x32x16_bf16 v[16:31], v[180:183], v[160:163], v[16:31]
K2FL_L1b_pv1:
    ds_read_b128 v[180:183], v229 offset:58368
    v_cvt_pk_bf16_f32 v164, v232, v233
    v_add_f32 v225, v225, v233
    v_exp_f32 v236, v140
    v_exp_f32 v237, v141
    v_add_f32 v224, v224, v234
    s_waitcnt lgkmcnt(6)
    s_cbranch_vccnz K2FL_L1b_pv2
    v_mfma_f32_32x32x16_bf16 v[32:47], v[184:187], v[160:163], v[32:47]
K2FL_L1b_pv2:
    ds_read_b128 v[184:187], v229 offset:59392
    v_cvt_pk_bf16_f32 v165, v234, v235
    v_add_f32 v225, v225, v235
    v_exp_f32 v238, v142
    v_exp_f32 v239, v143
    v_add_f32 v224, v224, v236
    s_cbranch_vccnz K2FL_L1b_pv3
    v_mfma_f32_32x32x16_bf16 v[48:63], v[188:191], v[160:163], v[48:63]
K2FL_L1b_pv3:
    ds_read_b128 v[188:191], v229 offset:60416
    v_cvt_pk_bf16_f32 v166, v236, v237
    v_add_f32 v225, v225, v237
    v_add_f32 v224, v224, v238
    v_cvt_pk_bf16_f32 v167, v238, v239
    v_add_f32 v225, v225, v239
    s_nop 1
    s_waitcnt lgkmcnt(6)
    s_cbranch_vccnz K2FL_L1b_pv4
    v_mfma_f32_32x32x16_bf16 v[0:15], v[192:195], v[164:167], v[0:15]
K2FL_L1b_pv4:
    ds_read_b128 v[192:195], v229 offset:61440
    v_exp_f32 v232, v144
    v_exp_f32 v233, v145
    v_exp_f32 v234, v146
    v_exp_f32 v235, v147
    v_add_f32 v224, v224, v232
    s_cbranch_vccnz K2FL_L1b_pv5
    v_mfma_f32_32x32x16_bf16 v[16:31], v[196:199], v[164:167], v[16:31]
K2FL_L1b_pv5:
    ds_read_b128 v[196:199], v229 offset:62464
    v_cvt_pk_bf16_f32 v168, v232, v233
    v_add_f32 v225, v225, v233
    v_exp_f32 v236, v148
    v_exp_f32 v237, v149
    v_add_f32 v224, v224, v234
    s_waitcnt lgkmcnt(6)
    s_cbranch_vccnz K2FL_L1b_pv6
    v_mfma_f32_32x32x16_bf16 v[32:47], v[200:203], v[164:167], v[32:47]
K2FL_L1b_pv6:
    ds_read_b128 v[200:203], v229 offset:63488
    v_cvt_pk_bf16_f32 v169, v234, v235
    v_add_f32 v225, v225, v235
    v_exp_f32 v238, v150
    v_exp_f32 v239, v151
    v_add_f32 v224, v224, v236
    s_cbranch_vccnz K2FL_L1b_pv7
    v_mfma_f32_32x32x16_bf16 v[48:63], v[204:207], v[164:167], v[48:63]
K2FL_L1b_pv7:
    ds_read_b128 v[204:207], v229 offset:64512
    v_cvt_pk_bf16_f32 v170, v236, v237
    v_add_f32 v225, v225, v237
    v_add_f32 v224, v224, v238
    v_cvt_pk_bf16_f32 v171, v238, v239
    v_add_f32 v225, v225, v239
    s_nop 1
    s_waitcnt lgkmcnt(7)
    s_waitcnt vmcnt(8)
    s_barrier
    s_cmp_lt_u32 s62, 3
    s_cselect_b64 vcc, -1, 0
    s_cbranch_vccnz K2FL_L1b_pv8
    v_mfma_f32_32x32x16_bf16 v[0:15], v[176:179], v[168:171], v[0:15]
K2FL_L1b_pv8:
    v_exp_f32 v232, v152
    v_exp_f32 v233, v153
    v_exp_f32 v234, v154
    v_exp_f32 v235, v155
    v_add_f32 v224, v224, v232
    s_waitcnt lgkmcnt(6)
    s_cbranch_vccnz K2FL_L1b_pv9
    v_mfma_f32_32x32x16_bf16 v[16:31], v[180:183], v[168:171], v[16:31]
K2FL_L1b_pv9:
    v_cvt_pk_bf16_f32 v172, v232, v233
    v_add_f32 v225, v225, v233
    v_exp_f32 v236, v156
    v_exp_f32 v237, v157
    v_add_f32 v224, v224, v234
    s_waitcnt lgkmcnt(5)
    s_cbranch_vccnz K2FL_L1b_pv10
    v_mfma_f32_32x32x16_bf16 v[32:47], v[184:187], v[168:171], v[32:47]
K2FL_L1b_pv10:
    v_cvt_pk_bf16_f32 v173, v234, v235
    v_add_f32 v225, v225, v235
    v_exp_f32 v238, v158
    v_exp_f32 v239, v159
    v_add_f32 v224, v224, v236
    s_waitcnt lgkmcnt(4)
    s_cbranch_vccnz K2FL_L1b_pv11
    v_mfma_f32_32x32x16_bf16 v[48:63], v[188:191], v[168:171], v[48:63]
K2FL_L1b_pv11:
    v_cvt_pk_bf16_f32 v174, v236, v237
    v_add_f32 v225, v225, v237
    v_add_f32 v224, v224, v238
    v_cvt_pk_bf16_f32 v175, v238, v239
    v_add_f32 v225, v225, v239
    s_nop 1
    s_waitcnt lgkmcnt(3)
    s_cbranch_vccnz K2FL_L1b_pv12
    v_mfma_f32_32x32x16_bf16 v[0:15], v[192:195], v[172:175], v[0:15]
K2FL_L1b_pv12:
    s_cmp_eq_u32 s60, 0
    s_cbranch_scc1 K2FL_L1b_nl
    s_add_u32 s64, s51, 3
    s_cmp_ge_u32 s64, s18
    s_cbranch_scc1 K2FL_L1b_nl
    s_add_u32 s65, s64, 1
    s_and_b32 s66, s65, 3
    s_lshl_b32 s66, s66, 14
    s_add_u32 m0, s66, s45
    s_lshl_b32 s65, s65, 14
    s_add_u32 s65, s65, s46
    buffer_load_dwordx4 v230, s[28:31], s65 offen offset:0 lds
    buffer_load_dwordx4 v230, s[28:31], s65 offen offset:1024 lds
    buffer_load_dwordx4 v230, s[28:31], s65 offen offset:2048 lds
    buffer_load_dwordx4 v230, s[28:31], s65 offen offset:3072 lds
    s_add_u32 s66, s64, 2
    s_and_b32 s66, s66, 3
    s_lshl_b32 s66, s66, 14
    s_add_u32 s66, s66, s45
    s_add_u32 m0, s66, 98304
    s_sub_u32 s65, s65, 16384
    buffer_load_dwordx4 v230, s[32:35], s65 offen offset:0 lds
    buffer_load_dwordx4 v230, s[32:35], s65 offen offset:1024 lds
    buffer_load_dwordx4 v230, s[32:35], s65 offen offset:2048 lds
    buffer_load_dwordx4 v230, s[32:35], s65 offen offset:3072 lds
K2FL_L1b_nl:
    s_waitcnt lgkmcnt(2)
    s_cbranch_vccnz K2FL_L1b_pv13
    v_mfma_f32_32x32x16_bf16 v[16:31], v[196:199], v[172:175], v[16:31]
K2FL_L1b_pv13:
    s_waitcnt lgkmcnt(1)
    s_cbranch_vccnz K2FL_L1b_pv14
    v_mfma_f32_32x32x16_bf16 v[32:47], v[200:203], v[172:175], v[32:47]
K2FL_L1b_pv14:
    s_waitcnt lgkmcnt(0)
    s_cbranch_vccnz K2FL_L1b_pv15
    v_mfma_f32_32x32x16_bf16 v[48:63], v[204:207], v[172:175], v[48:63]
K2FL_L1b_pv15:
    s_nop 1
    s_add_u32 s51, s51, 1
    s_branch K2F_EPI
K2FH_PRE:
    s_mov_b32 s20, s8
    s_and_b32 s21, s9, 0xffff
    s_mov_b32 s22, 5242880
    s_mov_b32 s23, 0x00020000
    s_mov_b32 s24, s10
    s_and_b32 s25, s11, 0xffff
    s_mov_b32 s26, 7077888
    s_mov_b32 s27, 0x00020000
    s_mov_b32 s96, s12
    s_and_b32 s97, s13, 0xffff
    s_mov_b32 s98, 7077888
    s_mov_b32 s99, 0x00020000
    s_lshl_b32 s65, s2, 2
    s_add_u32 s65, s65, s62
    s_lshl_b32 s65, s65, 10
K2FH_U0:
    s_waitcnt lgkmcnt(4)
    v_mfma_f32_32x32x16_bf16 v[128:143], v[176:179], v[64:67], v[208:223]
    ds_read_b128 v[176:179], v230 offset:24576
    v_exp_f32 v232, v96
    v_exp_f32 v233, v97
    v_mfma_f32_32x32x16_bf16 v[128:143], v[180:183], v[68:71], v[128:143]
    ds_read_b128 v[180:183], v230 offset:25600
    v_exp_f32 v234, v98
    v_exp_f32 v235, v99
    v_mfma_f32_32x32x16_bf16 v[128:143], v[184:187], v[72:75], v[128:143]
    ds_read_b128 v[184:187], v230 offset:26624
    v_add_f32 v224, v224, v232
    v_cvt_pk_bf16_f32 v160, v232, v233
    v_add_f32 v225, v225, v233
    v_exp_f32 v236, v100
    v_mfma_f32_32x32x16_bf16 v[128:143], v[188:191], v[76:79], v[128:143]
    ds_read_b128 v[188:191], v230 offset:27648
    v_exp_f32 v237, v101
    v_add_f32 v224, v224, v234
    v_cvt_pk_bf16_f32 v161, v234, v235
    s_waitcnt lgkmcnt(4)
    v_mfma_f32_32x32x16_bf16 v[128:143], v[192:195], v[80:83], v[128:143]
    ds_read_b128 v[192:195], v230 offset:28672
    v_add_f32 v225, v225, v235
    v_exp_f32 v238, v102
    v_mfma_f32_32x32x16_bf16 v[128:143], v[196:199], v[84:87], v[128:143]
    ds_read_b128 v[196:199], v230 offset:29696
    v_exp_f32 v239, v103
    v_add_f32 v224, v224, v236
    v_cvt_pk_bf16_f32 v162, v236, v237
    v_add_f32 v225, v225, v237
    v_mfma_f32_32x32x16_bf16 v[128:143], v[200:203], v[88:91], v[128:143]
    ds_read_b128 v[200:203], v230 offset:30720
    v_add_f32 v224, v224, v238
    v_cvt_pk_bf16_f32 v163, v238, v239
    v_add_f32 v225, v225, v239
    v_exp_f32 v232, v104
    v_mfma_f32_32x32x16_bf16 v[128:143], v[204:207], v[92:95], v[128:143]
    ds_read_b128 v[204:207], v230 offset:31744
    v_exp_f32 v233, v105
    v_exp_f32 v234, v106
    s_waitcnt lgkmcnt(4)
    v_mfma_f32_32x32x16_bf16 v[144:159], v[176:179], v[64:67], v[208:223]
    ds_read_b128 v[176:179], v229 offset:32768
    v_exp_f32 v235, v107
    v_add_f32 v224, v224, v232
    v_mfma_f32_32x32x16_bf16 v[144:159], v[180:183], v[68:71], v[144:159]
    ds_read_b128 v[180:183], v229 offset:33792
    v_cvt_pk_bf16_f32 v164, v232, v233
    v_add_f32 v225, v225, v233
    v_exp_f32 v236, v108
    v_mfma_f32_32x32x16_bf16 v[144:159], v[184:187], v[72:75], v[144:159]
    ds_read_b128 v[184:187], v229 offset:34816
    v_exp_f32 v237, v109
    v_add_f32 v224, v224, v234
    v_cvt_pk_bf16_f32 v165, v234, v235
    v_add_f32 v225, v225, v235
    v_mfma_f32_32x32x16_bf16 v[144:159], v[188:191], v[76:79], v[144:159]
    ds_read_b128 v[188:191], v229 offset:35840
    v_exp_f32 v238, v110
    v_exp_f32 v239, v111
    s_waitcnt lgkmcnt(4)
    v_mfma_f32_32x32x16_bf16 v[144:159], v[192:195], v[80:83], v[144:159]
    ds_read_b128 v[192:195], v229 offset:36864
    v_add_f32 v224, v224, v236
    v_cvt_pk_bf16_f32 v166, v236, v237
    v_add_f32 v225, v225, v237
    v_add_f32 v224, v224, v238
    v_mfma_f32_32x32x16_bf16 v[144:159], v[196:199], v[84:87], v[144:159]
    ds_read_b128 v[196:199], v229 offset:37888
    v_cvt_pk_bf16_f32 v167, v238, v239
    v_add_f32 v225, v225, v239
    v_exp_f32 v232, v112
    v_mfma_f32_32x32x16_bf16 v[144:159], v[200:203], v[88:91], v[144:159]
    ds_read_b128 v[200:203], v229 offset:38912
    v_exp_f32 v233, v113
    v_exp_f32 v234, v114
    v_mfma_f32_32x32x16_bf16 v[144:159], v[204:207], v[92:95], v[144:159]
    ds_read_b128 v[204:207], v229 offset:39936
    v_exp_f32 v235, v115
    v_add_f32 v224, v224, v232
    v_cvt_pk_bf16_f32 v168, v232, v233
    s_waitcnt lgkmcnt(4)
    v_mfma_f32_32x32x16_bf16 v[0:15], v[176:179], v[160:163], v[0:15]
    ds_read_b128 v[176:179], v229 offset:40960
    v_add_f32 v225, v225, v233
    v_exp_f32 v236, v116
    v_exp_f32 v237, v117
    v_mfma_f32_32x32x16_bf16 v[16:31], v[180:183], v[160:163], v[16:31]
    ds_read_b128 v[180:183], v229 offset:41984
    v_add_f32 v224, v224, v234
    v_cvt_pk_bf16_f32 v169, v234, v235
    v_add_f32 v225, v225, v235
    v_mfma_f32_32x32x16_bf16 v[32:47], v[184:187], v[160:163], v[32:47]
    ds_read_b128 v[184:187], v229 offset:43008
    v_exp_f32 v238, v118
    v_exp_f32 v239, v119
    v_add_f32 v224, v224, v236
    v_mfma_f32_32x32x16_bf16 v[48:63], v[188:191], v[160:163], v[48:63]
    ds_read_b128 v[188:191], v229 offset:44032
    v_cvt_pk_bf16_f32 v170, v236, v237
    v_add_f32 v225, v225, v237
    v_add_f32 v224, v224, v238
    v_cvt_pk_bf16_f32 v171, v238, v239
    s_waitcnt lgkmcnt(4)
    v_mfma_f32_32x32x16_bf16 v[0:15], v[192:195], v[164:167], v[0:15]
    ds_read_b128 v[192:195], v229 offset:45056
    v_add_f32 v225, v225, v239
    v_exp_f32 v232, v120
    v_exp_f32 v233, v121
    v_mfma_f32_32x32x16_bf16 v[16:31], v[196:199], v[164:167], v[16:31]
    ds_read_b128 v[196:199], v229 offset:46080
    v_exp_f32 v234, v122
    v_exp_f32 v235, v123
    v_mfma_f32_32x32x16_bf16 v[32:47], v[200:203], v[164:167], v[32:47]
    ds_read_b128 v[200:203], v229 offset:47104
    v_add_f32 v224, v224, v232
    v_cvt_pk_bf16_f32 v172, v232, v233
    v_add_f32 v225, v225, v233
    v_mfma_f32_32x32x16_bf16 v[48:63], v[204:207], v[164:167], v[48:63]
    ds_read_b128 v[204:207], v229 offset:48128
    v_exp_f32 v236, v124
    v_exp_f32 v237, v125
    v_add_f32 v224, v224, v234
    s_waitcnt lgkmcnt(4)
    s_barrier
    v_mfma_f32_32x32x16_bf16 v[0:15], v[176:179], v[168:171], v[0:15]
    ds_read_b128 v[176:179], v230 offset:32768
    v_cvt_pk_bf16_f32 v173, v234, v235
    v_add_f32 v225, v225, v235
    v_exp_f32 v238, v126
    v_mfma_f32_32x32x16_bf16 v[16:31], v[180:183], v[168:171], v[16:31]
    ds_read_b128 v[180:183], v230 offset:33792
    v_exp_f32 v239, v127
    v_add_f32 v224, v224, v236
    v_cvt_pk_bf16_f32 v174, v236, v237
    v_mfma_f32_32x32x16_bf16 v[32:47], v[184:187], v[168:171], v[32:47]
    ds_read_b128 v[184:187], v230 offset:34816
    v_add_f32 v225, v225, v237
    v_add_f32 v224, v224, v238
    v_cvt_pk_bf16_f32 v175, v238, v239
    v_add_f32 v225, v225, v239
    v_mfma_f32_32x32x16_bf16 v[48:63], v[188:191], v[168:171], v[48:63]
    ds_read_b128 v[188:191], v230 offset:35840
    s_waitcnt lgkmcnt(4)
    v_mfma_f32_32x32x16_bf16 v[0:15], v[192:195], v[172:175], v[0:15]
    ds_read_b128 v[192:195], v230 offset:36864
    buffer_load_dwordx4 v[248:251], v230, s[20:23], s65 offen
    v_mfma_f32_32x32x16_bf16 v[16:31], v[196:199], v[172:175], v[16:31]
    ds_read_b128 v[196:199], v230 offset:37888
    buffer_load_dwordx4 v[252:255], v230, s[24:27], s65 offen
    v_mfma_f32_32x32x16_bf16 v[32:47], v[200:203], v[172:175], v[32:47]
    ds_read_b128 v[200:203], v230 offset:38912
    buffer_load_dwordx4 v[240:243], v230, s[96:99], s65 offen
    v_mfma_f32_32x32x16_bf16 v[48:63], v[204:207], v[172:175], v[48:63]
    ds_read_b128 v[204:207], v230 offset:39936
    s_add_u32 s65, s65, 1048576
    s_add_u32 s51, s51, 1
    s_cmp_ge_u32 s51, s49
    s_cbranch_scc1 K2FH_M1a
K2FH_U1:
    s_waitcnt lgkmcnt(4)
    v_mfma_f32_32x32x16_bf16 v[96:111], v[176:179], v[64:67], v[208:223]
    ds_read_b128 v[176:179], v230 offset:40960
    v_exp_f32 v232, v128
    v_exp_f32 v233, v129
    v_mfma_f32_32x32x16_bf16 v[96:111], v[180:183], v[68:71], v[96:111]
    ds_read_b128 v[180:183], v230 offset:41984
    v_exp_f32 v234, v130
    v_exp_f32 v235, v131
    v_mfma_f32_32x32x16_bf16 v[96:111], v[184:187], v[72:75], v[96:111]
    ds_read_b128 v[184:187], v230 offset:43008
    v_add_f32 v224, v224, v232
    v_cvt_pk_bf16_f32 v160, v232, v233
    v_add_f32 v225, v225, v233
    v_exp_f32 v236, v132
    v_mfma_f32_32x32x16_bf16 v[96:111], v[188:191], v[76:79], v[96:111]
    ds_read_b128 v[188:191], v230 offset:44032
    v_exp_f32 v237, v133
    v_add_f32 v224, v224, v234
    v_cvt_pk_bf16_f32 v161, v234, v235
    s_waitcnt lgkmcnt(4)
    v_mfma_f32_32x32x16_bf16 v[96:111], v[192:195], v[80:83], v[96:111]
    ds_read_b128 v[192:195], v230 offset:45056
    v_add_f32 v225, v225, v235
    v_exp_f32 v238, v134
    v_mfma_f32_32x32x16_bf16 v[96:111], v[196:199], v[84:87], v[96:111]
    ds_read_b128 v[196:199], v230 offset:46080
    v_exp_f32 v239, v135
    v_add_f32 v224, v224, v236
    v_cvt_pk_bf16_f32 v162, v236, v237
    v_add_f32 v225, v225, v237
    v_mfma_f32_32x32x16_bf16 v[96:111], v[200:203], v[88:91], v[96:111]
    ds_read_b128 v[200:203], v230 offset:47104
    v_add_f32 v224, v224, v238
    v_cvt_pk_bf16_f32 v163, v238, v239
    v_add_f32 v225, v225, v239
    v_exp_f32 v232, v136
    v_mfma_f32_32x32x16_bf16 v[96:111], v[204:207], v[92:95], v[96:111]
    ds_read_b128 v[204:207], v230 offset:48128
    v_exp_f32 v233, v137
    v_exp_f32 v234, v138
    s_waitcnt lgkmcnt(4)
    v_mfma_f32_32x32x16_bf16 v[112:127], v[176:179], v[64:67], v[208:223]
    ds_read_b128 v[176:179], v229 offset:49152
    v_exp_f32 v235, v139
    v_add_f32 v224, v224, v232
    v_mfma_f32_32x32x16_bf16 v[112:127], v[180:183], v[68:71], v[112:127]
    ds_read_b128 v[180:183], v229 offset:50176
    v_cvt_pk_bf16_f32 v164, v232, v233
    v_add_f32 v225, v225, v233
    v_exp_f32 v236, v140
    v_mfma_f32_32x32x16_bf16 v[112:127], v[184:187], v[72:75], v[112:127]
    ds_read_b128 v[184:187], v229 offset:51200
    v_exp_f32 v237, v141
    v_add_f32 v224, v224, v234
    v_cvt_pk_bf16_f32 v165, v234, v235
    v_add_f32 v225, v225, v235
    v_mfma_f32_32x32x16_bf16 v[112:127], v[188:191], v[76:79], v[112:127]
    ds_read_b128 v[188:191], v229 offset:52224
    v_exp_f32 v238, v142
    v_exp_f32 v239, v143
    s_waitcnt lgkmcnt(4)
    v_mfma_f32_32x32x16_bf16 v[112:127], v[192:195], v[80:83], v[112:127]
    ds_read_b128 v[192:195], v229 offset:53248
    v_add_f32 v224, v224, v236
    v_cvt_pk_bf16_f32 v166, v236, v237
    v_add_f32 v225, v225, v237
    v_add_f32 v224, v224, v238
    v_mfma_f32_32x32x16_bf16 v[112:127], v[196:199], v[84:87], v[112:127]
    ds_read_b128 v[196:199], v229 offset:54272
    v_cvt_pk_bf16_f32 v167, v238, v239
    v_add_f32 v225, v225, v239
    v_exp_f32 v232, v144
    v_mfma_f32_32x32x16_bf16 v[112:127], v[200:203], v[88:91], v[112:127]
    ds_read_b128 v[200:203], v229 offset:55296
    v_exp_f32 v233, v145
    v_exp_f32 v234, v146
    v_mfma_f32_32x32x16_bf16 v[112:127], v[204:207], v[92:95], v[112:127]
    ds_read_b128 v[204:207], v229 offset:56320
    v_exp_f32 v235, v147
    v_add_f32 v224, v224, v232
    v_cvt_pk_bf16_f32 v168, v232, v233
    s_waitcnt lgkmcnt(4)
    v_mfma_f32_32x32x16_bf16 v[0:15], v[176:179], v[160:163], v[0:15]
    ds_read_b128 v[176:179], v229 offset:57344
    v_add_f32 v225, v225, v233
    v_exp_f32 v236, v148
    v_exp_f32 v237, v149
    v_mfma_f32_32x32x16_bf16 v[16:31], v[180:183], v[160:163], v[16:31]
    ds_read_b128 v[180:183], v229 offset:58368
    v_add_f32 v224, v224, v234
    v_cvt_pk_bf16_f32 v169, v234, v235
    v_add_f32 v225, v225, v235
    v_mfma_f32_32x32x16_bf16 v[32:47], v[184:187], v[160:163], v[32:47]
    ds_read_b128 v[184:187], v229 offset:59392
    v_exp_f32 v238, v150
    v_exp_f32 v239, v151
    v_add_f32 v224, v224, v236
    v_mfma_f32_32x32x16_bf16 v[48:63], v[188:191], v[160:163], v[48:63]
    ds_read_b128 v[188:191], v229 offset:60416
    v_cvt_pk_bf16_f32 v170, v236, v237
    v_add_f32 v225, v225, v237
    v_add_f32 v224, v224, v238
    v_cvt_pk_bf16_f32 v171, v238, v239
    s_waitcnt lgkmcnt(4)
    v_mfma_f32_32x32x16_bf16 v[0:15], v[192:195], v[164:167], v[0:15]
    ds_read_b128 v[192:195], v229 offset:61440
    v_add_f32 v225, v225, v239
    v_exp_f32 v232, v152
    v_exp_f32 v233, v153
    v_mfma_f32_32x32x16_bf16 v[16:31], v[196:199], v[164:167], v[16:31]
    ds_read_b128 v[196:199], v229 offset:62464
    v_exp_f32 v234, v154
    v_exp_f32 v235, v155
    v_mfma_f32_32x32x16_bf16 v[32:47], v[200:203], v[164:167], v[32:47]
    ds_read_b128 v[200:203], v229 offset:63488
    v_add_f32 v224, v224, v232
    v_cvt_pk_bf16_f32 v172, v232, v233
    v_add_f32 v225, v225, v233
    v_mfma_f32_32x32x16_bf16 v[48:63], v[204:207], v[164:167], v[48:63]
    ds_read_b128 v[204:207], v229 offset:64512
    v_exp_f32 v236, v156
    v_exp_f32 v237, v157
    v_add_f32 v224, v224, v234
    s_waitcnt lgkmcnt(4)
    s_barrier
    v_mfma_f32_32x32x16_bf16 v[0:15], v[176:179], v[168:171], v[0:15]
    ds_read_b128 v[176:179], v230 offset:49152
    v_cvt_pk_bf16_f32 v173, v234, v235
    v_add_f32 v225, v225, v235
    v_exp_f32 v238, v158
    v_mfma_f32_32x32x16_bf16 v[16:31], v[180:183], v[168:171], v[16:31]
    ds_read_b128 v[180:183], v230 offset:50176
    v_exp_f32 v239, v159
    v_add_f32 v224, v224, v236
    v_cvt_pk_bf16_f32 v174, v236, v237
    v_mfma_f32_32x32x16_bf16 v[32:47], v[184:187], v[168:171], v[32:47]
    ds_read_b128 v[184:187], v230 offset:51200
    v_add_f32 v225, v225, v237
    v_add_f32 v224, v224, v238
    v_cvt_pk_bf16_f32 v175, v238, v239
    v_add_f32 v225, v225, v239
    v_mfma_f32_32x32x16_bf16 v[48:63], v[188:191], v[168:171], v[48:63]
    ds_read_b128 v[188:191], v230 offset:52224
    s_waitcnt lgkmcnt(4)
    v_mfma_f32_32x32x16_bf16 v[0:15], v[192:195], v[172:175], v[0:15]
    ds_read_b128 v[192:195], v230 offset:53248
    v_mfma_f32_32x32x16_bf16 v[16:31], v[196:199], v[172:175], v[16:31]
    ds_read_b128 v[196:199], v230 offset:54272
    v_mfma_f32_32x32x16_bf16 v[32:47], v[200:203], v[172:175], v[32:47]
    ds_read_b128 v[200:203], v230 offset:55296
    v_mfma_f32_32x32x16_bf16 v[48:63], v[204:207], v[172:175], v[48:63]
    ds_read_b128 v[204:207], v230 offset:56320
    s_add_u32 s51, s51, 1
K2FH_U2:
    s_waitcnt lgkmcnt(4)
    v_mfma_f32_32x32x16_bf16 v[128:143], v[176:179], v[64:67], v[208:223]
    ds_read_b128 v[176:179], v230 offset:57344
    v_exp_f32 v232, v96
    v_exp_f32 v233, v97
    v_mfma_f32_32x32x16_bf16 v[128:143], v[180:183], v[68:71], v[128:143]
    ds_read_b128 v[180:183], v230 offset:58368
    v_exp_f32 v234, v98
    v_exp_f32 v235, v99
    v_mfma_f32_32x32x16_bf16 v[128:143], v[184:187], v[72:75], v[128:143]
    ds_read_b128 v[184:187], v230 offset:59392
    v_add_f32 v224, v224, v232
    v_cvt_pk_bf16_f32 v160, v232, v233
    v_add_f32 v225, v225, v233
    v_exp_f32 v236, v100
    v_mfma_f32_32x32x16_bf16 v[128:143], v[188:191], v[76:79], v[128:143]
    ds_read_b128 v[188:191], v230 offset:60416
    v_exp_f32 v237, v101
    v_add_f32 v224, v224, v234
    v_cvt_pk_bf16_f32 v161, v234, v235
    s_waitcnt lgkmcnt(4)
    v_mfma_f32_32x32x16_bf16 v[128:143], v[192:195], v[80:83], v[128:143]
    ds_read_b128 v[192:195], v230 offset:61440
    v_add_f32 v225, v225, v235
    v_exp_f32 v238, v102
    v_mfma_f32_32x32x16_bf16 v[128:143], v[196:199], v[84:87], v[128:143]
    ds_read_b128 v[196:199], v230 offset:62464
    v_exp_f32 v239, v103
    v_add_f32 v224, v224, v236
    v_cvt_pk_bf16_f32 v162, v236, v237
    v_add_f32 v225, v225, v237
    v_mfma_f32_32x32x16_bf16 v[128:143], v[200:203], v[88:91], v[128:143]
    ds_read_b128 v[200:203], v230 offset:63488
    v_add_f32 v224, v224, v238
    v_cvt_pk_bf16_f32 v163, v238, v239
    v_add_f32 v225, v225, v239
    v_exp_f32 v232, v104
    v_mfma_f32_32x32x16_bf16 v[128:143], v[204:207], v[92:95], v[128:143]
    ds_read_b128 v[204:207], v230 offset:64512
    v_exp_f32 v233, v105
    v_exp_f32 v234, v106
    s_waitcnt lgkmcnt(4)
    v_mfma_f32_32x32x16_bf16 v[144:159], v[176:179], v[64:67], v[208:223]
    ds_read_b128 v[176:179], v229 offset:0
    v_exp_f32 v235, v107
    v_add_f32 v224, v224, v232
    v_mfma_f32_32x32x16_bf16 v[144:159], v[180:183], v[68:71], v[144:159]
    ds_read_b128 v[180:183], v229 offset:1024
    v_cvt_pk_bf16_f32 v164, v232, v233
    v_add_f32 v225, v225, v233
    v_exp_f32 v236, v108
    v_mfma_f32_32x32x16_bf16 v[144:159], v[184:187], v[72:75], v[144:159]
    ds_read_b128 v[184:187], v229 offset:2048
    v_exp_f32 v237, v109
    v_add_f32 v224, v224, v234
    v_cvt_pk_bf16_f32 v165, v234, v235
    v_add_f32 v225, v225, v235
    v_mfma_f32_32x32x16_bf16 v[144:159], v[188:191], v[76:79], v[144:159]
    ds_read_b128 v[188:191], v229 offset:3072
    v_exp_f32 v238, v110
    v_exp_f32 v239, v111
    s_waitcnt lgkmcnt(4)
    v_mfma_f32_32x32x16_bf16 v[144:159], v[192:195], v[80:83], v[144:159]
    ds_read_b128 v[192:195], v229 offset:4096
    v_add_f32 v224, v224, v236
    v_cvt_pk_bf16_f32 v166, v236, v237
    v_add_f32 v225, v225, v237
    v_add_f32 v224, v224, v238
    v_mfma_f32_32x32x16_bf16 v[144:159], v[196:199], v[84:87], v[144:159]
    ds_read_b128 v[196:199], v229 offset:5120
    v_cvt_pk_bf16_f32 v167, v238, v239
    v_add_f32 v225, v225, v239
    v_exp_f32 v232, v112
    v_mfma_f32_32x32x16_bf16 v[144:159], v[200:203], v[88:91], v[144:159]
    ds_read_b128 v[200:203], v229 offset:6144
    v_exp_f32 v233, v113
    v_exp_f32 v234, v114
    v_mfma_f32_32x32x16_bf16 v[144:159], v[204:207], v[92:95], v[144:159]
    ds_read_b128 v[204:207], v229 offset:7168
    v_exp_f32 v235, v115
    v_add_f32 v224, v224, v232
    v_cvt_pk_bf16_f32 v168, v232, v233
    s_waitcnt lgkmcnt(4)
    v_mfma_f32_32x32x16_bf16 v[0:15], v[176:179], v[160:163], v[0:15]
    ds_read_b128 v[176:179], v229 offset:8192
    v_add_f32 v225, v225, v233
    v_exp_f32 v236, v116
    v_exp_f32 v237, v117
    v_mfma_f32_32x32x16_bf16 v[16:31], v[180:183], v[160:163], v[16:31]
    ds_read_b128 v[180:183], v229 offset:9216
    v_add_f32 v224, v224, v234
    v_cvt_pk_bf16_f32 v169, v234, v235
    v_add_f32 v225, v225, v235
    v_mfma_f32_32x32x16_bf16 v[32:47], v[184:187], v[160:163], v[32:47]
    ds_read_b128 v[184:187], v229 offset:10240
    v_exp_f32 v238, v118
    v_exp_f32 v239, v119
    v_add_f32 v224, v224, v236
    v_mfma_f32_32x32x16_bf16 v[48:63], v[188:191], v[160:163], v[48:63]
    ds_read_b128 v[188:191], v229 offset:11264
    v_cvt_pk_bf16_f32 v170, v236, v237
    v_add_f32 v225, v225, v237
    v_add_f32 v224, v224, v238
    v_cvt_pk_bf16_f32 v171, v238, v239
    s_waitcnt lgkmcnt(4)
    v_mfma_f32_32x32x16_bf16 v[0:15], v[192:195], v[164:167], v[0:15]
    ds_read_b128 v[192:195], v229 offset:12288
    v_add_f32 v225, v225, v239
    v_exp_f32 v232, v120
    v_exp_f32 v233, v121
    v_mfma_f32_32x32x16_bf16 v[16:31], v[196:199], v[164:167], v[16:31]
    ds_read_b128 v[196:199], v229 offset:13312
    v_exp_f32 v234, v122
    v_exp_f32 v235, v123
    v_mfma_f32_32x32x16_bf16 v[32:47], v[200:203], v[164:167], v[32:47]
    ds_read_b128 v[200:203], v229 offset:14336
    v_add_f32 v224, v224, v232
    v_cvt_pk_bf16_f32 v172, v232, v233
    v_add_f32 v225, v225, v233
    v_mfma_f32_32x32x16_bf16 v[48:63], v[204:207], v[164:167], v[48:63]
    ds_read_b128 v[204:207], v229 offset:15360
    v_exp_f32 v236, v124
    v_exp_f32 v237, v125
    v_add_f32 v224, v224, v234
    s_waitcnt lgkmcnt(4)
    s_barrier
    v_mfma_f32_32x32x16_bf16 v[0:15], v[176:179], v[168:171], v[0:15]
    ds_read_b128 v[176:179], v230 offset:0
    v_cvt_pk_bf16_f32 v173, v234, v235
    v_add_f32 v225, v225, v235
    v_exp_f32 v238, v126
    v_mfma_f32_32x32x16_bf16 v[16:31], v[180:183], v[168:171], v[16:31]
    ds_read_b128 v[180:183], v230 offset:1024
    v_exp_f32 v239, v127
    v_add_f32 v224, v224, v236
    v_cvt_pk_bf16_f32 v174, v236, v237
    v_mfma_f32_32x32x16_bf16 v[32:47], v[184:187], v[168:171], v[32:47]
    ds_read_b128 v[184:187], v230 offset:2048
    v_add_f32 v225, v225, v237
    v_add_f32 v224, v224, v238
    v_cvt_pk_bf16_f32 v175, v238, v239
    v_add_f32 v225, v225, v239
    v_mfma_f32_32x32x16_bf16 v[48:63], v[188:191], v[168:171], v[48:63]
    ds_read_b128 v[188:191], v230 offset:3072
    s_waitcnt lgkmcnt(4)
    v_mfma_f32_32x32x16_bf16 v[0:15], v[192:195], v[172:175], v[0:15]
    ds_read_b128 v[192:195], v230 offset:4096
    buffer_load_dwordx4 v[248:251], v230, s[20:23], s65 offen
    v_mfma_f32_32x32x16_bf16 v[16:31], v[196:199], v[172:175], v[16:31]
    ds_read_b128 v[196:199], v230 offset:5120
    buffer_load_dwordx4 v[252:255], v230, s[24:27], s65 offen
    v_mfma_f32_32x32x16_bf16 v[32:47], v[200:203], v[172:175], v[32:47]
    ds_read_b128 v[200:203], v230 offset:6144
    buffer_load_dwordx4 v[240:243], v230, s[96:99], s65 offen
    v_mfma_f32_32x32x16_bf16 v[48:63], v[204:207], v[172:175], v[48:63]
    ds_read_b128 v[204:207], v230 offset:7168
    s_add_u32 s65, s65, 1048576
    s_add_u32 s51, s51, 1
    s_cmp_ge_u32 s51, s49
    s_cbranch_scc1 K2FH_M1b
K2FH_U3:
    s_waitcnt lgkmcnt(4)
    v_mfma_f32_32x32x16_bf16 v[96:111], v[176:179], v[64:67], v[208:223]
    ds_read_b128 v[176:179], v230 offset:8192
    v_exp_f32 v232, v128
    v_exp_f32 v233, v129
    v_mfma_f32_32x32x16_bf16 v[96:111], v[180:183], v[68:71], v[96:111]
    ds_read_b128 v[180:183], v230 offset:9216
    v_exp_f32 v234, v130
    v_exp_f32 v235, v131
    v_mfma_f32_32x32x16_bf16 v[96:111], v[184:187], v[72:75], v[96:111]
    ds_read_b128 v[184:187], v230 offset:10240
    v_add_f32 v224, v224, v232
    v_cvt_pk_bf16_f32 v160, v232, v233
    v_add_f32 v225, v225, v233
    v_exp_f32 v236, v132
    v_mfma_f32_32x32x16_bf16 v[96:111], v[188:191], v[76:79], v[96:111]
    ds_read_b128 v[188:191], v230 offset:11264
    v_exp_f32 v237, v133
    v_add_f32 v224, v224, v234
    v_cvt_pk_bf16_f32 v161, v234, v235
    s_waitcnt lgkmcnt(4)
    v_mfma_f32_32x32x16_bf16 v[96:111], v[192:195], v[80:83], v[96:111]
    ds_read_b128 v[192:195], v230 offset:12288
    v_add_f32 v225, v225, v235
    v_exp_f32 v238, v134
    v_mfma_f32_32x32x16_bf16 v[96:111], v[196:199], v[84:87], v[96:111]
    ds_read_b128 v[196:199], v230 offset:13312
    v_exp_f32 v239, v135
    v_add_f32 v224, v224, v236
    v_cvt_pk_bf16_f32 v162, v236, v237
    v_add_f32 v225, v225, v237
    v_mfma_f32_32x32x16_bf16 v[96:111], v[200:203], v[88:91], v[96:111]
    ds_read_b128 v[200:203], v230 offset:14336
    v_add_f32 v224, v224, v238
    v_cvt_pk_bf16_f32 v163, v238, v239
    v_add_f32 v225, v225, v239
    v_exp_f32 v232, v136
    v_mfma_f32_32x32x16_bf16 v[96:111], v[204:207], v[92:95], v[96:111]
    ds_read_b128 v[204:207], v230 offset:15360
    v_exp_f32 v233, v137
    v_exp_f32 v234, v138
    s_waitcnt lgkmcnt(4)
    v_mfma_f32_32x32x16_bf16 v[112:127], v[176:179], v[64:67], v[208:223]
    ds_read_b128 v[176:179], v229 offset:16384
    v_exp_f32 v235, v139
    v_add_f32 v224, v224, v232
    v_mfma_f32_32x32x16_bf16 v[112:127], v[180:183], v[68:71], v[112:127]
    ds_read_b128 v[180:183], v229 offset:17408
    v_cvt_pk_bf16_f32 v164, v232, v233
    v_add_f32 v225, v225, v233
    v_exp_f32 v236, v140
    v_mfma_f32_32x32x16_bf16 v[112:127], v[184:187], v[72:75], v[112:127]
    ds_read_b128 v[184:187], v229 offset:18432
    v_exp_f32 v237, v141
    v_add_f32 v224, v224, v234
    v_cvt_pk_bf16_f32 v165, v234, v235
    v_add_f32 v225, v225, v235
    v_mfma_f32_32x32x16_bf16 v[112:127], v[188:191], v[76:79], v[112:127]
    ds_read_b128 v[188:191], v229 offset:19456
    v_exp_f32 v238, v142
    v_exp_f32 v239, v143
    s_waitcnt lgkmcnt(4)
    v_mfma_f32_32x32x16_bf16 v[112:127], v[192:195], v[80:83], v[112:127]
    ds_read_b128 v[192:195], v229 offset:20480
    v_add_f32 v224, v224, v236
    v_cvt_pk_bf16_f32 v166, v236, v237
    v_add_f32 v225, v225, v237
    v_add_f32 v224, v224, v238
    v_mfma_f32_32x32x16_bf16 v[112:127], v[196:199], v[84:87], v[112:127]
    ds_read_b128 v[196:199], v229 offset:21504
    v_cvt_pk_bf16_f32 v167, v238, v239
    v_add_f32 v225, v225, v239
    v_exp_f32 v232, v144
    v_mfma_f32_32x32x16_bf16 v[112:127], v[200:203], v[88:91], v[112:127]
    ds_read_b128 v[200:203], v229 offset:22528
    v_exp_f32 v233, v145
    v_exp_f32 v234, v146
    v_mfma_f32_32x32x16_bf16 v[112:127], v[204:207], v[92:95], v[112:127]
    ds_read_b128 v[204:207], v229 offset:23552
    v_exp_f32 v235, v147
    v_add_f32 v224, v224, v232
    v_cvt_pk_bf16_f32 v168, v232, v233
    s_waitcnt lgkmcnt(4)
    v_mfma_f32_32x32x16_bf16 v[0:15], v[176:179], v[160:163], v[0:15]
    ds_read_b128 v[176:179], v229 offset:24576
    v_add_f32 v225, v225, v233
    v_exp_f32 v236, v148
    v_exp_f32 v237, v149
    v_mfma_f32_32x32x16_bf16 v[16:31], v[180:183], v[160:163], v[16:31]
    ds_read_b128 v[180:183], v229 offset:25600
    v_add_f32 v224, v224, v234
    v_cvt_pk_bf16_f32 v169, v234, v235
    v_add_f32 v225, v225, v235
    v_mfma_f32_32x32x16_bf16 v[32:47], v[184:187], v[160:163], v[32:47]
    ds_read_b128 v[184:187], v229 offset:26624
    v_exp_f32 v238, v150
    v_exp_f32 v239, v151
    v_add_f32 v224, v224, v236
    v_mfma_f32_32x32x16_bf16 v[48:63], v[188:191], v[160:163], v[48:63]
    ds_read_b128 v[188:191], v229 offset:27648
    v_cvt_pk_bf16_f32 v170, v236, v237
    v_add_f32 v225, v225, v237
    v_add_f32 v224, v224, v238
    v_cvt_pk_bf16_f32 v171, v238, v239
    s_waitcnt lgkmcnt(4)
    v_mfma_f32_32x32x16_bf16 v[0:15], v[192:195], v[164:167], v[0:15]
    ds_read_b128 v[192:195], v229 offset:28672
    v_add_f32 v225, v225, v239
    v_exp_f32 v232, v152
    v_exp_f32 v233, v153
    v_mfma_f32_32x32x16_bf16 v[16:31], v[196:199], v[164:167], v[16:31]
    ds_read_b128 v[196:199], v229 offset:29696
    v_exp_f32 v234, v154
    v_exp_f32 v235, v155
    v_mfma_f32_32x32x16_bf16 v[32:47], v[200:203], v[164:167], v[32:47]
    ds_read_b128 v[200:203], v229 offset:30720
    v_add_f32 v224, v224, v232
    v_cvt_pk_bf16_f32 v172, v232, v233
    v_add_f32 v225, v225, v233
    v_mfma_f32_32x32x16_bf16 v[48:63], v[204:207], v[164:167], v[48:63]
    ds_read_b128 v[204:207], v229 offset:31744
    v_exp_f32 v236, v156
    v_exp_f32 v237, v157
    v_add_f32 v224, v224, v234
    s_waitcnt lgkmcnt(4)
    s_barrier
    v_mfma_f32_32x32x16_bf16 v[0:15], v[176:179], v[168:171], v[0:15]
    ds_read_b128 v[176:179], v230 offset:16384
    v_cvt_pk_bf16_f32 v173, v234, v235
    v_add_f32 v225, v225, v235
    v_exp_f32 v238, v158
    v_mfma_f32_32x32x16_bf16 v[16:31], v[180:183], v[168:171], v[16:31]
    ds_read_b128 v[180:183], v230 offset:17408
    v_exp_f32 v239, v159
    v_add_f32 v224, v224, v236
    v_cvt_pk_bf16_f32 v174, v236, v237
    v_mfma_f32_32x32x16_bf16 v[32:47], v[184:187], v[168:171], v[32:47]
    ds_read_b128 v[184:187], v230 offset:18432
    v_add_f32 v225, v225, v237
    v_add_f32 v224, v224, v238
    v_cvt_pk_bf16_f32 v175, v238, v239
    v_add_f32 v225, v225, v239
    v_mfma_f32_32x32x16_bf16 v[48:63], v[188:191], v[168:171], v[48:63]
    ds_read_b128 v[188:191], v230 offset:19456
    s_waitcnt lgkmcnt(4)
    v_mfma_f32_32x32x16_bf16 v[0:15], v[192:195], v[172:175], v[0:15]
    ds_read_b128 v[192:195], v230 offset:20480
    v_mfma_f32_32x32x16_bf16 v[16:31], v[196:199], v[172:175], v[16:31]
    ds_read_b128 v[196:199], v230 offset:21504
    v_mfma_f32_32x32x16_bf16 v[32:47], v[200:203], v[172:175], v[32:47]
    ds_read_b128 v[200:203], v230 offset:22528
    v_mfma_f32_32x32x16_bf16 v[48:63], v[204:207], v[172:175], v[48:63]
    ds_read_b128 v[204:207], v230 offset:23552
    s_add_u32 s51, s51, 1
    s_branch K2FH_U0
K2FH_M1a:
    s_waitcnt lgkmcnt(4)
    v_mfma_f32_32x32x16_bf16 v[96:111], v[176:179], v[64:67], v[208:223]
    ds_read_b128 v[176:179], v230 offset:40960
    v_exp_f32 v232, v128
    v_exp_f32 v233, v129
    v_exp_f32 v234, v130
    v_mfma_f32_32x32x16_bf16 v[96:111], v[180:183], v[68:71], v[96:111]
    ds_read_b128 v[180:183], v230 offset:41984
    v_exp_f32 v235, v131
    v_add_f32 v224, v224, v232
    v_cvt_pk_bf16_f32 v160, v232, v233
    v_mfma_f32_32x32x16_bf16 v[96:111], v[184:187], v[72:75], v[96:111]
    ds_read_b128 v[184:187], v230 offset:43008
    v_add_f32 v225, v225, v233
    v_exp_f32 v236, v132
    v_exp_f32 v237, v133
    v_add_f32 v224, v224, v234
    v_mfma_f32_32x32x16_bf16 v[96:111], v[188:191], v[76:79], v[96:111]
    ds_read_b128 v[188:191], v230 offset:44032
    v_cvt_pk_bf16_f32 v161, v234, v235
    v_add_f32 v225, v225, v235
    v_exp_f32 v238, v134
    s_waitcnt lgkmcnt(4)
    v_mfma_f32_32x32x16_bf16 v[96:111], v[192:195], v[80:83], v[96:111]
    ds_read_b128 v[192:195], v230 offset:45056
    v_exp_f32 v239, v135
    v_add_f32 v224, v224, v236
    v_cvt_pk_bf16_f32 v162, v236, v237
    v_add_f32 v225, v225, v237
    v_add_f32 v224, v224, v238
    v_mfma_f32_32x32x16_bf16 v[96:111], v[196:199], v[84:87], v[96:111]
    ds_read_b128 v[196:199], v230 offset:46080
    v_cvt_pk_bf16_f32 v163, v238, v239
    v_add_f32 v225, v225, v239
    v_exp_f32 v232, v136
    v_exp_f32 v233, v137
    v_mfma_f32_32x32x16_bf16 v[96:111], v[200:203], v[88:91], v[96:111]
    ds_read_b128 v[200:203], v230 offset:47104
    v_exp_f32 v234, v138
    v_exp_f32 v235, v139
    v_add_f32 v224, v224, v232
    v_mfma_f32_32x32x16_bf16 v[96:111], v[204:207], v[92:95], v[96:111]
    ds_read_b128 v[204:207], v230 offset:48128
    v_cvt_pk_bf16_f32 v164, v232, v233
    v_add_f32 v225, v225, v233
    v_exp_f32 v236, v140
    s_waitcnt lgkmcnt(4)
    s_cmp_lt_u32 s62, 1
    s_cselect_b64 vcc, -1, 0
    s_cbranch_vccnz K2FH_M1a_qk8
    v_mfma_f32_32x32x16_bf16 v[112:127], v[176:179], v[64:67], v[208:223]
K2FH_M1a_qk8:
    ds_read_b128 v[176:179], v229 offset:49152
    v_exp_f32 v237, v141
    v_add_f32 v224, v224, v234
    v_cvt_pk_bf16_f32 v165, v234, v235
    v_add_f32 v225, v225, v235
    v_exp_f32 v238, v142
    s_cbranch_vccnz K2FH_M1a_qk9
    v_mfma_f32_32x32x16_bf16 v[112:127], v[180:183], v[68:71], v[112:127]
K2FH_M1a_qk9:
    ds_read_b128 v[180:183], v229 offset:50176
    v_exp_f32 v239, v143
    v_add_f32 v224, v224, v236
    v_cvt_pk_bf16_f32 v166, v236, v237
    s_cbranch_vccnz K2FH_M1a_qk10
    v_mfma_f32_32x32x16_bf16 v[112:127], v[184:187], v[72:75], v[112:127]
K2FH_M1a_qk10:
    ds_read_b128 v[184:187], v229 offset:51200
    v_add_f32 v225, v225, v237
    v_add_f32 v224, v224, v238
    v_cvt_pk_bf16_f32 v167, v238, v239
    v_add_f32 v225, v225, v239
    v_exp_f32 v232, v144
    s_cbranch_vccnz K2FH_M1a_qk11
    v_mfma_f32_32x32x16_bf16 v[112:127], v[188:191], v[76:79], v[112:127]
K2FH_M1a_qk11:
    ds_read_b128 v[188:191], v229 offset:52224
    v_exp_f32 v233, v145
    v_exp_f32 v234, v146
    s_waitcnt lgkmcnt(4)
    s_cbranch_vccnz K2FH_M1a_qk12
    v_mfma_f32_32x32x16_bf16 v[112:127], v[192:195], v[80:83], v[112:127]
K2FH_M1a_qk12:
    ds_read_b128 v[192:195], v229 offset:53248
    v_exp_f32 v235, v147
    v_add_f32 v224, v224, v232
    v_cvt_pk_bf16_f32 v168, v232, v233
    v_add_f32 v225, v225, v233
    v_exp_f32 v236, v148
    s_cbranch_vccnz K2FH_M1a_qk13
    v_mfma_f32_32x32x16_bf16 v[112:127], v[196:199], v[84:87], v[112:127]
K2FH_M1a_qk13:
    ds_read_b128 v[196:199], v229 offset:54272
    v_exp_f32 v237, v149
    v_add_f32 v224, v224, v234
    v_cvt_pk_bf16_f32 v169, v234, v235
    s_cbranch_vccnz K2FH_M1a_qk14
    v_mfma_f32_32x32x16_bf16 v[112:127], v[200:203], v[88:91], v[112:127]
K2FH_M1a_qk14:
    ds_read_b128 v[200:203], v229 offset:55296
    v_add_f32 v225, v225, v235
    v_exp_f32 v238, v150
    v_exp_f32 v239, v151
    v_add_f32 v224, v224, v236
    s_cbranch_vccnz K2FH_M1a_qk15
    v_mfma_f32_32x32x16_bf16 v[112:127], v[204:207], v[92:95], v[112:127]
K2FH_M1a_qk15:
    ds_read_b128 v[204:207], v229 offset:56320
    v_cvt_pk_bf16_f32 v170, v236, v237
    v_add_f32 v225, v225, v237
    v_add_f32 v224, v224, v238
    v_cvt_pk_bf16_f32 v171, v238, v239
    v_add_f32 v225, v225, v239
    s_waitcnt lgkmcnt(4)
    v_mfma_f32_32x32x16_bf16 v[0:15], v[176:179], v[160:163], v[0:15]
    ds_read_b128 v[176:179], v229 offset:57344
    v_exp_f32 v232, v152
    v_exp_f32 v233, v153
    v_mfma_f32_32x32x16_bf16 v[16:31], v[180:183], v[160:163], v[16:31]
    ds_read_b128 v[180:183], v229 offset:58368
    v_exp_f32 v234, v154
    v_exp_f32 v235, v155
    v_add_f32 v224, v224, v232
    v_mfma_f32_32x32x16_bf16 v[32:47], v[184:187], v[160:163], v[32:47]
    ds_read_b128 v[184:187], v229 offset:59392
    v_cvt_pk_bf16_f32 v172, v232, v233
    v_add_f32 v225, v225, v233
    v_exp_f32 v236, v156
    v_mfma_f32_32x32x16_bf16 v[48:63], v[188:191], v[160:163], v[48:63]
    ds_read_b128 v[188:191], v229 offset:60416
    v_exp_f32 v237, v157
    v_add_f32 v224, v224, v234
    v_cvt_pk_bf16_f32 v173, v234, v235
    v_add_f32 v225, v225, v235
    s_waitcnt lgkmcnt(4)
    v_mfma_f32_32x32x16_bf16 v[0:15], v[192:195], v[164:167], v[0:15]
    ds_read_b128 v[192:195], v229 offset:61440
    v_exp_f32 v238, v158
    v_exp_f32 v239, v159
    v_add_f32 v224, v224, v236
    v_mfma_f32_32x32x16_bf16 v[16:31], v[196:199], v[164:167], v[16:31]
    ds_read_b128 v[196:199], v229 offset:62464
    v_cvt_pk_bf16_f32 v174, v236, v237
    v_add_f32 v225, v225, v237
    v_add_f32 v224, v224, v238
    v_cvt_pk_bf16_f32 v175, v238, v239
    v_add_f32 v225, v225, v239
    v_mfma_f32_32x32x16_bf16 v[32:47], v[200:203], v[164:167], v[32:47]
    ds_read_b128 v[200:203], v229 offset:63488
    s_add_u32 s54, s51, 1
    s_lshl_b32 s67, s54, 6
    v_subrev_u32 v227, s67, v231
    v_mov_b32 v226, s52
    v_cmp_le_i32 s[56:57], 0, v227
    v_cmp_le_i32 s[58:59], 1, v227
    v_cmp_le_i32 s[92:93], 2, v227
    v_mfma_f32_32x32x16_bf16 v[48:63], v[204:207], v[164:167], v[48:63]
    ds_read_b128 v[204:207], v229 offset:64512
    v_cmp_le_i32 s[94:95], 3, v227
    v_cndmask_b32 v96, v226, v96, s[56:57]
    v_cndmask_b32 v97, v226, v97, s[58:59]
    v_cndmask_b32 v98, v226, v98, s[92:93]
    v_cndmask_b32 v99, v226, v99, s[94:95]
    v_cmp_le_i32 s[56:57], 8, v227
    v_cmp_le_i32 s[58:59], 9, v227
    s_waitcnt lgkmcnt(4)
    s_barrier
    v_mfma_f32_32x32x16_bf16 v[0:15], v[176:179], v[168:171], v[0:15]
    ds_read_b128 v[176:179], v230 offset:49152
    v_cmp_le_i32 s[92:93], 10, v227
    v_cmp_le_i32 s[94:95], 11, v227
    v_cndmask_b32 v100, v226, v100, s[56:57]
    v_cndmask_b32 v101, v226, v101, s[58:59]
    v_cndmask_b32 v102, v226, v102, s[92:93]
    v_cndmask_b32 v103, v226, v103, s[94:95]
    v_mfma_f32_32x32x16_bf16 v[16:31], v[180:183], v[168:171], v[16:31]
    ds_read_b128 v[180:183], v230 offset:50176
    v_cmp_le_i32 s[56:57], 16, v227
    v_cmp_le_i32 s[58:59], 17, v227
    v_cmp_le_i32 s[92:93], 18, v227
    v_cmp_le_i32 s[94:95], 19, v227
    v_cndmask_b32 v104, v226, v104, s[56:57]
    v_cndmask_b32 v105, v226, v105, s[58:59]
    v_cndmask_b32 v106, v226, v106, s[92:93]
    v_mfma_f32_32x32x16_bf16 v[32:47], v[184:187], v[168:171], v[32:47]
    ds_read_b128 v[184:187], v230 offset:51200
    v_cndmask_b32 v107, v226, v107, s[94:95]
    v_cmp_le_i32 s[56:57], 24, v227
    v_cmp_le_i32 s[58:59], 25, v227
    v_cmp_le_i32 s[92:93], 26, v227
    v_cmp_le_i32 s[94:95], 27, v227
    v_cndmask_b32 v108, v226, v108, s[56:57]
    v_cndmask_b32 v109, v226, v109, s[58:59]
    v_mfma_f32_32x32x16_bf16 v[48:63], v[188:191], v[168:171], v[48:63]
    ds_read_b128 v[188:191], v230 offset:52224
    v_cndmask_b32 v110, v226, v110, s[92:93]
    v_cndmask_b32 v111, v226, v111, s[94:95]
    v_cmp_le_i32 s[56:57], 32, v227
    v_cmp_le_i32 s[58:59], 33, v227
    v_cmp_le_i32 s[92:93], 34, v227
    v_cmp_le_i32 s[94:95], 35, v227
    v_cndmask_b32 v112, v226, v112, s[56:57]
    s_waitcnt lgkmcnt(4)
    v_mfma_f32_32x32x16_bf16 v[0:15], v[192:195], v[172:175], v[0:15]
    ds_read_b128 v[192:195], v230 offset:53248
    v_cndmask_b32 v113, v226, v113, s[58:59]
    v_cndmask_b32 v114, v226, v114, s[92:93]
    v_cndmask_b32 v115, v226, v115, s[94:95]
    v_cmp_le_i32 s[56:57], 40, v227
    v_cmp_le_i32 s[58:59], 41, v227
    v_cmp_le_i32 s[92:93], 42, v227
    v_cmp_le_i32 s[94:95], 43, v227
    v_mfma_f32_32x32x16_bf16 v[16:31], v[196:199], v[172:175], v[16:31]
    ds_read_b128 v[196:199], v230 offset:54272
    v_cndmask_b32 v116, v226, v116, s[56:57]
    v_cndmask_b32 v117, v226, v117, s[58:59]
    v_cndmask_b32 v118, v226, v118, s[92:93]
    v_cndmask_b32 v119, v226, v119, s[94:95]
    v_cmp_le_i32 s[56:57], 48, v227
    v_cmp_le_i32 s[58:59], 49, v227
    v_mfma_f32_32x32x16_bf16 v[32:47], v[200:203], v[172:175], v[32:47]
    ds_read_b128 v[200:203], v230 offset:55296
    v_cmp_le_i32 s[92:93], 50, v227
    v_cmp_le_i32 s[94:95], 51, v227
    v_cndmask_b32 v120, v226, v120, s[56:57]
    v_cndmask_b32 v121, v226, v121, s[58:59]
    v_cndmask_b32 v122, v226, v122, s[92:93]
    v_cndmask_b32 v123, v226, v123, s[94:95]
    v_cmp_le_i32 s[56:57], 56, v227
    v_mfma_f32_32x32x16_bf16 v[48:63], v[204:207], v[172:175], v[48:63]
    ds_read_b128 v[204:207], v230 offset:56320
    v_cmp_le_i32 s[58:59], 57, v227
    v_cmp_le_i32 s[92:93], 58, v227
    v_cmp_le_i32 s[94:95], 59, v227
    v_cndmask_b32 v124, v226, v124, s[56:57]
    v_cndmask_b32 v125, v226, v125, s[58:59]
    v_cndmask_b32 v126, v226, v126, s[92:93]
    v_cndmask_b32 v127, v226, v127, s[94:95]
    s_add_u32 s51, s51, 1
K2FH_M0a:
    s_waitcnt lgkmcnt(4)
    s_cmp_lt_u32 s62, 2
    s_cselect_b64 vcc, -1, 0
    s_cbranch_vccnz K2FH_M0a_qk0
    v_mfma_f32_32x32x16_bf16 v[128:143], v[176:179], v[64:67], v[208:223]
K2FH_M0a_qk0:
    ds_read_b128 v[176:179], v230 offset:57344
    v_exp_f32 v232, v96
    v_exp_f32 v233, v97
    v_exp_f32 v234, v98
    s_cbranch_vccnz K2FH_M0a_qk1
    v_mfma_f32_32x32x16_bf16 v[128:143], v[180:183], v[68:71], v[128:143]
K2FH_M0a_qk1:
    ds_read_b128 v[180:183], v230 offset:58368
    v_exp_f32 v235, v99
    v_add_f32 v224, v224, v232
    v_cvt_pk_bf16_f32 v160, v232, v233
    s_cbranch_vccnz K2FH_M0a_qk2
    v_mfma_f32_32x32x16_bf16 v[128:143], v[184:187], v[72:75], v[128:143]
K2FH_M0a_qk2:
    ds_read_b128 v[184:187], v230 offset:59392
    v_add_f32 v225, v225, v233
    v_exp_f32 v236, v100
    v_exp_f32 v237, v101
    v_add_f32 v224, v224, v234
    s_cbranch_vccnz K2FH_M0a_qk3
    v_mfma_f32_32x32x16_bf16 v[128:143], v[188:191], v[76:79], v[128:143]
K2FH_M0a_qk3:
    ds_read_b128 v[188:191], v230 offset:60416
    v_cvt_pk_bf16_f32 v161, v234, v235
    v_add_f32 v225, v225, v235
    v_exp_f32 v238, v102
    s_waitcnt lgkmcnt(4)
    s_cbranch_vccnz K2FH_M0a_qk4
    v_mfma_f32_32x32x16_bf16 v[128:143], v[192:195], v[80:83], v[128:143]
K2FH_M0a_qk4:
    ds_read_b128 v[192:195], v230 offset:61440
    v_exp_f32 v239, v103
    v_add_f32 v224, v224, v236
    v_cvt_pk_bf16_f32 v162, v236, v237
    v_add_f32 v225, v225, v237
    v_add_f32 v224, v224, v238
    s_cbranch_vccnz K2FH_M0a_qk5
    v_mfma_f32_32x32x16_bf16 v[128:143], v[196:199], v[84:87], v[128:143]
K2FH_M0a_qk5:
    ds_read_b128 v[196:199], v230 offset:62464
    v_cvt_pk_bf16_f32 v163, v238, v239
    v_add_f32 v225, v225, v239
    v_exp_f32 v232, v104
    v_exp_f32 v233, v105
    s_cbranch_vccnz K2FH_M0a_qk6
    v_mfma_f32_32x32x16_bf16 v[128:143], v[200:203], v[88:91], v[128:143]
K2FH_M0a_qk6:
    ds_read_b128 v[200:203], v230 offset:63488
    v_exp_f32 v234, v106
    v_exp_f32 v235, v107
    v_add_f32 v224, v224, v232
    s_cbranch_vccnz K2FH_M0a_qk7
    v_mfma_f32_32x32x16_bf16 v[128:143], v[204:207], v[92:95], v[128:143]
K2FH_M0a_qk7:
    ds_read_b128 v[204:207], v230 offset:64512
    v_cvt_pk_bf16_f32 v164, v232, v233
    v_add_f32 v225, v225, v233
    v_exp_f32 v236, v108
    s_waitcnt lgkmcnt(4)
    s_cmp_lt_u32 s62, 3
    s_cselect_b64 vcc, -1, 0
    s_cbranch_vccnz K2FH_M0a_qk8
    v_mfma_f32_32x32x16_bf16 v[144:159], v[176:179], v[64:67], v[208:223]
K2FH_M0a_qk8:
    ds_read_b128 v[176:179], v229 offset:0
    v_exp_f32 v237, v109
    v_add_f32 v224, v224, v234
    v_cvt_pk_bf16_f32 v165, v234, v235
    v_add_f32 v225, v225, v235
    v_exp_f32 v238, v110
    s_cbranch_vccnz K2FH_M0a_qk9
    v_mfma_f32_32x32x16_bf16 v[144:159], v[180:183], v[68:71], v[144:159]
K2FH_M0a_qk9:
    ds_read_b128 v[180:183], v229 offset:1024
    v_exp_f32 v239, v111
    v_add_f32 v224, v224, v236
    v_cvt_pk_bf16_f32 v166, v236, v237
    s_cbranch_vccnz K2FH_M0a_qk10
    v_mfma_f32_32x32x16_bf16 v[144:159], v[184:187], v[72:75], v[144:159]
K2FH_M0a_qk10:
    ds_read_b128 v[184:187], v229 offset:2048
    v_add_f32 v225, v225, v237
    v_add_f32 v224, v224, v238
    v_cvt_pk_bf16_f32 v167, v238, v239
    v_add_f32 v225, v225, v239
    v_exp_f32 v232, v112
    s_cbranch_vccnz K2FH_M0a_qk11
    v_mfma_f32_32x32x16_bf16 v[144:159], v[188:191], v[76:79], v[144:159]
K2FH_M0a_qk11:
    ds_read_b128 v[188:191], v229 offset:3072
    v_exp_f32 v233, v113
    v_exp_f32 v234, v114
    s_waitcnt lgkmcnt(4)
    s_cbranch_vccnz K2FH_M0a_qk12
    v_mfma_f32_32x32x16_bf16 v[144:159], v[192:195], v[80:83], v[144:159]
K2FH_M0a_qk12:
    ds_read_b128 v[192:195], v229 offset:4096
    v_exp_f32 v235, v115
    v_add_f32 v224, v224, v232
    v_cvt_pk_bf16_f32 v168, v232, v233
    v_add_f32 v225, v225, v233
    v_exp_f32 v236, v116
    s_cbranch_vccnz K2FH_M0a_qk13
    v_mfma_f32_32x32x16_bf16 v[144:159], v[196:199], v[84:87], v[144:159]
K2FH_M0a_qk13:
    ds_read_b128 v[196:199], v229 offset:5120
    v_exp_f32 v237, v117
    v_add_f32 v224, v224, v234
    v_cvt_pk_bf16_f32 v169, v234, v235
    s_cbranch_vccnz K2FH_M0a_qk14
    v_mfma_f32_32x32x16_bf16 v[144:159], v[200:203], v[88:91], v[144:159]
K2FH_M0a_qk14:
    ds_read_b128 v[200:203], v229 offset:6144
    v_add_f32 v225, v225, v235
    v_exp_f32 v238, v118
    v_exp_f32 v239, v119
    v_add_f32 v224, v224, v236
    s_cbranch_vccnz K2FH_M0a_qk15
    v_mfma_f32_32x32x16_bf16 v[144:159], v[204:207], v[92:95], v[144:159]
K2FH_M0a_qk15:
    ds_read_b128 v[204:207], v229 offset:7168
    v_cvt_pk_bf16_f32 v170, v236, v237
    v_add_f32 v225, v225, v237
    v_add_f32 v224, v224, v238
    v_cvt_pk_bf16_f32 v171, v238, v239
    v_add_f32 v225, v225, v239
    s_waitcnt lgkmcnt(4)
    v_mfma_f32_32x32x16_bf16 v[0:15], v[176:179], v[160:163], v[0:15]
    ds_read_b128 v[176:179], v229 offset:8192
    v_exp_f32 v232, v120
    v_exp_f32 v233, v121
    v_mfma_f32_32x32x16_bf16 v[16:31], v[180:183], v[160:163], v[16:31]
    ds_read_b128 v[180:183], v229 offset:9216
    v_exp_f32 v234, v122
    v_exp_f32 v235, v123
    v_add_f32 v224, v224, v232
    v_mfma_f32_32x32x16_bf16 v[32:47], v[184:187], v[160:163], v[32:47]
    ds_read_b128 v[184:187], v229 offset:10240
    v_cvt_pk_bf16_f32 v172, v232, v233
    v_add_f32 v225, v225, v233
    v_exp_f32 v236, v124
    v_mfma_f32_32x32x16_bf16 v[48:63], v[188:191], v[160:163], v[48:63]
    ds_read_b128 v[188:191], v229 offset:11264
    v_exp_f32 v237, v125
    v_add_f32 v224, v224, v234
    v_cvt_pk_bf16_f32 v173, v234, v235
    v_add_f32 v225, v225, v235
    s_waitcnt lgkmcnt(4)
    v_mfma_f32_32x32x16_bf16 v[0:15], v[192:195], v[164:167], v[0:15]
    ds_read_b128 v[192:195], v229 offset:12288
    v_exp_f32 v238, v126
    v_exp_f32 v239, v127
    v_add_f32 v224, v224, v236
    v_mfma_f32_32x32x16_bf16 v[16:31], v[196:199], v[164:167], v[16:31]
    ds_read_b128 v[196:199], v229 offset:13312
    v_cvt_pk_bf16_f32 v174, v236, v237
    v_add_f32 v225, v225, v237
    v_add_f32 v224, v224, v238
    v_cvt_pk_bf16_f32 v175, v238, v239
    v_add_f32 v225, v225, v239
    v_mfma_f32_32x32x16_bf16 v[32:47], v[200:203], v[164:167], v[32:47]
    ds_read_b128 v[200:203], v229 offset:14336
    s_add_u32 s54, s51, 1
    s_lshl_b32 s67, s54, 6
    v_subrev_u32 v227, s67, v231
    v_mov_b32 v226, s52
    v_cmp_le_i32 s[56:57], 0, v227
    v_cmp_le_i32 s[58:59], 1, v227
    v_cmp_le_i32 s[92:93], 2, v227
    v_mfma_f32_32x32x16_bf16 v[48:63], v[204:207], v[164:167], v[48:63]
    ds_read_b128 v[204:207], v229 offset:15360
    v_cmp_le_i32 s[94:95], 3, v227
    v_cndmask_b32 v128, v226, v128, s[56:57]
    v_cndmask_b32 v129, v226, v129, s[58:59]
    v_cndmask_b32 v130, v226, v130, s[92:93]
    v_cndmask_b32 v131, v226, v131, s[94:95]
    v_cmp_le_i32 s[56:57], 8, v227
    v_cmp_le_i32 s[58:59], 9, v227
    s_waitcnt lgkmcnt(4)
    s_barrier
    s_cmp_lt_u32 s62, 1
    s_cselect_b64 vcc, -1, 0
    s_cbranch_vccnz K2FH_M0a_pv8
    v_mfma_f32_32x32x16_bf16 v[0:15], v[176:179], v[168:171], v[0:15]
K2FH_M0a_pv8:
    ds_read_b128 v[176:179], v229 offset:16384
    v_cmp_le_i32 s[92:93], 10, v227
    v_cmp_le_i32 s[94:95], 11, v227
    v_cndmask_b32 v132, v226, v132, s[56:57]
    v_cndmask_b32 v133, v226, v133, s[58:59]
    v_cndmask_b32 v134, v226, v134, s[92:93]
    v_cndmask_b32 v135, v226, v135, s[94:95]
    s_cbranch_vccnz K2FH_M0a_pv9
    v_mfma_f32_32x32x16_bf16 v[16:31], v[180:183], v[168:171], v[16:31]
K2FH_M0a_pv9:
    ds_read_b128 v[180:183], v229 offset:17408
    v_cmp_le_i32 s[56:57], 16, v227
    v_cmp_le_i32 s[58:59], 17, v227
    v_cmp_le_i32 s[92:93], 18, v227
    v_cmp_le_i32 s[94:95], 19, v227
    v_cndmask_b32 v136, v226, v136, s[56:57]
    v_cndmask_b32 v137, v226, v137, s[58:59]
    v_cndmask_b32 v138, v226, v138, s[92:93]
    s_cbranch_vccnz K2FH_M0a_pv10
    v_mfma_f32_32x32x16_bf16 v[32:47], v[184:187], v[168:171], v[32:47]
K2FH_M0a_pv10:
    ds_read_b128 v[184:187], v229 offset:18432
    v_cndmask_b32 v139, v226, v139, s[94:95]
    v_cmp_le_i32 s[56:57], 24, v227
    v_cmp_le_i32 s[58:59], 25, v227
    v_cmp_le_i32 s[92:93], 26, v227
    v_cmp_le_i32 s[94:95], 27, v227
    v_cndmask_b32 v140, v226, v140, s[56:57]
    v_cndmask_b32 v141, v226, v141, s[58:59]
    s_cbranch_vccnz K2FH_M0a_pv11
    v_mfma_f32_32x32x16_bf16 v[48:63], v[188:191], v[168:171], v[48:63]
K2FH_M0a_pv11:
    ds_read_b128 v[188:191], v229 offset:19456
    v_cndmask_b32 v142, v226, v142, s[92:93]
    v_cndmask_b32 v143, v226, v143, s[94:95]
    v_cmp_le_i32 s[56:57], 32, v227
    v_cmp_le_i32 s[58:59], 33, v227
    v_cmp_le_i32 s[92:93], 34, v227
    v_cmp_le_i32 s[94:95], 35, v227
    v_cndmask_b32 v144, v226, v144, s[56:57]
    s_waitcnt lgkmcnt(4)
    s_cbranch_vccnz K2FH_M0a_pv12
    v_mfma_f32_32x32x16_bf16 v[0:15], v[192:195], v[172:175], v[0:15]
K2FH_M0a_pv12:
    ds_read_b128 v[192:195], v229 offset:20480
    v_cndmask_b32 v145, v226, v145, s[58:59]
    v_cndmask_b32 v146, v226, v146, s[92:93]
    v_cndmask_b32 v147, v226, v147, s[94:95]
    v_cmp_le_i32 s[56:57], 40, v227
    v_cmp_le_i32 s[58:59], 41, v227
    v_cmp_le_i32 s[92:93], 42, v227
    v_cmp_le_i32 s[94:95], 43, v227
    s_cbranch_vccnz K2FH_M0a_pv13
    v_mfma_f32_32x32x16_bf16 v[16:31], v[196:199], v[172:175], v[16:31]
K2FH_M0a_pv13:
    ds_read_b128 v[196:199], v229 offset:21504
    v_cndmask_b32 v148, v226, v148, s[56:57]
    v_cndmask_b32 v149, v226, v149, s[58:59]
    v_cndmask_b32 v150, v226, v150, s[92:93]
    v_cndmask_b32 v151, v226, v151, s[94:95]
    v_cmp_le_i32 s[56:57], 48, v227
    v_cmp_le_i32 s[58:59], 49, v227
    s_cbranch_vccnz K2FH_M0a_pv14
    v_mfma_f32_32x32x16_bf16 v[32:47], v[200:203], v[172:175], v[32:47]
K2FH_M0a_pv14:
    ds_read_b128 v[200:203], v229 offset:22528
    v_cmp_le_i32 s[92:93], 50, v227
    v_cmp_le_i32 s[94:95], 51, v227
    v_cndmask_b32 v152, v226, v152, s[56:57]
    v_cndmask_b32 v153, v226, v153, s[58:59]
    v_cndmask_b32 v154, v226, v154, s[92:93]
    v_cndmask_b32 v155, v226, v155, s[94:95]
    v_cmp_le_i32 s[56:57], 56, v227
    s_cbranch_vccnz K2FH_M0a_pv15
    v_mfma_f32_32x32x16_bf16 v[48:63], v[204:207], v[172:175], v[48:63]
K2FH_M0a_pv15:
    ds_read_b128 v[204:207], v229 offset:23552
    v_cmp_le_i32 s[58:59], 57, v227
    v_cmp_le_i32 s[92:93], 58, v227
    v_cmp_le_i32 s[94:95], 59, v227
    v_cndmask_b32 v156, v226, v156, s[56:57]
    v_cndmask_b32 v157, v226, v157, s[58:59]
    v_cndmask_b32 v158, v226, v158, s[92:93]
    v_cndmask_b32 v159, v226, v159, s[94:95]
    s_add_u32 s51, s51, 1
K2FH_L1a:
    v_exp_f32 v232, v128
    v_exp_f32 v233, v129
    v_exp_f32 v234, v130
    v_exp_f32 v235, v131
    v_add_f32 v224, v224, v232
    v_cvt_pk_bf16_f32 v160, v232, v233
    v_add_f32 v225, v225, v233
    v_exp_f32 v236, v132
    v_exp_f32 v237, v133
    v_add_f32 v224, v224, v234
    v_cvt_pk_bf16_f32 v161, v234, v235
    v_add_f32 v225, v225, v235
    v_exp_f32 v238, v134
    v_exp_f32 v239, v135
    v_add_f32 v224, v224, v236
    v_cvt_pk_bf16_f32 v162, v236, v237
    v_add_f32 v225, v225, v237
    v_add_f32 v224, v224, v238
    v_cvt_pk_bf16_f32 v163, v238, v239
    v_add_f32 v225, v225, v239
    s_nop 0
    s_waitcnt lgkmcnt(6)
    s_cmp_lt_u32 s62, 2
    s_cselect_b64 vcc, -1, 0
    s_cbranch_vccnz K2FH_L1a_pv0
    v_mfma_f32_32x32x16_bf16 v[0:15], v[176:179], v[160:163], v[0:15]
K2FH_L1a_pv0:
    ds_read_b128 v[176:179], v229 offset:24576
    v_exp_f32 v232, v136
    v_exp_f32 v233, v137
    v_exp_f32 v234, v138
    v_exp_f32 v235, v139
    v_add_f32 v224, v224, v232
    s_cbranch_vccnz K2FH_L1a_pv1
    v_mfma_f32_32x32x16_bf16 v[16:31], v[180:183], v[160:163], v[16:31]
K2FH_L1a_pv1:
    ds_read_b128 v[180:183], v229 offset:25600
    v_cvt_pk_bf16_f32 v164, v232, v233
    v_add_f32 v225, v225, v233
    v_exp_f32 v236, v140
    v_exp_f32 v237, v141
    v_add_f32 v224, v224, v234
    s_waitcnt lgkmcnt(6)
    s_cbranch_vccnz K2FH_L1a_pv2
    v_mfma_f32_32x32x16_bf16 v[32:47], v[184:187], v[160:163], v[32:47]
K2FH_L1a_pv2:
    ds_read_b128 v[184:187], v229 offset:26624
    v_cvt_pk_bf16_f32 v165, v234, v235
    v_add_f32 v225, v225, v235
    v_exp_f32 v238, v142
    v_exp_f32 v239, v143
    v_add_f32 v224, v224, v236
    s_cbranch_vccnz K2FH_L1a_pv3
    v_mfma_f32_32x32x16_bf16 v[48:63], v[188:191], v[160:163], v[48:63]
K2FH_L1a_pv3:
    ds_read_b128 v[188:191], v229 offset:27648
    v_cvt_pk_bf16_f32 v166, v236, v237
    v_add_f32 v225, v225, v237
    v_add_f32 v224, v224, v238
    v_cvt_pk_bf16_f32 v167, v238, v239
    v_add_f32 v225, v225, v239
    s_nop 1
    s_waitcnt lgkmcnt(6)
    s_cbranch_vccnz K2FH_L1a_pv4
    v_mfma_f32_32x32x16_bf16 v[0:15], v[192:195], v[164:167], v[0:15]
K2FH_L1a_pv4:
    ds_read_b128 v[192:195], v229 offset:28672
    v_exp_f32 v232, v144
    v_exp_f32 v233, v145
    v_exp_f32 v234, v146
    v_exp_f32 v235, v147
    v_add_f32 v224, v224, v232
    s_cbranch_vccnz K2FH_L1a_pv5
    v_mfma_f32_32x32x16_bf16 v[16:31], v[196:199], v[164:167], v[16:31]
K2FH_L1a_pv5:
    ds_read_b128 v[196:199], v229 offset:29696
    v_cvt_pk_bf16_f32 v168, v232, v233
    v_add_f32 v225, v225, v233
    v_exp_f32 v236, v148
    v_exp_f32 v237, v149
    v_add_f32 v224, v224, v234
    s_waitcnt lgkmcnt(6)
    s_cbranch_vccnz K2FH_L1a_pv6
    v_mfma_f32_32x32x16_bf16 v[32:47], v[200:203], v[164:167], v[32:47]
K2FH_L1a_pv6:
    ds_read_b128 v[200:203], v229 offset:30720
    v_cvt_pk_bf16_f32 v169, v234, v235
    v_add_f32 v225, v225, v235
    v_exp_f32 v238, v150
    v_exp_f32 v239, v151
    v_add_f32 v224, v224, v236
    s_cbranch_vccnz K2FH_L1a_pv7
    v_mfma_f32_32x32x16_bf16 v[48:63], v[204:207], v[164:167], v[48:63]
K2FH_L1a_pv7:
    ds_read_b128 v[204:207], v229 offset:31744
    v_cvt_pk_bf16_f32 v170, v236, v237
    v_add_f32 v225, v225, v237
    v_add_f32 v224, v224, v238
    v_cvt_pk_bf16_f32 v171, v238, v239
    v_add_f32 v225, v225, v239
    s_nop 1
    s_waitcnt lgkmcnt(7)
    s_barrier
    s_cmp_lt_u32 s62, 3
    s_cselect_b64 vcc, -1, 0
    s_cbranch_vccnz K2FH_L1a_pv8
    v_mfma_f32_32x32x16_bf16 v[0:15], v[176:179], v[168:171], v[0:15]
K2FH_L1a_pv8:
    v_exp_f32 v232, v152
    v_exp_f32 v233, v153
    v_exp_f32 v234, v154
    v_exp_f32 v235, v155
    v_add_f32 v224, v224, v232
    s_waitcnt lgkmcnt(6)
    s_cbranch_vccnz K2FH_L1a_pv9
    v_mfma_f32_32x32x16_bf16 v[16:31], v[180:183], v[168:171], v[16:31]
K2FH_L1a_pv9:
    v_cvt_pk_bf16_f32 v172, v232, v233
    v_add_f32 v225, v225, v233
    v_exp_f32 v236, v156
    v_exp_f32 v237, v157
    v_add_f32 v224, v224, v234
    s_waitcnt lgkmcnt(5)
    s_cbranch_vccnz K2FH_L1a_pv10
    v_mfma_f32_32x32x16_bf16 v[32:47], v[184:187], v[168:171], v[32:47]
K2FH_L1a_pv10:
    v_cvt_pk_bf16_f32 v173, v234, v235
    v_add_f32 v225, v225, v235
    v_exp_f32 v238, v158
    v_exp_f32 v239, v159
    v_add_f32 v224, v224, v236
    s_waitcnt lgkmcnt(4)
    s_cbranch_vccnz K2FH_L1a_pv11
    v_mfma_f32_32x32x16_bf16 v[48:63], v[188:191], v[168:171], v[48:63]
K2FH_L1a_pv11:
    v_cvt_pk_bf16_f32 v174, v236, v237
    v_add_f32 v225, v225, v237
    v_add_f32 v224, v224, v238
    v_cvt_pk_bf16_f32 v175, v238, v239
    v_add_f32 v225, v225, v239
    s_nop 1
    s_waitcnt lgkmcnt(3)
    s_cbranch_vccnz K2FH_L1a_pv12
    v_mfma_f32_32x32x16_bf16 v[0:15], v[192:195], v[172:175], v[0:15]
K2FH_L1a_pv12:
    s_waitcnt lgkmcnt(2)
    s_cbranch_vccnz K2FH_L1a_pv13
    v_mfma_f32_32x32x16_bf16 v[16:31], v[196:199], v[172:175], v[16:31]
K2FH_L1a_pv13:
    s_waitcnt lgkmcnt(1)
    s_cbranch_vccnz K2FH_L1a_pv14
    v_mfma_f32_32x32x16_bf16 v[32:47], v[200:203], v[172:175], v[32:47]
K2FH_L1a_pv14:
    s_waitcnt lgkmcnt(0)
    s_cbranch_vccnz K2FH_L1a_pv15
    v_mfma_f32_32x32x16_bf16 v[48:63], v[204:207], v[172:175], v[48:63]
K2FH_L1a_pv15:
    s_nop 1
    s_add_u32 s51, s51, 1
    s_branch K2F_EPI
K2FH_M1b:
    s_waitcnt lgkmcnt(4)
    v_mfma_f32_32x32x16_bf16 v[96:111], v[176:179], v[64:67], v[208:223]
    ds_read_b128 v[176:179], v230 offset:8192
    v_exp_f32 v232, v128
    v_exp_f32 v233, v129
    v_exp_f32 v234, v130
    v_mfma_f32_32x32x16_bf16 v[96:111], v[180:183], v[68:71], v[96:111]
    ds_read_b128 v[180:183], v230 offset:9216
    v_exp_f32 v235, v131
    v_add_f32 v224, v224, v232
    v_cvt_pk_bf16_f32 v160, v232, v233
    v_mfma_f32_32x32x16_bf16 v[96:111], v[184:187], v[72:75], v[96:111]
    ds_read_b128 v[184:187], v230 offset:10240
    v_add_f32 v225, v225, v233
    v_exp_f32 v236, v132
    v_exp_f32 v237, v133
    v_add_f32 v224, v224, v234
    v_mfma_f32_32x32x16_bf16 v[96:111], v[188:191], v[76:79], v[96:111]
    ds_read_b128 v[188:191], v230 offset:11264
    v_cvt_pk_bf16_f32 v161, v234, v235
    v_add_f32 v225, v225, v235
    v_exp_f32 v238, v134
    s_waitcnt lgkmcnt(4)
    v_mfma_f32_32x32x16_bf16 v[96:111], v[192:195], v[80:83], v[96:111]
    ds_read_b128 v[192:195], v230 offset:12288
    v_exp_f32 v239, v135
    v_add_f32 v224, v224, v236
    v_cvt_pk_bf16_f32 v162, v236, v237
    v_add_f32 v225, v225, v237
    v_add_f32 v224, v224, v238
    v_mfma_f32_32x32x16_bf16 v[96:111], v[196:199], v[84:87], v[96:111]
    ds_read_b128 v[196:199], v230 offset:13312
    v_cvt_pk_bf16_f32 v163, v238, v239
    v_add_f32 v225, v225, v239
    v_exp_f32 v232, v136
    v_exp_f32 v233, v137
    v_mfma_f32_32x32x16_bf16 v[96:111], v[200:203], v[88:91], v[96:111]
    ds_read_b128 v[200:203], v230 offset:14336
    v_exp_f32 v234, v138
    v_exp_f32 v235, v139
    v_add_f32 v224, v224, v232
    v_mfma_f32_32x32x16_bf16 v[96:111], v[204:207], v[92:95], v[96:111]
    ds_read_b128 v[204:207], v230 offset:15360
    v_cvt_pk_bf16_f32 v164, v232, v233
    v_add_f32 v225, v225, v233
    v_exp_f32 v236, v140
    s_waitcnt lgkmcnt(4)
    s_cmp_lt_u32 s62, 1
    s_cselect_b64 vcc, -1, 0
    s_cbranch_vccnz K2FH_M1b_qk8
    v_mfma_f32_32x32x16_bf16 v[112:127], v[176:179], v[64:67], v[208:223]
K2FH_M1b_qk8:
    ds_read_b128 v[176:179], v229 offset:16384
    v_exp_f32 v237, v141
    v_add_f32 v224, v224, v234
    v_cvt_pk_bf16_f32 v165, v234, v235
    v_add_f32 v225, v225, v235
    v_exp_f32 v238, v142
    s_cbranch_vccnz K2FH_M1b_qk9
    v_mfma_f32_32x32x16_bf16 v[112:127], v[180:183], v[68:71], v[112:127]
K2FH_M1b_qk9:
    ds_read_b128 v[180:183], v229 offset:17408
    v_exp_f32 v239, v143
    v_add_f32 v224, v224, v236
    v_cvt_pk_bf16_f32 v166, v236, v237
    s_cbranch_vccnz K2FH_M1b_qk10
    v_mfma_f32_32x32x16_bf16 v[112:127], v[184:187], v[72:75], v[112:127]
K2FH_M1b_qk10:
    ds_read_b128 v[184:187], v229 offset:18432
    v_add_f32 v225, v225, v237
    v_add_f32 v224, v224, v238
    v_cvt_pk_bf16_f32 v167, v238, v239
    v_add_f32 v225, v225, v239
    v_exp_f32 v232, v144
    s_cbranch_vccnz K2FH_M1b_qk11
    v_mfma_f32_32x32x16_bf16 v[112:127], v[188:191], v[76:79], v[112:127]
K2FH_M1b_qk11:
    ds_read_b128 v[188:191], v229 offset:19456
    v_exp_f32 v233, v145
    v_exp_f32 v234, v146
    s_waitcnt lgkmcnt(4)
    s_cbranch_vccnz K2FH_M1b_qk12
    v_mfma_f32_32x32x16_bf16 v[112:127], v[192:195], v[80:83], v[112:127]
K2FH_M1b_qk12:
    ds_read_b128 v[192:195], v229 offset:20480
    v_exp_f32 v235, v147
    v_add_f32 v224, v224, v232
    v_cvt_pk_bf16_f32 v168, v232, v233
    v_add_f32 v225, v225, v233
    v_exp_f32 v236, v148
    s_cbranch_vccnz K2FH_M1b_qk13
    v_mfma_f32_32x32x16_bf16 v[112:127], v[196:199], v[84:87], v[112:127]
K2FH_M1b_qk13:
    ds_read_b128 v[196:199], v229 offset:21504
    v_exp_f32 v237, v149
    v_add_f32 v224, v224, v234
    v_cvt_pk_bf16_f32 v169, v234, v235
    s_cbranch_vccnz K2FH_M1b_qk14
    v_mfma_f32_32x32x16_bf16 v[112:127], v[200:203], v[88:91], v[112:127]
K2FH_M1b_qk14:
    ds_read_b128 v[200:203], v229 offset:22528
    v_add_f32 v225, v225, v235
    v_exp_f32 v238, v150
    v_exp_f32 v239, v151
    v_add_f32 v224, v224, v236
    s_cbranch_vccnz K2FH_M1b_qk15
    v_mfma_f32_32x32x16_bf16 v[112:127], v[204:207], v[92:95], v[112:127]
K2FH_M1b_qk15:
    ds_read_b128 v[204:207], v229 offset:23552
    v_cvt_pk_bf16_f32 v170, v236, v237
    v_add_f32 v225, v225, v237
    v_add_f32 v224, v224, v238
    v_cvt_pk_bf16_f32 v171, v238, v239
    v_add_f32 v225, v225, v239
    s_waitcnt lgkmcnt(4)
    v_mfma_f32_32x32x16_bf16 v[0:15], v[176:179], v[160:163], v[0:15]
    ds_read_b128 v[176:179], v229 offset:24576
    v_exp_f32 v232, v152
    v_exp_f32 v233, v153
    v_mfma_f32_32x32x16_bf16 v[16:31], v[180:183], v[160:163], v[16:31]
    ds_read_b128 v[180:183], v229 offset:25600
    v_exp_f32 v234, v154
    v_exp_f32 v235, v155
    v_add_f32 v224, v224, v232
    v_mfma_f32_32x32x16_bf16 v[32:47], v[184:187], v[160:163], v[32:47]
    ds_read_b128 v[184:187], v229 offset:26624
    v_cvt_pk_bf16_f32 v172, v232, v233
    v_add_f32 v225, v225, v233
    v_exp_f32 v236, v156
    v_mfma_f32_32x32x16_bf16 v[48:63], v[188:191], v[160:163], v[48:63]
    ds_read_b128 v[188:191], v229 offset:27648
    v_exp_f32 v237, v157
    v_add_f32 v224, v224, v234
    v_cvt_pk_bf16_f32 v173, v234, v235
    v_add_f32 v225, v225, v235
    s_waitcnt lgkmcnt(4)
    v_mfma_f32_32x32x16_bf16 v[0:15], v[192:195], v[164:167], v[0:15]
    ds_read_b128 v[192:195], v229 offset:28672
    v_exp_f32 v238, v158
    v_exp_f32 v239, v159
    v_add_f32 v224, v224, v236
    v_mfma_f32_32x32x16_bf16 v[16:31], v[196:199], v[164:167], v[16:31]
    ds_read_b128 v[196:199], v229 offset:29696
    v_cvt_pk_bf16_f32 v174, v236, v237
    v_add_f32 v225, v225, v237
    v_add_f32 v224, v224, v238
    v_cvt_pk_bf16_f32 v175, v238, v239
    v_add_f32 v225, v225, v239
    v_mfma_f32_32x32x16_bf16 v[32:47], v[200:203], v[164:167], v[32:47]
    ds_read_b128 v[200:203], v229 offset:30720
    s_add_u32 s54, s51, 1
    s_lshl_b32 s67, s54, 6
    v_subrev_u32 v227, s67, v231
    v_mov_b32 v226, s52
    v_cmp_le_i32 s[56:57], 0, v227
    v_cmp_le_i32 s[58:59], 1, v227
    v_cmp_le_i32 s[92:93], 2, v227
    v_mfma_f32_32x32x16_bf16 v[48:63], v[204:207], v[164:167], v[48:63]
    ds_read_b128 v[204:207], v229 offset:31744
    v_cmp_le_i32 s[94:95], 3, v227
    v_cndmask_b32 v96, v226, v96, s[56:57]
    v_cndmask_b32 v97, v226, v97, s[58:59]
    v_cndmask_b32 v98, v226, v98, s[92:93]
    v_cndmask_b32 v99, v226, v99, s[94:95]
    v_cmp_le_i32 s[56:57], 8, v227
    v_cmp_le_i32 s[58:59], 9, v227
    s_waitcnt lgkmcnt(4)
    s_barrier
    v_mfma_f32_32x32x16_bf16 v[0:15], v[176:179], v[168:171], v[0:15]
    ds_read_b128 v[176:179], v230 offset:16384
    v_cmp_le_i32 s[92:93], 10, v227
    v_cmp_le_i32 s[94:95], 11, v227
    v_cndmask_b32 v100, v226, v100, s[56:57]
    v_cndmask_b32 v101, v226, v101, s[58:59]
    v_cndmask_b32 v102, v226, v102, s[92:93]
    v_cndmask_b32 v103, v226, v103, s[94:95]
    v_mfma_f32_32x32x16_bf16 v[16:31], v[180:183], v[168:171], v[16:31]
    ds_read_b128 v[180:183], v230 offset:17408
    v_cmp_le_i32 s[56:57], 16, v227
    v_cmp_le_i32 s[58:59], 17, v227
    v_cmp_le_i32 s[92:93], 18, v227
    v_cmp_le_i32 s[94:95], 19, v227
    v_cndmask_b32 v104, v226, v104, s[56:57]
    v_cndmask_b32 v105, v226, v105, s[58:59]
    v_cndmask_b32 v106, v226, v106, s[92:93]
    v_mfma_f32_32x32x16_bf16 v[32:47], v[184:187], v[168:171], v[32:47]
    ds_read_b128 v[184:187], v230 offset:18432
    v_cndmask_b32 v107, v226, v107, s[94:95]
    v_cmp_le_i32 s[56:57], 24, v227
    v_cmp_le_i32 s[58:59], 25, v227
    v_cmp_le_i32 s[92:93], 26, v227
    v_cmp_le_i32 s[94:95], 27, v227
    v_cndmask_b32 v108, v226, v108, s[56:57]
    v_cndmask_b32 v109, v226, v109, s[58:59]
    v_mfma_f32_32x32x16_bf16 v[48:63], v[188:191], v[168:171], v[48:63]
    ds_read_b128 v[188:191], v230 offset:19456
    v_cndmask_b32 v110, v226, v110, s[92:93]
    v_cndmask_b32 v111, v226, v111, s[94:95]
    v_cmp_le_i32 s[56:57], 32, v227
    v_cmp_le_i32 s[58:59], 33, v227
    v_cmp_le_i32 s[92:93], 34, v227
    v_cmp_le_i32 s[94:95], 35, v227
    v_cndmask_b32 v112, v226, v112, s[56:57]
    s_waitcnt lgkmcnt(4)
    v_mfma_f32_32x32x16_bf16 v[0:15], v[192:195], v[172:175], v[0:15]
    ds_read_b128 v[192:195], v230 offset:20480
    v_cndmask_b32 v113, v226, v113, s[58:59]
    v_cndmask_b32 v114, v226, v114, s[92:93]
    v_cndmask_b32 v115, v226, v115, s[94:95]
    v_cmp_le_i32 s[56:57], 40, v227
    v_cmp_le_i32 s[58:59], 41, v227
    v_cmp_le_i32 s[92:93], 42, v227
    v_cmp_le_i32 s[94:95], 43, v227
    v_mfma_f32_32x32x16_bf16 v[16:31], v[196:199], v[172:175], v[16:31]
    ds_read_b128 v[196:199], v230 offset:21504
    v_cndmask_b32 v116, v226, v116, s[56:57]
    v_cndmask_b32 v117, v226, v117, s[58:59]
    v_cndmask_b32 v118, v226, v118, s[92:93]
    v_cndmask_b32 v119, v226, v119, s[94:95]
    v_cmp_le_i32 s[56:57], 48, v227
    v_cmp_le_i32 s[58:59], 49, v227
    v_mfma_f32_32x32x16_bf16 v[32:47], v[200:203], v[172:175], v[32:47]
    ds_read_b128 v[200:203], v230 offset:22528
    v_cmp_le_i32 s[92:93], 50, v227
    v_cmp_le_i32 s[94:95], 51, v227
    v_cndmask_b32 v120, v226, v120, s[56:57]
    v_cndmask_b32 v121, v226, v121, s[58:59]
    v_cndmask_b32 v122, v226, v122, s[92:93]
    v_cndmask_b32 v123, v226, v123, s[94:95]
    v_cmp_le_i32 s[56:57], 56, v227
    v_mfma_f32_32x32x16_bf16 v[48:63], v[204:207], v[172:175], v[48:63]
    ds_read_b128 v[204:207], v230 offset:23552
    v_cmp_le_i32 s[58:59], 57, v227
    v_cmp_le_i32 s[92:93], 58, v227
    v_cmp_le_i32 s[94:95], 59, v227
    v_cndmask_b32 v124, v226, v124, s[56:57]
    v_cndmask_b32 v125, v226, v125, s[58:59]
    v_cndmask_b32 v126, v226, v126, s[92:93]
    v_cndmask_b32 v127, v226, v127, s[94:95]
    s_add_u32 s51, s51, 1
K2FH_M0b:
    s_waitcnt lgkmcnt(4)
    s_cmp_lt_u32 s62, 2
    s_cselect_b64 vcc, -1, 0
    s_cbranch_vccnz K2FH_M0b_qk0
    v_mfma_f32_32x32x16_bf16 v[128:143], v[176:179], v[64:67], v[208:223]
K2FH_M0b_qk0:
    ds_read_b128 v[176:179], v230 offset:24576
    v_exp_f32 v232, v96
    v_exp_f32 v233, v97
    v_exp_f32 v234, v98
    s_cbranch_vccnz K2FH_M0b_qk1
    v_mfma_f32_32x32x16_bf16 v[128:143], v[180:183], v[68:71], v[128:143]
K2FH_M0b_qk1:
    ds_read_b128 v[180:183], v230 offset:25600
    v_exp_f32 v235, v99
    v_add_f32 v224, v224, v232
    v_cvt_pk_bf16_f32 v160, v232, v233
    s_cbranch_vccnz K2FH_M0b_qk2
    v_mfma_f32_32x32x16_bf16 v[128:143], v[184:187], v[72:75], v[128:143]
K2FH_M0b_qk2:
    ds_read_b128 v[184:187], v230 offset:26624
    v_add_f32 v225, v225, v233
    v_exp_f32 v236, v100
    v_exp_f32 v237, v101
    v_add_f32 v224, v224, v234
    s_cbranch_vccnz K2FH_M0b_qk3
    v_mfma_f32_32x32x16_bf16 v[128:143], v[188:191], v[76:79], v[128:143]
K2FH_M0b_qk3:
    ds_read_b128 v[188:191], v230 offset:27648
    v_cvt_pk_bf16_f32 v161, v234, v235
    v_add_f32 v225, v225, v235
    v_exp_f32 v238, v102
    s_waitcnt lgkmcnt(4)
    s_cbranch_vccnz K2FH_M0b_qk4
    v_mfma_f32_32x32x16_bf16 v[128:143], v[192:195], v[80:83], v[128:143]
K2FH_M0b_qk4:
    ds_read_b128 v[192:195], v230 offset:28672
    v_exp_f32 v239, v103
    v_add_f32 v224, v224, v236
    v_cvt_pk_bf16_f32 v162, v236, v237
    v_add_f32 v225, v225, v237
    v_add_f32 v224, v224, v238
    s_cbranch_vccnz K2FH_M0b_qk5
    v_mfma_f32_32x32x16_bf16 v[128:143], v[196:199], v[84:87], v[128:143]
K2FH_M0b_qk5:
    ds_read_b128 v[196:199], v230 offset:29696
    v_cvt_pk_bf16_f32 v163, v238, v239
    v_add_f32 v225, v225, v239
    v_exp_f32 v232, v104
    v_exp_f32 v233, v105
    s_cbranch_vccnz K2FH_M0b_qk6
    v_mfma_f32_32x32x16_bf16 v[128:143], v[200:203], v[88:91], v[128:143]
K2FH_M0b_qk6:
    ds_read_b128 v[200:203], v230 offset:30720
    v_exp_f32 v234, v106
    v_exp_f32 v235, v107
    v_add_f32 v224, v224, v232
    s_cbranch_vccnz K2FH_M0b_qk7
    v_mfma_f32_32x32x16_bf16 v[128:143], v[204:207], v[92:95], v[128:143]
K2FH_M0b_qk7:
    ds_read_b128 v[204:207], v230 offset:31744
    v_cvt_pk_bf16_f32 v164, v232, v233
    v_add_f32 v225, v225, v233
    v_exp_f32 v236, v108
    s_waitcnt lgkmcnt(4)
    s_cmp_lt_u32 s62, 3
    s_cselect_b64 vcc, -1, 0
    s_cbranch_vccnz K2FH_M0b_qk8
    v_mfma_f32_32x32x16_bf16 v[144:159], v[176:179], v[64:67], v[208:223]
K2FH_M0b_qk8:
    ds_read_b128 v[176:179], v229 offset:32768
    v_exp_f32 v237, v109
    v_add_f32 v224, v224, v234
    v_cvt_pk_bf16_f32 v165, v234, v235
    v_add_f32 v225, v225, v235
    v_exp_f32 v238, v110
    s_cbranch_vccnz K2FH_M0b_qk9
    v_mfma_f32_32x32x16_bf16 v[144:159], v[180:183], v[68:71], v[144:159]
K2FH_M0b_qk9:
    ds_read_b128 v[180:183], v229 offset:33792
    v_exp_f32 v239, v111
    v_add_f32 v224, v224, v236
    v_cvt_pk_bf16_f32 v166, v236, v237
    s_cbranch_vccnz K2FH_M0b_qk10
    v_mfma_f32_32x32x16_bf16 v[144:159], v[184:187], v[72:75], v[144:159]
K2FH_M0b_qk10:
    ds_read_b128 v[184:187], v229 offset:34816
    v_add_f32 v225, v225, v237
    v_add_f32 v224, v224, v238
    v_cvt_pk_bf16_f32 v167, v238, v239
    v_add_f32 v225, v225, v239
    v_exp_f32 v232, v112
    s_cbranch_vccnz K2FH_M0b_qk11
    v_mfma_f32_32x32x16_bf16 v[144:159], v[188:191], v[76:79], v[144:159]
K2FH_M0b_qk11:
    ds_read_b128 v[188:191], v229 offset:35840
    v_exp_f32 v233, v113
    v_exp_f32 v234, v114
    s_waitcnt lgkmcnt(4)
    s_cbranch_vccnz K2FH_M0b_qk12
    v_mfma_f32_32x32x16_bf16 v[144:159], v[192:195], v[80:83], v[144:159]
K2FH_M0b_qk12:
    ds_read_b128 v[192:195], v229 offset:36864
    v_exp_f32 v235, v115
    v_add_f32 v224, v224, v232
    v_cvt_pk_bf16_f32 v168, v232, v233
    v_add_f32 v225, v225, v233
    v_exp_f32 v236, v116
    s_cbranch_vccnz K2FH_M0b_qk13
    v_mfma_f32_32x32x16_bf16 v[144:159], v[196:199], v[84:87], v[144:159]
K2FH_M0b_qk13:
    ds_read_b128 v[196:199], v229 offset:37888
    v_exp_f32 v237, v117
    v_add_f32 v224, v224, v234
    v_cvt_pk_bf16_f32 v169, v234, v235
    s_cbranch_vccnz K2FH_M0b_qk14
    v_mfma_f32_32x32x16_bf16 v[144:159], v[200:203], v[88:91], v[144:159]
K2FH_M0b_qk14:
    ds_read_b128 v[200:203], v229 offset:38912
    v_add_f32 v225, v225, v235
    v_exp_f32 v238, v118
    v_exp_f32 v239, v119
    v_add_f32 v224, v224, v236
    s_cbranch_vccnz K2FH_M0b_qk15
    v_mfma_f32_32x32x16_bf16 v[144:159], v[204:207], v[92:95], v[144:159]
K2FH_M0b_qk15:
    ds_read_b128 v[204:207], v229 offset:39936
    v_cvt_pk_bf16_f32 v170, v236, v237
    v_add_f32 v225, v225, v237
    v_add_f32 v224, v224, v238
    v_cvt_pk_bf16_f32 v171, v238, v239
    v_add_f32 v225, v225, v239
    s_waitcnt lgkmcnt(4)
    v_mfma_f32_32x32x16_bf16 v[0:15], v[176:179], v[160:163], v[0:15]
    ds_read_b128 v[176:179], v229 offset:40960
    v_exp_f32 v232, v120
    v_exp_f32 v233, v121
    v_mfma_f32_32x32x16_bf16 v[16:31], v[180:183], v[160:163], v[16:31]
    ds_read_b128 v[180:183], v229 offset:41984
    v_exp_f32 v234, v122
    v_exp_f32 v235, v123
    v_add_f32 v224, v224, v232
    v_mfma_f32_32x32x16_bf16 v[32:47], v[184:187], v[160:163], v[32:47]
    ds_read_b128 v[184:187], v229 offset:43008
    v_cvt_pk_bf16_f32 v172, v232, v233
    v_add_f32 v225, v225, v233
    v_exp_f32 v236, v124
    v_mfma_f32_32x32x16_bf16 v[48:63], v[188:191], v[160:163], v[48:63]
    ds_read_b128 v[188:191], v229 offset:44032
    v_exp_f32 v237, v125
    v_add_f32 v224, v224, v234
    v_cvt_pk_bf16_f32 v173, v234, v235
    v_add_f32 v225, v225, v235
    s_waitcnt lgkmcnt(4)
    v_mfma_f32_32x32x16_bf16 v[0:15], v[192:195], v[164:167], v[0:15]
    ds_read_b128 v[192:195], v229 offset:45056
    v_exp_f32 v238, v126
    v_exp_f32 v239, v127
    v_add_f32 v224, v224, v236
    v_mfma_f32_32x32x16_bf16 v[16:31], v[196:199], v[164:167], v[16:31]
    ds_read_b128 v[196:199], v229 offset:46080
    v_cvt_pk_bf16_f32 v174, v236, v237
    v_add_f32 v225, v225, v237
    v_add_f32 v224, v224, v238
    v_cvt_pk_bf16_f32 v175, v238, v239
    v_add_f32 v225, v225, v239
    v_mfma_f32_32x32x16_bf16 v[32:47], v[200:203], v[164:167], v[32:47]
    ds_read_b128 v[200:203], v229 offset:47104
    s_add_u32 s54, s51, 1
    s_lshl_b32 s67, s54, 6
    v_subrev_u32 v227, s67, v231
    v_mov_b32 v226, s52
    v_cmp_le_i32 s[56:57], 0, v227
    v_cmp_le_i32 s[58:59], 1, v227
    v_cmp_le_i32 s[92:93], 2, v227
    v_mfma_f32_32x32x16_bf16 v[48:63], v[204:207], v[164:167], v[48:63]
    ds_read_b128 v[204:207], v229 offset:48128
    v_cmp_le_i32 s[94:95], 3, v227
    v_cndmask_b32 v128, v226, v128, s[56:57]
    v_cndmask_b32 v129, v226, v129, s[58:59]
    v_cndmask_b32 v130, v226, v130, s[92:93]
    v_cndmask_b32 v131, v226, v131, s[94:95]
    v_cmp_le_i32 s[56:57], 8, v227
    v_cmp_le_i32 s[58:59], 9, v227
    s_waitcnt lgkmcnt(4)
    s_barrier
    s_cmp_lt_u32 s62, 1
    s_cselect_b64 vcc, -1, 0
    s_cbranch_vccnz K2FH_M0b_pv8
    v_mfma_f32_32x32x16_bf16 v[0:15], v[176:179], v[168:171], v[0:15]
K2FH_M0b_pv8:
    ds_read_b128 v[176:179], v229 offset:49152
    v_cmp_le_i32 s[92:93], 10, v227
    v_cmp_le_i32 s[94:95], 11, v227
    v_cndmask_b32 v132, v226, v132, s[56:57]
    v_cndmask_b32 v133, v226, v133, s[58:59]
    v_cndmask_b32 v134, v226, v134, s[92:93]
    v_cndmask_b32 v135, v226, v135, s[94:95]
    s_cbranch_vccnz K2FH_M0b_pv9
    v_mfma_f32_32x32x16_bf16 v[16:31], v[180:183], v[168:171], v[16:31]
K2FH_M0b_pv9:
    ds_read_b128 v[180:183], v229 offset:50176
    v_cmp_le_i32 s[56:57], 16, v227
    v_cmp_le_i32 s[58:59], 17, v227
    v_cmp_le_i32 s[92:93], 18, v227
    v_cmp_le_i32 s[94:95], 19, v227
    v_cndmask_b32 v136, v226, v136, s[56:57]
    v_cndmask_b32 v137, v226, v137, s[58:59]
    v_cndmask_b32 v138, v226, v138, s[92:93]
    s_cbranch_vccnz K2FH_M0b_pv10
    v_mfma_f32_32x32x16_bf16 v[32:47], v[184:187], v[168:171], v[32:47]
K2FH_M0b_pv10:
    ds_read_b128 v[184:187], v229 offset:51200
    v_cndmask_b32 v139, v226, v139, s[94:95]
    v_cmp_le_i32 s[56:57], 24, v227
    v_cmp_le_i32 s[58:59], 25, v227
    v_cmp_le_i32 s[92:93], 26, v227
    v_cmp_le_i32 s[94:95], 27, v227
    v_cndmask_b32 v140, v226, v140, s[56:57]
    v_cndmask_b32 v141, v226, v141, s[58:59]
    s_cbranch_vccnz K2FH_M0b_pv11
    v_mfma_f32_32x32x16_bf16 v[48:63], v[188:191], v[168:171], v[48:63]
K2FH_M0b_pv11:
    ds_read_b128 v[188:191], v229 offset:52224
    v_cndmask_b32 v142, v226, v142, s[92:93]
    v_cndmask_b32 v143, v226, v143, s[94:95]
    v_cmp_le_i32 s[56:57], 32, v227
    v_cmp_le_i32 s[58:59], 33, v227
    v_cmp_le_i32 s[92:93], 34, v227
    v_cmp_le_i32 s[94:95], 35, v227
    v_cndmask_b32 v144, v226, v144, s[56:57]
    s_waitcnt lgkmcnt(4)
    s_cbranch_vccnz K2FH_M0b_pv12
    v_mfma_f32_32x32x16_bf16 v[0:15], v[192:195], v[172:175], v[0:15]
K2FH_M0b_pv12:
    ds_read_b128 v[192:195], v229 offset:53248
    v_cndmask_b32 v145, v226, v145, s[58:59]
    v_cndmask_b32 v146, v226, v146, s[92:93]
    v_cndmask_b32 v147, v226, v147, s[94:95]
    v_cmp_le_i32 s[56:57], 40, v227
    v_cmp_le_i32 s[58:59], 41, v227
    v_cmp_le_i32 s[92:93], 42, v227
    v_cmp_le_i32 s[94:95], 43, v227
    s_cbranch_vccnz K2FH_M0b_pv13
    v_mfma_f32_32x32x16_bf16 v[16:31], v[196:199], v[172:175], v[16:31]
K2FH_M0b_pv13:
    ds_read_b128 v[196:199], v229 offset:54272
    v_cndmask_b32 v148, v226, v148, s[56:57]
    v_cndmask_b32 v149, v226, v149, s[58:59]
    v_cndmask_b32 v150, v226, v150, s[92:93]
    v_cndmask_b32 v151, v226, v151, s[94:95]
    v_cmp_le_i32 s[56:57], 48, v227
    v_cmp_le_i32 s[58:59], 49, v227
    s_cbranch_vccnz K2FH_M0b_pv14
    v_mfma_f32_32x32x16_bf16 v[32:47], v[200:203], v[172:175], v[32:47]
K2FH_M0b_pv14:
    ds_read_b128 v[200:203], v229 offset:55296
    v_cmp_le_i32 s[92:93], 50, v227
    v_cmp_le_i32 s[94:95], 51, v227
    v_cndmask_b32 v152, v226, v152, s[56:57]
    v_cndmask_b32 v153, v226, v153, s[58:59]
    v_cndmask_b32 v154, v226, v154, s[92:93]
    v_cndmask_b32 v155, v226, v155, s[94:95]
    v_cmp_le_i32 s[56:57], 56, v227
    s_cbranch_vccnz K2FH_M0b_pv15
    v_mfma_f32_32x32x16_bf16 v[48:63], v[204:207], v[172:175], v[48:63]
K2FH_M0b_pv15:
    ds_read_b128 v[204:207], v229 offset:56320
    v_cmp_le_i32 s[58:59], 57, v227
    v_cmp_le_i32 s[92:93], 58, v227
    v_cmp_le_i32 s[94:95], 59, v227
    v_cndmask_b32 v156, v226, v156, s[56:57]
    v_cndmask_b32 v157, v226, v157, s[58:59]
    v_cndmask_b32 v158, v226, v158, s[92:93]
    v_cndmask_b32 v159, v226, v159, s[94:95]
    s_add_u32 s51, s51, 1
K2FH_L1b:
    v_exp_f32 v232, v128
    v_exp_f32 v233, v129
    v_exp_f32 v234, v130
    v_exp_f32 v235, v131
    v_add_f32 v224, v224, v232
    v_cvt_pk_bf16_f32 v160, v232, v233
    v_add_f32 v225, v225, v233
    v_exp_f32 v236, v132
    v_exp_f32 v237, v133
    v_add_f32 v224, v224, v234
    v_cvt_pk_bf16_f32 v161, v234, v235
    v_add_f32 v225, v225, v235
    v_exp_f32 v238, v134
    v_exp_f32 v239, v135
    v_add_f32 v224, v224, v236
    v_cvt_pk_bf16_f32 v162, v236, v237
    v_add_f32 v225, v225, v237
    v_add_f32 v224, v224, v238
    v_cvt_pk_bf16_f32 v163, v238, v239
    v_add_f32 v225, v225, v239
    s_nop 0
    s_waitcnt lgkmcnt(6)
    s_cmp_lt_u32 s62, 2
    s_cselect_b64 vcc, -1, 0
    s_cbranch_vccnz K2FH_L1b_pv0
    v_mfma_f32_32x32x16_bf16 v[0:15], v[176:179], v[160:163], v[0:15]
K2FH_L1b_pv0:
    ds_read_b128 v[176:179], v229 offset:57344
    v_exp_f32 v232, v136
    v_exp_f32 v233, v137
    v_exp_f32 v234, v138
    v_exp_f32 v235, v139
    v_add_f32 v224, v224, v232
    s_cbranch_vccnz K2FH_L1b_pv1
    v_mfma_f32_32x32x16_bf16 v[16:31], v[180:183], v[160:163], v[16:31]
K2FH_L1b_pv1:
    ds_read_b128 v[180:183], v229 offset:58368
    v_cvt_pk_bf16_f32 v164, v232, v233
    v_add_f32 v225, v225, v233
    v_exp_f32 v236, v140
    v_exp_f32 v237, v141
    v_add_f32 v224, v224, v234
    s_waitcnt lgkmcnt(6)
    s_cbranch_vccnz K2FH_L1b_pv2
    v_mfma_f32_32x32x16_bf16 v[32:47], v[184:187], v[160:163], v[32:47]
K2FH_L1b_pv2:
    ds_read_b128 v[184:187], v229 offset:59392
    v_cvt_pk_bf16_f32 v165, v234, v235
    v_add_f32 v225, v225, v235
    v_exp_f32 v238, v142
    v_exp_f32 v239, v143
    v_add_f32 v224, v224, v236
    s_cbranch_vccnz K2FH_L1b_pv3
    v_mfma_f32_32x32x16_bf16 v[48:63], v[188:191], v[160:163], v[48:63]
K2FH_L1b_pv3:
    ds_read_b128 v[188:191], v229 offset:60416
    v_cvt_pk_bf16_f32 v166, v236, v237
    v_add_f32 v225, v225, v237
    v_add_f32 v224, v224, v238
    v_cvt_pk_bf16_f32 v167, v238, v239
    v_add_f32 v225, v225, v239
    s_nop 1
    s_waitcnt lgkmcnt(6)
    s_cbranch_vccnz K2FH_L1b_pv4
    v_mfma_f32_32x32x16_bf16 v[0:15], v[192:195], v[164:167], v[0:15]
K2FH_L1b_pv4:
    ds_read_b128 v[192:195], v229 offset:61440
    v_exp_f32 v232, v144
    v_exp_f32 v233, v145
    v_exp_f32 v234, v146
    v_exp_f32 v235, v147
    v_add_f32 v224, v224, v232
    s_cbranch_vccnz K2FH_L1b_pv5
    v_mfma_f32_32x32x16_bf16 v[16:31], v[196:199], v[164:167], v[16:31]
K2FH_L1b_pv5:
    ds_read_b128 v[196:199], v229 offset:62464
    v_cvt_pk_bf16_f32 v168, v232, v233
    v_add_f32 v225, v225, v233
    v_exp_f32 v236, v148
    v_exp_f32 v237, v149
    v_add_f32 v224, v224, v234
    s_waitcnt lgkmcnt(6)
    s_cbranch_vccnz K2FH_L1b_pv6
    v_mfma_f32_32x32x16_bf16 v[32:47], v[200:203], v[164:167], v[32:47]
K2FH_L1b_pv6:
    ds_read_b128 v[200:203], v229 offset:63488
    v_cvt_pk_bf16_f32 v169, v234, v235
    v_add_f32 v225, v225, v235
    v_exp_f32 v238, v150
    v_exp_f32 v239, v151
    v_add_f32 v224, v224, v236
    s_cbranch_vccnz K2FH_L1b_pv7
    v_mfma_f32_32x32x16_bf16 v[48:63], v[204:207], v[164:167], v[48:63]
K2FH_L1b_pv7:
    ds_read_b128 v[204:207], v229 offset:64512
    v_cvt_pk_bf16_f32 v170, v236, v237
    v_add_f32 v225, v225, v237
    v_add_f32 v224, v224, v238
    v_cvt_pk_bf16_f32 v171, v238, v239
    v_add_f32 v225, v225, v239
    s_nop 1
    s_waitcnt lgkmcnt(7)
    s_barrier
    s_cmp_lt_u32 s62, 3
    s_cselect_b64 vcc, -1, 0
    s_cbranch_vccnz K2FH_L1b_pv8
    v_mfma_f32_32x32x16_bf16 v[0:15], v[176:179], v[168:171], v[0:15]
K2FH_L1b_pv8:
    v_exp_f32 v232, v152
    v_exp_f32 v233, v153
    v_exp_f32 v234, v154
    v_exp_f32 v235, v155
    v_add_f32 v224, v224, v232
    s_waitcnt lgkmcnt(6)
    s_cbranch_vccnz K2FH_L1b_pv9
    v_mfma_f32_32x32x16_bf16 v[16:31], v[180:183], v[168:171], v[16:31]
K2FH_L1b_pv9:
    v_cvt_pk_bf16_f32 v172, v232, v233
    v_add_f32 v225, v225, v233
    v_exp_f32 v236, v156
    v_exp_f32 v237, v157
    v_add_f32 v224, v224, v234
    s_waitcnt lgkmcnt(5)
    s_cbranch_vccnz K2FH_L1b_pv10
    v_mfma_f32_32x32x16_bf16 v[32:47], v[184:187], v[168:171], v[32:47]
K2FH_L1b_pv10:
    v_cvt_pk_bf16_f32 v173, v234, v235
    v_add_f32 v225, v225, v235
    v_exp_f32 v238, v158
    v_exp_f32 v239, v159
    v_add_f32 v224, v224, v236
    s_waitcnt lgkmcnt(4)
    s_cbranch_vccnz K2FH_L1b_pv11
    v_mfma_f32_32x32x16_bf16 v[48:63], v[188:191], v[168:171], v[48:63]
K2FH_L1b_pv11:
    v_cvt_pk_bf16_f32 v174, v236, v237
    v_add_f32 v225, v225, v237
    v_add_f32 v224, v224, v238
    v_cvt_pk_bf16_f32 v175, v238, v239
    v_add_f32 v225, v225, v239
    s_nop 1
    s_waitcnt lgkmcnt(3)
    s_cbranch_vccnz K2FH_L1b_pv12
    v_mfma_f32_32x32x16_bf16 v[0:15], v[192:195], v[172:175], v[0:15]
K2FH_L1b_pv12:
    s_waitcnt lgkmcnt(2)
    s_cbranch_vccnz K2FH_L1b_pv13
    v_mfma_f32_32x32x16_bf16 v[16:31], v[196:199], v[172:175], v[16:31]
K2FH_L1b_pv13:
    s_waitcnt lgkmcnt(1)
    s_cbranch_vccnz K2FH_L1b_pv14
    v_mfma_f32_32x32x16_bf16 v[32:47], v[200:203], v[172:175], v[32:47]
K2FH_L1b_pv14:
    s_waitcnt lgkmcnt(0)
    s_cbranch_vccnz K2FH_L1b_pv15
    v_mfma_f32_32x32x16_bf16 v[48:63], v[204:207], v[172:175], v[48:63]
K2FH_L1b_pv15:
    s_nop 1
    s_add_u32 s51, s51, 1
K2F_EPI:
    v_add_f32 v224, v224, v225
    v_mov_b32 v226, v224
    s_nop 1
    v_permlane32_swap_b32 v224, v226
    v_add_f32 v224, v224, v226
    v_mov_b32 v246, v224
    v_rcp_f32 v224, v224
    s_lshl_b32 s55, s63, 18
    s_lshl_b32 s56, s15, 13
    s_add_u32 s55, s55, s56
    s_nop 7
    v_add_f32 v246, v246, |v0|
    v_add_f32 v246, v246, |v1|
    v_mul_f32 v0, v0, v224
    v_mul_f32 v1, v1, v224
    v_cvt_pk_bf16_f32 v96, v0, v1
    v_add_f32 v246, v246, |v2|
    v_add_f32 v246, v246, |v3|
    v_mul_f32 v2, v2, v224
    v_mul_f32 v3, v3, v224
    v_cvt_pk_bf16_f32 v97, v2, v3
    v_add_f32 v246, v246, |v4|
    v_add_f32 v246, v246, |v5|
    v_mul_f32 v4, v4, v224
    v_mul_f32 v5, v5, v224
    v_cvt_pk_bf16_f32 v98, v4, v5
    v_add_f32 v246, v246, |v6|
    v_add_f32 v246, v246, |v7|
    v_mul_f32 v6, v6, v224
    v_mul_f32 v7, v7, v224
    v_cvt_pk_bf16_f32 v99, v6, v7
    buffer_store_dwordx4 v[96:99], v230, s[36:39], s55 offen offset:0 sc1
    v_add_f32 v246, v246, |v8|
    v_add_f32 v246, v246, |v9|
    v_mul_f32 v8, v8, v224
    v_mul_f32 v9, v9, v224
    v_cvt_pk_bf16_f32 v100, v8, v9
    v_add_f32 v246, v246, |v10|
    v_add_f32 v246, v246, |v11|
    v_mul_f32 v10, v10, v224
    v_mul_f32 v11, v11, v224
    v_cvt_pk_bf16_f32 v101, v10, v11
    v_add_f32 v246, v246, |v12|
    v_add_f32 v246, v246, |v13|
    v_mul_f32 v12, v12, v224
    v_mul_f32 v13, v13, v224
    v_cvt_pk_bf16_f32 v102, v12, v13
    v_add_f32 v246, v246, |v14|
    v_add_f32 v246, v246, |v15|
    v_mul_f32 v14, v14, v224
    v_mul_f32 v15, v15, v224
    v_cvt_pk_bf16_f32 v103, v14, v15
    buffer_store_dwordx4 v[100:103], v230, s[36:39], s55 offen offset:1024 sc1
    v_add_f32 v246, v246, |v16|
    v_add_f32 v246, v246, |v17|
    v_mul_f32 v16, v16, v224
    v_mul_f32 v17, v17, v224
    v_cvt_pk_bf16_f32 v104, v16, v17
    v_add_f32 v246, v246, |v18|
    v_add_f32 v246, v246, |v19|
    v_mul_f32 v18, v18, v224
    v_mul_f32 v19, v19, v224
    v_cvt_pk_bf16_f32 v105, v18, v19
    v_add_f32 v246, v246, |v20|
    v_add_f32 v246, v246, |v21|
    v_mul_f32 v20, v20, v224
    v_mul_f32 v21, v21, v224
    v_cvt_pk_bf16_f32 v106, v20, v21
    v_add_f32 v246, v246, |v22|
    v_add_f32 v246, v246, |v23|
    v_mul_f32 v22, v22, v224
    v_mul_f32 v23, v23, v224
    v_cvt_pk_bf16_f32 v107, v22, v23
    buffer_store_dwordx4 v[104:107], v230, s[36:39], s55 offen offset:2048 sc1
    v_add_f32 v246, v246, |v24|
    v_add_f32 v246, v246, |v25|
    v_mul_f32 v24, v24, v224
    v_mul_f32 v25, v25, v224
    v_cvt_pk_bf16_f32 v108, v24, v25
    v_add_f32 v246, v246, |v26|
    v_add_f32 v246, v246, |v27|
    v_mul_f32 v26, v26, v224
    v_mul_f32 v27, v27, v224
    v_cvt_pk_bf16_f32 v109, v26, v27
    v_add_f32 v246, v246, |v28|
    v_add_f32 v246, v246, |v29|
    v_mul_f32 v28, v28, v224
    v_mul_f32 v29, v29, v224
    v_cvt_pk_bf16_f32 v110, v28, v29
    v_add_f32 v246, v246, |v30|
    v_add_f32 v246, v246, |v31|
    v_mul_f32 v30, v30, v224
    v_mul_f32 v31, v31, v224
    v_cvt_pk_bf16_f32 v111, v30, v31
    buffer_store_dwordx4 v[108:111], v230, s[36:39], s55 offen offset:3072 sc1
    v_add_f32 v246, v246, |v32|
    v_add_f32 v246, v246, |v33|
    v_mul_f32 v32, v32, v224
    v_mul_f32 v33, v33, v224
    v_cvt_pk_bf16_f32 v112, v32, v33
    v_add_f32 v246, v246, |v34|
    v_add_f32 v246, v246, |v35|
    v_mul_f32 v34, v34, v224
    v_mul_f32 v35, v35, v224
    v_cvt_pk_bf16_f32 v113, v34, v35
    v_add_f32 v246, v246, |v36|
    v_add_f32 v246, v246, |v37|
    v_mul_f32 v36, v36, v224
    v_mul_f32 v37, v37, v224
    v_cvt_pk_bf16_f32 v114, v36, v37
    v_add_f32 v246, v246, |v38|
    v_add_f32 v246, v246, |v39|
    v_mul_f32 v38, v38, v224
    v_mul_f32 v39, v39, v224
    v_cvt_pk_bf16_f32 v115, v38, v39
    s_add_u32 s55, s55, 4096
    buffer_store_dwordx4 v[112:115], v230, s[36:39], s55 offen offset:0 sc1
    v_add_f32 v246, v246, |v40|
    v_add_f32 v246, v246, |v41|
    v_mul_f32 v40, v40, v224
    v_mul_f32 v41, v41, v224
    v_cvt_pk_bf16_f32 v116, v40, v41
    v_add_f32 v246, v246, |v42|
    v_add_f32 v246, v246, |v43|
    v_mul_f32 v42, v42, v224
    v_mul_f32 v43, v43, v224
    v_cvt_pk_bf16_f32 v117, v42, v43
    v_add_f32 v246, v246, |v44|
    v_add_f32 v246, v246, |v45|
    v_mul_f32 v44, v44, v224
    v_mul_f32 v45, v45, v224
    v_cvt_pk_bf16_f32 v118, v44, v45
    v_add_f32 v246, v246, |v46|
    v_add_f32 v246, v246, |v47|
    v_mul_f32 v46, v46, v224
    v_mul_f32 v47, v47, v224
    v_cvt_pk_bf16_f32 v119, v46, v47
    buffer_store_dwordx4 v[116:119], v230, s[36:39], s55 offen offset:1024 sc1
    v_add_f32 v246, v246, |v48|
    v_add_f32 v246, v246, |v49|
    v_mul_f32 v48, v48, v224
    v_mul_f32 v49, v49, v224
    v_cvt_pk_bf16_f32 v120, v48, v49
    v_add_f32 v246, v246, |v50|
    v_add_f32 v246, v246, |v51|
    v_mul_f32 v50, v50, v224
    v_mul_f32 v51, v51, v224
    v_cvt_pk_bf16_f32 v121, v50, v51
    v_add_f32 v246, v246, |v52|
    v_add_f32 v246, v246, |v53|
    v_mul_f32 v52, v52, v224
    v_mul_f32 v53, v53, v224
    v_cvt_pk_bf16_f32 v122, v52, v53
    v_add_f32 v246, v246, |v54|
    v_add_f32 v246, v246, |v55|
    v_mul_f32 v54, v54, v224
    v_mul_f32 v55, v55, v224
    v_cvt_pk_bf16_f32 v123, v54, v55
    buffer_store_dwordx4 v[120:123], v230, s[36:39], s55 offen offset:2048 sc1
    v_add_f32 v246, v246, |v56|
    v_add_f32 v246, v246, |v57|
    v_mul_f32 v56, v56, v224
    v_mul_f32 v57, v57, v224
    v_cvt_pk_bf16_f32 v124, v56, v57
    v_add_f32 v246, v246, |v58|
    v_add_f32 v246, v246, |v59|
    v_mul_f32 v58, v58, v224
    v_mul_f32 v59, v59, v224
    v_cvt_pk_bf16_f32 v125, v58, v59
    v_add_f32 v246, v246, |v60|
    v_add_f32 v246, v246, |v61|
    v_mul_f32 v60, v60, v224
    v_mul_f32 v61, v61, v224
    v_cvt_pk_bf16_f32 v126, v60, v61
    v_add_f32 v246, v246, |v62|
    v_add_f32 v246, v246, |v63|
    v_mul_f32 v62, v62, v224
    v_mul_f32 v63, v63, v224
    v_cvt_pk_bf16_f32 v127, v62, v63
    buffer_store_dwordx4 v[124:127], v230, s[36:39], s55 offen offset:3072 sc1
    v_mov_b32 v226, 0x71800000
    v_cmp_nlt_f32 vcc, v246, v226
    s_nop 1
    s_cbranch_vccz K2F_LD
    v_mov_b32 v226, 1
    v_mov_b32 v227, 81920
    ds_write_b32 v227, v226
K2F_LD:
    s_cmp_ge_u32 s51, s18
    s_cbranch_scc1 K2F_FIN
    s_add_u32 s64, s51, 2
    s_cmp_lt_u32 s64, s18
    s_cbranch_scc1 K2F_LDX_w8
    s_waitcnt vmcnt(0)
K2F_LDX_w8:
    s_waitcnt vmcnt(8)
    s_barrier
    s_cmp_eq_u32 s60, 0
    s_cbranch_scc1 K2F_LDX_nl
    s_add_u32 s64, s51, 3
    s_cmp_ge_u32 s64, s18
    s_cbranch_scc1 K2F_LDX_nl
    s_add_u32 s65, s64, 1
    s_and_b32 s66, s65, 3
    s_lshl_b32 s66, s66, 14
    s_add_u32 m0, s66, s45
    s_lshl_b32 s65, s65, 14
    s_add_u32 s65, s65, s46
    buffer_load_dwordx4 v230, s[28:31], s65 offen offset:0 lds
    buffer_load_dwordx4 v230, s[28:31], s65 offen offset:1024 lds
    buffer_load_dwordx4 v230, s[28:31], s65 offen offset:2048 lds
    buffer_load_dwordx4 v230, s[28:31], s65 offen offset:3072 lds
    s_add_u32 s66, s64, 2
    s_and_b32 s66, s66, 3
    s_lshl_b32 s66, s66, 14
    s_add_u32 s66, s66, s45
    s_add_u32 m0, s66, 98304
    s_sub_u32 s65, s65, 16384
    buffer_load_dwordx4 v230, s[32:35], s65 offen offset:0 lds
    buffer_load_dwordx4 v230, s[32:35], s65 offen offset:1024 lds
    buffer_load_dwordx4 v230, s[32:35], s65 offen offset:2048 lds
    buffer_load_dwordx4 v230, s[32:35], s65 offen offset:3072 lds
K2F_LDX_nl:
    s_add_u32 s51, s51, 1
    s_branch K2F_LD
K2F_FIN:
    v_mov_b32 v227, 81920
    s_waitcnt vmcnt(0) lgkmcnt(0)
    s_barrier
    ds_read_b32 v226, v227
    s_waitcnt lgkmcnt(0)
    v_readfirstlane_b32 s55, v226
    s_cmp_eq_u32 s55, 0
    s_cbranch_scc1 K2_END
    s_add_u32 m0, s41, 0
    s_add_u32 s47, s44, 0
    buffer_load_dwordx4 v230, s[28:31], s47 offen offset:0 lds
    buffer_load_dwordx4 v230, s[28:31], s47 offen offset:1024 lds
    s_add_u32 m0, s41, 16384
    s_add_u32 s47, s44, 16384
    buffer_load_dwordx4 v230, s[28:31], s47 offen offset:0 lds
    buffer_load_dwordx4 v230, s[28:31], s47 offen offset:1024 lds
    s_add_u32 m0, s41, 131072
    s_add_u32 s47, s44, 0
    buffer_load_dwordx4 v230, s[32:35], s47 offen offset:0 lds
    buffer_load_dwordx4 v230, s[32:35], s47 offen offset:1024 lds
    s_add_u32 m0, s41, 32768
    s_add_u32 s47, s44, 32768
    buffer_load_dwordx4 v230, s[28:31], s47 offen offset:0 lds
    buffer_load_dwordx4 v230, s[28:31], s47 offen offset:1024 lds
    s_add_u32 m0, s41, 147456
    s_add_u32 s47, s44, 16384
    buffer_load_dwordx4 v230, s[32:35], s47 offen offset:0 lds
    buffer_load_dwordx4 v230, s[32:35], s47 offen offset:1024 lds
    s_waitcnt vmcnt(0)
    s_barrier
    s_cmp_eq_u32 s60, 0
    s_cbranch_scc1 K2S_NOS2
    s_mov_b32 s64, 2
    s_add_u32 s65, s64, 1
    s_and_b32 s66, s65, 3
    s_lshl_b32 s66, s66, 14
    s_add_u32 m0, s66, s45
    s_lshl_b32 s65, s65, 14
    s_add_u32 s65, s65, s46
    buffer_load_dwordx4 v230, s[28:31], s65 offen offset:0 lds
    buffer_load_dwordx4 v230, s[28:31], s65 offen offset:1024 lds
    buffer_load_dwordx4 v230, s[28:31], s65 offen offset:2048 lds
    buffer_load_dwordx4 v230, s[28:31], s65 offen offset:3072 lds
    s_add_u32 s66, s64, 2
    s_and_b32 s66, s66, 3
    s_lshl_b32 s66, s66, 14
    s_add_u32 s66, s66, s45
    s_add_u32 m0, s66, 98304
    s_sub_u32 s65, s65, 16384
    buffer_load_dwordx4 v230, s[32:35], s65 offen offset:0 lds
    buffer_load_dwordx4 v230, s[32:35], s65 offen offset:1024 lds
    buffer_load_dwordx4 v230, s[32:35], s65 offen offset:2048 lds
    buffer_load_dwordx4 v230, s[32:35], s65 offen offset:3072 lds
K2S_NOS2:
    ds_read_b128 v[176:179], v230 offset:0
    ds_read_b128 v[180:183], v230 offset:1024
    ds_read_b128 v[184:187], v230 offset:2048
    ds_read_b128 v[188:191], v230 offset:3072
    ds_read_b128 v[192:195], v230 offset:4096
    ds_read_b128 v[196:199], v230 offset:5120
    ds_read_b128 v[200:203], v230 offset:6144
    ds_read_b128 v[204:207], v230 offset:7168
    v_add_u32 v228, 16384, v230
    v_add_u32 v229, 131072, v230
    s_mov_b32 s51, 0
    s_mov_b32 s52, 0xf149f2ca
    s_mov_b32 s53, 0x41000000
    s_waitcnt lgkmcnt(0)
    v_mfma_f32_32x32x16_bf16 v[96:111], v[176:179], v[64:67], 0
    ds_read_b128 v[176:179], v230 offset:8192
    v_mov_b32 v0, 0
    v_mov_b32 v1, 0
    v_mov_b32 v2, 0
    v_mov_b32 v3, 0
    v_mfma_f32_32x32x16_bf16 v[96:111], v[180:183], v[68:71], v[96:111]
    ds_read_b128 v[180:183], v230 offset:9216
    v_mov_b32 v4, 0
    v_mov_b32 v5, 0
    v_mov_b32 v6, 0
    v_mov_b32 v7, 0
    v_mfma_f32_32x32x16_bf16 v[96:111], v[184:187], v[72:75], v[96:111]
    ds_read_b128 v[184:187], v230 offset:10240
    v_mov_b32 v8, 0
    v_mov_b32 v9, 0
    v_mov_b32 v10, 0
    v_mov_b32 v11, 0
    v_mfma_f32_32x32x16_bf16 v[96:111], v[188:191], v[76:79], v[96:111]
    ds_read_b128 v[188:191], v230 offset:11264
    v_mov_b32 v12, 0
    v_mov_b32 v13, 0
    v_mov_b32 v14, 0
    v_mov_b32 v15, 0
    v_mfma_f32_32x32x16_bf16 v[96:111], v[192:195], v[80:83], v[96:111]
    ds_read_b128 v[192:195], v230 offset:12288
    v_mov_b32 v16, 0
    v_mov_b32 v17, 0
    v_mov_b32 v18, 0
    v_mov_b32 v19, 0
    v_mfma_f32_32x32x16_bf16 v[96:111], v[196:199], v[84:87], v[96:111]
    ds_read_b128 v[196:199], v230 offset:13312
    v_mov_b32 v20, 0
    v_mov_b32 v21, 0
    v_mov_b32 v22, 0
    v_mov_b32 v23, 0
    v_mfma_f32_32x32x16_bf16 v[96:111], v[200:203], v[88:91], v[96:111]
    ds_read_b128 v[200:203], v230 offset:14336
    v_mov_b32 v24, 0
    v_mov_b32 v25, 0
    v_mov_b32 v26, 0
    v_mov_b32 v27, 0
    v_mfma_f32_32x32x16_bf16 v[96:111], v[204:207], v[92:95], v[96:111]
    ds_read_b128 v[204:207], v230 offset:15360
    v_mov_b32 v28, 0
    v_mov_b32 v29, 0
    v_mov_b32 v30, 0
    v_mov_b32 v31, 0
    s_waitcnt lgkmcnt(7)
    v_mfma_f32_32x32x16_bf16 v[112:127], v[176:179], v[64:67], 0
    ds_read_b128 v[176:179], v228 offset:0
    v_mov_b32 v32, 0
    v_mov_b32 v33, 0
    v_mov_b32 v34, 0
    v_mov_b32 v35, 0
    s_waitcnt lgkmcnt(7)
    v_mfma_f32_32x32x16_bf16 v[112:127], v[180:183], v[68:71], v[112:127]
    ds_read_b128 v[180:183], v228 offset:1024
    v_mov_b32 v36, 0
    v_mov_b32 v37, 0
    v_mov_b32 v38, 0
    v_mov_b32 v39, 0
    s_waitcnt lgkmcnt(7)
    v_mfma_f32_32x32x16_bf16 v[112:127], v[184:187], v[72:75], v[112:127]
    ds_read_b128 v[184:187], v228 offset:2048
    v_mov_b32 v40, 0
    v_mov_b32 v41, 0
    v_mov_b32 v42, 0
    v_mov_b32 v43, 0
    s_waitcnt lgkmcnt(7)
    v_mfma_f32_32x32x16_bf16 v[112:127], v[188:191], v[76:79], v[112:127]
    ds_read_b128 v[188:191], v228 offset:3072
    v_mov_b32 v44, 0
    v_mov_b32 v45, 0
    v_mov_b32 v46, 0
    v_mov_b32 v47, 0
    s_waitcnt lgkmcnt(7)
    v_mfma_f32_32x32x16_bf16 v[112:127], v[192:195], v[80:83], v[112:127]
    ds_read_b128 v[192:195], v228 offset:4096
    v_mov_b32 v48, 0
    v_mov_b32 v49, 0
    v_mov_b32 v50, 0
    v_mov_b32 v51, 0
    s_waitcnt lgkmcnt(7)
    v_mfma_f32_32x32x16_bf16 v[112:127], v[196:199], v[84:87], v[112:127]
    ds_read_b128 v[196:199], v228 offset:5120
    v_mov_b32 v52, 0
    v_mov_b32 v53, 0
    v_mov_b32 v54, 0
    v_mov_b32 v55, 0
    s_waitcnt lgkmcnt(7)
    v_mfma_f32_32x32x16_bf16 v[112:127], v[200:203], v[88:91], v[112:127]
    ds_read_b128 v[200:203], v228 offset:6144
    v_mov_b32 v56, 0
    v_mov_b32 v57, 0
    v_mov_b32 v58, 0
    v_mov_b32 v59, 0
    s_waitcnt lgkmcnt(7)
    v_mfma_f32_32x32x16_bf16 v[112:127], v[204:207], v[92:95], v[112:127]
    ds_read_b128 v[204:207], v228 offset:7168
    v_mov_b32 v60, 0
    v_mov_b32 v61, 0
    v_mov_b32 v62, 0
    v_mov_b32 v63, 0
    v_mov_b32 v224, 0
    v_mov_b32 v225, 0
    s_mov_b32 s54, 0
    s_nop 7
    s_nop 3
    s_cmp_eq_u32 s61, 2
    s_cbranch_scc0 K2S_NOM
    s_lshl_b32 s67, s54, 6
    v_subrev_u32 v227, s67, v231
    v_mov_b32 v226, s52
    v_cmp_le_i32 s[56:57], 0, v227
    v_cmp_le_i32 s[58:59], 1, v227
    v_cmp_le_i32 s[92:93], 2, v227
    v_cmp_le_i32 s[94:95], 3, v227
    v_cndmask_b32 v96, v226, v96, s[56:57]
    v_cndmask_b32 v97, v226, v97, s[58:59]
    v_cndmask_b32 v98, v226, v98, s[92:93]
    v_cndmask_b32 v99, v226, v99, s[94:95]
    v_cmp_le_i32 s[56:57], 8, v227
    v_cmp_le_i32 s[58:59], 9, v227
    v_cmp_le_i32 s[92:93], 10, v227
    v_cmp_le_i32 s[94:95], 11, v227
    v_cndmask_b32 v100, v226, v100, s[56:57]
    v_cndmask_b32 v101, v226, v101, s[58:59]
    v_cndmask_b32 v102, v226, v102, s[92:93]
    v_cndmask_b32 v103, v226, v103, s[94:95]
    v_cmp_le_i32 s[56:57], 16, v227
    v_cmp_le_i32 s[58:59], 17, v227
    v_cmp_le_i32 s[92:93], 18, v227
    v_cmp_le_i32 s[94:95], 19, v227
    v_cndmask_b32 v104, v226, v104, s[56:57]
    v_cndmask_b32 v105, v226, v105, s[58:59]
    v_cndmask_b32 v106, v226, v106, s[92:93]
    v_cndmask_b32 v107, v226, v107, s[94:95]
    v_cmp_le_i32 s[56:57], 24, v227
    v_cmp_le_i32 s[58:59], 25, v227
    v_cmp_le_i32 s[92:93], 26, v227
    v_cmp_le_i32 s[94:95], 27, v227
    v_cndmask_b32 v108, v226, v108, s[56:57]
    v_cndmask_b32 v109, v226, v109, s[58:59]
    v_cndmask_b32 v110, v226, v110, s[92:93]
    v_cndmask_b32 v111, v226, v111, s[94:95]
    v_cmp_le_i32 s[56:57], 32, v227
    v_cmp_le_i32 s[58:59], 33, v227
    v_cmp_le_i32 s[92:93], 34, v227
    v_cmp_le_i32 s[94:95], 35, v227
    v_cndmask_b32 v112, v226, v112, s[56:57]
    v_cndmask_b32 v113, v226, v113, s[58:59]
    v_cndmask_b32 v114, v226, v114, s[92:93]
    v_cndmask_b32 v115, v226, v115, s[94:95]
    v_cmp_le_i32 s[56:57], 40, v227
    v_cmp_le_i32 s[58:59], 41, v227
    v_cmp_le_i32 s[92:93], 42, v227
    v_cmp_le_i32 s[94:95], 43, v227
    v_cndmask_b32 v116, v226, v116, s[56:57]
    v_cndmask_b32 v117, v226, v117, s[58:59]
    v_cndmask_b32 v118, v226, v118, s[92:93]
    v_cndmask_b32 v119, v226, v119, s[94:95]
    v_cmp_le_i32 s[56:57], 48, v227
    v_cmp_le_i32 s[58:59], 49, v227
    v_cmp_le_i32 s[92:93], 50, v227
    v_cmp_le_i32 s[94:95], 51, v227
    v_cndmask_b32 v120, v226, v120, s[56:57]
    v_cndmask_b32 v121, v226, v121, s[58:59]
    v_cndmask_b32 v122, v226, v122, s[92:93]
    v_cndmask_b32 v123, v226, v123, s[94:95]
    v_cmp_le_i32 s[56:57], 56, v227
    v_cmp_le_i32 s[58:59], 57, v227
    v_cmp_le_i32 s[92:93], 58, v227
    v_cmp_le_i32 s[94:95], 59, v227
    v_cndmask_b32 v124, v226, v124, s[56:57]
    v_cndmask_b32 v125, v226, v125, s[58:59]
    v_cndmask_b32 v126, v226, v126, s[92:93]
    v_cndmask_b32 v127, v226, v127, s[94:95]
K2S_NOM:
    v_max3_f32 v246, v96, v97, v98
    v_max3_f32 v226, v99, v100, v101
    v_max3_f32 v246, v246, v102, v103
    v_max3_f32 v226, v226, v104, v105
    v_max3_f32 v246, v246, v106, v107
    v_max3_f32 v226, v226, v108, v109
    v_max3_f32 v246, v246, v110, v111
    v_max3_f32 v226, v226, v112, v113
    v_max3_f32 v246, v246, v114, v115
    v_max3_f32 v226, v226, v116, v117
    v_max3_f32 v246, v246, v118, v119
    v_max3_f32 v226, v226, v120, v121
    v_max3_f32 v246, v246, v122, v123
    v_max3_f32 v226, v226, v124, v125
    v_max3_f32 v246, v246, v126, v127
    v_max_f32 v246, v246, v226
    v_mov_b32 v226, v246
    s_nop 1
    v_permlane32_swap_b32 v246, v226
    v_max_f32 v246, v246, v226
    v_sub_f32 v208, 0, v246
    v_sub_f32 v209, 0, v246
    v_sub_f32 v210, 0, v246
    v_sub_f32 v211, 0, v246
    v_sub_f32 v212, 0, v246
    v_sub_f32 v213, 0, v246
    v_sub_f32 v214, 0, v246
    v_sub_f32 v215, 0, v246
    v_sub_f32 v216, 0, v246
    v_sub_f32 v217, 0, v246
    v_sub_f32 v218, 0, v246
    v_sub_f32 v219, 0, v246
    v_sub_f32 v220, 0, v246
    v_sub_f32 v221, 0, v246
    v_sub_f32 v222, 0, v246
    v_sub_f32 v223, 0, v246
    v_sub_f32 v96, v96, v246
    v_sub_f32 v97, v97, v246
    v_sub_f32 v98, v98, v246
    v_sub_f32 v99, v99, v246
    v_sub_f32 v100, v100, v246
    v_sub_f32 v101, v101, v246
    v_sub_f32 v102, v102, v246
    v_sub_f32 v103, v103, v246
    v_sub_f32 v104, v104, v246
    v_sub_f32 v105, v105, v246
    v_sub_f32 v106, v106, v246
    v_sub_f32 v107, v107, v246
    v_sub_f32 v108, v108, v246
    v_sub_f32 v109, v109, v246
    v_sub_f32 v110, v110, v246
    v_sub_f32 v111, v111, v246
    v_sub_f32 v112, v112, v246
    v_sub_f32 v113, v113, v246
    v_sub_f32 v114, v114, v246
    v_sub_f32 v115, v115, v246
    v_sub_f32 v116, v116, v246
    v_sub_f32 v117, v117, v246
    v_sub_f32 v118, v118, v246
    v_sub_f32 v119, v119, v246
    v_sub_f32 v120, v120, v246
    v_sub_f32 v121, v121, v246
    v_sub_f32 v122, v122, v246
    v_sub_f32 v123, v123, v246
    v_sub_f32 v124, v124, v246
    v_sub_f32 v125, v125, v246
    v_sub_f32 v126, v126, v246
    v_sub_f32 v127, v127, v246
    s_sub_u32 s49, s61, 3
    s_cmp_eq_u32 s61, 2
    s_cbranch_scc1 K2S_M0
K2S_U0:
    s_waitcnt lgkmcnt(4)
    v_mfma_f32_32x32x16_bf16 v[128:143], v[176:179], v[64:67], v[208:223]
    ds_read_b128 v[176:179], v228 offset:8192
    v_exp_f32 v232, v96
    v_exp_f32 v233, v97
    v_exp_f32 v234, v98
    v_mfma_f32_32x32x16_bf16 v[128:143], v[180:183], v[68:71], v[128:143]
    ds_read_b128 v[180:183], v228 offset:9216
    v_exp_f32 v235, v99
    v_add_f32 v224, v224, v232
    v_cvt_pk_bf16_f32 v160, v232, v233
    v_mfma_f32_32x32x16_bf16 v[128:143], v[184:187], v[72:75], v[128:143]
    ds_read_b128 v[184:187], v228 offset:10240
    v_add_f32 v225, v225, v233
    v_exp_f32 v236, v100
    v_exp_f32 v237, v101
    v_add_f32 v224, v224, v234
    v_mfma_f32_32x32x16_bf16 v[128:143], v[188:191], v[76:79], v[128:143]
    ds_read_b128 v[188:191], v228 offset:11264
    v_cvt_pk_bf16_f32 v161, v234, v235
    v_add_f32 v225, v225, v235
    v_exp_f32 v238, v102
    s_waitcnt lgkmcnt(4)
    v_mfma_f32_32x32x16_bf16 v[128:143], v[192:195], v[80:83], v[128:143]
    ds_read_b128 v[192:195], v228 offset:12288
    v_exp_f32 v239, v103
    v_add_f32 v224, v224, v236
    v_cvt_pk_bf16_f32 v162, v236, v237
    v_add_f32 v225, v225, v237
    v_add_f32 v224, v224, v238
    v_mfma_f32_32x32x16_bf16 v[128:143], v[196:199], v[84:87], v[128:143]
    ds_read_b128 v[196:199], v228 offset:13312
    v_cvt_pk_bf16_f32 v163, v238, v239
    v_add_f32 v225, v225, v239
    v_exp_f32 v232, v104
    v_exp_f32 v233, v105
    v_mfma_f32_32x32x16_bf16 v[128:143], v[200:203], v[88:91], v[128:143]
    ds_read_b128 v[200:203], v228 offset:14336
    v_exp_f32 v234, v106
    v_exp_f32 v235, v107
    v_add_f32 v224, v224, v232
    v_mfma_f32_32x32x16_bf16 v[128:143], v[204:207], v[92:95], v[128:143]
    ds_read_b128 v[204:207], v228 offset:15360
    v_cvt_pk_bf16_f32 v164, v232, v233
    v_add_f32 v225, v225, v233
    v_exp_f32 v236, v108
    s_waitcnt lgkmcnt(4)
    v_mfma_f32_32x32x16_bf16 v[144:159], v[176:179], v[64:67], v[208:223]
    ds_read_b128 v[176:179], v229 offset:0
    v_exp_f32 v237, v109
    v_add_f32 v224, v224, v234
    v_cvt_pk_bf16_f32 v165, v234, v235
    v_add_f32 v225, v225, v235
    v_exp_f32 v238, v110
    s_add_u32 s55, s51, 2
    s_and_b32 s55, s55, 3
    s_lshl_b32 s55, s55, 14
    v_add_u32 v228, s55, v230
    v_mfma_f32_32x32x16_bf16 v[144:159], v[180:183], v[68:71], v[144:159]
    ds_read_b128 v[180:183], v229 offset:1024
    v_exp_f32 v239, v111
    v_add_f32 v224, v224, v236
    v_cvt_pk_bf16_f32 v166, v236, v237
    v_mfma_f32_32x32x16_bf16 v[144:159], v[184:187], v[72:75], v[144:159]
    ds_read_b128 v[184:187], v229 offset:2048
    v_add_f32 v225, v225, v237
    v_add_f32 v224, v224, v238
    v_cvt_pk_bf16_f32 v167, v238, v239
    v_add_f32 v225, v225, v239
    v_exp_f32 v232, v112
    v_mfma_f32_32x32x16_bf16 v[144:159], v[188:191], v[76:79], v[144:159]
    ds_read_b128 v[188:191], v229 offset:3072
    v_exp_f32 v233, v113
    v_exp_f32 v234, v114
    s_waitcnt lgkmcnt(4)
    v_mfma_f32_32x32x16_bf16 v[144:159], v[192:195], v[80:83], v[144:159]
    ds_read_b128 v[192:195], v229 offset:4096
    v_exp_f32 v235, v115
    v_add_f32 v224, v224, v232
    v_cvt_pk_bf16_f32 v168, v232, v233
    v_add_f32 v225, v225, v233
    v_exp_f32 v236, v116
    v_mfma_f32_32x32x16_bf16 v[144:159], v[196:199], v[84:87], v[144:159]
    ds_read_b128 v[196:199], v229 offset:5120
    v_exp_f32 v237, v117
    v_add_f32 v224, v224, v234
    v_cvt_pk_bf16_f32 v169, v234, v235
    v_mfma_f32_32x32x16_bf16 v[144:159], v[200:203], v[88:91], v[144:159]
    ds_read_b128 v[200:203], v229 offset:6144
    v_add_f32 v225, v225, v235
    v_exp_f32 v238, v118
    v_exp_f32 v239, v119
    v_add_f32 v224, v224, v236
    v_mfma_f32_32x32x16_bf16 v[144:159], v[204:207], v[92:95], v[144:159]
    ds_read_b128 v[204:207], v229 offset:7168
    v_cvt_pk_bf16_f32 v170, v236, v237
    v_add_f32 v225, v225, v237
    v_add_f32 v224, v224, v238
    v_cvt_pk_bf16_f32 v171, v238, v239
    v_add_f32 v225, v225, v239
    s_waitcnt lgkmcnt(4)
    v_mfma_f32_32x32x16_bf16 v[0:15], v[176:179], v[160:163], v[0:15]
    ds_read_b128 v[176:179], v229 offset:8192
    v_exp_f32 v232, v120
    v_exp_f32 v233, v121
    v_mfma_f32_32x32x16_bf16 v[16:31], v[180:183], v[160:163], v[16:31]
    ds_read_b128 v[180:183], v229 offset:9216
    v_exp_f32 v234, v122
    v_exp_f32 v235, v123
    v_add_f32 v224, v224, v232
    v_mfma_f32_32x32x16_bf16 v[32:47], v[184:187], v[160:163], v[32:47]
    ds_read_b128 v[184:187], v229 offset:10240
    v_cvt_pk_bf16_f32 v172, v232, v233
    v_add_f32 v225, v225, v233
    v_exp_f32 v236, v124
    v_mfma_f32_32x32x16_bf16 v[48:63], v[188:191], v[160:163], v[48:63]
    ds_read_b128 v[188:191], v229 offset:11264
    v_exp_f32 v237, v125
    v_add_f32 v224, v224, v234
    v_cvt_pk_bf16_f32 v173, v234, v235
    v_add_f32 v225, v225, v235
    s_waitcnt lgkmcnt(4)
    v_mfma_f32_32x32x16_bf16 v[0:15], v[192:195], v[164:167], v[0:15]
    ds_read_b128 v[192:195], v229 offset:12288
    v_exp_f32 v238, v126
    v_exp_f32 v239, v127
    v_add_f32 v224, v224, v236
    v_mfma_f32_32x32x16_bf16 v[16:31], v[196:199], v[164:167], v[16:31]
    ds_read_b128 v[196:199], v229 offset:13312
    v_cvt_pk_bf16_f32 v174, v236, v237
    v_add_f32 v225, v225, v237
    v_add_f32 v224, v224, v238
    v_cvt_pk_bf16_f32 v175, v238, v239
    v_add_f32 v225, v225, v239
    v_mfma_f32_32x32x16_bf16 v[32:47], v[200:203], v[164:167], v[32:47]
    ds_read_b128 v[200:203], v229 offset:14336
    v_max3_f32 v246, v128, v129, v130
    v_max3_f32 v226, v131, v132, v133
    v_mfma_f32_32x32x16_bf16 v[48:63], v[204:207], v[164:167], v[48:63]
    ds_read_b128 v[204:207], v229 offset:15360
    s_add_u32 s55, s51, 3
    s_and_b32 s55, s55, 3
    s_lshl_b32 s55, s55, 14
    s_add_u32 s55, s55, 98304
    v_add_u32 v229, s55, v230
    v_max3_f32 v246, v246, v134, v135
    v_max3_f32 v226, v226, v136, v137
    s_waitcnt lgkmcnt(4)
    s_add_u32 s64, s51, 2
    s_cmp_lt_u32 s64, s18
    s_cbranch_scc1 K2S_U0_w8
    s_waitcnt vmcnt(0)
K2S_U0_w8:
    s_waitcnt vmcnt(8)
    s_barrier
    v_mfma_f32_32x32x16_bf16 v[0:15], v[176:179], v[168:171], v[0:15]
    ds_read_b128 v[176:179], v228 offset:0
    v_max3_f32 v246, v246, v138, v139
    v_max3_f32 v226, v226, v140, v141
    v_mfma_f32_32x32x16_bf16 v[16:31], v[180:183], v[168:171], v[16:31]
    ds_read_b128 v[180:183], v228 offset:1024
    v_max3_f32 v246, v246, v142, v143
    v_max3_f32 v226, v226, v144, v145
    v_mfma_f32_32x32x16_bf16 v[32:47], v[184:187], v[168:171], v[32:47]
    ds_read_b128 v[184:187], v228 offset:2048
    v_max3_f32 v246, v246, v146, v147
    v_max3_f32 v226, v226, v148, v149
    v_mfma_f32_32x32x16_bf16 v[48:63], v[188:191], v[168:171], v[48:63]
    ds_read_b128 v[188:191], v228 offset:3072
    v_max3_f32 v246, v246, v150, v151
    v_max3_f32 v226, v226, v152, v153
    s_waitcnt lgkmcnt(4)
    v_mfma_f32_32x32x16_bf16 v[0:15], v[192:195], v[172:175], v[0:15]
    ds_read_b128 v[192:195], v228 offset:4096
    s_cmp_eq_u32 s60, 0
    s_cbranch_scc1 K2S_U0_nl
    s_add_u32 s64, s51, 3
    s_cmp_ge_u32 s64, s18
    s_cbranch_scc1 K2S_U0_nl
    s_add_u32 s65, s64, 1
    s_and_b32 s66, s65, 3
    s_lshl_b32 s66, s66, 14
    s_add_u32 m0, s66, s45
    s_lshl_b32 s65, s65, 14
    s_add_u32 s65, s65, s46
    buffer_load_dwordx4 v230, s[28:31], s65 offen offset:0 lds
    buffer_load_dwordx4 v230, s[28:31], s65 offen offset:1024 lds
    buffer_load_dwordx4 v230, s[28:31], s65 offen offset:2048 lds
    buffer_load_dwordx4 v230, s[28:31], s65 offen offset:3072 lds
    s_add_u32 s66, s64, 2
    s_and_b32 s66, s66, 3
    s_lshl_b32 s66, s66, 14
    s_add_u32 s66, s66, s45
    s_add_u32 m0, s66, 98304
    s_sub_u32 s65, s65, 16384
    buffer_load_dwordx4 v230, s[32:35], s65 offen offset:0 lds
    buffer_load_dwordx4 v230, s[32:35], s65 offen offset:1024 lds
    buffer_load_dwordx4 v230, s[32:35], s65 offen offset:2048 lds
    buffer_load_dwordx4 v230, s[32:35], s65 offen offset:3072 lds
K2S_U0_nl:
    v_max3_f32 v246, v246, v154, v155
    v_max3_f32 v226, v226, v156, v157
    v_mfma_f32_32x32x16_bf16 v[16:31], v[196:199], v[172:175], v[16:31]
    ds_read_b128 v[196:199], v228 offset:5120
    v_max3_f32 v246, v246, v158, v159
    v_max_f32 v246, v246, v226
    v_mfma_f32_32x32x16_bf16 v[32:47], v[200:203], v[172:175], v[32:47]
    ds_read_b128 v[200:203], v228 offset:6144
    v_mov_b32 v226, v246
    s_nop 1
    v_mfma_f32_32x32x16_bf16 v[48:63], v[204:207], v[172:175], v[48:63]
    ds_read_b128 v[204:207], v228 offset:7168
    v_permlane32_swap_b32 v246, v226
    v_max_f32 v246, v246, v226
    v_cmp_lt_f32 vcc, s53, v246
    s_add_u32 s51, s51, 1
    s_cbranch_vccnz K2S_U0_RS
K2S_U0_RET:
    s_cmp_ge_u32 s51, s49
    s_cbranch_scc1 K2S_M1
K2S_U1:
    s_waitcnt lgkmcnt(4)
    v_mfma_f32_32x32x16_bf16 v[96:111], v[176:179], v[64:67], v[208:223]
    ds_read_b128 v[176:179], v228 offset:8192
    v_exp_f32 v232, v128
    v_exp_f32 v233, v129
    v_exp_f32 v234, v130
    v_mfma_f32_32x32x16_bf16 v[96:111], v[180:183], v[68:71], v[96:111]
    ds_read_b128 v[180:183], v228 offset:9216
    v_exp_f32 v235, v131
    v_add_f32 v224, v224, v232
    v_cvt_pk_bf16_f32 v160, v232, v233
    v_mfma_f32_32x32x16_bf16 v[96:111], v[184:187], v[72:75], v[96:111]
    ds_read_b128 v[184:187], v228 offset:10240
    v_add_f32 v225, v225, v233
    v_exp_f32 v236, v132
    v_exp_f32 v237, v133
    v_add_f32 v224, v224, v234
    v_mfma_f32_32x32x16_bf16 v[96:111], v[188:191], v[76:79], v[96:111]
    ds_read_b128 v[188:191], v228 offset:11264
    v_cvt_pk_bf16_f32 v161, v234, v235
    v_add_f32 v225, v225, v235
    v_exp_f32 v238, v134
    s_waitcnt lgkmcnt(4)
    v_mfma_f32_32x32x16_bf16 v[96:111], v[192:195], v[80:83], v[96:111]
    ds_read_b128 v[192:195], v228 offset:12288
    v_exp_f32 v239, v135
    v_add_f32 v224, v224, v236
    v_cvt_pk_bf16_f32 v162, v236, v237
    v_add_f32 v225, v225, v237
    v_add_f32 v224, v224, v238
    v_mfma_f32_32x32x16_bf16 v[96:111], v[196:199], v[84:87], v[96:111]
    ds_read_b128 v[196:199], v228 offset:13312
    v_cvt_pk_bf16_f32 v163, v238, v239
    v_add_f32 v225, v225, v239
    v_exp_f32 v232, v136
    v_exp_f32 v233, v137
    v_mfma_f32_32x32x16_bf16 v[96:111], v[200:203], v[88:91], v[96:111]
    ds_read_b128 v[200:203], v228 offset:14336
    v_exp_f32 v234, v138
    v_exp_f32 v235, v139
    v_add_f32 v224, v224, v232
    v_mfma_f32_32x32x16_bf16 v[96:111], v[204:207], v[92:95], v[96:111]
    ds_read_b128 v[204:207], v228 offset:15360
    v_cvt_pk_bf16_f32 v164, v232, v233
    v_add_f32 v225, v225, v233
    v_exp_f32 v236, v140
    s_waitcnt lgkmcnt(4)
    v_mfma_f32_32x32x16_bf16 v[112:127], v[176:179], v[64:67], v[208:223]
    ds_read_b128 v[176:179], v229 offset:0
    v_exp_f32 v237, v141
    v_add_f32 v224, v224, v234
    v_cvt_pk_bf16_f32 v165, v234, v235
    v_add_f32 v225, v225, v235
    v_exp_f32 v238, v142
    s_add_u32 s55, s51, 2
    s_and_b32 s55, s55, 3
    s_lshl_b32 s55, s55, 14
    v_add_u32 v228, s55, v230
    v_mfma_f32_32x32x16_bf16 v[112:127], v[180:183], v[68:71], v[112:127]
    ds_read_b128 v[180:183], v229 offset:1024
    v_exp_f32 v239, v143
    v_add_f32 v224, v224, v236
    v_cvt_pk_bf16_f32 v166, v236, v237
    v_mfma_f32_32x32x16_bf16 v[112:127], v[184:187], v[72:75], v[112:127]
    ds_read_b128 v[184:187], v229 offset:2048
    v_add_f32 v225, v225, v237
    v_add_f32 v224, v224, v238
    v_cvt_pk_bf16_f32 v167, v238, v239
    v_add_f32 v225, v225, v239
    v_exp_f32 v232, v144
    v_mfma_f32_32x32x16_bf16 v[112:127], v[188:191], v[76:79], v[112:127]
    ds_read_b128 v[188:191], v229 offset:3072
    v_exp_f32 v233, v145
    v_exp_f32 v234, v146
    s_waitcnt lgkmcnt(4)
    v_mfma_f32_32x32x16_bf16 v[112:127], v[192:195], v[80:83], v[112:127]
    ds_read_b128 v[192:195], v229 offset:4096
    v_exp_f32 v235, v147
    v_add_f32 v224, v224, v232
    v_cvt_pk_bf16_f32 v168, v232, v233
    v_add_f32 v225, v225, v233
    v_exp_f32 v236, v148
    v_mfma_f32_32x32x16_bf16 v[112:127], v[196:199], v[84:87], v[112:127]
    ds_read_b128 v[196:199], v229 offset:5120
    v_exp_f32 v237, v149
    v_add_f32 v224, v224, v234
    v_cvt_pk_bf16_f32 v169, v234, v235
    v_mfma_f32_32x32x16_bf16 v[112:127], v[200:203], v[88:91], v[112:127]
    ds_read_b128 v[200:203], v229 offset:6144
    v_add_f32 v225, v225, v235
    v_exp_f32 v238, v150
    v_exp_f32 v239, v151
    v_add_f32 v224, v224, v236
    v_mfma_f32_32x32x16_bf16 v[112:127], v[204:207], v[92:95], v[112:127]
    ds_read_b128 v[204:207], v229 offset:7168
    v_cvt_pk_bf16_f32 v170, v236, v237
    v_add_f32 v225, v225, v237
    v_add_f32 v224, v224, v238
    v_cvt_pk_bf16_f32 v171, v238, v239
    v_add_f32 v225, v225, v239
    s_waitcnt lgkmcnt(4)
    v_mfma_f32_32x32x16_bf16 v[0:15], v[176:179], v[160:163], v[0:15]
    ds_read_b128 v[176:179], v229 offset:8192
    v_exp_f32 v232, v152
    v_exp_f32 v233, v153
    v_mfma_f32_32x32x16_bf16 v[16:31], v[180:183], v[160:163], v[16:31]
    ds_read_b128 v[180:183], v229 offset:9216
    v_exp_f32 v234, v154
    v_exp_f32 v235, v155
    v_add_f32 v224, v224, v232
    v_mfma_f32_32x32x16_bf16 v[32:47], v[184:187], v[160:163], v[32:47]
    ds_read_b128 v[184:187], v229 offset:10240
    v_cvt_pk_bf16_f32 v172, v232, v233
    v_add_f32 v225, v225, v233
    v_exp_f32 v236, v156
    v_mfma_f32_32x32x16_bf16 v[48:63], v[188:191], v[160:163], v[48:63]
    ds_read_b128 v[188:191], v229 offset:11264
    v_exp_f32 v237, v157
    v_add_f32 v224, v224, v234
    v_cvt_pk_bf16_f32 v173, v234, v235
    v_add_f32 v225, v225, v235
    s_waitcnt lgkmcnt(4)
    v_mfma_f32_32x32x16_bf16 v[0:15], v[192:195], v[164:167], v[0:15]
    ds_read_b128 v[192:195], v229 offset:12288
    v_exp_f32 v238, v158
    v_exp_f32 v239, v159
    v_add_f32 v224, v224, v236
    v_mfma_f32_32x32x16_bf16 v[16:31], v[196:199], v[164:167], v[16:31]
    ds_read_b128 v[196:199], v229 offset:13312
    v_cvt_pk_bf16_f32 v174, v236, v237
    v_add_f32 v225, v225, v237
    v_add_f32 v224, v224, v238
    v_cvt_pk_bf16_f32 v175, v238, v239
    v_add_f32 v225, v225, v239
    v_mfma_f32_32x32x16_bf16 v[32:47], v[200:203], v[164:167], v[32:47]
    ds_read_b128 v[200:203], v229 offset:14336
    v_max3_f32 v246, v96, v97, v98
    v_max3_f32 v226, v99, v100, v101
    v_mfma_f32_32x32x16_bf16 v[48:63], v[204:207], v[164:167], v[48:63]
    ds_read_b128 v[204:207], v229 offset:15360
    s_add_u32 s55, s51, 3
    s_and_b32 s55, s55, 3
    s_lshl_b32 s55, s55, 14
    s_add_u32 s55, s55, 98304
    v_add_u32 v229, s55, v230
    v_max3_f32 v246, v246, v102, v103
    v_max3_f32 v226, v226, v104, v105
    s_waitcnt lgkmcnt(4)
    s_add_u32 s64, s51, 2
    s_cmp_lt_u32 s64, s18
    s_cbranch_scc1 K2S_U1_w8
    s_waitcnt vmcnt(0)
K2S_U1_w8:
    s_waitcnt vmcnt(8)
    s_barrier
    v_mfma_f32_32x32x16_bf16 v[0:15], v[176:179], v[168:171], v[0:15]
    ds_read_b128 v[176:179], v228 offset:0
    v_max3_f32 v246, v246, v106, v107
    v_max3_f32 v226, v226, v108, v109
    v_mfma_f32_32x32x16_bf16 v[16:31], v[180:183], v[168:171], v[16:31]
    ds_read_b128 v[180:183], v228 offset:1024
    v_max3_f32 v246, v246, v110, v111
    v_max3_f32 v226, v226, v112, v113
    v_mfma_f32_32x32x16_bf16 v[32:47], v[184:187], v[168:171], v[32:47]
    ds_read_b128 v[184:187], v228 offset:2048
    v_max3_f32 v246, v246, v114, v115
    v_max3_f32 v226, v226, v116, v117
    v_mfma_f32_32x32x16_bf16 v[48:63], v[188:191], v[168:171], v[48:63]
    ds_read_b128 v[188:191], v228 offset:3072
    v_max3_f32 v246, v246, v118, v119
    v_max3_f32 v226, v226, v120, v121
    s_waitcnt lgkmcnt(4)
    v_mfma_f32_32x32x16_bf16 v[0:15], v[192:195], v[172:175], v[0:15]
    ds_read_b128 v[192:195], v228 offset:4096
    s_cmp_eq_u32 s60, 0
    s_cbranch_scc1 K2S_U1_nl
    s_add_u32 s64, s51, 3
    s_cmp_ge_u32 s64, s18
    s_cbranch_scc1 K2S_U1_nl
    s_add_u32 s65, s64, 1
    s_and_b32 s66, s65, 3
    s_lshl_b32 s66, s66, 14
    s_add_u32 m0, s66, s45
    s_lshl_b32 s65, s65, 14
    s_add_u32 s65, s65, s46
    buffer_load_dwordx4 v230, s[28:31], s65 offen offset:0 lds
    buffer_load_dwordx4 v230, s[28:31], s65 offen offset:1024 lds
    buffer_load_dwordx4 v230, s[28:31], s65 offen offset:2048 lds
    buffer_load_dwordx4 v230, s[28:31], s65 offen offset:3072 lds
    s_add_u32 s66, s64, 2
    s_and_b32 s66, s66, 3
    s_lshl_b32 s66, s66, 14
    s_add_u32 s66, s66, s45
    s_add_u32 m0, s66, 98304
    s_sub_u32 s65, s65, 16384
    buffer_load_dwordx4 v230, s[32:35], s65 offen offset:0 lds
    buffer_load_dwordx4 v230, s[32:35], s65 offen offset:1024 lds
    buffer_load_dwordx4 v230, s[32:35], s65 offen offset:2048 lds
    buffer_load_dwordx4 v230, s[32:35], s65 offen offset:3072 lds
K2S_U1_nl:
    v_max3_f32 v246, v246, v122, v123
    v_max3_f32 v226, v226, v124, v125
    v_mfma_f32_32x32x16_bf16 v[16:31], v[196:199], v[172:175], v[16:31]
    ds_read_b128 v[196:199], v228 offset:5120
    v_max3_f32 v246, v246, v126, v127
    v_max_f32 v246, v246, v226
    v_mfma_f32_32x32x16_bf16 v[32:47], v[200:203], v[172:175], v[32:47]
    ds_read_b128 v[200:203], v228 offset:6144
    v_mov_b32 v226, v246
    s_nop 1
    v_mfma_f32_32x32x16_bf16 v[48:63], v[204:207], v[172:175], v[48:63]
    ds_read_b128 v[204:207], v228 offset:7168
    v_permlane32_swap_b32 v246, v226
    v_max_f32 v246, v246, v226
    v_cmp_lt_f32 vcc, s53, v246
    s_add_u32 s51, s51, 1
    s_cbranch_vccnz K2S_U1_RS
K2S_U1_RET:
    s_branch K2S_U0
K2S_M1:
    s_waitcnt lgkmcnt(4)
    v_mfma_f32_32x32x16_bf16 v[96:111], v[176:179], v[64:67], v[208:223]
    ds_read_b128 v[176:179], v228 offset:8192
    v_exp_f32 v232, v128
    v_exp_f32 v233, v129
    v_exp_f32 v234, v130
    v_mfma_f32_32x32x16_bf16 v[96:111], v[180:183], v[68:71], v[96:111]
    ds_read_b128 v[180:183], v228 offset:9216
    v_exp_f32 v235, v131
    v_add_f32 v224, v224, v232
    v_cvt_pk_bf16_f32 v160, v232, v233
    v_mfma_f32_32x32x16_bf16 v[96:111], v[184:187], v[72:75], v[96:111]
    ds_read_b128 v[184:187], v228 offset:10240
    v_add_f32 v225, v225, v233
    v_exp_f32 v236, v132
    v_exp_f32 v237, v133
    v_add_f32 v224, v224, v234
    v_mfma_f32_32x32x16_bf16 v[96:111], v[188:191], v[76:79], v[96:111]
    ds_read_b128 v[188:191], v228 offset:11264
    v_cvt_pk_bf16_f32 v161, v234, v235
    v_add_f32 v225, v225, v235
    v_exp_f32 v238, v134
    s_waitcnt lgkmcnt(4)
    v_mfma_f32_32x32x16_bf16 v[96:111], v[192:195], v[80:83], v[96:111]
    ds_read_b128 v[192:195], v228 offset:12288
    v_exp_f32 v239, v135
    v_add_f32 v224, v224, v236
    v_cvt_pk_bf16_f32 v162, v236, v237
    v_add_f32 v225, v225, v237
    v_add_f32 v224, v224, v238
    v_mfma_f32_32x32x16_bf16 v[96:111], v[196:199], v[84:87], v[96:111]
    ds_read_b128 v[196:199], v228 offset:13312
    v_cvt_pk_bf16_f32 v163, v238, v239
    v_add_f32 v225, v225, v239
    v_exp_f32 v232, v136
    v_exp_f32 v233, v137
    v_mfma_f32_32x32x16_bf16 v[96:111], v[200:203], v[88:91], v[96:111]
    ds_read_b128 v[200:203], v228 offset:14336
    v_exp_f32 v234, v138
    v_exp_f32 v235, v139
    v_add_f32 v224, v224, v232
    v_mfma_f32_32x32x16_bf16 v[96:111], v[204:207], v[92:95], v[96:111]
    ds_read_b128 v[204:207], v228 offset:15360
    v_cvt_pk_bf16_f32 v164, v232, v233
    v_add_f32 v225, v225, v233
    v_exp_f32 v236, v140
    s_waitcnt lgkmcnt(4)
    v_mfma_f32_32x32x16_bf16 v[112:127], v[176:179], v[64:67], v[208:223]
    ds_read_b128 v[176:179], v229 offset:0
    v_exp_f32 v237, v141
    v_add_f32 v224, v224, v234
    v_cvt_pk_bf16_f32 v165, v234, v235
    v_add_f32 v225, v225, v235
    v_exp_f32 v238, v142
    s_add_u32 s55, s51, 2
    s_and_b32 s55, s55, 3
    s_lshl_b32 s55, s55, 14
    v_add_u32 v228, s55, v230
    v_mfma_f32_32x32x16_bf16 v[112:127], v[180:183], v[68:71], v[112:127]
    ds_read_b128 v[180:183], v229 offset:1024
    v_exp_f32 v239, v143
    v_add_f32 v224, v224, v236
    v_cvt_pk_bf16_f32 v166, v236, v237
    v_mfma_f32_32x32x16_bf16 v[112:127], v[184:187], v[72:75], v[112:127]
    ds_read_b128 v[184:187], v229 offset:2048
    v_add_f32 v225, v225, v237
    v_add_f32 v224, v224, v238
    v_cvt_pk_bf16_f32 v167, v238, v239
    v_add_f32 v225, v225, v239
    v_exp_f32 v232, v144
    v_mfma_f32_32x32x16_bf16 v[112:127], v[188:191], v[76:79], v[112:127]
    ds_read_b128 v[188:191], v229 offset:3072
    v_exp_f32 v233, v145
    v_exp_f32 v234, v146
    s_waitcnt lgkmcnt(4)
    v_mfma_f32_32x32x16_bf16 v[112:127], v[192:195], v[80:83], v[112:127]
    ds_read_b128 v[192:195], v229 offset:4096
    v_exp_f32 v235, v147
    v_add_f32 v224, v224, v232
    v_cvt_pk_bf16_f32 v168, v232, v233
    v_add_f32 v225, v225, v233
    v_exp_f32 v236, v148
    v_mfma_f32_32x32x16_bf16 v[112:127], v[196:199], v[84:87], v[112:127]
    ds_read_b128 v[196:199], v229 offset:5120
    v_exp_f32 v237, v149
    v_add_f32 v224, v224, v234
    v_cvt_pk_bf16_f32 v169, v234, v235
    v_mfma_f32_32x32x16_bf16 v[112:127], v[200:203], v[88:91], v[112:127]
    ds_read_b128 v[200:203], v229 offset:6144
    v_add_f32 v225, v225, v235
    v_exp_f32 v238, v150
    v_exp_f32 v239, v151
    v_add_f32 v224, v224, v236
    v_mfma_f32_32x32x16_bf16 v[112:127], v[204:207], v[92:95], v[112:127]
    ds_read_b128 v[204:207], v229 offset:7168
    v_cvt_pk_bf16_f32 v170, v236, v237
    v_add_f32 v225, v225, v237
    v_add_f32 v224, v224, v238
    v_cvt_pk_bf16_f32 v171, v238, v239
    v_add_f32 v225, v225, v239
    s_waitcnt lgkmcnt(4)
    v_mfma_f32_32x32x16_bf16 v[0:15], v[176:179], v[160:163], v[0:15]
    ds_read_b128 v[176:179], v229 offset:8192
    v_exp_f32 v232, v152
    v_exp_f32 v233, v153
    v_mfma_f32_32x32x16_bf16 v[16:31], v[180:183], v[160:163], v[16:31]
    ds_read_b128 v[180:183], v229 offset:9216
    v_exp_f32 v234, v154
    v_exp_f32 v235, v155
    v_add_f32 v224, v224, v232
    v_mfma_f32_32x32x16_bf16 v[32:47], v[184:187], v[160:163], v[32:47]
    ds_read_b128 v[184:187], v229 offset:10240
    v_cvt_pk_bf16_f32 v172, v232, v233
    v_add_f32 v225, v225, v233
    v_exp_f32 v236, v156
    v_mfma_f32_32x32x16_bf16 v[48:63], v[188:191], v[160:163], v[48:63]
    ds_read_b128 v[188:191], v229 offset:11264
    v_exp_f32 v237, v157
    v_add_f32 v224, v224, v234
    v_cvt_pk_bf16_f32 v173, v234, v235
    v_add_f32 v225, v225, v235
    s_waitcnt lgkmcnt(4)
    v_mfma_f32_32x32x16_bf16 v[0:15], v[192:195], v[164:167], v[0:15]
    ds_read_b128 v[192:195], v229 offset:12288
    v_exp_f32 v238, v158
    v_exp_f32 v239, v159
    v_add_f32 v224, v224, v236
    v_mfma_f32_32x32x16_bf16 v[16:31], v[196:199], v[164:167], v[16:31]
    ds_read_b128 v[196:199], v229 offset:13312
    v_cvt_pk_bf16_f32 v174, v236, v237
    v_add_f32 v225, v225, v237
    v_add_f32 v224, v224, v238
    v_cvt_pk_bf16_f32 v175, v238, v239
    v_add_f32 v225, v225, v239
    v_mfma_f32_32x32x16_bf16 v[32:47], v[200:203], v[164:167], v[32:47]
    ds_read_b128 v[200:203], v229 offset:14336
    s_add_u32 s54, s51, 1
    s_lshl_b32 s67, s54, 6
    v_subrev_u32 v227, s67, v231
    v_mov_b32 v226, s52
    v_cmp_le_i32 s[56:57], 0, v227
    v_cmp_le_i32 s[58:59], 1, v227
    v_cmp_le_i32 s[92:93], 2, v227
    v_cmp_le_i32 s[94:95], 3, v227
    v_cndmask_b32 v96, v226, v96, s[56:57]
    v_mfma_f32_32x32x16_bf16 v[48:63], v[204:207], v[164:167], v[48:63]
    ds_read_b128 v[204:207], v229 offset:15360
    s_add_u32 s55, s51, 3
    s_and_b32 s55, s55, 3
    s_lshl_b32 s55, s55, 14
    s_add_u32 s55, s55, 98304
    v_add_u32 v229, s55, v230
    v_cndmask_b32 v97, v226, v97, s[58:59]
    v_cndmask_b32 v98, v226, v98, s[92:93]
    v_cndmask_b32 v99, v226, v99, s[94:95]
    v_cmp_le_i32 s[56:57], 8, v227
    v_cmp_le_i32 s[58:59], 9, v227
    v_cmp_le_i32 s[92:93], 10, v227
    v_cmp_le_i32 s[94:95], 11, v227
    v_cndmask_b32 v100, v226, v100, s[56:57]
    v_cndmask_b32 v101, v226, v101, s[58:59]
    s_waitcnt lgkmcnt(4)
    s_add_u32 s64, s51, 2
    s_cmp_lt_u32 s64, s18
    s_cbranch_scc1 K2S_M1_w8
    s_waitcnt vmcnt(0)
K2S_M1_w8:
    s_waitcnt vmcnt(8)
    s_barrier
    v_mfma_f32_32x32x16_bf16 v[0:15], v[176:179], v[168:171], v[0:15]
    ds_read_b128 v[176:179], v228 offset:0
    v_cndmask_b32 v102, v226, v102, s[92:93]
    v_cndmask_b32 v103, v226, v103, s[94:95]
    v_cmp_le_i32 s[56:57], 16, v227
    v_cmp_le_i32 s[58:59], 17, v227
    v_cmp_le_i32 s[92:93], 18, v227
    v_cmp_le_i32 s[94:95], 19, v227
    v_cndmask_b32 v104, v226, v104, s[56:57]
    v_cndmask_b32 v105, v226, v105, s[58:59]
    v_mfma_f32_32x32x16_bf16 v[16:31], v[180:183], v[168:171], v[16:31]
    ds_read_b128 v[180:183], v228 offset:1024
    v_cndmask_b32 v106, v226, v106, s[92:93]
    v_cndmask_b32 v107, v226, v107, s[94:95]
    v_cmp_le_i32 s[56:57], 24, v227
    v_cmp_le_i32 s[58:59], 25, v227
    v_cmp_le_i32 s[92:93], 26, v227
    v_cmp_le_i32 s[94:95], 27, v227
    v_cndmask_b32 v108, v226, v108, s[56:57]
    v_cndmask_b32 v109, v226, v109, s[58:59]
    v_cndmask_b32 v110, v226, v110, s[92:93]
    v_mfma_f32_32x32x16_bf16 v[32:47], v[184:187], v[168:171], v[32:47]
    ds_read_b128 v[184:187], v228 offset:2048
    v_cndmask_b32 v111, v226, v111, s[94:95]
    v_cmp_le_i32 s[56:57], 32, v227
    v_cmp_le_i32 s[58:59], 33, v227
    v_cmp_le_i32 s[92:93], 34, v227
    v_cmp_le_i32 s[94:95], 35, v227
    v_cndmask_b32 v112, v226, v112, s[56:57]
    v_cndmask_b32 v113, v226, v113, s[58:59]
    v_cndmask_b32 v114, v226, v114, s[92:93]
    v_cndmask_b32 v115, v226, v115, s[94:95]
    v_mfma_f32_32x32x16_bf16 v[48:63], v[188:191], v[168:171], v[48:63]
    ds_read_b128 v[188:191], v228 offset:3072
    v_cmp_le_i32 s[56:57], 40, v227
    v_cmp_le_i32 s[58:59], 41, v227
    v_cmp_le_i32 s[92:93], 42, v227
    v_cmp_le_i32 s[94:95], 43, v227
    v_cndmask_b32 v116, v226, v116, s[56:57]
    v_cndmask_b32 v117, v226, v117, s[58:59]
    v_cndmask_b32 v118, v226, v118, s[92:93]
    v_cndmask_b32 v119, v226, v119, s[94:95]
    v_cmp_le_i32 s[56:57], 48, v227
    s_waitcnt lgkmcnt(4)
    v_mfma_f32_32x32x16_bf16 v[0:15], v[192:195], v[172:175], v[0:15]
    ds_read_b128 v[192:195], v228 offset:4096
    s_cmp_eq_u32 s60, 0
    s_cbranch_scc1 K2S_M1_nl
    s_add_u32 s64, s51, 3
    s_cmp_ge_u32 s64, s18
    s_cbranch_scc1 K2S_M1_nl
    s_add_u32 s65, s64, 1
    s_and_b32 s66, s65, 3
    s_lshl_b32 s66, s66, 14
    s_add_u32 m0, s66, s45
    s_lshl_b32 s65, s65, 14
    s_add_u32 s65, s65, s46
    buffer_load_dwordx4 v230, s[28:31], s65 offen offset:0 lds
    buffer_load_dwordx4 v230, s[28:31], s65 offen offset:1024 lds
    buffer_load_dwordx4 v230, s[28:31], s65 offen offset:2048 lds
    buffer_load_dwordx4 v230, s[28:31], s65 offen offset:3072 lds
    s_add_u32 s66, s64, 2
    s_and_b32 s66, s66, 3
    s_lshl_b32 s66, s66, 14
    s_add_u32 s66, s66, s45
    s_add_u32 m0, s66, 98304
    s_sub_u32 s65, s65, 16384
    buffer_load_dwordx4 v230, s[32:35], s65 offen offset:0 lds
    buffer_load_dwordx4 v230, s[32:35], s65 offen offset:1024 lds
    buffer_load_dwordx4 v230, s[32:35], s65 offen offset:2048 lds
    buffer_load_dwordx4 v230, s[32:35], s65 offen offset:3072 lds
K2S_M1_nl:
    v_cmp_le_i32 s[58:59], 49, v227
    v_cmp_le_i32 s[92:93], 50, v227
    v_cmp_le_i32 s[94:95], 51, v227
    v_cndmask_b32 v120, v226, v120, s[56:57]
    v_cndmask_b32 v121, v226, v121, s[58:59]
    v_cndmask_b32 v122, v226, v122, s[92:93]
    v_cndmask_b32 v123, v226, v123, s[94:95]
    v_cmp_le_i32 s[56:57], 56, v227
    v_cmp_le_i32 s[58:59], 57, v227
    v_mfma_f32_32x32x16_bf16 v[16:31], v[196:199], v[172:175], v[16:31]
    ds_read_b128 v[196:199], v228 offset:5120
    v_cmp_le_i32 s[92:93], 58, v227
    v_cmp_le_i32 s[94:95], 59, v227
    v_cndmask_b32 v124, v226, v124, s[56:57]
    v_cndmask_b32 v125, v226, v125, s[58:59]
    v_cndmask_b32 v126, v226, v126, s[92:93]
    v_cndmask_b32 v127, v226, v127, s[94:95]
    v_max3_f32 v246, v96, v97, v98
    v_max3_f32 v226, v99, v100, v101
    v_mfma_f32_32x32x16_bf16 v[32:47], v[200:203], v[172:175], v[32:47]
    ds_read_b128 v[200:203], v228 offset:6144
    v_max3_f32 v246, v246, v102, v103
    v_max3_f32 v226, v226, v104, v105
    v_max3_f32 v246, v246, v106, v107
    v_max3_f32 v226, v226, v108, v109
    v_max3_f32 v246, v246, v110, v111
    v_max3_f32 v226, v226, v112, v113
    v_max3_f32 v246, v246, v114, v115
    v_max3_f32 v226, v226, v116, v117
    v_max3_f32 v246, v246, v118, v119
    v_mfma_f32_32x32x16_bf16 v[48:63], v[204:207], v[172:175], v[48:63]
    ds_read_b128 v[204:207], v228 offset:7168
    v_max3_f32 v226, v226, v120, v121
    v_max3_f32 v246, v246, v122, v123
    v_max3_f32 v226, v226, v124, v125
    v_max3_f32 v246, v246, v126, v127
    v_max_f32 v246, v246, v226
    v_mov_b32 v226, v246
    s_nop 1
    v_permlane32_swap_b32 v246, v226
    v_max_f32 v246, v246, v226
    v_cmp_lt_f32 vcc, s53, v246
    s_add_u32 s51, s51, 1
    s_cbranch_vccnz K2S_M1_RS
K2S_M1_RET:
K2S_M0:
    s_waitcnt lgkmcnt(4)
    v_mfma_f32_32x32x16_bf16 v[128:143], v[176:179], v[64:67], v[208:223]
    ds_read_b128 v[176:179], v228 offset:8192
    v_exp_f32 v232, v96
    v_exp_f32 v233, v97
    v_exp_f32 v234, v98
    v_mfma_f32_32x32x16_bf16 v[128:143], v[180:183], v[68:71], v[128:143]
    ds_read_b128 v[180:183], v228 offset:9216
    v_exp_f32 v235, v99
    v_add_f32 v224, v224, v232
    v_cvt_pk_bf16_f32 v160, v232, v233
    v_mfma_f32_32x32x16_bf16 v[128:143], v[184:187], v[72:75], v[128:143]
    ds_read_b128 v[184:187], v228 offset:10240
    v_add_f32 v225, v225, v233
    v_exp_f32 v236, v100
    v_exp_f32 v237, v101
    v_add_f32 v224, v224, v234
    v_mfma_f32_32x32x16_bf16 v[128:143], v[188:191], v[76:79], v[128:143]
    ds_read_b128 v[188:191], v228 offset:11264
    v_cvt_pk_bf16_f32 v161, v234, v235
    v_add_f32 v225, v225, v235
    v_exp_f32 v238, v102
    s_waitcnt lgkmcnt(4)
    v_mfma_f32_32x32x16_bf16 v[128:143], v[192:195], v[80:83], v[128:143]
    ds_read_b128 v[192:195], v228 offset:12288
    v_exp_f32 v239, v103
    v_add_f32 v224, v224, v236
    v_cvt_pk_bf16_f32 v162, v236, v237
    v_add_f32 v225, v225, v237
    v_add_f32 v224, v224, v238
    v_mfma_f32_32x32x16_bf16 v[128:143], v[196:199], v[84:87], v[128:143]
    ds_read_b128 v[196:199], v228 offset:13312
    v_cvt_pk_bf16_f32 v163, v238, v239
    v_add_f32 v225, v225, v239
    v_exp_f32 v232, v104
    v_exp_f32 v233, v105
    v_mfma_f32_32x32x16_bf16 v[128:143], v[200:203], v[88:91], v[128:143]
    ds_read_b128 v[200:203], v228 offset:14336
    v_exp_f32 v234, v106
    v_exp_f32 v235, v107
    v_add_f32 v224, v224, v232
    v_mfma_f32_32x32x16_bf16 v[128:143], v[204:207], v[92:95], v[128:143]
    ds_read_b128 v[204:207], v228 offset:15360
    v_cvt_pk_bf16_f32 v164, v232, v233
    v_add_f32 v225, v225, v233
    v_exp_f32 v236, v108
    s_waitcnt lgkmcnt(4)
    v_mfma_f32_32x32x16_bf16 v[144:159], v[176:179], v[64:67], v[208:223]
    ds_read_b128 v[176:179], v229 offset:0
    v_exp_f32 v237, v109
    v_add_f32 v224, v224, v234
    v_cvt_pk_bf16_f32 v165, v234, v235
    v_add_f32 v225, v225, v235
    v_exp_f32 v238, v110
    s_add_u32 s55, s51, 2
    s_and_b32 s55, s55, 3
    s_lshl_b32 s55, s55, 14
    v_add_u32 v228, s55, v230
    v_mfma_f32_32x32x16_bf16 v[144:159], v[180:183], v[68:71], v[144:159]
    ds_read_b128 v[180:183], v229 offset:1024
    v_exp_f32 v239, v111
    v_add_f32 v224, v224, v236
    v_cvt_pk_bf16_f32 v166, v236, v237
    v_mfma_f32_32x32x16_bf16 v[144:159], v[184:187], v[72:75], v[144:159]
    ds_read_b128 v[184:187], v229 offset:2048
    v_add_f32 v225, v225, v237
    v_add_f32 v224, v224, v238
    v_cvt_pk_bf16_f32 v167, v238, v239
    v_add_f32 v225, v225, v239
    v_exp_f32 v232, v112
    v_mfma_f32_32x32x16_bf16 v[144:159], v[188:191], v[76:79], v[144:159]
    ds_read_b128 v[188:191], v229 offset:3072
    v_exp_f32 v233, v113
    v_exp_f32 v234, v114
    s_waitcnt lgkmcnt(4)
    v_mfma_f32_32x32x16_bf16 v[144:159], v[192:195], v[80:83], v[144:159]
    ds_read_b128 v[192:195], v229 offset:4096
    v_exp_f32 v235, v115
    v_add_f32 v224, v224, v232
    v_cvt_pk_bf16_f32 v168, v232, v233
    v_add_f32 v225, v225, v233
    v_exp_f32 v236, v116
    v_mfma_f32_32x32x16_bf16 v[144:159], v[196:199], v[84:87], v[144:159]
    ds_read_b128 v[196:199], v229 offset:5120
    v_exp_f32 v237, v117
    v_add_f32 v224, v224, v234
    v_cvt_pk_bf16_f32 v169, v234, v235
    v_mfma_f32_32x32x16_bf16 v[144:159], v[200:203], v[88:91], v[144:159]
    ds_read_b128 v[200:203], v229 offset:6144
    v_add_f32 v225, v225, v235
    v_exp_f32 v238, v118
    v_exp_f32 v239, v119
    v_add_f32 v224, v224, v236
    v_mfma_f32_32x32x16_bf16 v[144:159], v[204:207], v[92:95], v[144:159]
    ds_read_b128 v[204:207], v229 offset:7168
    v_cvt_pk_bf16_f32 v170, v236, v237
    v_add_f32 v225, v225, v237
    v_add_f32 v224, v224, v238
    v_cvt_pk_bf16_f32 v171, v238, v239
    v_add_f32 v225, v225, v239
    s_waitcnt lgkmcnt(4)
    v_mfma_f32_32x32x16_bf16 v[0:15], v[176:179], v[160:163], v[0:15]
    ds_read_b128 v[176:179], v229 offset:8192
    v_exp_f32 v232, v120
    v_exp_f32 v233, v121
    v_mfma_f32_32x32x16_bf16 v[16:31], v[180:183], v[160:163], v[16:31]
    ds_read_b128 v[180:183], v229 offset:9216
    v_exp_f32 v234, v122
    v_exp_f32 v235, v123
    v_add_f32 v224, v224, v232
    v_mfma_f32_32x32x16_bf16 v[32:47], v[184:187], v[160:163], v[32:47]
    ds_read_b128 v[184:187], v229 offset:10240
    v_cvt_pk_bf16_f32 v172, v232, v233
    v_add_f32 v225, v225, v233
    v_exp_f32 v236, v124
    v_mfma_f32_32x32x16_bf16 v[48:63], v[188:191], v[160:163], v[48:63]
    ds_read_b128 v[188:191], v229 offset:11264
    v_exp_f32 v237, v125
    v_add_f32 v224, v224, v234
    v_cvt_pk_bf16_f32 v173, v234, v235
    v_add_f32 v225, v225, v235
    s_waitcnt lgkmcnt(4)
    v_mfma_f32_32x32x16_bf16 v[0:15], v[192:195], v[164:167], v[0:15]
    ds_read_b128 v[192:195], v229 offset:12288
    v_exp_f32 v238, v126
    v_exp_f32 v239, v127
    v_add_f32 v224, v224, v236
    v_mfma_f32_32x32x16_bf16 v[16:31], v[196:199], v[164:167], v[16:31]
    ds_read_b128 v[196:199], v229 offset:13312
    v_cvt_pk_bf16_f32 v174, v236, v237
    v_add_f32 v225, v225, v237
    v_add_f32 v224, v224, v238
    v_cvt_pk_bf16_f32 v175, v238, v239
    v_add_f32 v225, v225, v239
    v_mfma_f32_32x32x16_bf16 v[32:47], v[200:203], v[164:167], v[32:47]
    ds_read_b128 v[200:203], v229 offset:14336
    s_add_u32 s54, s51, 1
    s_lshl_b32 s67, s54, 6
    v_subrev_u32 v227, s67, v231
    v_mov_b32 v226, s52
    v_cmp_le_i32 s[56:57], 0, v227
    v_cmp_le_i32 s[58:59], 1, v227
    v_cmp_le_i32 s[92:93], 2, v227
    v_cmp_le_i32 s[94:95], 3, v227
    v_cndmask_b32 v128, v226, v128, s[56:57]
    v_mfma_f32_32x32x16_bf16 v[48:63], v[204:207], v[164:167], v[48:63]
    ds_read_b128 v[204:207], v229 offset:15360
    s_add_u32 s55, s51, 3
    s_and_b32 s55, s55, 3
    s_lshl_b32 s55, s55, 14
    s_add_u32 s55, s55, 98304
    v_add_u32 v229, s55, v230
    v_cndmask_b32 v129, v226, v129, s[58:59]
    v_cndmask_b32 v130, v226, v130, s[92:93]
    v_cndmask_b32 v131, v226, v131, s[94:95]
    v_cmp_le_i32 s[56:57], 8, v227
    v_cmp_le_i32 s[58:59], 9, v227
    v_cmp_le_i32 s[92:93], 10, v227
    v_cmp_le_i32 s[94:95], 11, v227
    v_cndmask_b32 v132, v226, v132, s[56:57]
    v_cndmask_b32 v133, v226, v133, s[58:59]
    s_waitcnt lgkmcnt(4)
    s_add_u32 s64, s51, 2
    s_cmp_lt_u32 s64, s18
    s_cbranch_scc1 K2S_M0_w8
    s_waitcnt vmcnt(0)
K2S_M0_w8:
    s_waitcnt vmcnt(8)
    s_barrier
    v_mfma_f32_32x32x16_bf16 v[0:15], v[176:179], v[168:171], v[0:15]
    ds_read_b128 v[176:179], v229 offset:0
    v_cndmask_b32 v134, v226, v134, s[92:93]
    v_cndmask_b32 v135, v226, v135, s[94:95]
    v_cmp_le_i32 s[56:57], 16, v227
    v_cmp_le_i32 s[58:59], 17, v227
    v_cmp_le_i32 s[92:93], 18, v227
    v_cmp_le_i32 s[94:95], 19, v227
    v_cndmask_b32 v136, v226, v136, s[56:57]
    v_cndmask_b32 v137, v226, v137, s[58:59]
    v_mfma_f32_32x32x16_bf16 v[16:31], v[180:183], v[168:171], v[16:31]
    ds_read_b128 v[180:183], v229 offset:1024
    v_cndmask_b32 v138, v226, v138, s[92:93]
    v_cndmask_b32 v139, v226, v139, s[94:95]
    v_cmp_le_i32 s[56:57], 24, v227
    v_cmp_le_i32 s[58:59], 25, v227
    v_cmp_le_i32 s[92:93], 26, v227
    v_cmp_le_i32 s[94:95], 27, v227
    v_cndmask_b32 v140, v226, v140, s[56:57]
    v_cndmask_b32 v141, v226, v141, s[58:59]
    v_cndmask_b32 v142, v226, v142, s[92:93]
    v_mfma_f32_32x32x16_bf16 v[32:47], v[184:187], v[168:171], v[32:47]
    ds_read_b128 v[184:187], v229 offset:2048
    v_cndmask_b32 v143, v226, v143, s[94:95]
    v_cmp_le_i32 s[56:57], 32, v227
    v_cmp_le_i32 s[58:59], 33, v227
    v_cmp_le_i32 s[92:93], 34, v227
    v_cmp_le_i32 s[94:95], 35, v227
    v_cndmask_b32 v144, v226, v144, s[56:57]
    v_cndmask_b32 v145, v226, v145, s[58:59]
    v_cndmask_b32 v146, v226, v146, s[92:93]
    v_cndmask_b32 v147, v226, v147, s[94:95]
    v_mfma_f32_32x32x16_bf16 v[48:63], v[188:191], v[168:171], v[48:63]
    ds_read_b128 v[188:191], v229 offset:3072
    v_cmp_le_i32 s[56:57], 40, v227
    v_cmp_le_i32 s[58:59], 41, v227
    v_cmp_le_i32 s[92:93], 42, v227
    v_cmp_le_i32 s[94:95], 43, v227
    v_cndmask_b32 v148, v226, v148, s[56:57]
    v_cndmask_b32 v149, v226, v149, s[58:59]
    v_cndmask_b32 v150, v226, v150, s[92:93]
    v_cndmask_b32 v151, v226, v151, s[94:95]
    v_cmp_le_i32 s[56:57], 48, v227
    s_waitcnt lgkmcnt(4)
    v_mfma_f32_32x32x16_bf16 v[0:15], v[192:195], v[172:175], v[0:15]
    ds_read_b128 v[192:195], v229 offset:4096
    s_cmp_eq_u32 s60, 0
    s_cbranch_scc1 K2S_M0_nl
    s_add_u32 s64, s51, 3
    s_cmp_ge_u32 s64, s18
    s_cbranch_scc1 K2S_M0_nl
    s_add_u32 s65, s64, 1
    s_and_b32 s66, s65, 3
    s_lshl_b32 s66, s66, 14
    s_add_u32 m0, s66, s45
    s_lshl_b32 s65, s65, 14
    s_add_u32 s65, s65, s46
    buffer_load_dwordx4 v230, s[28:31], s65 offen offset:0 lds
    buffer_load_dwordx4 v230, s[28:31], s65 offen offset:1024 lds
    buffer_load_dwordx4 v230, s[28:31], s65 offen offset:2048 lds
    buffer_load_dwordx4 v230, s[28:31], s65 offen offset:3072 lds
    s_add_u32 s66, s64, 2
    s_and_b32 s66, s66, 3
    s_lshl_b32 s66, s66, 14
    s_add_u32 s66, s66, s45
    s_add_u32 m0, s66, 98304
    s_sub_u32 s65, s65, 16384
    buffer_load_dwordx4 v230, s[32:35], s65 offen offset:0 lds
    buffer_load_dwordx4 v230, s[32:35], s65 offen offset:1024 lds
    buffer_load_dwordx4 v230, s[32:35], s65 offen offset:2048 lds
    buffer_load_dwordx4 v230, s[32:35], s65 offen offset:3072 lds
K2S_M0_nl:
    v_cmp_le_i32 s[58:59], 49, v227
    v_cmp_le_i32 s[92:93], 50, v227
    v_cmp_le_i32 s[94:95], 51, v227
    v_cndmask_b32 v152, v226, v152, s[56:57]
    v_cndmask_b32 v153, v226, v153, s[58:59]
    v_cndmask_b32 v154, v226, v154, s[92:93]
    v_cndmask_b32 v155, v226, v155, s[94:95]
    v_cmp_le_i32 s[56:57], 56, v227
    v_cmp_le_i32 s[58:59], 57, v227
    v_mfma_f32_32x32x16_bf16 v[16:31], v[196:199], v[172:175], v[16:31]
    ds_read_b128 v[196:199], v229 offset:5120
    v_cmp_le_i32 s[92:93], 58, v227
    v_cmp_le_i32 s[94:95], 59, v227
    v_cndmask_b32 v156, v226, v156, s[56:57]
    v_cndmask_b32 v157, v226, v157, s[58:59]
    v_cndmask_b32 v158, v226, v158, s[92:93]
    v_cndmask_b32 v159, v226, v159, s[94:95]
    v_max3_f32 v246, v128, v129, v130
    v_max3_f32 v226, v131, v132, v133
    v_mfma_f32_32x32x16_bf16 v[32:47], v[200:203], v[172:175], v[32:47]
    ds_read_b128 v[200:203], v229 offset:6144
    v_max3_f32 v246, v246, v134, v135
    v_max3_f32 v226, v226, v136, v137
    v_max3_f32 v246, v246, v138, v139
    v_max3_f32 v226, v226, v140, v141
    v_max3_f32 v246, v246, v142, v143
    v_max3_f32 v226, v226, v144, v145
    v_max3_f32 v246, v246, v146, v147
    v_max3_f32 v226, v226, v148, v149
    v_max3_f32 v246, v246, v150, v151
    v_mfma_f32_32x32x16_bf16 v[48:63], v[204:207], v[172:175], v[48:63]
    ds_read_b128 v[204:207], v229 offset:7168
    v_max3_f32 v226, v226, v152, v153
    v_max3_f32 v246, v246, v154, v155
    v_max3_f32 v226, v226, v156, v157
    v_max3_f32 v246, v246, v158, v159
    v_max_f32 v246, v246, v226
    v_mov_b32 v226, v246
    s_nop 1
    v_permlane32_swap_b32 v246, v226
    v_max_f32 v246, v246, v226
    v_cmp_lt_f32 vcc, s53, v246
    s_add_u32 s51, s51, 1
    s_cbranch_vccnz K2S_M0_RS
K2S_M0_RET:
K2S_L1:
    v_exp_f32 v232, v128
    v_exp_f32 v233, v129
    v_exp_f32 v234, v130
    v_exp_f32 v235, v131
    v_add_f32 v224, v224, v232
    v_cvt_pk_bf16_f32 v160, v232, v233
    v_add_f32 v225, v225, v233
    v_exp_f32 v236, v132
    v_exp_f32 v237, v133
    v_add_f32 v224, v224, v234
    v_cvt_pk_bf16_f32 v161, v234, v235
    v_add_f32 v225, v225, v235
    v_exp_f32 v238, v134
    v_exp_f32 v239, v135
    v_add_f32 v224, v224, v236
    v_cvt_pk_bf16_f32 v162, v236, v237
    v_add_f32 v225, v225, v237
    v_add_f32 v224, v224, v238
    v_cvt_pk_bf16_f32 v163, v238, v239
    v_add_f32 v225, v225, v239
    s_nop 0
    s_waitcnt lgkmcnt(6)
    v_mfma_f32_32x32x16_bf16 v[0:15], v[176:179], v[160:163], v[0:15]
    ds_read_b128 v[176:179], v229 offset:8192
    v_exp_f32 v232, v136
    v_exp_f32 v233, v137
    v_exp_f32 v234, v138
    v_exp_f32 v235, v139
    v_add_f32 v224, v224, v232
    v_mfma_f32_32x32x16_bf16 v[16:31], v[180:183], v[160:163], v[16:31]
    ds_read_b128 v[180:183], v229 offset:9216
    v_cvt_pk_bf16_f32 v164, v232, v233
    v_add_f32 v225, v225, v233
    v_exp_f32 v236, v140
    v_exp_f32 v237, v141
    v_add_f32 v224, v224, v234
    s_waitcnt lgkmcnt(6)
    v_mfma_f32_32x32x16_bf16 v[32:47], v[184:187], v[160:163], v[32:47]
    ds_read_b128 v[184:187], v229 offset:10240
    v_cvt_pk_bf16_f32 v165, v234, v235
    v_add_f32 v225, v225, v235
    v_exp_f32 v238, v142
    v_exp_f32 v239, v143
    v_add_f32 v224, v224, v236
    v_mfma_f32_32x32x16_bf16 v[48:63], v[188:191], v[160:163], v[48:63]
    ds_read_b128 v[188:191], v229 offset:11264
    v_cvt_pk_bf16_f32 v166, v236, v237
    v_add_f32 v225, v225, v237
    v_add_f32 v224, v224, v238
    v_cvt_pk_bf16_f32 v167, v238, v239
    v_add_f32 v225, v225, v239
    s_nop 1
    s_waitcnt lgkmcnt(6)
    v_mfma_f32_32x32x16_bf16 v[0:15], v[192:195], v[164:167], v[0:15]
    ds_read_b128 v[192:195], v229 offset:12288
    v_exp_f32 v232, v144
    v_exp_f32 v233, v145
    v_exp_f32 v234, v146
    v_exp_f32 v235, v147
    v_add_f32 v224, v224, v232
    v_mfma_f32_32x32x16_bf16 v[16:31], v[196:199], v[164:167], v[16:31]
    ds_read_b128 v[196:199], v229 offset:13312
    v_cvt_pk_bf16_f32 v168, v232, v233
    v_add_f32 v225, v225, v233
    v_exp_f32 v236, v148
    v_exp_f32 v237, v149
    v_add_f32 v224, v224, v234
    s_waitcnt lgkmcnt(6)
    v_mfma_f32_32x32x16_bf16 v[32:47], v[200:203], v[164:167], v[32:47]
    ds_read_b128 v[200:203], v229 offset:14336
    v_cvt_pk_bf16_f32 v169, v234, v235
    v_add_f32 v225, v225, v235
    v_exp_f32 v238, v150
    v_exp_f32 v239, v151
    v_add_f32 v224, v224, v236
    v_mfma_f32_32x32x16_bf16 v[48:63], v[204:207], v[164:167], v[48:63]
    ds_read_b128 v[204:207], v229 offset:15360
    v_cvt_pk_bf16_f32 v170, v236, v237
    v_add_f32 v225, v225, v237
    v_add_f32 v224, v224, v238
    v_cvt_pk_bf16_f32 v171, v238, v239
    v_add_f32 v225, v225, v239
    s_nop 1
    s_waitcnt lgkmcnt(7)
    s_add_u32 s64, s51, 2
    s_cmp_lt_u32 s64, s18
    s_cbranch_scc1 K2S_L1_w8
    s_waitcnt vmcnt(0)
K2S_L1_w8:
    s_waitcnt vmcnt(8)
    s_barrier
    v_mfma_f32_32x32x16_bf16 v[0:15], v[176:179], v[168:171], v[0:15]
    v_exp_f32 v232, v152
    v_exp_f32 v233, v153
    v_exp_f32 v234, v154
    v_exp_f32 v235, v155
    v_add_f32 v224, v224, v232
    s_waitcnt lgkmcnt(6)
    v_mfma_f32_32x32x16_bf16 v[16:31], v[180:183], v[168:171], v[16:31]
    v_cvt_pk_bf16_f32 v172, v232, v233
    v_add_f32 v225, v225, v233
    v_exp_f32 v236, v156
    v_exp_f32 v237, v157
    v_add_f32 v224, v224, v234
    s_waitcnt lgkmcnt(5)
    v_mfma_f32_32x32x16_bf16 v[32:47], v[184:187], v[168:171], v[32:47]
    v_cvt_pk_bf16_f32 v173, v234, v235
    v_add_f32 v225, v225, v235
    v_exp_f32 v238, v158
    v_exp_f32 v239, v159
    v_add_f32 v224, v224, v236
    s_waitcnt lgkmcnt(4)
    v_mfma_f32_32x32x16_bf16 v[48:63], v[188:191], v[168:171], v[48:63]
    v_cvt_pk_bf16_f32 v174, v236, v237
    v_add_f32 v225, v225, v237
    v_add_f32 v224, v224, v238
    v_cvt_pk_bf16_f32 v175, v238, v239
    v_add_f32 v225, v225, v239
    s_nop 1
    s_waitcnt lgkmcnt(3)
    v_mfma_f32_32x32x16_bf16 v[0:15], v[192:195], v[172:175], v[0:15]
    s_cmp_eq_u32 s60, 0
    s_cbranch_scc1 K2S_L1_nl
    s_add_u32 s64, s51, 3
    s_cmp_ge_u32 s64, s18
    s_cbranch_scc1 K2S_L1_nl
    s_add_u32 s65, s64, 1
    s_and_b32 s66, s65, 3
    s_lshl_b32 s66, s66, 14
    s_add_u32 m0, s66, s45
    s_lshl_b32 s65, s65, 14
    s_add_u32 s65, s65, s46
    buffer_load_dwordx4 v230, s[28:31], s65 offen offset:0 lds
    buffer_load_dwordx4 v230, s[28:31], s65 offen offset:1024 lds
    buffer_load_dwordx4 v230, s[28:31], s65 offen offset:2048 lds
    buffer_load_dwordx4 v230, s[28:31], s65 offen offset:3072 lds
    s_add_u32 s66, s64, 2
    s_and_b32 s66, s66, 3
    s_lshl_b32 s66, s66, 14
    s_add_u32 s66, s66, s45
    s_add_u32 m0, s66, 98304
    s_sub_u32 s65, s65, 16384
    buffer_load_dwordx4 v230, s[32:35], s65 offen offset:0 lds
    buffer_load_dwordx4 v230, s[32:35], s65 offen offset:1024 lds
    buffer_load_dwordx4 v230, s[32:35], s65 offen offset:2048 lds
    buffer_load_dwordx4 v230, s[32:35], s65 offen offset:3072 lds
K2S_L1_nl:
    s_waitcnt lgkmcnt(2)
    v_mfma_f32_32x32x16_bf16 v[16:31], v[196:199], v[172:175], v[16:31]
    s_waitcnt lgkmcnt(1)
    v_mfma_f32_32x32x16_bf16 v[32:47], v[200:203], v[172:175], v[32:47]
    s_waitcnt lgkmcnt(0)
    v_mfma_f32_32x32x16_bf16 v[48:63], v[204:207], v[172:175], v[48:63]
    s_nop 1
    s_add_u32 s51, s51, 1
    v_add_f32 v224, v224, v225
    v_mov_b32 v226, v224
    s_nop 1
    v_permlane32_swap_b32 v224, v226
    v_add_f32 v224, v224, v226
    v_mov_b32 v246, v224
    v_rcp_f32 v224, v224
    s_lshl_b32 s55, s63, 18
    s_lshl_b32 s56, s15, 13
    s_add_u32 s55, s55, s56
    s_nop 7
    v_mul_f32 v0, v0, v224
    v_mul_f32 v1, v1, v224
    v_cvt_pk_bf16_f32 v96, v0, v1
    v_mul_f32 v2, v2, v224
    v_mul_f32 v3, v3, v224
    v_cvt_pk_bf16_f32 v97, v2, v3
    v_mul_f32 v4, v4, v224
    v_mul_f32 v5, v5, v224
    v_cvt_pk_bf16_f32 v98, v4, v5
    v_mul_f32 v6, v6, v224
    v_mul_f32 v7, v7, v224
    v_cvt_pk_bf16_f32 v99, v6, v7
    buffer_store_dwordx4 v[96:99], v230, s[36:39], s55 offen offset:0 sc1
    v_mul_f32 v8, v8, v224
    v_mul_f32 v9, v9, v224
    v_cvt_pk_bf16_f32 v100, v8, v9
    v_mul_f32 v10, v10, v224
    v_mul_f32 v11, v11, v224
    v_cvt_pk_bf16_f32 v101, v10, v11
    v_mul_f32 v12, v12, v224
    v_mul_f32 v13, v13, v224
    v_cvt_pk_bf16_f32 v102, v12, v13
    v_mul_f32 v14, v14, v224
    v_mul_f32 v15, v15, v224
    v_cvt_pk_bf16_f32 v103, v14, v15
    buffer_store_dwordx4 v[100:103], v230, s[36:39], s55 offen offset:1024 sc1
    v_mul_f32 v16, v16, v224
    v_mul_f32 v17, v17, v224
    v_cvt_pk_bf16_f32 v104, v16, v17
    v_mul_f32 v18, v18, v224
    v_mul_f32 v19, v19, v224
    v_cvt_pk_bf16_f32 v105, v18, v19
    v_mul_f32 v20, v20, v224
    v_mul_f32 v21, v21, v224
    v_cvt_pk_bf16_f32 v106, v20, v21
    v_mul_f32 v22, v22, v224
    v_mul_f32 v23, v23, v224
    v_cvt_pk_bf16_f32 v107, v22, v23
    buffer_store_dwordx4 v[104:107], v230, s[36:39], s55 offen offset:2048 sc1
    v_mul_f32 v24, v24, v224
    v_mul_f32 v25, v25, v224
    v_cvt_pk_bf16_f32 v108, v24, v25
    v_mul_f32 v26, v26, v224
    v_mul_f32 v27, v27, v224
    v_cvt_pk_bf16_f32 v109, v26, v27
    v_mul_f32 v28, v28, v224
    v_mul_f32 v29, v29, v224
    v_cvt_pk_bf16_f32 v110, v28, v29
    v_mul_f32 v30, v30, v224
    v_mul_f32 v31, v31, v224
    v_cvt_pk_bf16_f32 v111, v30, v31
    buffer_store_dwordx4 v[108:111], v230, s[36:39], s55 offen offset:3072 sc1
    v_mul_f32 v32, v32, v224
    v_mul_f32 v33, v33, v224
    v_cvt_pk_bf16_f32 v112, v32, v33
    v_mul_f32 v34, v34, v224
    v_mul_f32 v35, v35, v224
    v_cvt_pk_bf16_f32 v113, v34, v35
    v_mul_f32 v36, v36, v224
    v_mul_f32 v37, v37, v224
    v_cvt_pk_bf16_f32 v114, v36, v37
    v_mul_f32 v38, v38, v224
    v_mul_f32 v39, v39, v224
    v_cvt_pk_bf16_f32 v115, v38, v39
    s_add_u32 s55, s55, 4096
    buffer_store_dwordx4 v[112:115], v230, s[36:39], s55 offen offset:0 sc1
    v_mul_f32 v40, v40, v224
    v_mul_f32 v41, v41, v224
    v_cvt_pk_bf16_f32 v116, v40, v41
    v_mul_f32 v42, v42, v224
    v_mul_f32 v43, v43, v224
    v_cvt_pk_bf16_f32 v117, v42, v43
    v_mul_f32 v44, v44, v224
    v_mul_f32 v45, v45, v224
    v_cvt_pk_bf16_f32 v118, v44, v45
    v_mul_f32 v46, v46, v224
    v_mul_f32 v47, v47, v224
    v_cvt_pk_bf16_f32 v119, v46, v47
    buffer_store_dwordx4 v[116:119], v230, s[36:39], s55 offen offset:1024 sc1
    v_mul_f32 v48, v48, v224
    v_mul_f32 v49, v49, v224
    v_cvt_pk_bf16_f32 v120, v48, v49
    v_mul_f32 v50, v50, v224
    v_mul_f32 v51, v51, v224
    v_cvt_pk_bf16_f32 v121, v50, v51
    v_mul_f32 v52, v52, v224
    v_mul_f32 v53, v53, v224
    v_cvt_pk_bf16_f32 v122, v52, v53
    v_mul_f32 v54, v54, v224
    v_mul_f32 v55, v55, v224
    v_cvt_pk_bf16_f32 v123, v54, v55
    buffer_store_dwordx4 v[120:123], v230, s[36:39], s55 offen offset:2048 sc1
    v_mul_f32 v56, v56, v224
    v_mul_f32 v57, v57, v224
    v_cvt_pk_bf16_f32 v124, v56, v57
    v_mul_f32 v58, v58, v224
    v_mul_f32 v59, v59, v224
    v_cvt_pk_bf16_f32 v125, v58, v59
    v_mul_f32 v60, v60, v224
    v_mul_f32 v61, v61, v224
    v_cvt_pk_bf16_f32 v126, v60, v61
    v_mul_f32 v62, v62, v224
    v_mul_f32 v63, v63, v224
    v_cvt_pk_bf16_f32 v127, v62, v63
    buffer_store_dwordx4 v[124:127], v230, s[36:39], s55 offen offset:3072 sc1
K2S_LD:
    s_cmp_ge_u32 s51, s18
    s_cbranch_scc1 K2S_FIN
    s_add_u32 s64, s51, 2
    s_cmp_lt_u32 s64, s18
    s_cbranch_scc1 K2S_LDX_w8
    s_waitcnt vmcnt(0)
K2S_LDX_w8:
    s_waitcnt vmcnt(8)
    s_barrier
    s_cmp_eq_u32 s60, 0
    s_cbranch_scc1 K2S_LDX_nl
    s_add_u32 s64, s51, 3
    s_cmp_ge_u32 s64, s18
    s_cbranch_scc1 K2S_LDX_nl
    s_add_u32 s65, s64, 1
    s_and_b32 s66, s65, 3
    s_lshl_b32 s66, s66, 14
    s_add_u32 m0, s66, s45
    s_lshl_b32 s65, s65, 14
    s_add_u32 s65, s65, s46
    buffer_load_dwordx4 v230, s[28:31], s65 offen offset:0 lds
    buffer_load_dwordx4 v230, s[28:31], s65 offen offset:1024 lds
    buffer_load_dwordx4 v230, s[28:31], s65 offen offset:2048 lds
    buffer_load_dwordx4 v230, s[28:31], s65 offen offset:3072 lds
    s_add_u32 s66, s64, 2
    s_and_b32 s66, s66, 3
    s_lshl_b32 s66, s66, 14
    s_add_u32 s66, s66, s45
    s_add_u32 m0, s66, 98304
    s_sub_u32 s65, s65, 16384
    buffer_load_dwordx4 v230, s[32:35], s65 offen offset:0 lds
    buffer_load_dwordx4 v230, s[32:35], s65 offen offset:1024 lds
    buffer_load_dwordx4 v230, s[32:35], s65 offen offset:2048 lds
    buffer_load_dwordx4 v230, s[32:35], s65 offen offset:3072 lds
K2S_LDX_nl:
    s_add_u32 s51, s51, 1
    s_branch K2S_LD
K2S_U0_RS:
    s_nop 7
    s_nop 7
    v_max_f32 v246, 0, v246
    v_sub_f32 v226, 0, v246
    v_exp_f32 v226, v226
    v_sub_f32 v128, v128, v246
    v_sub_f32 v129, v129, v246
    v_sub_f32 v130, v130, v246
    v_sub_f32 v131, v131, v246
    v_sub_f32 v132, v132, v246
    v_sub_f32 v133, v133, v246
    v_sub_f32 v134, v134, v246
    v_sub_f32 v135, v135, v246
    v_sub_f32 v136, v136, v246
    v_sub_f32 v137, v137, v246
    v_sub_f32 v138, v138, v246
    v_sub_f32 v139, v139, v246
    v_sub_f32 v140, v140, v246
    v_sub_f32 v141, v141, v246
    v_sub_f32 v142, v142, v246
    v_sub_f32 v143, v143, v246
    v_sub_f32 v144, v144, v246
    v_sub_f32 v145, v145, v246
    v_sub_f32 v146, v146, v246
    v_sub_f32 v147, v147, v246
    v_sub_f32 v148, v148, v246
    v_sub_f32 v149, v149, v246
    v_sub_f32 v150, v150, v246
    v_sub_f32 v151, v151, v246
    v_sub_f32 v152, v152, v246
    v_sub_f32 v153, v153, v246
    v_sub_f32 v154, v154, v246
    v_sub_f32 v155, v155, v246
    v_sub_f32 v156, v156, v246
    v_sub_f32 v157, v157, v246
    v_sub_f32 v158, v158, v246
    v_sub_f32 v159, v159, v246
    v_sub_f32 v208, v208, v246
    v_sub_f32 v209, v209, v246
    v_sub_f32 v210, v210, v246
    v_sub_f32 v211, v211, v246
    v_sub_f32 v212, v212, v246
    v_sub_f32 v213, v213, v246
    v_sub_f32 v214, v214, v246
    v_sub_f32 v215, v215, v246
    v_sub_f32 v216, v216, v246
    v_sub_f32 v217, v217, v246
    v_sub_f32 v218, v218, v246
    v_sub_f32 v219, v219, v246
    v_sub_f32 v220, v220, v246
    v_sub_f32 v221, v221, v246
    v_sub_f32 v222, v222, v246
    v_sub_f32 v223, v223, v246
    v_mul_f32 v0, v0, v226
    v_mul_f32 v1, v1, v226
    v_mul_f32 v2, v2, v226
    v_mul_f32 v3, v3, v226
    v_mul_f32 v4, v4, v226
    v_mul_f32 v5, v5, v226
    v_mul_f32 v6, v6, v226
    v_mul_f32 v7, v7, v226
    v_mul_f32 v8, v8, v226
    v_mul_f32 v9, v9, v226
    v_mul_f32 v10, v10, v226
    v_mul_f32 v11, v11, v226
    v_mul_f32 v12, v12, v226
    v_mul_f32 v13, v13, v226
    v_mul_f32 v14, v14, v226
    v_mul_f32 v15, v15, v226
    v_mul_f32 v16, v16, v226
    v_mul_f32 v17, v17, v226
    v_mul_f32 v18, v18, v226
    v_mul_f32 v19, v19, v226
    v_mul_f32 v20, v20, v226
    v_mul_f32 v21, v21, v226
    v_mul_f32 v22, v22, v226
    v_mul_f32 v23, v23, v226
    v_mul_f32 v24, v24, v226
    v_mul_f32 v25, v25, v226
    v_mul_f32 v26, v26, v226
    v_mul_f32 v27, v27, v226
    v_mul_f32 v28, v28, v226
    v_mul_f32 v29, v29, v226
    v_mul_f32 v30, v30, v226
    v_mul_f32 v31, v31, v226
    v_mul_f32 v32, v32, v226
    v_mul_f32 v33, v33, v226
    v_mul_f32 v34, v34, v226
    v_mul_f32 v35, v35, v226
    v_mul_f32 v36, v36, v226
    v_mul_f32 v37, v37, v226
    v_mul_f32 v38, v38, v226
    v_mul_f32 v39, v39, v226
    v_mul_f32 v40, v40, v226
    v_mul_f32 v41, v41, v226
    v_mul_f32 v42, v42, v226
    v_mul_f32 v43, v43, v226
    v_mul_f32 v44, v44, v226
    v_mul_f32 v45, v45, v226
    v_mul_f32 v46, v46, v226
    v_mul_f32 v47, v47, v226
    v_mul_f32 v48, v48, v226
    v_mul_f32 v49, v49, v226
    v_mul_f32 v50, v50, v226
    v_mul_f32 v51, v51, v226
    v_mul_f32 v52, v52, v226
    v_mul_f32 v53, v53, v226
    v_mul_f32 v54, v54, v226
    v_mul_f32 v55, v55, v226
    v_mul_f32 v56, v56, v226
    v_mul_f32 v57, v57, v226
    v_mul_f32 v58, v58, v226
    v_mul_f32 v59, v59, v226
    v_mul_f32 v60, v60, v226
    v_mul_f32 v61, v61, v226
    v_mul_f32 v62, v62, v226
    v_mul_f32 v63, v63, v226
    v_mul_f32 v224, v224, v226
    v_mul_f32 v225, v225, v226
    s_nop 1
    s_branch K2S_U0_RET
K2S_U1_RS:
    s_nop 7
    s_nop 7
    v_max_f32 v246, 0, v246
    v_sub_f32 v226, 0, v246
    v_exp_f32 v226, v226
    v_sub_f32 v96, v96, v246
    v_sub_f32 v97, v97, v246
    v_sub_f32 v98, v98, v246
    v_sub_f32 v99, v99, v246
    v_sub_f32 v100, v100, v246
    v_sub_f32 v101, v101, v246
    v_sub_f32 v102, v102, v246
    v_sub_f32 v103, v103, v246
    v_sub_f32 v104, v104, v246
    v_sub_f32 v105, v105, v246
    v_sub_f32 v106, v106, v246
    v_sub_f32 v107, v107, v246
    v_sub_f32 v108, v108, v246
    v_sub_f32 v109, v109, v246
    v_sub_f32 v110, v110, v246
    v_sub_f32 v111, v111, v246
    v_sub_f32 v112, v112, v246
    v_sub_f32 v113, v113, v246
    v_sub_f32 v114, v114, v246
    v_sub_f32 v115, v115, v246
    v_sub_f32 v116, v116, v246
    v_sub_f32 v117, v117, v246
    v_sub_f32 v118, v118, v246
    v_sub_f32 v119, v119, v246
    v_sub_f32 v120, v120, v246
    v_sub_f32 v121, v121, v246
    v_sub_f32 v122, v122, v246
    v_sub_f32 v123, v123, v246
    v_sub_f32 v124, v124, v246
    v_sub_f32 v125, v125, v246
    v_sub_f32 v126, v126, v246
    v_sub_f32 v127, v127, v246
    v_sub_f32 v208, v208, v246
    v_sub_f32 v209, v209, v246
    v_sub_f32 v210, v210, v246
    v_sub_f32 v211, v211, v246
    v_sub_f32 v212, v212, v246
    v_sub_f32 v213, v213, v246
    v_sub_f32 v214, v214, v246
    v_sub_f32 v215, v215, v246
    v_sub_f32 v216, v216, v246
    v_sub_f32 v217, v217, v246
    v_sub_f32 v218, v218, v246
    v_sub_f32 v219, v219, v246
    v_sub_f32 v220, v220, v246
    v_sub_f32 v221, v221, v246
    v_sub_f32 v222, v222, v246
    v_sub_f32 v223, v223, v246
    v_mul_f32 v0, v0, v226
    v_mul_f32 v1, v1, v226
    v_mul_f32 v2, v2, v226
    v_mul_f32 v3, v3, v226
    v_mul_f32 v4, v4, v226
    v_mul_f32 v5, v5, v226
    v_mul_f32 v6, v6, v226
    v_mul_f32 v7, v7, v226
    v_mul_f32 v8, v8, v226
    v_mul_f32 v9, v9, v226
    v_mul_f32 v10, v10, v226
    v_mul_f32 v11, v11, v226
    v_mul_f32 v12, v12, v226
    v_mul_f32 v13, v13, v226
    v_mul_f32 v14, v14, v226
    v_mul_f32 v15, v15, v226
    v_mul_f32 v16, v16, v226
    v_mul_f32 v17, v17, v226
    v_mul_f32 v18, v18, v226
    v_mul_f32 v19, v19, v226
    v_mul_f32 v20, v20, v226
    v_mul_f32 v21, v21, v226
    v_mul_f32 v22, v22, v226
    v_mul_f32 v23, v23, v226
    v_mul_f32 v24, v24, v226
    v_mul_f32 v25, v25, v226
    v_mul_f32 v26, v26, v226
    v_mul_f32 v27, v27, v226
    v_mul_f32 v28, v28, v226
    v_mul_f32 v29, v29, v226
    v_mul_f32 v30, v30, v226
    v_mul_f32 v31, v31, v226
    v_mul_f32 v32, v32, v226
    v_mul_f32 v33, v33, v226
    v_mul_f32 v34, v34, v226
    v_mul_f32 v35, v35, v226
    v_mul_f32 v36, v36, v226
    v_mul_f32 v37, v37, v226
    v_mul_f32 v38, v38, v226
    v_mul_f32 v39, v39, v226
    v_mul_f32 v40, v40, v226
    v_mul_f32 v41, v41, v226
    v_mul_f32 v42, v42, v226
    v_mul_f32 v43, v43, v226
    v_mul_f32 v44, v44, v226
    v_mul_f32 v45, v45, v226
    v_mul_f32 v46, v46, v226
    v_mul_f32 v47, v47, v226
    v_mul_f32 v48, v48, v226
    v_mul_f32 v49, v49, v226
    v_mul_f32 v50, v50, v226
    v_mul_f32 v51, v51, v226
    v_mul_f32 v52, v52, v226
    v_mul_f32 v53, v53, v226
    v_mul_f32 v54, v54, v226
    v_mul_f32 v55, v55, v226
    v_mul_f32 v56, v56, v226
    v_mul_f32 v57, v57, v226
    v_mul_f32 v58, v58, v226
    v_mul_f32 v59, v59, v226
    v_mul_f32 v60, v60, v226
    v_mul_f32 v61, v61, v226
    v_mul_f32 v62, v62, v226
    v_mul_f32 v63, v63, v226
    v_mul_f32 v224, v224, v226
    v_mul_f32 v225, v225, v226
    s_nop 1
    s_branch K2S_U1_RET
K2S_M1_RS:
    s_nop 7
    s_nop 7
    v_max_f32 v246, 0, v246
    v_sub_f32 v226, 0, v246
    v_exp_f32 v226, v226
    v_sub_f32 v96, v96, v246
    v_sub_f32 v97, v97, v246
    v_sub_f32 v98, v98, v246
    v_sub_f32 v99, v99, v246
    v_sub_f32 v100, v100, v246
    v_sub_f32 v101, v101, v246
    v_sub_f32 v102, v102, v246
    v_sub_f32 v103, v103, v246
    v_sub_f32 v104, v104, v246
    v_sub_f32 v105, v105, v246
    v_sub_f32 v106, v106, v246
    v_sub_f32 v107, v107, v246
    v_sub_f32 v108, v108, v246
    v_sub_f32 v109, v109, v246
    v_sub_f32 v110, v110, v246
    v_sub_f32 v111, v111, v246
    v_sub_f32 v112, v112, v246
    v_sub_f32 v113, v113, v246
    v_sub_f32 v114, v114, v246
    v_sub_f32 v115, v115, v246
    v_sub_f32 v116, v116, v246
    v_sub_f32 v117, v117, v246
    v_sub_f32 v118, v118, v246
    v_sub_f32 v119, v119, v246
    v_sub_f32 v120, v120, v246
    v_sub_f32 v121, v121, v246
    v_sub_f32 v122, v122, v246
    v_sub_f32 v123, v123, v246
    v_sub_f32 v124, v124, v246
    v_sub_f32 v125, v125, v246
    v_sub_f32 v126, v126, v246
    v_sub_f32 v127, v127, v246
    v_sub_f32 v208, v208, v246
    v_sub_f32 v209, v209, v246
    v_sub_f32 v210, v210, v246
    v_sub_f32 v211, v211, v246
    v_sub_f32 v212, v212, v246
    v_sub_f32 v213, v213, v246
    v_sub_f32 v214, v214, v246
    v_sub_f32 v215, v215, v246
    v_sub_f32 v216, v216, v246
    v_sub_f32 v217, v217, v246
    v_sub_f32 v218, v218, v246
    v_sub_f32 v219, v219, v246
    v_sub_f32 v220, v220, v246
    v_sub_f32 v221, v221, v246
    v_sub_f32 v222, v222, v246
    v_sub_f32 v223, v223, v246
    v_mul_f32 v0, v0, v226
    v_mul_f32 v1, v1, v226
    v_mul_f32 v2, v2, v226
    v_mul_f32 v3, v3, v226
    v_mul_f32 v4, v4, v226
    v_mul_f32 v5, v5, v226
    v_mul_f32 v6, v6, v226
    v_mul_f32 v7, v7, v226
    v_mul_f32 v8, v8, v226
    v_mul_f32 v9, v9, v226
    v_mul_f32 v10, v10, v226
    v_mul_f32 v11, v11, v226
    v_mul_f32 v12, v12, v226
    v_mul_f32 v13, v13, v226
    v_mul_f32 v14, v14, v226
    v_mul_f32 v15, v15, v226
    v_mul_f32 v16, v16, v226
    v_mul_f32 v17, v17, v226
    v_mul_f32 v18, v18, v226
    v_mul_f32 v19, v19, v226
    v_mul_f32 v20, v20, v226
    v_mul_f32 v21, v21, v226
    v_mul_f32 v22, v22, v226
    v_mul_f32 v23, v23, v226
    v_mul_f32 v24, v24, v226
    v_mul_f32 v25, v25, v226
    v_mul_f32 v26, v26, v226
    v_mul_f32 v27, v27, v226
    v_mul_f32 v28, v28, v226
    v_mul_f32 v29, v29, v226
    v_mul_f32 v30, v30, v226
    v_mul_f32 v31, v31, v226
    v_mul_f32 v32, v32, v226
    v_mul_f32 v33, v33, v226
    v_mul_f32 v34, v34, v226
    v_mul_f32 v35, v35, v226
    v_mul_f32 v36, v36, v226
    v_mul_f32 v37, v37, v226
    v_mul_f32 v38, v38, v226
    v_mul_f32 v39, v39, v226
    v_mul_f32 v40, v40, v226
    v_mul_f32 v41, v41, v226
    v_mul_f32 v42, v42, v226
    v_mul_f32 v43, v43, v226
    v_mul_f32 v44, v44, v226
    v_mul_f32 v45, v45, v226
    v_mul_f32 v46, v46, v226
    v_mul_f32 v47, v47, v226
    v_mul_f32 v48, v48, v226
    v_mul_f32 v49, v49, v226
    v_mul_f32 v50, v50, v226
    v_mul_f32 v51, v51, v226
    v_mul_f32 v52, v52, v226
    v_mul_f32 v53, v53, v226
    v_mul_f32 v54, v54, v226
    v_mul_f32 v55, v55, v226
    v_mul_f32 v56, v56, v226
    v_mul_f32 v57, v57, v226
    v_mul_f32 v58, v58, v226
    v_mul_f32 v59, v59, v226
    v_mul_f32 v60, v60, v226
    v_mul_f32 v61, v61, v226
    v_mul_f32 v62, v62, v226
    v_mul_f32 v63, v63, v226
    v_mul_f32 v224, v224, v226
    v_mul_f32 v225, v225, v226
    s_nop 1
    s_branch K2S_M1_RET
K2S_M0_RS:
    s_nop 7
    s_nop 7
    v_max_f32 v246, 0, v246
    v_sub_f32 v226, 0, v246
    v_exp_f32 v226, v226
    v_sub_f32 v128, v128, v246
    v_sub_f32 v129, v129, v246
    v_sub_f32 v130, v130, v246
    v_sub_f32 v131, v131, v246
    v_sub_f32 v132, v132, v246
    v_sub_f32 v133, v133, v246
    v_sub_f32 v134, v134, v246
    v_sub_f32 v135, v135, v246
    v_sub_f32 v136, v136, v246
    v_sub_f32 v137, v137, v246
    v_sub_f32 v138, v138, v246
    v_sub_f32 v139, v139, v246
    v_sub_f32 v140, v140, v246
    v_sub_f32 v141, v141, v246
    v_sub_f32 v142, v142, v246
    v_sub_f32 v143, v143, v246
    v_sub_f32 v144, v144, v246
    v_sub_f32 v145, v145, v246
    v_sub_f32 v146, v146, v246
    v_sub_f32 v147, v147, v246
    v_sub_f32 v148, v148, v246
    v_sub_f32 v149, v149, v246
    v_sub_f32 v150, v150, v246
    v_sub_f32 v151, v151, v246
    v_sub_f32 v152, v152, v246
    v_sub_f32 v153, v153, v246
    v_sub_f32 v154, v154, v246
    v_sub_f32 v155, v155, v246
    v_sub_f32 v156, v156, v246
    v_sub_f32 v157, v157, v246
    v_sub_f32 v158, v158, v246
    v_sub_f32 v159, v159, v246
    v_sub_f32 v208, v208, v246
    v_sub_f32 v209, v209, v246
    v_sub_f32 v210, v210, v246
    v_sub_f32 v211, v211, v246
    v_sub_f32 v212, v212, v246
    v_sub_f32 v213, v213, v246
    v_sub_f32 v214, v214, v246
    v_sub_f32 v215, v215, v246
    v_sub_f32 v216, v216, v246
    v_sub_f32 v217, v217, v246
    v_sub_f32 v218, v218, v246
    v_sub_f32 v219, v219, v246
    v_sub_f32 v220, v220, v246
    v_sub_f32 v221, v221, v246
    v_sub_f32 v222, v222, v246
    v_sub_f32 v223, v223, v246
    v_mul_f32 v0, v0, v226
    v_mul_f32 v1, v1, v226
    v_mul_f32 v2, v2, v226
    v_mul_f32 v3, v3, v226
    v_mul_f32 v4, v4, v226
    v_mul_f32 v5, v5, v226
    v_mul_f32 v6, v6, v226
    v_mul_f32 v7, v7, v226
    v_mul_f32 v8, v8, v226
    v_mul_f32 v9, v9, v226
    v_mul_f32 v10, v10, v226
    v_mul_f32 v11, v11, v226
    v_mul_f32 v12, v12, v226
    v_mul_f32 v13, v13, v226
    v_mul_f32 v14, v14, v226
    v_mul_f32 v15, v15, v226
    v_mul_f32 v16, v16, v226
    v_mul_f32 v17, v17, v226
    v_mul_f32 v18, v18, v226
    v_mul_f32 v19, v19, v226
    v_mul_f32 v20, v20, v226
    v_mul_f32 v21, v21, v226
    v_mul_f32 v22, v22, v226
    v_mul_f32 v23, v23, v226
    v_mul_f32 v24, v24, v226
    v_mul_f32 v25, v25, v226
    v_mul_f32 v26, v26, v226
    v_mul_f32 v27, v27, v226
    v_mul_f32 v28, v28, v226
    v_mul_f32 v29, v29, v226
    v_mul_f32 v30, v30, v226
    v_mul_f32 v31, v31, v226
    v_mul_f32 v32, v32, v226
    v_mul_f32 v33, v33, v226
    v_mul_f32 v34, v34, v226
    v_mul_f32 v35, v35, v226
    v_mul_f32 v36, v36, v226
    v_mul_f32 v37, v37, v226
    v_mul_f32 v38, v38, v226
    v_mul_f32 v39, v39, v226
    v_mul_f32 v40, v40, v226
    v_mul_f32 v41, v41, v226
    v_mul_f32 v42, v42, v226
    v_mul_f32 v43, v43, v226
    v_mul_f32 v44, v44, v226
    v_mul_f32 v45, v45, v226
    v_mul_f32 v46, v46, v226
    v_mul_f32 v47, v47, v226
    v_mul_f32 v48, v48, v226
    v_mul_f32 v49, v49, v226
    v_mul_f32 v50, v50, v226
    v_mul_f32 v51, v51, v226
    v_mul_f32 v52, v52, v226
    v_mul_f32 v53, v53, v226
    v_mul_f32 v54, v54, v226
    v_mul_f32 v55, v55, v226
    v_mul_f32 v56, v56, v226
    v_mul_f32 v57, v57, v226
    v_mul_f32 v58, v58, v226
    v_mul_f32 v59, v59, v226
    v_mul_f32 v60, v60, v226
    v_mul_f32 v61, v61, v226
    v_mul_f32 v62, v62, v226
    v_mul_f32 v63, v63, v226
    v_mul_f32 v224, v224, v226
    v_mul_f32 v225, v225, v226
    s_nop 1
    s_branch K2S_M0_RET
K2S_FIN:
K2_END:
    s_endpgm
k2_kernel_end:
.globl k3_kernel
.p2align 8
.type k3_kernel,@function
k3_kernel:
    s_cmp_ge_u32 s2, 256
    s_cbranch_scc1 K3_END
    s_load_dwordx2 s[4:5], s[0:1], 40
    s_load_dwordx2 s[6:7], s[0:1], 104
    v_and_b32 v248, 63, v0
    v_lshrrev_b32 v249, 6, v0
    s_nop 0
    v_readfirstlane_b32 s14, v249
    s_and_b32 s15, s2, 3
    s_bfe_u32 s16, s2, 0x20003
    s_lshr_b32 s17, s2, 5
    s_bfe_u32 s18, s2, 0x10002
    s_lshl_b32 s18, s18, 3
    s_add_u32 s17, s17, s18
    s_and_b32 s51, s14, 3
    s_lshr_b32 s52, s14, 2
    s_lshl_b32 s18, s17, 2
    s_add_u32 s18, s18, s51
    v_lshlrev_b32 v252, 4, v248
    s_mul_i32 s19, s16, 320
    s_mul_i32 s40, s51, 16*1280
    s_add_u32 s19, s19, s40
    s_movk_i32 s41, 3277
    s_movk_i32 s42, 1280
    v_add_u32 v249, 0, v248
    v_mul_u32_u24 v250, s41, v249
    v_lshrrev_b32 v250, 16, v250
    v_mul_u32_u24 v251, 20, v250
    v_sub_u32 v249, v249, v251
    v_mul_u32_u24 v250, s42, v250
    v_lshl_add_u32 v249, v249, 4, v250
    v_add_u32 v249, s19, v249
    v_add_u32 v123, 0, v249
    v_add_u32 v249, 64, v248
    v_mul_u32_u24 v250, s41, v249
    v_lshrrev_b32 v250, 16, v250
    v_mul_u32_u24 v251, 20, v250
    v_sub_u32 v249, v249, v251
    v_mul_u32_u24 v250, s42, v250
    v_lshl_add_u32 v249, v249, 4, v250
    v_add_u32 v249, s19, v249
    v_add_u32 v124, 4294966272, v249
    v_add_u32 v249, 128, v248
    v_mul_u32_u24 v250, s41, v249
    v_lshrrev_b32 v250, 16, v250
    v_mul_u32_u24 v251, 20, v250
    v_sub_u32 v249, v249, v251
    v_mul_u32_u24 v250, s42, v250
    v_lshl_add_u32 v249, v249, 4, v250
    v_add_u32 v249, s19, v249
    v_add_u32 v125, 4294965248, v249
    v_add_u32 v249, 192, v248
    v_mul_u32_u24 v250, s41, v249
    v_lshrrev_b32 v250, 16, v250
    v_mul_u32_u24 v251, 20, v250
    v_sub_u32 v249, v249, v251
    v_mul_u32_u24 v250, s42, v250
    v_lshl_add_u32 v249, v249, 4, v250
    v_add_u32 v249, s19, v249
    v_add_u32 v126, 4294964224, v249
    v_add_u32 v249, 256, v248
    v_mul_u32_u24 v250, s41, v249
    v_lshrrev_b32 v250, 16, v250
    v_mul_u32_u24 v251, 20, v250
    v_sub_u32 v249, v249, v251
    v_mul_u32_u24 v250, s42, v250
    v_lshl_add_u32 v249, v249, 4, v250
    v_add_u32 v249, s19, v249
    v_add_u32 v127, 0, v249
    s_mul_i32 s43, s14, 5120
    s_lshl_b32 s53, s15, 1
    s_add_u32 s53, s53, s52
    s_mul_i32 s44, s53, 512*1280
    s_lshl_b32 s45, s18, 18
    s_lshl_b32 s46, s53, 15
    s_add_u32 s45, s45, s46
    s_waitcnt lgkmcnt(0)
    s_mov_b32 s20, s4
    s_and_b32 s21, s5, 0xffff
    s_mov_b32 s22, 5242880
    s_mov_b32 s23, 0x00020000
    s_add_u32 s24, s6, 37748736
    s_addc_u32 s25, s7, 0
    s_and_b32 s25, s25, 0xffff
    s_mov_b32 s26, 16777216
    s_mov_b32 s27, 0x00020000
    s_add_u32 s28, s6, 54525952
    s_addc_u32 s29, s7, 0
    s_and_b32 s29, s29, 0xffff
    s_mov_b32 s30, 10485760
    s_mov_b32 s31, 0x00020000
    s_add_u32 m0, s43, 0
    s_add_u32 s47, s44, 0
    buffer_load_dwordx4 v123, s[20:23], s47 offen offset:0 lds
    buffer_load_dwordx4 v124, s[20:23], s47 offen offset:1024 lds
    buffer_load_dwordx4 v125, s[20:23], s47 offen offset:2048 lds
    buffer_load_dwordx4 v126, s[20:23], s47 offen offset:3072 lds
    s_add_u32 m0, s43, 4096
    s_nop 0
    buffer_load_dwordx4 v127, s[20:23], s47 offen lds
    s_add_u32 s48, s45, 0
    buffer_load_dwordx4 v[0:3], v252, s[24:27], s48 offen
    s_add_u32 s48, s45, 1024
    buffer_load_dwordx4 v[4:7], v252, s[24:27], s48 offen
    s_add_u32 s48, s45, 2048
    buffer_load_dwordx4 v[8:11], v252, s[24:27], s48 offen
    s_add_u32 s48, s45, 3072
    buffer_load_dwordx4 v[12:15], v252, s[24:27], s48 offen
    s_add_u32 m0, s43, 40960
    s_add_u32 s47, s44, 81920
    buffer_load_dwordx4 v123, s[20:23], s47 offen offset:0 lds
    buffer_load_dwordx4 v124, s[20:23], s47 offen offset:1024 lds
    buffer_load_dwordx4 v125, s[20:23], s47 offen offset:2048 lds
    buffer_load_dwordx4 v126, s[20:23], s47 offen offset:3072 lds
    s_add_u32 m0, s43, 45056
    s_nop 0
    buffer_load_dwordx4 v127, s[20:23], s47 offen lds
    v_bfe_u32 v249, v248, 2, 2
    v_lshrrev_b32 v250, 5, v248
    v_lshl_add_u32 v249, v250, 2, v249
    v_mul_u32_u24 v249, 320, v249
    v_bfe_u32 v250, v248, 4, 1
    v_lshl_add_u32 v249, v250, 5, v249
    v_and_b32 v250, 3, v248
    v_lshl_add_u32 v253, v250, 3, v249
    s_mul_i32 s54, s52, 20480
    v_add_u32 v253, s54, v253
    v_add_u32 v254, 40960, v253
    v_add_u32 v255, 81920, v253
    v_add_u32 v251, 122880, v253
    s_waitcnt vmcnt(9) lgkmcnt(0)
    s_barrier
    ds_read_b64_tr_b16 v[208:209], v253 offset:0
    ds_read_b64_tr_b16 v[210:211], v253 offset:2560
    ds_read_b64_tr_b16 v[212:213], v253 offset:64
    ds_read_b64_tr_b16 v[214:215], v253 offset:2624
    ds_read_b64_tr_b16 v[216:217], v253 offset:128
    ds_read_b64_tr_b16 v[218:219], v253 offset:2688
    ds_read_b64_tr_b16 v[220:221], v253 offset:192
    ds_read_b64_tr_b16 v[222:223], v253 offset:2752
    ds_read_b64_tr_b16 v[224:225], v253 offset:256
    ds_read_b64_tr_b16 v[226:227], v253 offset:2816
    s_add_u32 s48, s45, 4096
    buffer_load_dwordx4 v[16:19], v252, s[24:27], s48 offen
    s_add_u32 s48, s45, 5120
    buffer_load_dwordx4 v[20:23], v252, s[24:27], s48 offen
    s_add_u32 s48, s45, 6144
    buffer_load_dwordx4 v[24:27], v252, s[24:27], s48 offen
    s_add_u32 s48, s45, 7168
    buffer_load_dwordx4 v[28:31], v252, s[24:27], s48 offen
    s_waitcnt vmcnt(12) lgkmcnt(0)
    v_mfma_f32_32x32x16_bf16 v[128:143], v[208:211], v[0:3], 0
    ds_read_b64_tr_b16 v[228:229], v253 offset:5120
    ds_read_b64_tr_b16 v[230:231], v253 offset:7680
    ds_read_b64_tr_b16 v[232:233], v253 offset:5184
    v_mfma_f32_32x32x16_bf16 v[144:159], v[212:215], v[0:3], 0
    ds_read_b64_tr_b16 v[234:235], v253 offset:7744
    ds_read_b64_tr_b16 v[236:237], v253 offset:5248
    ds_read_b64_tr_b16 v[238:239], v253 offset:7808
    v_mfma_f32_32x32x16_bf16 v[160:175], v[216:219], v[0:3], 0
    ds_read_b64_tr_b16 v[240:241], v253 offset:5312
    ds_read_b64_tr_b16 v[242:243], v253 offset:7872
    ds_read_b64_tr_b16 v[244:245], v253 offset:5376
    v_mfma_f32_32x32x16_bf16 v[176:191], v[220:223], v[0:3], 0
    ds_read_b64_tr_b16 v[246:247], v253 offset:7936
    s_add_u32 m0, s43, 81920
    s_add_u32 s47, s44, 163840
    buffer_load_dwordx4 v123, s[20:23], s47 offen offset:0 lds
    buffer_load_dwordx4 v124, s[20:23], s47 offen offset:1024 lds
    buffer_load_dwordx4 v125, s[20:23], s47 offen offset:2048 lds
    buffer_load_dwordx4 v126, s[20:23], s47 offen offset:3072 lds
    s_add_u32 m0, s43, 86016
    s_nop 0
    buffer_load_dwordx4 v127, s[20:23], s47 offen lds
    v_mfma_f32_32x32x16_bf16 v[192:207], v[224:227], v[0:3], 0
    s_waitcnt vmcnt(16) lgkmcnt(0)
    v_mfma_f32_32x32x16_bf16 v[128:143], v[228:231], v[4:7], v[128:143]
    ds_read_b64_tr_b16 v[208:209], v253 offset:10240
    ds_read_b64_tr_b16 v[210:211], v253 offset:12800
    ds_read_b64_tr_b16 v[212:213], v253 offset:10304
    v_mfma_f32_32x32x16_bf16 v[144:159], v[232:235], v[4:7], v[144:159]
    ds_read_b64_tr_b16 v[214:215], v253 offset:12864
    ds_read_b64_tr_b16 v[216:217], v253 offset:10368
    ds_read_b64_tr_b16 v[218:219], v253 offset:12928
    v_mfma_f32_32x32x16_bf16 v[160:175], v[236:239], v[4:7], v[160:175]
    ds_read_b64_tr_b16 v[220:221], v253 offset:10432
    ds_read_b64_tr_b16 v[222:223], v253 offset:12992
    ds_read_b64_tr_b16 v[224:225], v253 offset:10496
    v_mfma_f32_32x32x16_bf16 v[176:191], v[240:243], v[4:7], v[176:191]
    ds_read_b64_tr_b16 v[226:227], v253 offset:13056
    s_add_u32 s48, s45, 8192
    buffer_load_dwordx4 v[32:35], v252, s[24:27], s48 offen
    s_add_u32 s48, s45, 9216
    buffer_load_dwordx4 v[36:39], v252, s[24:27], s48 offen
    v_mfma_f32_32x32x16_bf16 v[192:207], v[244:247], v[4:7], v[192:207]
    s_add_u32 s48, s45, 10240
    buffer_load_dwordx4 v[40:43], v252, s[24:27], s48 offen
    s_add_u32 s48, s45, 11264
    buffer_load_dwordx4 v[44:47], v252, s[24:27], s48 offen
    s_waitcnt vmcnt(19) lgkmcnt(0)
    v_mfma_f32_32x32x16_bf16 v[128:143], v[208:211], v[8:11], v[128:143]
    ds_read_b64_tr_b16 v[228:229], v253 offset:15360
    ds_read_b64_tr_b16 v[230:231], v253 offset:17920
    ds_read_b64_tr_b16 v[232:233], v253 offset:15424
    v_mfma_f32_32x32x16_bf16 v[144:159], v[212:215], v[8:11], v[144:159]
    ds_read_b64_tr_b16 v[234:235], v253 offset:17984
    ds_read_b64_tr_b16 v[236:237], v253 offset:15488
    ds_read_b64_tr_b16 v[238:239], v253 offset:18048
    v_mfma_f32_32x32x16_bf16 v[160:175], v[216:219], v[8:11], v[160:175]
    ds_read_b64_tr_b16 v[240:241], v253 offset:15552
    ds_read_b64_tr_b16 v[242:243], v253 offset:18112
    ds_read_b64_tr_b16 v[244:245], v253 offset:15616
    v_mfma_f32_32x32x16_bf16 v[176:191], v[220:223], v[8:11], v[176:191]
    ds_read_b64_tr_b16 v[246:247], v253 offset:18176
    s_add_u32 m0, s43, 122880
    s_add_u32 s47, s44, 245760
    buffer_load_dwordx4 v123, s[20:23], s47 offen offset:0 lds
    buffer_load_dwordx4 v124, s[20:23], s47 offen offset:1024 lds
    buffer_load_dwordx4 v125, s[20:23], s47 offen offset:2048 lds
    buffer_load_dwordx4 v126, s[20:23], s47 offen offset:3072 lds
    s_add_u32 m0, s43, 126976
    s_nop 0
    buffer_load_dwordx4 v127, s[20:23], s47 offen lds
    v_mfma_f32_32x32x16_bf16 v[192:207], v[224:227], v[8:11], v[192:207]
    s_waitcnt vmcnt(18) lgkmcnt(0)
    s_barrier
    v_mfma_f32_32x32x16_bf16 v[128:143], v[228:231], v[12:15], v[128:143]
    ds_read_b64_tr_b16 v[208:209], v254 offset:0
    ds_read_b64_tr_b16 v[210:211], v254 offset:2560
    ds_read_b64_tr_b16 v[212:213], v254 offset:64
    v_mfma_f32_32x32x16_bf16 v[144:159], v[232:235], v[12:15], v[144:159]
    ds_read_b64_tr_b16 v[214:215], v254 offset:2624
    ds_read_b64_tr_b16 v[216:217], v254 offset:128
    ds_read_b64_tr_b16 v[218:219], v254 offset:2688
    v_mfma_f32_32x32x16_bf16 v[160:175], v[236:239], v[12:15], v[160:175]
    ds_read_b64_tr_b16 v[220:221], v254 offset:192
    ds_read_b64_tr_b16 v[222:223], v254 offset:2752
    ds_read_b64_tr_b16 v[224:225], v254 offset:256
    v_mfma_f32_32x32x16_bf16 v[176:191], v[240:243], v[12:15], v[176:191]
    ds_read_b64_tr_b16 v[226:227], v254 offset:2816
    s_add_u32 s48, s45, 12288
    buffer_load_dwordx4 v[48:51], v252, s[24:27], s48 offen
    s_add_u32 s48, s45, 13312
    buffer_load_dwordx4 v[52:55], v252, s[24:27], s48 offen
    v_mfma_f32_32x32x16_bf16 v[192:207], v[244:247], v[12:15], v[192:207]
    s_waitcnt vmcnt(19) lgkmcnt(0)
    v_mfma_f32_32x32x16_bf16 v[128:143], v[208:211], v[16:19], v[128:143]
    ds_read_b64_tr_b16 v[228:229], v254 offset:5120
    ds_read_b64_tr_b16 v[230:231], v254 offset:7680
    ds_read_b64_tr_b16 v[232:233], v254 offset:5184
    v_mfma_f32_32x32x16_bf16 v[144:159], v[212:215], v[16:19], v[144:159]
    ds_read_b64_tr_b16 v[234:235], v254 offset:7744
    ds_read_b64_tr_b16 v[236:237], v254 offset:5248
    ds_read_b64_tr_b16 v[238:239], v254 offset:7808
    v_mfma_f32_32x32x16_bf16 v[160:175], v[216:219], v[16:19], v[160:175]
    ds_read_b64_tr_b16 v[240:241], v254 offset:5312
    ds_read_b64_tr_b16 v[242:243], v254 offset:7872
    ds_read_b64_tr_b16 v[244:245], v254 offset:5376
    v_mfma_f32_32x32x16_bf16 v[176:191], v[220:223], v[16:19], v[176:191]
    ds_read_b64_tr_b16 v[246:247], v254 offset:7936
    s_add_u32 s48, s45, 14336
    buffer_load_dwordx4 v[56:59], v252, s[24:27], s48 offen
    s_add_u32 s48, s45, 15360
    buffer_load_dwordx4 v[60:63], v252, s[24:27], s48 offen
    v_mfma_f32_32x32x16_bf16 v[192:207], v[224:227], v[16:19], v[192:207]
    s_waitcnt vmcnt(20) lgkmcnt(0)
    v_mfma_f32_32x32x16_bf16 v[128:143], v[228:231], v[20:23], v[128:143]
    ds_read_b64_tr_b16 v[208:209], v254 offset:10240
    ds_read_b64_tr_b16 v[210:211], v254 offset:12800
    ds_read_b64_tr_b16 v[212:213], v254 offset:10304
    v_mfma_f32_32x32x16_bf16 v[144:159], v[232:235], v[20:23], v[144:159]
    ds_read_b64_tr_b16 v[214:215], v254 offset:12864
    ds_read_b64_tr_b16 v[216:217], v254 offset:10368
    ds_read_b64_tr_b16 v[218:219], v254 offset:12928
    v_mfma_f32_32x32x16_bf16 v[160:175], v[236:239], v[20:23], v[160:175]
    ds_read_b64_tr_b16 v[220:221], v254 offset:10432
    ds_read_b64_tr_b16 v[222:223], v254 offset:12992
    ds_read_b64_tr_b16 v[224:225], v254 offset:10496
    v_mfma_f32_32x32x16_bf16 v[176:191], v[240:243], v[20:23], v[176:191]
    ds_read_b64_tr_b16 v[226:227], v254 offset:13056
    s_add_u32 m0, s43, 0
    s_add_u32 s47, s44, 327680
    buffer_load_dwordx4 v123, s[20:23], s47 offen offset:0 lds
    buffer_load_dwordx4 v124, s[20:23], s47 offen offset:1024 lds
    buffer_load_dwordx4 v125, s[20:23], s47 offen offset:2048 lds
    buffer_load_dwordx4 v126, s[20:23], s47 offen offset:3072 lds
    s_add_u32 m0, s43, 4096
    s_nop 0
    buffer_load_dwordx4 v127, s[20:23], s47 offen lds
    v_mfma_f32_32x32x16_bf16 v[192:207], v[244:247], v[20:23], v[192:207]
    s_waitcnt vmcnt(24) lgkmcnt(0)
    v_mfma_f32_32x32x16_bf16 v[128:143], v[208:211], v[24:27], v[128:143]
    ds_read_b64_tr_b16 v[228:229], v254 offset:15360
    ds_read_b64_tr_b16 v[230:231], v254 offset:17920
    ds_read_b64_tr_b16 v[232:233], v254 offset:15424
    v_mfma_f32_32x32x16_bf16 v[144:159], v[212:215], v[24:27], v[144:159]
    ds_read_b64_tr_b16 v[234:235], v254 offset:17984
    ds_read_b64_tr_b16 v[236:237], v254 offset:15488
    ds_read_b64_tr_b16 v[238:239], v254 offset:18048
    v_mfma_f32_32x32x16_bf16 v[160:175], v[216:219], v[24:27], v[160:175]
    ds_read_b64_tr_b16 v[240:241], v254 offset:15552
    ds_read_b64_tr_b16 v[242:243], v254 offset:18112
    ds_read_b64_tr_b16 v[244:245], v254 offset:15616
    v_mfma_f32_32x32x16_bf16 v[176:191], v[220:223], v[24:27], v[176:191]
    ds_read_b64_tr_b16 v[246:247], v254 offset:18176
    v_mfma_f32_32x32x16_bf16 v[192:207], v[224:227], v[24:27], v[192:207]
    s_waitcnt vmcnt(18) lgkmcnt(0)
    s_barrier
    v_mfma_f32_32x32x16_bf16 v[128:143], v[228:231], v[28:31], v[128:143]
    ds_read_b64_tr_b16 v[208:209], v255 offset:0
    ds_read_b64_tr_b16 v[210:211], v255 offset:2560
    ds_read_b64_tr_b16 v[212:213], v255 offset:64
    v_mfma_f32_32x32x16_bf16 v[144:159], v[232:235], v[28:31], v[144:159]
    ds_read_b64_tr_b16 v[214:215], v255 offset:2624
    ds_read_b64_tr_b16 v[216:217], v255 offset:128
    ds_read_b64_tr_b16 v[218:219], v255 offset:2688
    v_mfma_f32_32x32x16_bf16 v[160:175], v[236:239], v[28:31], v[160:175]
    ds_read_b64_tr_b16 v[220:221], v255 offset:192
    ds_read_b64_tr_b16 v[222:223], v255 offset:2752
    ds_read_b64_tr_b16 v[224:225], v255 offset:256
    v_mfma_f32_32x32x16_bf16 v[176:191], v[240:243], v[28:31], v[176:191]
    ds_read_b64_tr_b16 v[226:227], v255 offset:2816
    s_add_u32 s48, s45, 16384
    buffer_load_dwordx4 v[64:67], v252, s[24:27], s48 offen
    s_add_u32 s48, s45, 17408
    buffer_load_dwordx4 v[68:71], v252, s[24:27], s48 offen
    v_mfma_f32_32x32x16_bf16 v[192:207], v[244:247], v[28:31], v[192:207]
    s_waitcnt vmcnt(19) lgkmcnt(0)
    v_mfma_f32_32x32x16_bf16 v[128:143], v[208:211], v[32:35], v[128:143]
    ds_read_b64_tr_b16 v[228:229], v255 offset:5120
    ds_read_b64_tr_b16 v[230:231], v255 offset:7680
    ds_read_b64_tr_b16 v[232:233], v255 offset:5184
    v_mfma_f32_32x32x16_bf16 v[144:159], v[212:215], v[32:35], v[144:159]
    ds_read_b64_tr_b16 v[234:235], v255 offset:7744
    ds_read_b64_tr_b16 v[236:237], v255 offset:5248
    ds_read_b64_tr_b16 v[238:239], v255 offset:7808
    v_mfma_f32_32x32x16_bf16 v[160:175], v[216:219], v[32:35], v[160:175]
    ds_read_b64_tr_b16 v[240:241], v255 offset:5312
    ds_read_b64_tr_b16 v[242:243], v255 offset:7872
    ds_read_b64_tr_b16 v[244:245], v255 offset:5376
    v_mfma_f32_32x32x16_bf16 v[176:191], v[220:223], v[32:35], v[176:191]
    ds_read_b64_tr_b16 v[246:247], v255 offset:7936
    s_add_u32 s48, s45, 18432
    buffer_load_dwordx4 v[72:75], v252, s[24:27], s48 offen
    s_add_u32 s48, s45, 19456
    buffer_load_dwordx4 v[76:79], v252, s[24:27], s48 offen
    v_mfma_f32_32x32x16_bf16 v[192:207], v[224:227], v[32:35], v[192:207]
    s_waitcnt vmcnt(20) lgkmcnt(0)
    v_mfma_f32_32x32x16_bf16 v[128:143], v[228:231], v[36:39], v[128:143]
    ds_read_b64_tr_b16 v[208:209], v255 offset:10240
    ds_read_b64_tr_b16 v[210:211], v255 offset:12800
    ds_read_b64_tr_b16 v[212:213], v255 offset:10304
    v_mfma_f32_32x32x16_bf16 v[144:159], v[232:235], v[36:39], v[144:159]
    ds_read_b64_tr_b16 v[214:215], v255 offset:12864
    ds_read_b64_tr_b16 v[216:217], v255 offset:10368
    ds_read_b64_tr_b16 v[218:219], v255 offset:12928
    v_mfma_f32_32x32x16_bf16 v[160:175], v[236:239], v[36:39], v[160:175]
    ds_read_b64_tr_b16 v[220:221], v255 offset:10432
    ds_read_b64_tr_b16 v[222:223], v255 offset:12992
    ds_read_b64_tr_b16 v[224:225], v255 offset:10496
    v_mfma_f32_32x32x16_bf16 v[176:191], v[240:243], v[36:39], v[176:191]
    ds_read_b64_tr_b16 v[226:227], v255 offset:13056
    s_add_u32 m0, s43, 40960
    s_add_u32 s47, s44, 409600
    buffer_load_dwordx4 v123, s[20:23], s47 offen offset:0 lds
    buffer_load_dwordx4 v124, s[20:23], s47 offen offset:1024 lds
    buffer_load_dwordx4 v125, s[20:23], s47 offen offset:2048 lds
    buffer_load_dwordx4 v126, s[20:23], s47 offen offset:3072 lds
    s_add_u32 m0, s43, 45056
    s_nop 0
    buffer_load_dwordx4 v127, s[20:23], s47 offen lds
    v_mfma_f32_32x32x16_bf16 v[192:207], v[244:247], v[36:39], v[192:207]
    s_waitcnt vmcnt(24) lgkmcnt(0)
    v_mfma_f32_32x32x16_bf16 v[128:143], v[208:211], v[40:43], v[128:143]
    ds_read_b64_tr_b16 v[228:229], v255 offset:15360
    ds_read_b64_tr_b16 v[230:231], v255 offset:17920
    ds_read_b64_tr_b16 v[232:233], v255 offset:15424
    v_mfma_f32_32x32x16_bf16 v[144:159], v[212:215], v[40:43], v[144:159]
    ds_read_b64_tr_b16 v[234:235], v255 offset:17984
    ds_read_b64_tr_b16 v[236:237], v255 offset:15488
    ds_read_b64_tr_b16 v[238:239], v255 offset:18048
    v_mfma_f32_32x32x16_bf16 v[160:175], v[216:219], v[40:43], v[160:175]
    ds_read_b64_tr_b16 v[240:241], v255 offset:15552
    ds_read_b64_tr_b16 v[242:243], v255 offset:18112
    ds_read_b64_tr_b16 v[244:245], v255 offset:15616
    v_mfma_f32_32x32x16_bf16 v[176:191], v[220:223], v[40:43], v[176:191]
    ds_read_b64_tr_b16 v[246:247], v255 offset:18176
    v_mfma_f32_32x32x16_bf16 v[192:207], v[224:227], v[40:43], v[192:207]
    s_waitcnt vmcnt(18) lgkmcnt(0)
    s_barrier
    v_mfma_f32_32x32x16_bf16 v[128:143], v[228:231], v[44:47], v[128:143]
    ds_read_b64_tr_b16 v[208:209], v251 offset:0
    ds_read_b64_tr_b16 v[210:211], v251 offset:2560
    ds_read_b64_tr_b16 v[212:213], v251 offset:64
    v_mfma_f32_32x32x16_bf16 v[144:159], v[232:235], v[44:47], v[144:159]
    ds_read_b64_tr_b16 v[214:215], v251 offset:2624
    ds_read_b64_tr_b16 v[216:217], v251 offset:128
    ds_read_b64_tr_b16 v[218:219], v251 offset:2688
    v_mfma_f32_32x32x16_bf16 v[160:175], v[236:239], v[44:47], v[160:175]
    ds_read_b64_tr_b16 v[220:221], v251 offset:192
    ds_read_b64_tr_b16 v[222:223], v251 offset:2752
    ds_read_b64_tr_b16 v[224:225], v251 offset:256
    v_mfma_f32_32x32x16_bf16 v[176:191], v[240:243], v[44:47], v[176:191]
    ds_read_b64_tr_b16 v[226:227], v251 offset:2816
    s_add_u32 s48, s45, 20480
    buffer_load_dwordx4 v[80:83], v252, s[24:27], s48 offen
    s_add_u32 s48, s45, 21504
    buffer_load_dwordx4 v[84:87], v252, s[24:27], s48 offen
    v_mfma_f32_32x32x16_bf16 v[192:207], v[244:247], v[44:47], v[192:207]
    s_waitcnt vmcnt(19) lgkmcnt(0)
    v_mfma_f32_32x32x16_bf16 v[128:143], v[208:211], v[48:51], v[128:143]
    ds_read_b64_tr_b16 v[228:229], v251 offset:5120
    ds_read_b64_tr_b16 v[230:231], v251 offset:7680
    ds_read_b64_tr_b16 v[232:233], v251 offset:5184
    v_mfma_f32_32x32x16_bf16 v[144:159], v[212:215], v[48:51], v[144:159]
    ds_read_b64_tr_b16 v[234:235], v251 offset:7744
    ds_read_b64_tr_b16 v[236:237], v251 offset:5248
    ds_read_b64_tr_b16 v[238:239], v251 offset:7808
    v_mfma_f32_32x32x16_bf16 v[160:175], v[216:219], v[48:51], v[160:175]
    ds_read_b64_tr_b16 v[240:241], v251 offset:5312
    ds_read_b64_tr_b16 v[242:243], v251 offset:7872
    ds_read_b64_tr_b16 v[244:245], v251 offset:5376
    v_mfma_f32_32x32x16_bf16 v[176:191], v[220:223], v[48:51], v[176:191]
    ds_read_b64_tr_b16 v[246:247], v251 offset:7936
    s_add_u32 s48, s45, 22528
    buffer_load_dwordx4 v[88:91], v252, s[24:27], s48 offen
    s_add_u32 s48, s45, 23552
    buffer_load_dwordx4 v[92:95], v252, s[24:27], s48 offen
    v_mfma_f32_32x32x16_bf16 v[192:207], v[224:227], v[48:51], v[192:207]
    s_waitcnt vmcnt(20) lgkmcnt(0)
    v_mfma_f32_32x32x16_bf16 v[128:143], v[228:231], v[52:55], v[128:143]
    ds_read_b64_tr_b16 v[208:209], v251 offset:10240
    ds_read_b64_tr_b16 v[210:211], v251 offset:12800
    ds_read_b64_tr_b16 v[212:213], v251 offset:10304
    v_mfma_f32_32x32x16_bf16 v[144:159], v[232:235], v[52:55], v[144:159]
    ds_read_b64_tr_b16 v[214:215], v251 offset:12864
    ds_read_b64_tr_b16 v[216:217], v251 offset:10368
    ds_read_b64_tr_b16 v[218:219], v251 offset:12928
    v_mfma_f32_32x32x16_bf16 v[160:175], v[236:239], v[52:55], v[160:175]
    ds_read_b64_tr_b16 v[220:221], v251 offset:10432
    ds_read_b64_tr_b16 v[222:223], v251 offset:12992
    ds_read_b64_tr_b16 v[224:225], v251 offset:10496
    v_mfma_f32_32x32x16_bf16 v[176:191], v[240:243], v[52:55], v[176:191]
    ds_read_b64_tr_b16 v[226:227], v251 offset:13056
    s_add_u32 m0, s43, 81920
    s_add_u32 s47, s44, 491520
    buffer_load_dwordx4 v123, s[20:23], s47 offen offset:0 lds
    buffer_load_dwordx4 v124, s[20:23], s47 offen offset:1024 lds
    buffer_load_dwordx4 v125, s[20:23], s47 offen offset:2048 lds
    buffer_load_dwordx4 v126, s[20:23], s47 offen offset:3072 lds
    s_add_u32 m0, s43, 86016
    s_nop 0
    buffer_load_dwordx4 v127, s[20:23], s47 offen lds
    v_mfma_f32_32x32x16_bf16 v[192:207], v[244:247], v[52:55], v[192:207]
    s_waitcnt vmcnt(24) lgkmcnt(0)
    v_mfma_f32_32x32x16_bf16 v[128:143], v[208:211], v[56:59], v[128:143]
    ds_read_b64_tr_b16 v[228:229], v251 offset:15360
    ds_read_b64_tr_b16 v[230:231], v251 offset:17920
    ds_read_b64_tr_b16 v[232:233], v251 offset:15424
    v_mfma_f32_32x32x16_bf16 v[144:159], v[212:215], v[56:59], v[144:159]
    ds_read_b64_tr_b16 v[234:235], v251 offset:17984
    ds_read_b64_tr_b16 v[236:237], v251 offset:15488
    ds_read_b64_tr_b16 v[238:239], v251 offset:18048
    v_mfma_f32_32x32x16_bf16 v[160:175], v[216:219], v[56:59], v[160:175]
    ds_read_b64_tr_b16 v[240:241], v251 offset:15552
    ds_read_b64_tr_b16 v[242:243], v251 offset:18112
    ds_read_b64_tr_b16 v[244:245], v251 offset:15616
    v_mfma_f32_32x32x16_bf16 v[176:191], v[220:223], v[56:59], v[176:191]
    ds_read_b64_tr_b16 v[246:247], v251 offset:18176
    v_mfma_f32_32x32x16_bf16 v[192:207], v[224:227], v[56:59], v[192:207]
    s_waitcnt vmcnt(18) lgkmcnt(0)
    s_barrier
    v_mfma_f32_32x32x16_bf16 v[128:143], v[228:231], v[60:63], v[128:143]
    ds_read_b64_tr_b16 v[208:209], v253 offset:0
    ds_read_b64_tr_b16 v[210:211], v253 offset:2560
    ds_read_b64_tr_b16 v[212:213], v253 offset:64
    v_mfma_f32_32x32x16_bf16 v[144:159], v[232:235], v[60:63], v[144:159]
    ds_read_b64_tr_b16 v[214:215], v253 offset:2624
    ds_read_b64_tr_b16 v[216:217], v253 offset:128
    ds_read_b64_tr_b16 v[218:219], v253 offset:2688
    v_mfma_f32_32x32x16_bf16 v[160:175], v[236:239], v[60:63], v[160:175]
    ds_read_b64_tr_b16 v[220:221], v253 offset:192
    ds_read_b64_tr_b16 v[222:223], v253 offset:2752
    ds_read_b64_tr_b16 v[224:225], v253 offset:256
    v_mfma_f32_32x32x16_bf16 v[176:191], v[240:243], v[60:63], v[176:191]
    ds_read_b64_tr_b16 v[226:227], v253 offset:2816
    s_add_u32 s48, s45, 24576
    buffer_load_dwordx4 v[96:99], v252, s[24:27], s48 offen
    s_add_u32 s48, s45, 25600
    buffer_load_dwordx4 v[100:103], v252, s[24:27], s48 offen
    v_mfma_f32_32x32x16_bf16 v[192:207], v[244:247], v[60:63], v[192:207]
    s_waitcnt vmcnt(19) lgkmcnt(0)
    v_mfma_f32_32x32x16_bf16 v[128:143], v[208:211], v[64:67], v[128:143]
    ds_read_b64_tr_b16 v[228:229], v253 offset:5120
    ds_read_b64_tr_b16 v[230:231], v253 offset:7680
    ds_read_b64_tr_b16 v[232:233], v253 offset:5184
    v_mfma_f32_32x32x16_bf16 v[144:159], v[212:215], v[64:67], v[144:159]
    ds_read_b64_tr_b16 v[234:235], v253 offset:7744
    ds_read_b64_tr_b16 v[236:237], v253 offset:5248
    ds_read_b64_tr_b16 v[238:239], v253 offset:7808
    v_mfma_f32_32x32x16_bf16 v[160:175], v[216:219], v[64:67], v[160:175]
    ds_read_b64_tr_b16 v[240:241], v253 offset:5312
    ds_read_b64_tr_b16 v[242:243], v253 offset:7872
    ds_read_b64_tr_b16 v[244:245], v253 offset:5376
    v_mfma_f32_32x32x16_bf16 v[176:191], v[220:223], v[64:67], v[176:191]
    ds_read_b64_tr_b16 v[246:247], v253 offset:7936
    s_add_u32 s48, s45, 26624
    buffer_load_dwordx4 v[104:107], v252, s[24:27], s48 offen
    s_add_u32 s48, s45, 27648
    buffer_load_dwordx4 v[108:111], v252, s[24:27], s48 offen
    v_mfma_f32_32x32x16_bf16 v[192:207], v[224:227], v[64:67], v[192:207]
    s_waitcnt vmcnt(20) lgkmcnt(0)
    v_mfma_f32_32x32x16_bf16 v[128:143], v[228:231], v[68:71], v[128:143]
    ds_read_b64_tr_b16 v[208:209], v253 offset:10240
    ds_read_b64_tr_b16 v[210:211], v253 offset:12800
    ds_read_b64_tr_b16 v[212:213], v253 offset:10304
    v_mfma_f32_32x32x16_bf16 v[144:159], v[232:235], v[68:71], v[144:159]
    ds_read_b64_tr_b16 v[214:215], v253 offset:12864
    ds_read_b64_tr_b16 v[216:217], v253 offset:10368
    ds_read_b64_tr_b16 v[218:219], v253 offset:12928
    v_mfma_f32_32x32x16_bf16 v[160:175], v[236:239], v[68:71], v[160:175]
    ds_read_b64_tr_b16 v[220:221], v253 offset:10432
    ds_read_b64_tr_b16 v[222:223], v253 offset:12992
    ds_read_b64_tr_b16 v[224:225], v253 offset:10496
    v_mfma_f32_32x32x16_bf16 v[176:191], v[240:243], v[68:71], v[176:191]
    ds_read_b64_tr_b16 v[226:227], v253 offset:13056
    s_add_u32 m0, s43, 122880
    s_add_u32 s47, s44, 573440
    buffer_load_dwordx4 v123, s[20:23], s47 offen offset:0 lds
    buffer_load_dwordx4 v124, s[20:23], s47 offen offset:1024 lds
    buffer_load_dwordx4 v125, s[20:23], s47 offen offset:2048 lds
    buffer_load_dwordx4 v126, s[20:23], s47 offen offset:3072 lds
    s_add_u32 m0, s43, 126976
    s_nop 0
    buffer_load_dwordx4 v127, s[20:23], s47 offen lds
    v_mfma_f32_32x32x16_bf16 v[192:207], v[244:247], v[68:71], v[192:207]
    s_waitcnt vmcnt(24) lgkmcnt(0)
    v_mfma_f32_32x32x16_bf16 v[128:143], v[208:211], v[72:75], v[128:143]
    ds_read_b64_tr_b16 v[228:229], v253 offset:15360
    ds_read_b64_tr_b16 v[230:231], v253 offset:17920
    ds_read_b64_tr_b16 v[232:233], v253 offset:15424
    v_mfma_f32_32x32x16_bf16 v[144:159], v[212:215], v[72:75], v[144:159]
    ds_read_b64_tr_b16 v[234:235], v253 offset:17984
    ds_read_b64_tr_b16 v[236:237], v253 offset:15488
    ds_read_b64_tr_b16 v[238:239], v253 offset:18048
    v_mfma_f32_32x32x16_bf16 v[160:175], v[216:219], v[72:75], v[160:175]
    ds_read_b64_tr_b16 v[240:241], v253 offset:15552
    ds_read_b64_tr_b16 v[242:243], v253 offset:18112
    ds_read_b64_tr_b16 v[244:245], v253 offset:15616
    v_mfma_f32_32x32x16_bf16 v[176:191], v[220:223], v[72:75], v[176:191]
    ds_read_b64_tr_b16 v[246:247], v253 offset:18176
    s_add_u32 s48, s45, 28672
    buffer_load_dwordx4 v[112:115], v252, s[24:27], s48 offen
    s_add_u32 s48, s45, 29696
    buffer_load_dwordx4 v[116:119], v252, s[24:27], s48 offen
    v_mfma_f32_32x32x16_bf16 v[192:207], v[224:227], v[72:75], v[192:207]
    s_waitcnt vmcnt(20) lgkmcnt(0)
    s_barrier
    v_mfma_f32_32x32x16_bf16 v[128:143], v[228:231], v[76:79], v[128:143]
    ds_read_b64_tr_b16 v[208:209], v254 offset:0
    ds_read_b64_tr_b16 v[210:211], v254 offset:2560
    ds_read_b64_tr_b16 v[212:213], v254 offset:64
    v_mfma_f32_32x32x16_bf16 v[144:159], v[232:235], v[76:79], v[144:159]
    ds_read_b64_tr_b16 v[214:215], v254 offset:2624
    ds_read_b64_tr_b16 v[216:217], v254 offset:128
    ds_read_b64_tr_b16 v[218:219], v254 offset:2688
    v_mfma_f32_32x32x16_bf16 v[160:175], v[236:239], v[76:79], v[160:175]
    ds_read_b64_tr_b16 v[220:221], v254 offset:192
    ds_read_b64_tr_b16 v[222:223], v254 offset:2752
    ds_read_b64_tr_b16 v[224:225], v254 offset:256
    v_mfma_f32_32x32x16_bf16 v[176:191], v[240:243], v[76:79], v[176:191]
    ds_read_b64_tr_b16 v[226:227], v254 offset:2816
    s_add_u32 s48, s45, 30720
    buffer_load_dwordx4 v[120:123], v252, s[24:27], s48 offen
    s_add_u32 s48, s45, 31744
    buffer_load_dwordx4 v[124:127], v252, s[24:27], s48 offen
    v_mfma_f32_32x32x16_bf16 v[192:207], v[244:247], v[76:79], v[192:207]
    s_waitcnt vmcnt(21) lgkmcnt(0)
    v_mfma_f32_32x32x16_bf16 v[128:143], v[208:211], v[80:83], v[128:143]
    ds_read_b64_tr_b16 v[228:229], v254 offset:5120
    ds_read_b64_tr_b16 v[230:231], v254 offset:7680
    ds_read_b64_tr_b16 v[232:233], v254 offset:5184
    v_mfma_f32_32x32x16_bf16 v[144:159], v[212:215], v[80:83], v[144:159]
    ds_read_b64_tr_b16 v[234:235], v254 offset:7744
    ds_read_b64_tr_b16 v[236:237], v254 offset:5248
    ds_read_b64_tr_b16 v[238:239], v254 offset:7808
    v_mfma_f32_32x32x16_bf16 v[160:175], v[216:219], v[80:83], v[160:175]
    ds_read_b64_tr_b16 v[240:241], v254 offset:5312
    ds_read_b64_tr_b16 v[242:243], v254 offset:7872
    ds_read_b64_tr_b16 v[244:245], v254 offset:5376
    v_mfma_f32_32x32x16_bf16 v[176:191], v[220:223], v[80:83], v[176:191]
    ds_read_b64_tr_b16 v[246:247], v254 offset:7936
    v_mfma_f32_32x32x16_bf16 v[192:207], v[224:227], v[80:83], v[192:207]
    s_waitcnt vmcnt(20) lgkmcnt(0)
    v_mfma_f32_32x32x16_bf16 v[128:143], v[228:231], v[84:87], v[128:143]
    ds_read_b64_tr_b16 v[208:209], v254 offset:10240
    ds_read_b64_tr_b16 v[210:211], v254 offset:12800
    ds_read_b64_tr_b16 v[212:213], v254 offset:10304
    v_mfma_f32_32x32x16_bf16 v[144:159], v[232:235], v[84:87], v[144:159]
    ds_read_b64_tr_b16 v[214:215], v254 offset:12864
    ds_read_b64_tr_b16 v[216:217], v254 offset:10368
    ds_read_b64_tr_b16 v[218:219], v254 offset:12928
    v_mfma_f32_32x32x16_bf16 v[160:175], v[236:239], v[84:87], v[160:175]
    ds_read_b64_tr_b16 v[220:221], v254 offset:10432
    ds_read_b64_tr_b16 v[222:223], v254 offset:12992
    ds_read_b64_tr_b16 v[224:225], v254 offset:10496
    v_mfma_f32_32x32x16_bf16 v[176:191], v[240:243], v[84:87], v[176:191]
    ds_read_b64_tr_b16 v[226:227], v254 offset:13056
    v_mfma_f32_32x32x16_bf16 v[192:207], v[244:247], v[84:87], v[192:207]
    s_waitcnt vmcnt(19) lgkmcnt(0)
    v_mfma_f32_32x32x16_bf16 v[128:143], v[208:211], v[88:91], v[128:143]
    ds_read_b64_tr_b16 v[228:229], v254 offset:15360
    ds_read_b64_tr_b16 v[230:231], v254 offset:17920
    ds_read_b64_tr_b16 v[232:233], v254 offset:15424
    v_mfma_f32_32x32x16_bf16 v[144:159], v[212:215], v[88:91], v[144:159]
    ds_read_b64_tr_b16 v[234:235], v254 offset:17984
    ds_read_b64_tr_b16 v[236:237], v254 offset:15488
    ds_read_b64_tr_b16 v[238:239], v254 offset:18048
    v_mfma_f32_32x32x16_bf16 v[160:175], v[216:219], v[88:91], v[160:175]
    ds_read_b64_tr_b16 v[240:241], v254 offset:15552
    ds_read_b64_tr_b16 v[242:243], v254 offset:18112
    ds_read_b64_tr_b16 v[244:245], v254 offset:15616
    v_mfma_f32_32x32x16_bf16 v[176:191], v[220:223], v[88:91], v[176:191]
    ds_read_b64_tr_b16 v[246:247], v254 offset:18176
    v_mfma_f32_32x32x16_bf16 v[192:207], v[224:227], v[88:91], v[192:207]
    s_waitcnt vmcnt(13) lgkmcnt(0)
    s_barrier
    v_mfma_f32_32x32x16_bf16 v[128:143], v[228:231], v[92:95], v[128:143]
    ds_read_b64_tr_b16 v[208:209], v255 offset:0
    ds_read_b64_tr_b16 v[210:211], v255 offset:2560
    ds_read_b64_tr_b16 v[212:213], v255 offset:64
    v_mfma_f32_32x32x16_bf16 v[144:159], v[232:235], v[92:95], v[144:159]
    ds_read_b64_tr_b16 v[214:215], v255 offset:2624
    ds_read_b64_tr_b16 v[216:217], v255 offset:128
    ds_read_b64_tr_b16 v[218:219], v255 offset:2688
    v_mfma_f32_32x32x16_bf16 v[160:175], v[236:239], v[92:95], v[160:175]
    ds_read_b64_tr_b16 v[220:221], v255 offset:192
    ds_read_b64_tr_b16 v[222:223], v255 offset:2752
    ds_read_b64_tr_b16 v[224:225], v255 offset:256
    v_mfma_f32_32x32x16_bf16 v[176:191], v[240:243], v[92:95], v[176:191]
    ds_read_b64_tr_b16 v[226:227], v255 offset:2816
    v_mfma_f32_32x32x16_bf16 v[192:207], v[244:247], v[92:95], v[192:207]
    s_waitcnt vmcnt(12) lgkmcnt(0)
    v_mfma_f32_32x32x16_bf16 v[128:143], v[208:211], v[96:99], v[128:143]
    ds_read_b64_tr_b16 v[228:229], v255 offset:5120
    ds_read_b64_tr_b16 v[230:231], v255 offset:7680
    ds_read_b64_tr_b16 v[232:233], v255 offset:5184
    v_mfma_f32_32x32x16_bf16 v[144:159], v[212:215], v[96:99], v[144:159]
    ds_read_b64_tr_b16 v[234:235], v255 offset:7744
    ds_read_b64_tr_b16 v[236:237], v255 offset:5248
    ds_read_b64_tr_b16 v[238:239], v255 offset:7808
    v_mfma_f32_32x32x16_bf16 v[160:175], v[216:219], v[96:99], v[160:175]
    ds_read_b64_tr_b16 v[240:241], v255 offset:5312
    ds_read_b64_tr_b16 v[242:243], v255 offset:7872
    ds_read_b64_tr_b16 v[244:245], v255 offset:5376
    v_mfma_f32_32x32x16_bf16 v[176:191], v[220:223], v[96:99], v[176:191]
    ds_read_b64_tr_b16 v[246:247], v255 offset:7936
    v_mfma_f32_32x32x16_bf16 v[192:207], v[224:227], v[96:99], v[192:207]
    s_waitcnt vmcnt(11) lgkmcnt(0)
    v_mfma_f32_32x32x16_bf16 v[128:143], v[228:231], v[100:103], v[128:143]
    ds_read_b64_tr_b16 v[208:209], v255 offset:10240
    ds_read_b64_tr_b16 v[210:211], v255 offset:12800
    ds_read_b64_tr_b16 v[212:213], v255 offset:10304
    v_mfma_f32_32x32x16_bf16 v[144:159], v[232:235], v[100:103], v[144:159]
    ds_read_b64_tr_b16 v[214:215], v255 offset:12864
    ds_read_b64_tr_b16 v[216:217], v255 offset:10368
    ds_read_b64_tr_b16 v[218:219], v255 offset:12928
    v_mfma_f32_32x32x16_bf16 v[160:175], v[236:239], v[100:103], v[160:175]
    ds_read_b64_tr_b16 v[220:221], v255 offset:10432
    ds_read_b64_tr_b16 v[222:223], v255 offset:12992
    ds_read_b64_tr_b16 v[224:225], v255 offset:10496
    v_mfma_f32_32x32x16_bf16 v[176:191], v[240:243], v[100:103], v[176:191]
    ds_read_b64_tr_b16 v[226:227], v255 offset:13056
    v_mfma_f32_32x32x16_bf16 v[192:207], v[244:247], v[100:103], v[192:207]
    s_waitcnt vmcnt(10) lgkmcnt(0)
    v_mfma_f32_32x32x16_bf16 v[128:143], v[208:211], v[104:107], v[128:143]
    ds_read_b64_tr_b16 v[228:229], v255 offset:15360
    ds_read_b64_tr_b16 v[230:231], v255 offset:17920
    ds_read_b64_tr_b16 v[232:233], v255 offset:15424
    v_mfma_f32_32x32x16_bf16 v[144:159], v[212:215], v[104:107], v[144:159]
    ds_read_b64_tr_b16 v[234:235], v255 offset:17984
    ds_read_b64_tr_b16 v[236:237], v255 offset:15488
    ds_read_b64_tr_b16 v[238:239], v255 offset:18048
    v_mfma_f32_32x32x16_bf16 v[160:175], v[216:219], v[104:107], v[160:175]
    ds_read_b64_tr_b16 v[240:241], v255 offset:15552
    ds_read_b64_tr_b16 v[242:243], v255 offset:18112
    ds_read_b64_tr_b16 v[244:245], v255 offset:15616
    v_mfma_f32_32x32x16_bf16 v[176:191], v[220:223], v[104:107], v[176:191]
    ds_read_b64_tr_b16 v[246:247], v255 offset:18176
    v_mfma_f32_32x32x16_bf16 v[192:207], v[224:227], v[104:107], v[192:207]
    s_waitcnt vmcnt(4) lgkmcnt(0)
    s_barrier
    v_mfma_f32_32x32x16_bf16 v[128:143], v[228:231], v[108:111], v[128:143]
    ds_read_b64_tr_b16 v[208:209], v251 offset:0
    ds_read_b64_tr_b16 v[210:211], v251 offset:2560
    ds_read_b64_tr_b16 v[212:213], v251 offset:64
    v_mfma_f32_32x32x16_bf16 v[144:159], v[232:235], v[108:111], v[144:159]
    ds_read_b64_tr_b16 v[214:215], v251 offset:2624
    ds_read_b64_tr_b16 v[216:217], v251 offset:128
    ds_read_b64_tr_b16 v[218:219], v251 offset:2688
    v_mfma_f32_32x32x16_bf16 v[160:175], v[236:239], v[108:111], v[160:175]
    ds_read_b64_tr_b16 v[220:221], v251 offset:192
    ds_read_b64_tr_b16 v[222:223], v251 offset:2752
    ds_read_b64_tr_b16 v[224:225], v251 offset:256
    v_mfma_f32_32x32x16_bf16 v[176:191], v[240:243], v[108:111], v[176:191]
    ds_read_b64_tr_b16 v[226:227], v251 offset:2816
    v_mfma_f32_32x32x16_bf16 v[192:207], v[244:247], v[108:111], v[192:207]
    s_waitcnt vmcnt(3) lgkmcnt(0)
    v_mfma_f32_32x32x16_bf16 v[128:143], v[208:211], v[112:115], v[128:143]
    ds_read_b64_tr_b16 v[228:229], v251 offset:5120
    ds_read_b64_tr_b16 v[230:231], v251 offset:7680
    ds_read_b64_tr_b16 v[232:233], v251 offset:5184
    v_mfma_f32_32x32x16_bf16 v[144:159], v[212:215], v[112:115], v[144:159]
    ds_read_b64_tr_b16 v[234:235], v251 offset:7744
    ds_read_b64_tr_b16 v[236:237], v251 offset:5248
    ds_read_b64_tr_b16 v[238:239], v251 offset:7808
    v_mfma_f32_32x32x16_bf16 v[160:175], v[216:219], v[112:115], v[160:175]
    ds_read_b64_tr_b16 v[240:241], v251 offset:5312
    ds_read_b64_tr_b16 v[242:243], v251 offset:7872
    ds_read_b64_tr_b16 v[244:245], v251 offset:5376
    v_mfma_f32_32x32x16_bf16 v[176:191], v[220:223], v[112:115], v[176:191]
    ds_read_b64_tr_b16 v[246:247], v251 offset:7936
    v_mfma_f32_32x32x16_bf16 v[192:207], v[224:227], v[112:115], v[192:207]
    s_waitcnt vmcnt(2) lgkmcnt(0)
    v_mfma_f32_32x32x16_bf16 v[128:143], v[228:231], v[116:119], v[128:143]
    ds_read_b64_tr_b16 v[208:209], v251 offset:10240
    ds_read_b64_tr_b16 v[210:211], v251 offset:12800
    ds_read_b64_tr_b16 v[212:213], v251 offset:10304
    v_mfma_f32_32x32x16_bf16 v[144:159], v[232:235], v[116:119], v[144:159]
    ds_read_b64_tr_b16 v[214:215], v251 offset:12864
    ds_read_b64_tr_b16 v[216:217], v251 offset:10368
    ds_read_b64_tr_b16 v[218:219], v251 offset:12928
    v_mfma_f32_32x32x16_bf16 v[160:175], v[236:239], v[116:119], v[160:175]
    ds_read_b64_tr_b16 v[220:221], v251 offset:10432
    ds_read_b64_tr_b16 v[222:223], v251 offset:12992
    ds_read_b64_tr_b16 v[224:225], v251 offset:10496
    v_mfma_f32_32x32x16_bf16 v[176:191], v[240:243], v[116:119], v[176:191]
    ds_read_b64_tr_b16 v[226:227], v251 offset:13056
    v_mfma_f32_32x32x16_bf16 v[192:207], v[244:247], v[116:119], v[192:207]
    s_waitcnt vmcnt(1) lgkmcnt(0)
    v_mfma_f32_32x32x16_bf16 v[128:143], v[208:211], v[120:123], v[128:143]
    ds_read_b64_tr_b16 v[228:229], v251 offset:15360
    ds_read_b64_tr_b16 v[230:231], v251 offset:17920
    ds_read_b64_tr_b16 v[232:233], v251 offset:15424
    v_mfma_f32_32x32x16_bf16 v[144:159], v[212:215], v[120:123], v[144:159]
    ds_read_b64_tr_b16 v[234:235], v251 offset:17984
    ds_read_b64_tr_b16 v[236:237], v251 offset:15488
    ds_read_b64_tr_b16 v[238:239], v251 offset:18048
    v_mfma_f32_32x32x16_bf16 v[160:175], v[216:219], v[120:123], v[160:175]
    ds_read_b64_tr_b16 v[240:241], v251 offset:15552
    ds_read_b64_tr_b16 v[242:243], v251 offset:18112
    ds_read_b64_tr_b16 v[244:245], v251 offset:15616
    v_mfma_f32_32x32x16_bf16 v[176:191], v[220:223], v[120:123], v[176:191]
    ds_read_b64_tr_b16 v[246:247], v251 offset:18176
    v_mfma_f32_32x32x16_bf16 v[192:207], v[224:227], v[120:123], v[192:207]
    s_waitcnt vmcnt(0) lgkmcnt(0)
    v_mfma_f32_32x32x16_bf16 v[128:143], v[228:231], v[124:127], v[128:143]
    v_mfma_f32_32x32x16_bf16 v[144:159], v[232:235], v[124:127], v[144:159]
    v_mfma_f32_32x32x16_bf16 v[160:175], v[236:239], v[124:127], v[160:175]
    v_mfma_f32_32x32x16_bf16 v[176:191], v[240:243], v[124:127], v[176:191]
    v_mfma_f32_32x32x16_bf16 v[192:207], v[244:247], v[124:127], v[192:207]
    s_mul_i32 s54, s14, 10240
    v_add_u32 v249, s54, v252
    s_xor_b32 s55, s14, 4
    s_mul_i32 s55, s55, 10240
    v_add_u32 v250, s55, v252
    s_mul_i32 s49, s15, 2621440
    s_mul_i32 s50, s18, 40960
    s_add_u32 s49, s49, s50
    s_mul_i32 s50, s16, 10240
    s_add_u32 s49, s49, s50
    s_mul_i32 s50, s52, 5120
    s_add_u32 s49, s49, s50
    s_add_u32 s50, s49, 4096
    s_cmp_eq_u32 s52, 0
    s_cbranch_scc0 K3_KH1
    ds_write_b128 v249, v[168:171] offset:0
    ds_write_b128 v249, v[172:175] offset:1024
    ds_write_b128 v249, v[176:179] offset:2048
    ds_write_b128 v249, v[180:183] offset:3072
    ds_write_b128 v249, v[184:187] offset:4096
    ds_write_b128 v249, v[188:191] offset:5120
    ds_write_b128 v249, v[192:195] offset:6144
    ds_write_b128 v249, v[196:199] offset:7168
    ds_write_b128 v249, v[200:203] offset:8192
    ds_write_b128 v249, v[204:207] offset:9216
    s_waitcnt lgkmcnt(0)
    s_barrier
    ds_read_b128 v[0:3], v250 offset:0
    ds_read_b128 v[4:7], v250 offset:1024
    ds_read_b128 v[8:11], v250 offset:2048
    ds_read_b128 v[12:15], v250 offset:3072
    ds_read_b128 v[16:19], v250 offset:4096
    ds_read_b128 v[20:23], v250 offset:5120
    ds_read_b128 v[24:27], v250 offset:6144
    ds_read_b128 v[28:31], v250 offset:7168
    ds_read_b128 v[32:35], v250 offset:8192
    ds_read_b128 v[36:39], v250 offset:9216
    s_waitcnt lgkmcnt(8)
    v_add_f32 v128, v128, v0
    v_add_f32 v129, v129, v1
    v_add_f32 v130, v130, v2
    v_add_f32 v131, v131, v3
    v_add_f32 v132, v132, v4
    v_add_f32 v133, v133, v5
    v_add_f32 v134, v134, v6
    v_add_f32 v135, v135, v7
    v_cvt_pk_bf16_f32 v64, v128, v129
    v_cvt_pk_bf16_f32 v65, v130, v131
    v_cvt_pk_bf16_f32 v66, v132, v133
    v_cvt_pk_bf16_f32 v67, v134, v135
    buffer_store_dwordx4 v[64:67], v252, s[28:31], s49 offen offset:0 sc1
    s_waitcnt lgkmcnt(6)
    v_add_f32 v136, v136, v8
    v_add_f32 v137, v137, v9
    v_add_f32 v138, v138, v10
    v_add_f32 v139, v139, v11
    v_add_f32 v140, v140, v12
    v_add_f32 v141, v141, v13
    v_add_f32 v142, v142, v14
    v_add_f32 v143, v143, v15
    v_cvt_pk_bf16_f32 v68, v136, v137
    v_cvt_pk_bf16_f32 v69, v138, v139
    v_cvt_pk_bf16_f32 v70, v140, v141
    v_cvt_pk_bf16_f32 v71, v142, v143
    buffer_store_dwordx4 v[68:71], v252, s[28:31], s49 offen offset:1024 sc1
    s_waitcnt lgkmcnt(4)
    v_add_f32 v144, v144, v16
    v_add_f32 v145, v145, v17
    v_add_f32 v146, v146, v18
    v_add_f32 v147, v147, v19
    v_add_f32 v148, v148, v20
    v_add_f32 v149, v149, v21
    v_add_f32 v150, v150, v22
    v_add_f32 v151, v151, v23
    v_cvt_pk_bf16_f32 v72, v144, v145
    v_cvt_pk_bf16_f32 v73, v146, v147
    v_cvt_pk_bf16_f32 v74, v148, v149
    v_cvt_pk_bf16_f32 v75, v150, v151
    buffer_store_dwordx4 v[72:75], v252, s[28:31], s49 offen offset:2048 sc1
    s_waitcnt lgkmcnt(2)
    v_add_f32 v152, v152, v24
    v_add_f32 v153, v153, v25
    v_add_f32 v154, v154, v26
    v_add_f32 v155, v155, v27
    v_add_f32 v156, v156, v28
    v_add_f32 v157, v157, v29
    v_add_f32 v158, v158, v30
    v_add_f32 v159, v159, v31
    v_cvt_pk_bf16_f32 v76, v152, v153
    v_cvt_pk_bf16_f32 v77, v154, v155
    v_cvt_pk_bf16_f32 v78, v156, v157
    v_cvt_pk_bf16_f32 v79, v158, v159
    buffer_store_dwordx4 v[76:79], v252, s[28:31], s49 offen offset:3072 sc1
    s_waitcnt lgkmcnt(0)
    v_add_f32 v160, v160, v32
    v_add_f32 v161, v161, v33
    v_add_f32 v162, v162, v34
    v_add_f32 v163, v163, v35
    v_add_f32 v164, v164, v36
    v_add_f32 v165, v165, v37
    v_add_f32 v166, v166, v38
    v_add_f32 v167, v167, v39
    v_cvt_pk_bf16_f32 v80, v160, v161
    v_cvt_pk_bf16_f32 v81, v162, v163
    v_cvt_pk_bf16_f32 v82, v164, v165
    v_cvt_pk_bf16_f32 v83, v166, v167
    buffer_store_dwordx4 v[80:83], v252, s[28:31], s50 offen offset:0 sc1
    s_endpgm
K3_KH1:
    ds_write_b128 v249, v[128:131] offset:0
    ds_write_b128 v249, v[132:135] offset:1024
    ds_write_b128 v249, v[136:139] offset:2048
    ds_write_b128 v249, v[140:143] offset:3072
    ds_write_b128 v249, v[144:147] offset:4096
    ds_write_b128 v249, v[148:151] offset:5120
    ds_write_b128 v249, v[152:155] offset:6144
    ds_write_b128 v249, v[156:159] offset:7168
    ds_write_b128 v249, v[160:163] offset:8192
    ds_write_b128 v249, v[164:167] offset:9216
    s_waitcnt lgkmcnt(0)
    s_barrier
    ds_read_b128 v[0:3], v250 offset:0
    ds_read_b128 v[4:7], v250 offset:1024
    ds_read_b128 v[8:11], v250 offset:2048
    ds_read_b128 v[12:15], v250 offset:3072
    ds_read_b128 v[16:19], v250 offset:4096
    ds_read_b128 v[20:23], v250 offset:5120
    ds_read_b128 v[24:27], v250 offset:6144
    ds_read_b128 v[28:31], v250 offset:7168
    ds_read_b128 v[32:35], v250 offset:8192
    ds_read_b128 v[36:39], v250 offset:9216
    s_waitcnt lgkmcnt(8)
    v_add_f32 v168, v168, v0
    v_add_f32 v169, v169, v1
    v_add_f32 v170, v170, v2
    v_add_f32 v171, v171, v3
    v_add_f32 v172, v172, v4
    v_add_f32 v173, v173, v5
    v_add_f32 v174, v174, v6
    v_add_f32 v175, v175, v7
    v_cvt_pk_bf16_f32 v64, v168, v169
    v_cvt_pk_bf16_f32 v65, v170, v171
    v_cvt_pk_bf16_f32 v66, v172, v173
    v_cvt_pk_bf16_f32 v67, v174, v175
    buffer_store_dwordx4 v[64:67], v252, s[28:31], s49 offen offset:0 sc1
    s_waitcnt lgkmcnt(6)
    v_add_f32 v176, v176, v8
    v_add_f32 v177, v177, v9
    v_add_f32 v178, v178, v10
    v_add_f32 v179, v179, v11
    v_add_f32 v180, v180, v12
    v_add_f32 v181, v181, v13
    v_add_f32 v182, v182, v14
    v_add_f32 v183, v183, v15
    v_cvt_pk_bf16_f32 v68, v176, v177
    v_cvt_pk_bf16_f32 v69, v178, v179
    v_cvt_pk_bf16_f32 v70, v180, v181
    v_cvt_pk_bf16_f32 v71, v182, v183
    buffer_store_dwordx4 v[68:71], v252, s[28:31], s49 offen offset:1024 sc1
    s_waitcnt lgkmcnt(4)
    v_add_f32 v184, v184, v16
    v_add_f32 v185, v185, v17
    v_add_f32 v186, v186, v18
    v_add_f32 v187, v187, v19
    v_add_f32 v188, v188, v20
    v_add_f32 v189, v189, v21
    v_add_f32 v190, v190, v22
    v_add_f32 v191, v191, v23
    v_cvt_pk_bf16_f32 v72, v184, v185
    v_cvt_pk_bf16_f32 v73, v186, v187
    v_cvt_pk_bf16_f32 v74, v188, v189
    v_cvt_pk_bf16_f32 v75, v190, v191
    buffer_store_dwordx4 v[72:75], v252, s[28:31], s49 offen offset:2048 sc1
    s_waitcnt lgkmcnt(2)
    v_add_f32 v192, v192, v24
    v_add_f32 v193, v193, v25
    v_add_f32 v194, v194, v26
    v_add_f32 v195, v195, v27
    v_add_f32 v196, v196, v28
    v_add_f32 v197, v197, v29
    v_add_f32 v198, v198, v30
    v_add_f32 v199, v199, v31
    v_cvt_pk_bf16_f32 v76, v192, v193
    v_cvt_pk_bf16_f32 v77, v194, v195
    v_cvt_pk_bf16_f32 v78, v196, v197
    v_cvt_pk_bf16_f32 v79, v198, v199
    buffer_store_dwordx4 v[76:79], v252, s[28:31], s49 offen offset:3072 sc1
    s_waitcnt lgkmcnt(0)
    v_add_f32 v200, v200, v32
    v_add_f32 v201, v201, v33
    v_add_f32 v202, v202, v34
    v_add_f32 v203, v203, v35
    v_add_f32 v204, v204, v36
    v_add_f32 v205, v205, v37
    v_add_f32 v206, v206, v38
    v_add_f32 v207, v207, v39
    v_cvt_pk_bf16_f32 v80, v200, v201
    v_cvt_pk_bf16_f32 v81, v202, v203
    v_cvt_pk_bf16_f32 v82, v204, v205
    v_cvt_pk_bf16_f32 v83, v206, v207
    buffer_store_dwordx4 v[80:83], v252, s[28:31], s50 offen offset:0 sc1
    s_endpgm
K3_END:
    s_endpgm
k3_kernel_end:
.globl k4_kernel
.p2align 8
.type k4_kernel,@function
k4_kernel:
    s_cmp_ge_u32 s2, 256
    s_cbranch_scc1 K4_END
    s_load_dwordx2 s[4:5], s[0:1], 0
    s_load_dwordx2 s[6:7], s[0:1], 104
    v_and_b32 v1, 7, v0
    v_lshrrev_b32 v2, 3, v0
    s_lshl_b32 s14, s2, 3
    v_add_u32 v3, s14, v1
    s_lshr_b32 s15, s2, 2
    s_mul_i32 s16, s15, 40960
    v_and_b32 v4, 31, v3
    v_lshlrev_b32 v4, 4, v4
    v_lshl_add_u32 v4, v2, 10, v4
    v_add_u32 v4, s16, v4
    s_movk_i32 s17, 1280
    v_mul_u32_u24 v5, s17, v3
    v_lshl_add_u32 v5, v2, 5, v5
    s_waitcnt lgkmcnt(0)
    s_mov_b32 s20, s4
    s_and_b32 s21, s5, 0xffff
    s_mov_b32 s22, 2621440
    s_mov_b32 s23, 0x00020000
    s_add_u32 s24, s6, 54525952
    s_addc_u32 s25, s7, 0
    s_and_b32 s25, s25, 0xffff
    s_mov_b32 s26, 10485760
    s_mov_b32 s27, 0x00020000
    s_add_u32 s28, s6, 100663296
    s_addc_u32 s29, s7, 0
    s_and_b32 s29, s29, 0xffff
    s_mov_b32 s30, 2621440
    s_mov_b32 s31, 0x00020000
    s_add_u32 s32, s6, 104857600
    s_addc_u32 s33, s7, 0
    s_and_b32 s33, s33, 0xffff
    s_mov_b32 s34, 2621440
    s_mov_b32 s35, 0x00020000
    s_mov_b32 s18, 0
    buffer_load_dwordx4 v[32:35], v4, s[24:27], s18 offen
    buffer_load_dwordx4 v[36:39], v4, s[24:27], s18 offen offset:512
    s_mov_b32 s18, 2621440
    buffer_load_dwordx4 v[40:43], v4, s[24:27], s18 offen
    buffer_load_dwordx4 v[44:47], v4, s[24:27], s18 offen offset:512
    s_mov_b32 s18, 5242880
    buffer_load_dwordx4 v[48:51], v4, s[24:27], s18 offen
    buffer_load_dwordx4 v[52:55], v4, s[24:27], s18 offen offset:512
    s_mov_b32 s18, 7864320
    buffer_load_dwordx4 v[56:59], v4, s[24:27], s18 offen
    buffer_load_dwordx4 v[60:63], v4, s[24:27], s18 offen offset:512
    buffer_load_dwordx4 v[96:99], v5, s[20:23], 0 offen
    buffer_load_dwordx4 v[100:103], v5, s[20:23], 0 offen offset:16
    v_mul_u32_u24 v6, 80, v1
    v_lshrrev_b32 v7, 4, v0
    v_lshl_add_u32 v7, v7, 2, v6
    s_waitcnt vmcnt(8)
    v_lshlrev_b32 v16, 16, v32
    v_and_b32 v17, 0xffff0000, v32
    v_lshlrev_b32 v18, 16, v33
    v_and_b32 v19, 0xffff0000, v33
    v_lshlrev_b32 v20, 16, v36
    v_and_b32 v21, 0xffff0000, v36
    v_lshlrev_b32 v22, 16, v37
    v_and_b32 v23, 0xffff0000, v37
    v_lshlrev_b32 v24, 16, v34
    v_and_b32 v25, 0xffff0000, v34
    v_lshlrev_b32 v26, 16, v35
    v_and_b32 v27, 0xffff0000, v35
    v_lshlrev_b32 v28, 16, v38
    v_and_b32 v29, 0xffff0000, v38
    v_lshlrev_b32 v30, 16, v39
    v_and_b32 v31, 0xffff0000, v39
    s_waitcnt vmcnt(6)
    v_lshlrev_b32 v8, 16, v40
    v_and_b32 v9, 0xffff0000, v40
    v_add_f32 v16, v16, v8
    v_add_f32 v17, v17, v9
    v_lshlrev_b32 v8, 16, v41
    v_and_b32 v9, 0xffff0000, v41
    v_add_f32 v18, v18, v8
    v_add_f32 v19, v19, v9
    v_lshlrev_b32 v8, 16, v44
    v_and_b32 v9, 0xffff0000, v44
    v_add_f32 v20, v20, v8
    v_add_f32 v21, v21, v9
    v_lshlrev_b32 v8, 16, v45
    v_and_b32 v9, 0xffff0000, v45
    v_add_f32 v22, v22, v8
    v_add_f32 v23, v23, v9
    v_lshlrev_b32 v8, 16, v42
    v_and_b32 v9, 0xffff0000, v42
    v_add_f32 v24, v24, v8
    v_add_f32 v25, v25, v9
    v_lshlrev_b32 v8, 16, v43
    v_and_b32 v9, 0xffff0000, v43
    v_add_f32 v26, v26, v8
    v_add_f32 v27, v27, v9
    v_lshlrev_b32 v8, 16, v46
    v_and_b32 v9, 0xffff0000, v46
    v_add_f32 v28, v28, v8
    v_add_f32 v29, v29, v9
    v_lshlrev_b32 v8, 16, v47
    v_and_b32 v9, 0xffff0000, v47
    v_add_f32 v30, v30, v8
    v_add_f32 v31, v31, v9
    s_waitcnt vmcnt(4)
    v_lshlrev_b32 v8, 16, v48
    v_and_b32 v9, 0xffff0000, v48
    v_add_f32 v16, v16, v8
    v_add_f32 v17, v17, v9
    v_lshlrev_b32 v8, 16, v49
    v_and_b32 v9, 0xffff0000, v49
    v_add_f32 v18, v18, v8
    v_add_f32 v19, v19, v9
    v_lshlrev_b32 v8, 16, v52
    v_and_b32 v9, 0xffff0000, v52
    v_add_f32 v20, v20, v8
    v_add_f32 v21, v21, v9
    v_lshlrev_b32 v8, 16, v53
    v_and_b32 v9, 0xffff0000, v53
    v_add_f32 v22, v22, v8
    v_add_f32 v23, v23, v9
    v_lshlrev_b32 v8, 16, v50
    v_and_b32 v9, 0xffff0000, v50
    v_add_f32 v24, v24, v8
    v_add_f32 v25, v25, v9
    v_lshlrev_b32 v8, 16, v51
    v_and_b32 v9, 0xffff0000, v51
    v_add_f32 v26, v26, v8
    v_add_f32 v27, v27, v9
    v_lshlrev_b32 v8, 16, v54
    v_and_b32 v9, 0xffff0000, v54
    v_add_f32 v28, v28, v8
    v_add_f32 v29, v29, v9
    v_lshlrev_b32 v8, 16, v55
    v_and_b32 v9, 0xffff0000, v55
    v_add_f32 v30, v30, v8
    v_add_f32 v31, v31, v9
    s_waitcnt vmcnt(2)
    v_lshlrev_b32 v8, 16, v56
    v_and_b32 v9, 0xffff0000, v56
    v_add_f32 v16, v16, v8
    v_add_f32 v17, v17, v9
    v_lshlrev_b32 v8, 16, v57
    v_and_b32 v9, 0xffff0000, v57
    v_add_f32 v18, v18, v8
    v_add_f32 v19, v19, v9
    v_lshlrev_b32 v8, 16, v60
    v_and_b32 v9, 0xffff0000, v60
    v_add_f32 v20, v20, v8
    v_add_f32 v21, v21, v9
    v_lshlrev_b32 v8, 16, v61
    v_and_b32 v9, 0xffff0000, v61
    v_add_f32 v22, v22, v8
    v_add_f32 v23, v23, v9
    v_lshlrev_b32 v8, 16, v58
    v_and_b32 v9, 0xffff0000, v58
    v_add_f32 v24, v24, v8
    v_add_f32 v25, v25, v9
    v_lshlrev_b32 v8, 16, v59
    v_and_b32 v9, 0xffff0000, v59
    v_add_f32 v26, v26, v8
    v_add_f32 v27, v27, v9
    v_lshlrev_b32 v8, 16, v62
    v_and_b32 v9, 0xffff0000, v62
    v_add_f32 v28, v28, v8
    v_add_f32 v29, v29, v9
    v_lshlrev_b32 v8, 16, v63
    v_and_b32 v9, 0xffff0000, v63
    v_add_f32 v30, v30, v8
    v_add_f32 v31, v31, v9
    s_waitcnt vmcnt(0)
    v_cvt_pk_bf16_f32 v8, v16, v17
    v_lshlrev_b32 v16, 16, v8
    v_and_b32 v17, 0xffff0000, v8
    v_lshlrev_b32 v8, 16, v96
    v_and_b32 v9, 0xffff0000, v96
    v_add_f32 v16, v16, v8
    v_add_f32 v17, v17, v9
    v_cvt_pk_bf16_f32 v32, v16, v17
    v_lshlrev_b32 v16, 16, v32
    v_and_b32 v17, 0xffff0000, v32
    v_cvt_pk_bf16_f32 v8, v18, v19
    v_lshlrev_b32 v18, 16, v8
    v_and_b32 v19, 0xffff0000, v8
    v_lshlrev_b32 v8, 16, v97
    v_and_b32 v9, 0xffff0000, v97
    v_add_f32 v18, v18, v8
    v_add_f32 v19, v19, v9
    v_cvt_pk_bf16_f32 v33, v18, v19
    v_lshlrev_b32 v18, 16, v33
    v_and_b32 v19, 0xffff0000, v33
    v_cvt_pk_bf16_f32 v8, v20, v21
    v_lshlrev_b32 v20, 16, v8
    v_and_b32 v21, 0xffff0000, v8
    v_lshlrev_b32 v8, 16, v98
    v_and_b32 v9, 0xffff0000, v98
    v_add_f32 v20, v20, v8
    v_add_f32 v21, v21, v9
    v_cvt_pk_bf16_f32 v34, v20, v21
    v_lshlrev_b32 v20, 16, v34
    v_and_b32 v21, 0xffff0000, v34
    v_cvt_pk_bf16_f32 v8, v22, v23
    v_lshlrev_b32 v22, 16, v8
    v_and_b32 v23, 0xffff0000, v8
    v_lshlrev_b32 v8, 16, v99
    v_and_b32 v9, 0xffff0000, v99
    v_add_f32 v22, v22, v8
    v_add_f32 v23, v23, v9
    v_cvt_pk_bf16_f32 v35, v22, v23
    v_lshlrev_b32 v22, 16, v35
    v_and_b32 v23, 0xffff0000, v35
    v_cvt_pk_bf16_f32 v8, v24, v25
    v_lshlrev_b32 v24, 16, v8
    v_and_b32 v25, 0xffff0000, v8
    v_lshlrev_b32 v8, 16, v100
    v_and_b32 v9, 0xffff0000, v100
    v_add_f32 v24, v24, v8
    v_add_f32 v25, v25, v9
    v_cvt_pk_bf16_f32 v36, v24, v25
    v_lshlrev_b32 v24, 16, v36
    v_and_b32 v25, 0xffff0000, v36
    v_cvt_pk_bf16_f32 v8, v26, v27
    v_lshlrev_b32 v26, 16, v8
    v_and_b32 v27, 0xffff0000, v8
    v_lshlrev_b32 v8, 16, v101
    v_and_b32 v9, 0xffff0000, v101
    v_add_f32 v26, v26, v8
    v_add_f32 v27, v27, v9
    v_cvt_pk_bf16_f32 v37, v26, v27
    v_lshlrev_b32 v26, 16, v37
    v_and_b32 v27, 0xffff0000, v37
    v_cvt_pk_bf16_f32 v8, v28, v29
    v_lshlrev_b32 v28, 16, v8
    v_and_b32 v29, 0xffff0000, v8
    v_lshlrev_b32 v8, 16, v102
    v_and_b32 v9, 0xffff0000, v102
    v_add_f32 v28, v28, v8
    v_add_f32 v29, v29, v9
    v_cvt_pk_bf16_f32 v38, v28, v29
    v_lshlrev_b32 v28, 16, v38
    v_and_b32 v29, 0xffff0000, v38
    v_cvt_pk_bf16_f32 v8, v30, v31
    v_lshlrev_b32 v30, 16, v8
    v_and_b32 v31, 0xffff0000, v8
    v_lshlrev_b32 v8, 16, v103
    v_and_b32 v9, 0xffff0000, v103
    v_add_f32 v30, v30, v8
    v_add_f32 v31, v31, v9
    v_cvt_pk_bf16_f32 v39, v30, v31
    v_lshlrev_b32 v30, 16, v39
    v_and_b32 v31, 0xffff0000, v39
    buffer_store_dwordx4 v[32:35], v5, s[28:31], 0 offen sc1
    buffer_store_dwordx4 v[36:39], v5, s[28:31], 0 offen offset:16 sc1
    v_add_f32 v10, v16, v17
    v_add_f32 v10, v10, v18
    v_add_f32 v10, v10, v19
    v_add_f32 v10, v10, v20
    v_add_f32 v10, v10, v21
    v_add_f32 v10, v10, v22
    v_add_f32 v10, v10, v23
    v_add_f32 v10, v10, v24
    v_add_f32 v10, v10, v25
    v_add_f32 v10, v10, v26
    v_add_f32 v10, v10, v27
    v_add_f32 v10, v10, v28
    v_add_f32 v10, v10, v29
    v_add_f32 v10, v10, v30
    v_add_f32 v10, v10, v31
    s_nop 1
    v_add_f32_dpp v10, v10, v10 row_ror:8 row_mask:0xf bank_mask:0xf
    ds_write_b32 v7, v10 offset:12288
    s_waitcnt lgkmcnt(0)
    s_barrier
    ds_read_b128 v[40:43], v6 offset:12288
    ds_read_b128 v[44:47], v6 offset:12304
    ds_read_b128 v[48:51], v6 offset:12320
    ds_read_b128 v[52:55], v6 offset:12336
    ds_read_b128 v[56:59], v6 offset:12352
    s_waitcnt lgkmcnt(0)
    v_add_f32 v10, v40, v41
    v_add_f32 v10, v10, v42
    v_add_f32 v10, v10, v43
    v_add_f32 v10, v10, v44
    v_add_f32 v10, v10, v45
    v_add_f32 v10, v10, v46
    v_add_f32 v10, v10, v47
    v_add_f32 v10, v10, v48
    v_add_f32 v10, v10, v49
    v_add_f32 v10, v10, v50
    v_add_f32 v10, v10, v51
    v_add_f32 v10, v10, v52
    v_add_f32 v10, v10, v53
    v_add_f32 v10, v10, v54
    v_add_f32 v10, v10, v55
    v_add_f32 v10, v10, v56
    v_add_f32 v10, v10, v57
    v_add_f32 v10, v10, v58
    v_add_f32 v10, v10, v59
    v_mul_f32 v10, 0.0015625, v10
    v_sub_f32 v8, v16, v10
    v_mul_f32 v11, v8, v8
    v_sub_f32 v8, v17, v10
    v_fmac_f32 v11, v8, v8
    v_sub_f32 v8, v18, v10
    v_fmac_f32 v11, v8, v8
    v_sub_f32 v8, v19, v10
    v_fmac_f32 v11, v8, v8
    v_sub_f32 v8, v20, v10
    v_fmac_f32 v11, v8, v8
    v_sub_f32 v8, v21, v10
    v_fmac_f32 v11, v8, v8
    v_sub_f32 v8, v22, v10
    v_fmac_f32 v11, v8, v8
    v_sub_f32 v8, v23, v10
    v_fmac_f32 v11, v8, v8
    v_sub_f32 v8, v24, v10
    v_fmac_f32 v11, v8, v8
    v_sub_f32 v8, v25, v10
    v_fmac_f32 v11, v8, v8
    v_sub_f32 v8, v26, v10
    v_fmac_f32 v11, v8, v8
    v_sub_f32 v8, v27, v10
    v_fmac_f32 v11, v8, v8
    v_sub_f32 v8, v28, v10
    v_fmac_f32 v11, v8, v8
    v_sub_f32 v8, v29, v10
    v_fmac_f32 v11, v8, v8
    v_sub_f32 v8, v30, v10
    v_fmac_f32 v11, v8, v8
    v_sub_f32 v8, v31, v10
    v_fmac_f32 v11, v8, v8
    s_nop 1
    v_add_f32_dpp v11, v11, v11 row_ror:8 row_mask:0xf bank_mask:0xf
    ds_write_b32 v7, v11 offset:13312
    s_waitcnt lgkmcnt(0)
    s_barrier
    ds_read_b128 v[40:43], v6 offset:13312
    ds_read_b128 v[44:47], v6 offset:13328
    ds_read_b128 v[48:51], v6 offset:13344
    ds_read_b128 v[52:55], v6 offset:13360
    ds_read_b128 v[56:59], v6 offset:13376
    s_waitcnt lgkmcnt(0)
    v_add_f32 v11, v40, v41
    v_add_f32 v11, v11, v42
    v_add_f32 v11, v11, v43
    v_add_f32 v11, v11, v44
    v_add_f32 v11, v11, v45
    v_add_f32 v11, v11, v46
    v_add_f32 v11, v11, v47
    v_add_f32 v11, v11, v48
    v_add_f32 v11, v11, v49
    v_add_f32 v11, v11, v50
    v_add_f32 v11, v11, v51
    v_add_f32 v11, v11, v52
    v_add_f32 v11, v11, v53
    v_add_f32 v11, v11, v54
    v_add_f32 v11, v11, v55
    v_add_f32 v11, v11, v56
    v_add_f32 v11, v11, v57
    v_add_f32 v11, v11, v58
    v_add_f32 v11, v11, v59
    v_mul_f32 v11, 0.0015625, v11
    v_cvt_pk_bf16_f32 v11, v11, v11
    v_and_b32 v11, 0xffff0000, v11
    v_add_f32 v11, 0x3727c5ac, v11
    v_cvt_pk_bf16_f32 v11, v11, v11
    v_and_b32 v11, 0xffff0000, v11
    v_sqrt_f32 v11, v11
    s_nop 0
    v_cvt_pk_bf16_f32 v11, v11, v11
    v_and_b32 v11, 0xffff0000, v11
    v_rcp_f32 v11, v11
    v_cvt_pk_bf16_f32 v10, v10, v10
    v_and_b32 v10, 0xffff0000, v10
    v_sub_f32 v16, v16, v10
    v_sub_f32 v17, v17, v10
    v_cvt_pk_bf16_f32 v8, v16, v17
    v_lshlrev_b32 v16, 16, v8
    v_and_b32 v17, 0xffff0000, v8
    v_mul_f32 v16, v16, v11
    v_mul_f32 v17, v17, v11
    v_cvt_pk_bf16_f32 v64, v16, v17
    v_lshlrev_b32 v16, 16, v64
    v_and_b32 v17, 0xffff0000, v64
    v_sub_f32 v18, v18, v10
    v_sub_f32 v19, v19, v10
    v_cvt_pk_bf16_f32 v8, v18, v19
    v_lshlrev_b32 v18, 16, v8
    v_and_b32 v19, 0xffff0000, v8
    v_mul_f32 v18, v18, v11
    v_mul_f32 v19, v19, v11
    v_cvt_pk_bf16_f32 v65, v18, v19
    v_lshlrev_b32 v18, 16, v65
    v_and_b32 v19, 0xffff0000, v65
    v_sub_f32 v20, v20, v10
    v_sub_f32 v21, v21, v10
    v_cvt_pk_bf16_f32 v8, v20, v21
    v_lshlrev_b32 v20, 16, v8
    v_and_b32 v21, 0xffff0000, v8
    v_mul_f32 v20, v20, v11
    v_mul_f32 v21, v21, v11
    v_cvt_pk_bf16_f32 v66, v20, v21
    v_lshlrev_b32 v20, 16, v66
    v_and_b32 v21, 0xffff0000, v66
    v_sub_f32 v22, v22, v10
    v_sub_f32 v23, v23, v10
    v_cvt_pk_bf16_f32 v8, v22, v23
    v_lshlrev_b32 v22, 16, v8
    v_and_b32 v23, 0xffff0000, v8
    v_mul_f32 v22, v22, v11
    v_mul_f32 v23, v23, v11
    v_cvt_pk_bf16_f32 v67, v22, v23
    v_lshlrev_b32 v22, 16, v67
    v_and_b32 v23, 0xffff0000, v67
    v_sub_f32 v24, v24, v10
    v_sub_f32 v25, v25, v10
    v_cvt_pk_bf16_f32 v8, v24, v25
    v_lshlrev_b32 v24, 16, v8
    v_and_b32 v25, 0xffff0000, v8
    v_mul_f32 v24, v24, v11
    v_mul_f32 v25, v25, v11
    v_cvt_pk_bf16_f32 v68, v24, v25
    v_lshlrev_b32 v24, 16, v68
    v_and_b32 v25, 0xffff0000, v68
    v_sub_f32 v26, v26, v10
    v_sub_f32 v27, v27, v10
    v_cvt_pk_bf16_f32 v8, v26, v27
    v_lshlrev_b32 v26, 16, v8
    v_and_b32 v27, 0xffff0000, v8
    v_mul_f32 v26, v26, v11
    v_mul_f32 v27, v27, v11
    v_cvt_pk_bf16_f32 v69, v26, v27
    v_lshlrev_b32 v26, 16, v69
    v_and_b32 v27, 0xffff0000, v69
    v_sub_f32 v28, v28, v10
    v_sub_f32 v29, v29, v10
    v_cvt_pk_bf16_f32 v8, v28, v29
    v_lshlrev_b32 v28, 16, v8
    v_and_b32 v29, 0xffff0000, v8
    v_mul_f32 v28, v28, v11
    v_mul_f32 v29, v29, v11
    v_cvt_pk_bf16_f32 v70, v28, v29
    v_lshlrev_b32 v28, 16, v70
    v_and_b32 v29, 0xffff0000, v70
    v_sub_f32 v30, v30, v10
    v_sub_f32 v31, v31, v10
    v_cvt_pk_bf16_f32 v8, v30, v31
    v_lshlrev_b32 v30, 16, v8
    v_and_b32 v31, 0xffff0000, v8
    v_mul_f32 v30, v30, v11
    v_mul_f32 v31, v31, v11
    v_cvt_pk_bf16_f32 v71, v30, v31
    v_lshlrev_b32 v30, 16, v71
    v_and_b32 v31, 0xffff0000, v71
    v_add_f32 v10, v16, v17
    v_add_f32 v10, v10, v18
    v_add_f32 v10, v10, v19
    v_add_f32 v10, v10, v20
    v_add_f32 v10, v10, v21
    v_add_f32 v10, v10, v22
    v_add_f32 v10, v10, v23
    v_add_f32 v10, v10, v24
    v_add_f32 v10, v10, v25
    v_add_f32 v10, v10, v26
    v_add_f32 v10, v10, v27
    v_add_f32 v10, v10, v28
    v_add_f32 v10, v10, v29
    v_add_f32 v10, v10, v30
    v_add_f32 v10, v10, v31
    s_nop 1
    v_add_f32_dpp v10, v10, v10 row_ror:8 row_mask:0xf bank_mask:0xf
    ds_write_b32 v7, v10 offset:14336
    s_waitcnt lgkmcnt(0)
    s_barrier
    ds_read_b128 v[40:43], v6 offset:14336
    ds_read_b128 v[44:47], v6 offset:14352
    ds_read_b128 v[48:51], v6 offset:14368
    ds_read_b128 v[52:55], v6 offset:14384
    ds_read_b128 v[56:59], v6 offset:14400
    s_waitcnt lgkmcnt(0)
    v_add_f32 v10, v40, v41
    v_add_f32 v10, v10, v42
    v_add_f32 v10, v10, v43
    v_add_f32 v10, v10, v44
    v_add_f32 v10, v10, v45
    v_add_f32 v10, v10, v46
    v_add_f32 v10, v10, v47
    v_add_f32 v10, v10, v48
    v_add_f32 v10, v10, v49
    v_add_f32 v10, v10, v50
    v_add_f32 v10, v10, v51
    v_add_f32 v10, v10, v52
    v_add_f32 v10, v10, v53
    v_add_f32 v10, v10, v54
    v_add_f32 v10, v10, v55
    v_add_f32 v10, v10, v56
    v_add_f32 v10, v10, v57
    v_add_f32 v10, v10, v58
    v_add_f32 v10, v10, v59
    v_mul_f32 v10, 0.0015625, v10
    v_sub_f32 v8, v16, v10
    v_mul_f32 v11, v8, v8
    v_sub_f32 v8, v17, v10
    v_fmac_f32 v11, v8, v8
    v_sub_f32 v8, v18, v10
    v_fmac_f32 v11, v8, v8
    v_sub_f32 v8, v19, v10
    v_fmac_f32 v11, v8, v8
    v_sub_f32 v8, v20, v10
    v_fmac_f32 v11, v8, v8
    v_sub_f32 v8, v21, v10
    v_fmac_f32 v11, v8, v8
    v_sub_f32 v8, v22, v10
    v_fmac_f32 v11, v8, v8
    v_sub_f32 v8, v23, v10
    v_fmac_f32 v11, v8, v8
    v_sub_f32 v8, v24, v10
    v_fmac_f32 v11, v8, v8
    v_sub_f32 v8, v25, v10
    v_fmac_f32 v11, v8, v8
    v_sub_f32 v8, v26, v10
    v_fmac_f32 v11, v8, v8
    v_sub_f32 v8, v27, v10
    v_fmac_f32 v11, v8, v8
    v_sub_f32 v8, v28, v10
    v_fmac_f32 v11, v8, v8
    v_sub_f32 v8, v29, v10
    v_fmac_f32 v11, v8, v8
    v_sub_f32 v8, v30, v10
    v_fmac_f32 v11, v8, v8
    v_sub_f32 v8, v31, v10
    v_fmac_f32 v11, v8, v8
    s_nop 1
    v_add_f32_dpp v11, v11, v11 row_ror:8 row_mask:0xf bank_mask:0xf
    ds_write_b32 v7, v11 offset:15360
    s_waitcnt lgkmcnt(0)
    s_barrier
    ds_read_b128 v[40:43], v6 offset:15360
    ds_read_b128 v[44:47], v6 offset:15376
    ds_read_b128 v[48:51], v6 offset:15392
    ds_read_b128 v[52:55], v6 offset:15408
    ds_read_b128 v[56:59], v6 offset:15424
    s_waitcnt lgkmcnt(0)
    v_add_f32 v11, v40, v41
    v_add_f32 v11, v11, v42
    v_add_f32 v11, v11, v43
    v_add_f32 v11, v11, v44
    v_add_f32 v11, v11, v45
    v_add_f32 v11, v11, v46
    v_add_f32 v11, v11, v47
    v_add_f32 v11, v11, v48
    v_add_f32 v11, v11, v49
    v_add_f32 v11, v11, v50
    v_add_f32 v11, v11, v51
    v_add_f32 v11, v11, v52
    v_add_f32 v11, v11, v53
    v_add_f32 v11, v11, v54
    v_add_f32 v11, v11, v55
    v_add_f32 v11, v11, v56
    v_add_f32 v11, v11, v57
    v_add_f32 v11, v11, v58
    v_add_f32 v11, v11, v59
    v_mul_f32 v11, 0.0015625, v11
    v_cvt_pk_bf16_f32 v11, v11, v11
    v_and_b32 v11, 0xffff0000, v11
    v_add_f32 v11, 0x3727c5ac, v11
    v_cvt_pk_bf16_f32 v11, v11, v11
    v_and_b32 v11, 0xffff0000, v11
    v_sqrt_f32 v11, v11
    s_nop 0
    v_cvt_pk_bf16_f32 v11, v11, v11
    v_and_b32 v11, 0xffff0000, v11
    v_rcp_f32 v11, v11
    v_cvt_pk_bf16_f32 v10, v10, v10
    v_and_b32 v10, 0xffff0000, v10
    v_sub_f32 v16, v16, v10
    v_sub_f32 v17, v17, v10
    v_cvt_pk_bf16_f32 v8, v16, v17
    v_lshlrev_b32 v16, 16, v8
    v_and_b32 v17, 0xffff0000, v8
    v_mul_f32 v16, v16, v11
    v_mul_f32 v17, v17, v11
    v_cvt_pk_bf16_f32 v64, v16, v17
    v_sub_f32 v18, v18, v10
    v_sub_f32 v19, v19, v10
    v_cvt_pk_bf16_f32 v8, v18, v19
    v_lshlrev_b32 v18, 16, v8
    v_and_b32 v19, 0xffff0000, v8
    v_mul_f32 v18, v18, v11
    v_mul_f32 v19, v19, v11
    v_cvt_pk_bf16_f32 v65, v18, v19
    v_sub_f32 v20, v20, v10
    v_sub_f32 v21, v21, v10
    v_cvt_pk_bf16_f32 v8, v20, v21
    v_lshlrev_b32 v20, 16, v8
    v_and_b32 v21, 0xffff0000, v8
    v_mul_f32 v20, v20, v11
    v_mul_f32 v21, v21, v11
    v_cvt_pk_bf16_f32 v66, v20, v21
    v_sub_f32 v22, v22, v10
    v_sub_f32 v23, v23, v10
    v_cvt_pk_bf16_f32 v8, v22, v23
    v_lshlrev_b32 v22, 16, v8
    v_and_b32 v23, 0xffff0000, v8
    v_mul_f32 v22, v22, v11
    v_mul_f32 v23, v23, v11
    v_cvt_pk_bf16_f32 v67, v22, v23
    v_sub_f32 v24, v24, v10
    v_sub_f32 v25, v25, v10
    v_cvt_pk_bf16_f32 v8, v24, v25
    v_lshlrev_b32 v24, 16, v8
    v_and_b32 v25, 0xffff0000, v8
    v_mul_f32 v24, v24, v11
    v_mul_f32 v25, v25, v11
    v_cvt_pk_bf16_f32 v68, v24, v25
    v_sub_f32 v26, v26, v10
    v_sub_f32 v27, v27, v10
    v_cvt_pk_bf16_f32 v8, v26, v27
    v_lshlrev_b32 v26, 16, v8
    v_and_b32 v27, 0xffff0000, v8
    v_mul_f32 v26, v26, v11
    v_mul_f32 v27, v27, v11
    v_cvt_pk_bf16_f32 v69, v26, v27
    v_sub_f32 v28, v28, v10
    v_sub_f32 v29, v29, v10
    v_cvt_pk_bf16_f32 v8, v28, v29
    v_lshlrev_b32 v28, 16, v8
    v_and_b32 v29, 0xffff0000, v8
    v_mul_f32 v28, v28, v11
    v_mul_f32 v29, v29, v11
    v_cvt_pk_bf16_f32 v70, v28, v29
    v_sub_f32 v30, v30, v10
    v_sub_f32 v31, v31, v10
    v_cvt_pk_bf16_f32 v8, v30, v31
    v_lshlrev_b32 v30, 16, v8
    v_and_b32 v31, 0xffff0000, v8
    v_mul_f32 v30, v30, v11
    v_mul_f32 v31, v31, v11
    v_cvt_pk_bf16_f32 v71, v30, v31
    s_movk_i32 s17, 272
    v_mul_u32_u24 v8, s17, v2
    v_lshl_add_u32 v8, v1, 1, v8
    ds_write_b16 v8, v64 offset:0
    ds_write_b16_d16_hi v8, v64 offset:16
    ds_write_b16 v8, v65 offset:32
    ds_write_b16_d16_hi v8, v65 offset:48
    ds_write_b16 v8, v66 offset:64
    ds_write_b16_d16_hi v8, v66 offset:80
    ds_write_b16 v8, v67 offset:96
    ds_write_b16_d16_hi v8, v67 offset:112
    ds_write_b16 v8, v68 offset:128
    ds_write_b16_d16_hi v8, v68 offset:144
    ds_write_b16 v8, v69 offset:160
    ds_write_b16_d16_hi v8, v69 offset:176
    ds_write_b16 v8, v70 offset:192
    ds_write_b16_d16_hi v8, v70 offset:208
    ds_write_b16 v8, v71 offset:224
    ds_write_b16_d16_hi v8, v71 offset:240
    v_lshrrev_b32 v9, 4, v0
    v_add_u32 v10, v9, v0
    v_lshlrev_b32 v10, 4, v10
    v_and_b32 v11, 15, v0
    v_lshlrev_b32 v11, 4, v11
    v_lshl_add_u32 v11, v9, 16, v11
    s_lshl_b32 s18, s15, 10
    s_and_b32 s19, s2, 3
    s_lshl_b32 s19, s19, 8
    s_add_u32 s18, s18, s19
    s_waitcnt lgkmcnt(0)
    s_barrier
    ds_read_b128 v[40:43], v10
    ds_read_b128 v[44:47], v10 offset:5440
    s_add_u32 s19, s18, 1310720
    s_waitcnt lgkmcnt(1)
    buffer_store_dwordx4 v[40:43], v11, s[32:35], s18 offen sc1
    s_waitcnt lgkmcnt(0)
    buffer_store_dwordx4 v[44:47], v11, s[32:35], s19 offen sc1
K4_END:
    s_endpgm
k4_kernel_end:
.globl k5_kernel
.p2align 8
.type k5_kernel,@function
k5_kernel:
    s_cmp_ge_u32 s2, 216
    s_cbranch_scc1 K5_END
    s_load_dwordx4 s[4:7], s[0:1], 56
    s_load_dwordx2 s[8:9], s[0:1], 104
    v_mov_b32 v245, v0
    v_and_b32 v241, 63, v0
    v_lshrrev_b32 v242, 6, v0
    s_nop 0
    v_readfirstlane_b32 s14, v242
    s_and_b32 s15, s2, 7
    s_mul_i32 s15, s15, 27
    s_lshr_b32 s16, s2, 3
    s_add_u32 s16, s16, s15
    s_lshr_b32 s15, s16, 3
    s_and_b32 s16, s16, 7
    v_lshlrev_b32 v240, 4, v241
    v_lshrrev_b32 v242, 3, v241
    s_movk_i32 s17, 3456
    v_mul_u32_u24 v242, s17, v242
    s_lshl_b32 s18, s15, 7
    v_add_u32 v242, s18, v242
    v_bfe_u32 v243, v241, 4, 1
    v_lshlrev_b32 v243, 1, v243
    v_and_b32 v244, 7, v241
    v_xor_b32 v243, v243, v244
    v_lshl_add_u32 v232, v243, 4, v242
    v_xor_b32 v244, 4, v243
    v_lshl_add_u32 v233, v244, 4, v242
    v_add_u32 v233, 26624, v233
    v_lshl_add_u32 v234, v243, 4, v242
    v_add_u32 v234, 53248, v234
    v_xor_b32 v244, 4, v243
    v_lshl_add_u32 v235, v244, 4, v242
    v_add_u32 v235, 79872, v235
    s_mul_i32 s19, s14, 884736
    s_mul_i32 s50, s14, 20480
    s_mul_i32 s51, s16, 327680
    s_mul_i32 s52, s14, 8192
    s_add_u32 s51, s51, s52
    s_add_u32 s40, s51, 0
    s_add_u32 s45, s51, 4096
    s_add_u32 s41, s51, 65536
    s_add_u32 s46, s51, 69632
    s_add_u32 s42, s51, 131072
    s_add_u32 s47, s51, 135168
    s_add_u32 s43, s51, 196608
    s_add_u32 s48, s51, 200704
    s_add_u32 s44, s51, 262144
    s_add_u32 s49, s51, 266240
    s_waitcnt lgkmcnt(0)
    s_mov_b32 s20, s4
    s_and_b32 s21, s5, 0xffff
    s_mov_b32 s22, 7077888
    s_mov_b32 s23, 0x00020000
    s_add_u32 s24, s8, 104857600
    s_addc_u32 s25, s9, 0
    s_and_b32 s25, s25, 0xffff
    s_mov_b32 s26, 2621440
    s_mov_b32 s27, 0x00020000
    s_add_u32 s28, s8, 109051904
    s_addc_u32 s29, s9, 0
    s_and_b32 s29, s29, 0xffff
    s_mov_b32 s30, 2211840
    s_mov_b32 s31, 0x00020000
    s_mov_b32 s32, s6
    s_and_b32 s33, s7, 0xffff
    s_mov_b32 s34, 3456
    s_mov_b32 s35, 0x00020000
    s_add_u32 m0, s50, 0
    s_add_u32 s53, s19, 0
    buffer_load_dwordx4 v232, s[20:23], s53 offen offset:0 lds
    buffer_load_dwordx4 v233, s[20:23], s53 offen offset:1024 lds
    buffer_load_dwordx4 v234, s[20:23], s53 offen offset:2048 lds
    buffer_load_dwordx4 v235, s[20:23], s53 offen offset:3072 lds
    buffer_load_dwordx4 v[0:3], v240, s[24:27], s40 offen offset:0
    buffer_load_dwordx4 v[4:7], v240, s[24:27], s41 offen offset:0
    buffer_load_dwordx4 v[8:11], v240, s[24:27], s42 offen offset:0
    buffer_load_dwordx4 v[12:15], v240, s[24:27], s43 offen offset:0
    buffer_load_dwordx4 v[16:19], v240, s[24:27], s44 offen offset:0
    s_add_u32 m0, s50, 4096
    s_add_u32 s53, s19, 110592
    buffer_load_dwordx4 v232, s[20:23], s53 offen offset:0 lds
    buffer_load_dwordx4 v233, s[20:23], s53 offen offset:1024 lds
    buffer_load_dwordx4 v234, s[20:23], s53 offen offset:2048 lds
    buffer_load_dwordx4 v235, s[20:23], s53 offen offset:3072 lds
    buffer_load_dwordx4 v[20:23], v240, s[24:27], s40 offen offset:1024
    buffer_load_dwordx4 v[24:27], v240, s[24:27], s41 offen offset:1024
    buffer_load_dwordx4 v[28:31], v240, s[24:27], s42 offen offset:1024
    buffer_load_dwordx4 v[32:35], v240, s[24:27], s43 offen offset:1024
    buffer_load_dwordx4 v[36:39], v240, s[24:27], s44 offen offset:1024
    v_bfe_u32 v242, v241, 2, 2
    v_lshrrev_b32 v243, 4, v241
    v_lshl_add_u32 v244, v243, 3, v242
    v_lshlrev_b32 v244, 7, v244
    v_add_u32 v244, s50, v244
    v_and_b32 v236, 3, v241
    v_lshl_add_u32 v244, v236, 3, v244
    v_lshrrev_b32 v242, 1, v242
    v_and_b32 v243, 1, v243
    v_lshl_add_u32 v242, v243, 1, v242
    v_xor_b32 v243, 0, v242
    v_lshl_add_u32 v236, v243, 5, v244
    v_xor_b32 v243, 1, v242
    v_lshl_add_u32 v237, v243, 5, v244
    v_xor_b32 v243, 2, v242
    v_lshl_add_u32 v238, v243, 5, v244
    v_xor_b32 v243, 3, v242
    v_lshl_add_u32 v239, v243, 5, v244
    v_lshrrev_b32 v242, 4, v241
    v_lshlrev_b32 v242, 3, v242
    buffer_load_dwordx2 v[246:247], v242, s[32:35], s18 offen offset:0
    buffer_load_dwordx2 v[248:249], v242, s[32:35], s18 offen offset:32
    buffer_load_dwordx2 v[250:251], v242, s[32:35], s18 offen offset:64
    buffer_load_dwordx2 v[252:253], v242, s[32:35], s18 offen offset:96
    s_waitcnt vmcnt(18) lgkmcnt(0)
    ds_read_b64_tr_b16 v[200:201], v236 offset:0
    ds_read_b64_tr_b16 v[202:203], v236 offset:512
    ds_read_b64_tr_b16 v[204:205], v237 offset:0
    ds_read_b64_tr_b16 v[206:207], v237 offset:512
    ds_read_b64_tr_b16 v[208:209], v238 offset:0
    ds_read_b64_tr_b16 v[210:211], v238 offset:512
    ds_read_b64_tr_b16 v[212:213], v239 offset:0
    ds_read_b64_tr_b16 v[214:215], v239 offset:512
    s_add_u32 m0, s50, 8192
    s_add_u32 s53, s19, 221184
    buffer_load_dwordx4 v232, s[20:23], s53 offen offset:0 lds
    buffer_load_dwordx4 v233, s[20:23], s53 offen offset:1024 lds
    buffer_load_dwordx4 v234, s[20:23], s53 offen offset:2048 lds
    buffer_load_dwordx4 v235, s[20:23], s53 offen offset:3072 lds
    buffer_load_dwordx4 v[40:43], v240, s[24:27], s40 offen offset:2048
    buffer_load_dwordx4 v[44:47], v240, s[24:27], s41 offen offset:2048
    buffer_load_dwordx4 v[48:51], v240, s[24:27], s42 offen offset:2048
    buffer_load_dwordx4 v[52:55], v240, s[24:27], s43 offen offset:2048
    buffer_load_dwordx4 v[56:59], v240, s[24:27], s44 offen offset:2048
    s_waitcnt vmcnt(18) lgkmcnt(0)
    v_mfma_f32_16x16x32_bf16 v[120:123], v[200:203], v[0:3], 0
    ds_read_b64_tr_b16 v[216:217], v236 offset:4096
    v_mfma_f32_16x16x32_bf16 v[136:139], v[200:203], v[4:7], 0
    ds_read_b64_tr_b16 v[218:219], v236 offset:4608
    v_mfma_f32_16x16x32_bf16 v[152:155], v[200:203], v[8:11], 0
    ds_read_b64_tr_b16 v[220:221], v237 offset:4096
    v_mfma_f32_16x16x32_bf16 v[168:171], v[200:203], v[12:15], 0
    ds_read_b64_tr_b16 v[222:223], v237 offset:4608
    v_mfma_f32_16x16x32_bf16 v[184:187], v[200:203], v[16:19], 0
    ds_read_b64_tr_b16 v[224:225], v238 offset:4096
    v_mfma_f32_16x16x32_bf16 v[124:127], v[204:207], v[0:3], 0
    ds_read_b64_tr_b16 v[226:227], v238 offset:4608
    v_mfma_f32_16x16x32_bf16 v[140:143], v[204:207], v[4:7], 0
    ds_read_b64_tr_b16 v[228:229], v239 offset:4096
    v_mfma_f32_16x16x32_bf16 v[156:159], v[204:207], v[8:11], 0
    ds_read_b64_tr_b16 v[230:231], v239 offset:4608
    v_mfma_f32_16x16x32_bf16 v[172:175], v[204:207], v[12:15], 0
    s_add_u32 m0, s50, 12288
    s_add_u32 s53, s19, 331776
    buffer_load_dwordx4 v232, s[20:23], s53 offen offset:0 lds
    buffer_load_dwordx4 v233, s[20:23], s53 offen offset:1024 lds
    buffer_load_dwordx4 v234, s[20:23], s53 offen offset:2048 lds
    buffer_load_dwordx4 v235, s[20:23], s53 offen offset:3072 lds
    v_mfma_f32_16x16x32_bf16 v[188:191], v[204:207], v[16:19], 0
    buffer_load_dwordx4 v[60:63], v240, s[24:27], s40 offen offset:3072
    v_mfma_f32_16x16x32_bf16 v[128:131], v[208:211], v[0:3], 0
    buffer_load_dwordx4 v[64:67], v240, s[24:27], s41 offen offset:3072
    v_mfma_f32_16x16x32_bf16 v[144:147], v[208:211], v[4:7], 0
    buffer_load_dwordx4 v[68:71], v240, s[24:27], s42 offen offset:3072
    v_mfma_f32_16x16x32_bf16 v[160:163], v[208:211], v[8:11], 0
    buffer_load_dwordx4 v[72:75], v240, s[24:27], s43 offen offset:3072
    v_mfma_f32_16x16x32_bf16 v[176:179], v[208:211], v[12:15], 0
    buffer_load_dwordx4 v[76:79], v240, s[24:27], s44 offen offset:3072
    v_mfma_f32_16x16x32_bf16 v[192:195], v[208:211], v[16:19], 0
    v_mfma_f32_16x16x32_bf16 v[132:135], v[212:215], v[0:3], 0
    v_mfma_f32_16x16x32_bf16 v[148:151], v[212:215], v[4:7], 0
    v_mfma_f32_16x16x32_bf16 v[164:167], v[212:215], v[8:11], 0
    v_mfma_f32_16x16x32_bf16 v[180:183], v[212:215], v[12:15], 0
    v_mfma_f32_16x16x32_bf16 v[196:199], v[212:215], v[16:19], 0
    s_waitcnt vmcnt(14) lgkmcnt(0)
    v_mfma_f32_16x16x32_bf16 v[120:123], v[216:219], v[20:23], v[120:123]
    ds_read_b64_tr_b16 v[200:201], v236 offset:8192
    v_mfma_f32_16x16x32_bf16 v[136:139], v[216:219], v[24:27], v[136:139]
    ds_read_b64_tr_b16 v[202:203], v236 offset:8704
    v_mfma_f32_16x16x32_bf16 v[152:155], v[216:219], v[28:31], v[152:155]
    ds_read_b64_tr_b16 v[204:205], v237 offset:8192
    v_mfma_f32_16x16x32_bf16 v[168:171], v[216:219], v[32:35], v[168:171]
    ds_read_b64_tr_b16 v[206:207], v237 offset:8704
    v_mfma_f32_16x16x32_bf16 v[184:187], v[216:219], v[36:39], v[184:187]
    ds_read_b64_tr_b16 v[208:209], v238 offset:8192
    v_mfma_f32_16x16x32_bf16 v[124:127], v[220:223], v[20:23], v[124:127]
    ds_read_b64_tr_b16 v[210:211], v238 offset:8704
    v_mfma_f32_16x16x32_bf16 v[140:143], v[220:223], v[24:27], v[140:143]
    ds_read_b64_tr_b16 v[212:213], v239 offset:8192
    v_mfma_f32_16x16x32_bf16 v[156:159], v[220:223], v[28:31], v[156:159]
    ds_read_b64_tr_b16 v[214:215], v239 offset:8704
    v_mfma_f32_16x16x32_bf16 v[172:175], v[220:223], v[32:35], v[172:175]
    s_add_u32 m0, s50, 16384
    s_add_u32 s53, s19, 442368
    buffer_load_dwordx4 v232, s[20:23], s53 offen offset:0 lds
    buffer_load_dwordx4 v233, s[20:23], s53 offen offset:1024 lds
    buffer_load_dwordx4 v234, s[20:23], s53 offen offset:2048 lds
    buffer_load_dwordx4 v235, s[20:23], s53 offen offset:3072 lds
    v_mfma_f32_16x16x32_bf16 v[188:191], v[220:223], v[36:39], v[188:191]
    buffer_load_dwordx4 v[80:83], v240, s[24:27], s45 offen offset:0
    v_mfma_f32_16x16x32_bf16 v[128:131], v[224:227], v[20:23], v[128:131]
    buffer_load_dwordx4 v[84:87], v240, s[24:27], s46 offen offset:0
    v_mfma_f32_16x16x32_bf16 v[144:147], v[224:227], v[24:27], v[144:147]
    buffer_load_dwordx4 v[88:91], v240, s[24:27], s47 offen offset:0
    v_mfma_f32_16x16x32_bf16 v[160:163], v[224:227], v[28:31], v[160:163]
    buffer_load_dwordx4 v[92:95], v240, s[24:27], s48 offen offset:0
    v_mfma_f32_16x16x32_bf16 v[176:179], v[224:227], v[32:35], v[176:179]
    buffer_load_dwordx4 v[96:99], v240, s[24:27], s49 offen offset:0
    v_mfma_f32_16x16x32_bf16 v[192:195], v[224:227], v[36:39], v[192:195]
    v_mfma_f32_16x16x32_bf16 v[132:135], v[228:231], v[20:23], v[132:135]
    v_mfma_f32_16x16x32_bf16 v[148:151], v[228:231], v[24:27], v[148:151]
    v_mfma_f32_16x16x32_bf16 v[164:167], v[228:231], v[28:31], v[164:167]
    v_mfma_f32_16x16x32_bf16 v[180:183], v[228:231], v[32:35], v[180:183]
    v_mfma_f32_16x16x32_bf16 v[196:199], v[228:231], v[36:39], v[196:199]
    s_waitcnt vmcnt(14) lgkmcnt(0)
    v_mfma_f32_16x16x32_bf16 v[120:123], v[200:203], v[40:43], v[120:123]
    ds_read_b64_tr_b16 v[216:217], v236 offset:12288
    v_mfma_f32_16x16x32_bf16 v[136:139], v[200:203], v[44:47], v[136:139]
    ds_read_b64_tr_b16 v[218:219], v236 offset:12800
    v_mfma_f32_16x16x32_bf16 v[152:155], v[200:203], v[48:51], v[152:155]
    ds_read_b64_tr_b16 v[220:221], v237 offset:12288
    v_mfma_f32_16x16x32_bf16 v[168:171], v[200:203], v[52:55], v[168:171]
    ds_read_b64_tr_b16 v[222:223], v237 offset:12800
    v_mfma_f32_16x16x32_bf16 v[184:187], v[200:203], v[56:59], v[184:187]
    ds_read_b64_tr_b16 v[224:225], v238 offset:12288
    v_mfma_f32_16x16x32_bf16 v[124:127], v[204:207], v[40:43], v[124:127]
    ds_read_b64_tr_b16 v[226:227], v238 offset:12800
    v_mfma_f32_16x16x32_bf16 v[140:143], v[204:207], v[44:47], v[140:143]
    ds_read_b64_tr_b16 v[228:229], v239 offset:12288
    v_mfma_f32_16x16x32_bf16 v[156:159], v[204:207], v[48:51], v[156:159]
    ds_read_b64_tr_b16 v[230:231], v239 offset:12800
    v_mfma_f32_16x16x32_bf16 v[172:175], v[204:207], v[52:55], v[172:175]
    s_add_u32 m0, s50, 0
    s_add_u32 s53, s19, 552960
    buffer_load_dwordx4 v232, s[20:23], s53 offen offset:0 lds
    buffer_load_dwordx4 v233, s[20:23], s53 offen offset:1024 lds
    buffer_load_dwordx4 v234, s[20:23], s53 offen offset:2048 lds
    buffer_load_dwordx4 v235, s[20:23], s53 offen offset:3072 lds
    v_mfma_f32_16x16x32_bf16 v[188:191], v[204:207], v[56:59], v[188:191]
    buffer_load_dwordx4 v[100:103], v240, s[24:27], s45 offen offset:1024
    v_mfma_f32_16x16x32_bf16 v[128:131], v[208:211], v[40:43], v[128:131]
    buffer_load_dwordx4 v[104:107], v240, s[24:27], s46 offen offset:1024
    v_mfma_f32_16x16x32_bf16 v[144:147], v[208:211], v[44:47], v[144:147]
    buffer_load_dwordx4 v[108:111], v240, s[24:27], s47 offen offset:1024
    v_mfma_f32_16x16x32_bf16 v[160:163], v[208:211], v[48:51], v[160:163]
    buffer_load_dwordx4 v[112:115], v240, s[24:27], s48 offen offset:1024
    v_mfma_f32_16x16x32_bf16 v[176:179], v[208:211], v[52:55], v[176:179]
    buffer_load_dwordx4 v[116:119], v240, s[24:27], s49 offen offset:1024
    v_mfma_f32_16x16x32_bf16 v[192:195], v[208:211], v[56:59], v[192:195]
    v_mfma_f32_16x16x32_bf16 v[132:135], v[212:215], v[40:43], v[132:135]
    v_mfma_f32_16x16x32_bf16 v[148:151], v[212:215], v[44:47], v[148:151]
    v_mfma_f32_16x16x32_bf16 v[164:167], v[212:215], v[48:51], v[164:167]
    v_mfma_f32_16x16x32_bf16 v[180:183], v[212:215], v[52:55], v[180:183]
    v_mfma_f32_16x16x32_bf16 v[196:199], v[212:215], v[56:59], v[196:199]
    s_waitcnt vmcnt(14) lgkmcnt(0)
    v_mfma_f32_16x16x32_bf16 v[120:123], v[216:219], v[60:63], v[120:123]
    ds_read_b64_tr_b16 v[200:201], v236 offset:16384
    v_mfma_f32_16x16x32_bf16 v[136:139], v[216:219], v[64:67], v[136:139]
    ds_read_b64_tr_b16 v[202:203], v236 offset:16896
    v_mfma_f32_16x16x32_bf16 v[152:155], v[216:219], v[68:71], v[152:155]
    ds_read_b64_tr_b16 v[204:205], v237 offset:16384
    v_mfma_f32_16x16x32_bf16 v[168:171], v[216:219], v[72:75], v[168:171]
    ds_read_b64_tr_b16 v[206:207], v237 offset:16896
    v_mfma_f32_16x16x32_bf16 v[184:187], v[216:219], v[76:79], v[184:187]
    ds_read_b64_tr_b16 v[208:209], v238 offset:16384
    v_mfma_f32_16x16x32_bf16 v[124:127], v[220:223], v[60:63], v[124:127]
    ds_read_b64_tr_b16 v[210:211], v238 offset:16896
    v_mfma_f32_16x16x32_bf16 v[140:143], v[220:223], v[64:67], v[140:143]
    ds_read_b64_tr_b16 v[212:213], v239 offset:16384
    v_mfma_f32_16x16x32_bf16 v[156:159], v[220:223], v[68:71], v[156:159]
    ds_read_b64_tr_b16 v[214:215], v239 offset:16896
    v_mfma_f32_16x16x32_bf16 v[172:175], v[220:223], v[72:75], v[172:175]
    s_add_u32 m0, s50, 4096
    s_add_u32 s53, s19, 663552
    buffer_load_dwordx4 v232, s[20:23], s53 offen offset:0 lds
    buffer_load_dwordx4 v233, s[20:23], s53 offen offset:1024 lds
    buffer_load_dwordx4 v234, s[20:23], s53 offen offset:2048 lds
    buffer_load_dwordx4 v235, s[20:23], s53 offen offset:3072 lds
    v_mfma_f32_16x16x32_bf16 v[188:191], v[220:223], v[76:79], v[188:191]
    buffer_load_dwordx4 v[0:3], v240, s[24:27], s45 offen offset:2048
    v_mfma_f32_16x16x32_bf16 v[128:131], v[224:227], v[60:63], v[128:131]
    buffer_load_dwordx4 v[4:7], v240, s[24:27], s46 offen offset:2048
    v_mfma_f32_16x16x32_bf16 v[144:147], v[224:227], v[64:67], v[144:147]
    buffer_load_dwordx4 v[8:11], v240, s[24:27], s47 offen offset:2048
    v_mfma_f32_16x16x32_bf16 v[160:163], v[224:227], v[68:71], v[160:163]
    buffer_load_dwordx4 v[12:15], v240, s[24:27], s48 offen offset:2048
    v_mfma_f32_16x16x32_bf16 v[176:179], v[224:227], v[72:75], v[176:179]
    buffer_load_dwordx4 v[16:19], v240, s[24:27], s49 offen offset:2048
    v_mfma_f32_16x16x32_bf16 v[192:195], v[224:227], v[76:79], v[192:195]
    v_mfma_f32_16x16x32_bf16 v[132:135], v[228:231], v[60:63], v[132:135]
    v_mfma_f32_16x16x32_bf16 v[148:151], v[228:231], v[64:67], v[148:151]
    v_mfma_f32_16x16x32_bf16 v[164:167], v[228:231], v[68:71], v[164:167]
    v_mfma_f32_16x16x32_bf16 v[180:183], v[228:231], v[72:75], v[180:183]
    v_mfma_f32_16x16x32_bf16 v[196:199], v[228:231], v[76:79], v[196:199]
    s_waitcnt vmcnt(14) lgkmcnt(0)
    v_mfma_f32_16x16x32_bf16 v[120:123], v[200:203], v[80:83], v[120:123]
    ds_read_b64_tr_b16 v[216:217], v236 offset:0
    v_mfma_f32_16x16x32_bf16 v[136:139], v[200:203], v[84:87], v[136:139]
    ds_read_b64_tr_b16 v[218:219], v236 offset:512
    v_mfma_f32_16x16x32_bf16 v[152:155], v[200:203], v[88:91], v[152:155]
    ds_read_b64_tr_b16 v[220:221], v237 offset:0
    v_mfma_f32_16x16x32_bf16 v[168:171], v[200:203], v[92:95], v[168:171]
    ds_read_b64_tr_b16 v[222:223], v237 offset:512
    v_mfma_f32_16x16x32_bf16 v[184:187], v[200:203], v[96:99], v[184:187]
    ds_read_b64_tr_b16 v[224:225], v238 offset:0
    v_mfma_f32_16x16x32_bf16 v[124:127], v[204:207], v[80:83], v[124:127]
    ds_read_b64_tr_b16 v[226:227], v238 offset:512
    v_mfma_f32_16x16x32_bf16 v[140:143], v[204:207], v[84:87], v[140:143]
    ds_read_b64_tr_b16 v[228:229], v239 offset:0
    v_mfma_f32_16x16x32_bf16 v[156:159], v[204:207], v[88:91], v[156:159]
    ds_read_b64_tr_b16 v[230:231], v239 offset:512
    v_mfma_f32_16x16x32_bf16 v[172:175], v[204:207], v[92:95], v[172:175]
    s_add_u32 m0, s50, 8192
    s_add_u32 s53, s19, 774144
    buffer_load_dwordx4 v232, s[20:23], s53 offen offset:0 lds
    buffer_load_dwordx4 v233, s[20:23], s53 offen offset:1024 lds
    buffer_load_dwordx4 v234, s[20:23], s53 offen offset:2048 lds
    buffer_load_dwordx4 v235, s[20:23], s53 offen offset:3072 lds
    v_mfma_f32_16x16x32_bf16 v[188:191], v[204:207], v[96:99], v[188:191]
    buffer_load_dwordx4 v[20:23], v240, s[24:27], s45 offen offset:3072
    v_mfma_f32_16x16x32_bf16 v[128:131], v[208:211], v[80:83], v[128:131]
    buffer_load_dwordx4 v[24:27], v240, s[24:27], s46 offen offset:3072
    v_mfma_f32_16x16x32_bf16 v[144:147], v[208:211], v[84:87], v[144:147]
    buffer_load_dwordx4 v[28:31], v240, s[24:27], s47 offen offset:3072
    v_mfma_f32_16x16x32_bf16 v[160:163], v[208:211], v[88:91], v[160:163]
    buffer_load_dwordx4 v[32:35], v240, s[24:27], s48 offen offset:3072
    v_mfma_f32_16x16x32_bf16 v[176:179], v[208:211], v[92:95], v[176:179]
    buffer_load_dwordx4 v[36:39], v240, s[24:27], s49 offen offset:3072
    v_mfma_f32_16x16x32_bf16 v[192:195], v[208:211], v[96:99], v[192:195]
    v_mfma_f32_16x16x32_bf16 v[132:135], v[212:215], v[80:83], v[132:135]
    v_mfma_f32_16x16x32_bf16 v[148:151], v[212:215], v[84:87], v[148:151]
    v_mfma_f32_16x16x32_bf16 v[164:167], v[212:215], v[88:91], v[164:167]
    v_mfma_f32_16x16x32_bf16 v[180:183], v[212:215], v[92:95], v[180:183]
    v_mfma_f32_16x16x32_bf16 v[196:199], v[212:215], v[96:99], v[196:199]
    s_waitcnt vmcnt(14) lgkmcnt(0)
    v_mfma_f32_16x16x32_bf16 v[120:123], v[216:219], v[100:103], v[120:123]
    ds_read_b64_tr_b16 v[200:201], v236 offset:4096
    v_mfma_f32_16x16x32_bf16 v[136:139], v[216:219], v[104:107], v[136:139]
    ds_read_b64_tr_b16 v[202:203], v236 offset:4608
    v_mfma_f32_16x16x32_bf16 v[152:155], v[216:219], v[108:111], v[152:155]
    ds_read_b64_tr_b16 v[204:205], v237 offset:4096
    v_mfma_f32_16x16x32_bf16 v[168:171], v[216:219], v[112:115], v[168:171]
    ds_read_b64_tr_b16 v[206:207], v237 offset:4608
    v_mfma_f32_16x16x32_bf16 v[184:187], v[216:219], v[116:119], v[184:187]
    ds_read_b64_tr_b16 v[208:209], v238 offset:4096
    v_mfma_f32_16x16x32_bf16 v[124:127], v[220:223], v[100:103], v[124:127]
    ds_read_b64_tr_b16 v[210:211], v238 offset:4608
    v_mfma_f32_16x16x32_bf16 v[140:143], v[220:223], v[104:107], v[140:143]
    ds_read_b64_tr_b16 v[212:213], v239 offset:4096
    v_mfma_f32_16x16x32_bf16 v[156:159], v[220:223], v[108:111], v[156:159]
    ds_read_b64_tr_b16 v[214:215], v239 offset:4608
    v_mfma_f32_16x16x32_bf16 v[172:175], v[220:223], v[112:115], v[172:175]
    v_mfma_f32_16x16x32_bf16 v[188:191], v[220:223], v[116:119], v[188:191]
    v_mfma_f32_16x16x32_bf16 v[128:131], v[224:227], v[100:103], v[128:131]
    v_mfma_f32_16x16x32_bf16 v[144:147], v[224:227], v[104:107], v[144:147]
    v_mfma_f32_16x16x32_bf16 v[160:163], v[224:227], v[108:111], v[160:163]
    v_mfma_f32_16x16x32_bf16 v[176:179], v[224:227], v[112:115], v[176:179]
    v_mfma_f32_16x16x32_bf16 v[192:195], v[224:227], v[116:119], v[192:195]
    v_mfma_f32_16x16x32_bf16 v[132:135], v[228:231], v[100:103], v[132:135]
    v_mfma_f32_16x16x32_bf16 v[148:151], v[228:231], v[104:107], v[148:151]
    v_mfma_f32_16x16x32_bf16 v[164:167], v[228:231], v[108:111], v[164:167]
    v_mfma_f32_16x16x32_bf16 v[180:183], v[228:231], v[112:115], v[180:183]
    v_mfma_f32_16x16x32_bf16 v[196:199], v[228:231], v[116:119], v[196:199]
    s_waitcnt vmcnt(5) lgkmcnt(0)
    v_mfma_f32_16x16x32_bf16 v[120:123], v[200:203], v[0:3], v[120:123]
    ds_read_b64_tr_b16 v[216:217], v236 offset:8192
    v_mfma_f32_16x16x32_bf16 v[136:139], v[200:203], v[4:7], v[136:139]
    ds_read_b64_tr_b16 v[218:219], v236 offset:8704
    v_mfma_f32_16x16x32_bf16 v[152:155], v[200:203], v[8:11], v[152:155]
    ds_read_b64_tr_b16 v[220:221], v237 offset:8192
    v_mfma_f32_16x16x32_bf16 v[168:171], v[200:203], v[12:15], v[168:171]
    ds_read_b64_tr_b16 v[222:223], v237 offset:8704
    v_mfma_f32_16x16x32_bf16 v[184:187], v[200:203], v[16:19], v[184:187]
    ds_read_b64_tr_b16 v[224:225], v238 offset:8192
    v_mfma_f32_16x16x32_bf16 v[124:127], v[204:207], v[0:3], v[124:127]
    ds_read_b64_tr_b16 v[226:227], v238 offset:8704
    v_mfma_f32_16x16x32_bf16 v[140:143], v[204:207], v[4:7], v[140:143]
    ds_read_b64_tr_b16 v[228:229], v239 offset:8192
    v_mfma_f32_16x16x32_bf16 v[156:159], v[204:207], v[8:11], v[156:159]
    ds_read_b64_tr_b16 v[230:231], v239 offset:8704
    v_mfma_f32_16x16x32_bf16 v[172:175], v[204:207], v[12:15], v[172:175]
    v_mfma_f32_16x16x32_bf16 v[188:191], v[204:207], v[16:19], v[188:191]
    v_mfma_f32_16x16x32_bf16 v[128:131], v[208:211], v[0:3], v[128:131]
    v_mfma_f32_16x16x32_bf16 v[144:147], v[208:211], v[4:7], v[144:147]
    v_mfma_f32_16x16x32_bf16 v[160:163], v[208:211], v[8:11], v[160:163]
    v_mfma_f32_16x16x32_bf16 v[176:179], v[208:211], v[12:15], v[176:179]
    v_mfma_f32_16x16x32_bf16 v[192:195], v[208:211], v[16:19], v[192:195]
    v_mfma_f32_16x16x32_bf16 v[132:135], v[212:215], v[0:3], v[132:135]
    v_mfma_f32_16x16x32_bf16 v[148:151], v[212:215], v[4:7], v[148:151]
    v_mfma_f32_16x16x32_bf16 v[164:167], v[212:215], v[8:11], v[164:167]
    v_mfma_f32_16x16x32_bf16 v[180:183], v[212:215], v[12:15], v[180:183]
    v_mfma_f32_16x16x32_bf16 v[196:199], v[212:215], v[16:19], v[196:199]
    s_waitcnt vmcnt(0) lgkmcnt(0)
    v_mfma_f32_16x16x32_bf16 v[120:123], v[216:219], v[20:23], v[120:123]
    v_mfma_f32_16x16x32_bf16 v[136:139], v[216:219], v[24:27], v[136:139]
    v_mfma_f32_16x16x32_bf16 v[152:155], v[216:219], v[28:31], v[152:155]
    v_mfma_f32_16x16x32_bf16 v[168:171], v[216:219], v[32:35], v[168:171]
    v_mfma_f32_16x16x32_bf16 v[184:187], v[216:219], v[36:39], v[184:187]
    v_mfma_f32_16x16x32_bf16 v[124:127], v[220:223], v[20:23], v[124:127]
    v_mfma_f32_16x16x32_bf16 v[140:143], v[220:223], v[24:27], v[140:143]
    v_mfma_f32_16x16x32_bf16 v[156:159], v[220:223], v[28:31], v[156:159]
    v_mfma_f32_16x16x32_bf16 v[172:175], v[220:223], v[32:35], v[172:175]
    v_mfma_f32_16x16x32_bf16 v[188:191], v[220:223], v[36:39], v[188:191]
    v_mfma_f32_16x16x32_bf16 v[128:131], v[224:227], v[20:23], v[128:131]
    v_mfma_f32_16x16x32_bf16 v[144:147], v[224:227], v[24:27], v[144:147]
    v_mfma_f32_16x16x32_bf16 v[160:163], v[224:227], v[28:31], v[160:163]
    v_mfma_f32_16x16x32_bf16 v[176:179], v[224:227], v[32:35], v[176:179]
    v_mfma_f32_16x16x32_bf16 v[192:195], v[224:227], v[36:39], v[192:195]
    v_mfma_f32_16x16x32_bf16 v[132:135], v[228:231], v[20:23], v[132:135]
    v_mfma_f32_16x16x32_bf16 v[148:151], v[228:231], v[24:27], v[148:151]
    v_mfma_f32_16x16x32_bf16 v[164:167], v[228:231], v[28:31], v[164:167]
    v_mfma_f32_16x16x32_bf16 v[180:183], v[228:231], v[32:35], v[180:183]
    v_mfma_f32_16x16x32_bf16 v[196:199], v[228:231], v[36:39], v[196:199]
    v_add_u32 v242, s50, v240
    s_nop 7
    ds_write_b128 v242, v[120:123] offset:0
    ds_write_b128 v242, v[136:139] offset:4096
    ds_write_b128 v242, v[152:155] offset:8192
    ds_write_b128 v242, v[168:171] offset:12288
    ds_write_b128 v242, v[184:187] offset:16384
    ds_write_b128 v242, v[124:127] offset:1024
    ds_write_b128 v242, v[140:143] offset:5120
    ds_write_b128 v242, v[156:159] offset:9216
    ds_write_b128 v242, v[172:175] offset:13312
    ds_write_b128 v242, v[188:191] offset:17408
    ds_write_b128 v242, v[128:131] offset:2048
    ds_write_b128 v242, v[144:147] offset:6144
    ds_write_b128 v242, v[160:163] offset:10240
    ds_write_b128 v242, v[176:179] offset:14336
    ds_write_b128 v242, v[192:195] offset:18432
    ds_write_b128 v242, v[132:135] offset:3072
    ds_write_b128 v242, v[148:151] offset:7168
    ds_write_b128 v242, v[164:167] offset:11264
    ds_write_b128 v242, v[180:183] offset:15360
    ds_write_b128 v242, v[196:199] offset:19456
    s_lshl_b32 s54, s14, 12
    v_add_u32 v242, s54, v240
    v_add_u32 v243, 81920, v242
    s_waitcnt vmcnt(0) lgkmcnt(0)
    s_barrier
    s_cmp_ge_u32 s14, 5
    s_cbranch_scc1 K5_END
    s_mov_b32 s56, 0xc0135761
    v_mov_b32 v244, 0xbdd2d3e8
    s_mul_i32 s57, s16, 5
    s_add_u32 s57, s57, s14
    s_mul_i32 s57, s57, 54*1024
    s_lshl_b32 s58, s15, 11
    s_add_u32 s57, s57, s58
    ds_read_b128 v[0:3], v242 offset:0
    ds_read_b128 v[4:7], v242 offset:20480
    ds_read_b128 v[8:11], v242 offset:40960
    ds_read_b128 v[12:15], v242 offset:61440
    ds_read_b128 v[16:19], v243 offset:0
    ds_read_b128 v[20:23], v243 offset:20480
    ds_read_b128 v[24:27], v243 offset:40960
    ds_read_b128 v[28:31], v243 offset:61440
    ds_read_b128 v[32:35], v242 offset:1024
    ds_read_b128 v[36:39], v242 offset:21504
    ds_read_b128 v[40:43], v242 offset:41984
    ds_read_b128 v[44:47], v242 offset:62464
    ds_read_b128 v[48:51], v243 offset:1024
    ds_read_b128 v[52:55], v243 offset:21504
    ds_read_b128 v[56:59], v243 offset:41984
    s_waitcnt lgkmcnt(7)
    ds_read_b128 v[60:63], v243 offset:62464
    v_add_f32 v0, v0, v16
    v_add_f32 v1, v1, v17
    v_add_f32 v2, v2, v18
    v_add_f32 v3, v3, v19
    v_add_f32 v4, v4, v20
    v_add_f32 v5, v5, v21
    v_add_f32 v6, v6, v22
    v_add_f32 v7, v7, v23
    v_add_f32 v8, v8, v24
    v_add_f32 v9, v9, v25
    v_add_f32 v10, v10, v26
    v_add_f32 v11, v11, v27
    v_add_f32 v12, v12, v28
    v_add_f32 v13, v13, v29
    v_add_f32 v14, v14, v30
    v_add_f32 v15, v15, v31
    v_add_f32 v0, v0, v8
    v_add_f32 v1, v1, v9
    v_add_f32 v2, v2, v10
    v_add_f32 v3, v3, v11
    v_add_f32 v4, v4, v12
    v_add_f32 v5, v5, v13
    v_add_f32 v6, v6, v14
    v_add_f32 v7, v7, v15
    v_add_f32 v0, v0, v4
    v_add_f32 v1, v1, v5
    v_add_f32 v2, v2, v6
    v_add_f32 v3, v3, v7
    v_cvt_pk_bf16_f32 v8, v0, v1
    v_lshlrev_b32 v0, 16, v8
    v_and_b32 v1, 0xffff0000, v8
    v_lshlrev_b32 v8, 16, v246
    v_and_b32 v9, 0xffff0000, v246
    v_add_f32 v0, v0, v8
    v_add_f32 v1, v1, v9
    v_cvt_pk_bf16_f32 v8, v0, v1
    v_lshlrev_b32 v0, 16, v8
    v_and_b32 v1, 0xffff0000, v8
    v_mul_f32 v8, v0, v0
    v_fma_f32 v8, v8, v244, s56
    v_mul_f32 v8, v8, v0
    v_exp_f32 v8, v8
    v_mul_f32 v9, v1, v1
    v_fma_f32 v9, v9, v244, s56
    v_mul_f32 v9, v9, v1
    v_exp_f32 v9, v9
    v_add_f32 v8, 1.0, v8
    v_add_f32 v9, 1.0, v9
    v_rcp_f32 v8, v8
    v_rcp_f32 v9, v9
    s_nop 0
    v_mul_f32 v0, v0, v8
    v_mul_f32 v1, v1, v9
    v_cvt_pk_bf16_f32 v128, v0, v1
    v_cvt_pk_bf16_f32 v10, v2, v3
    v_lshlrev_b32 v2, 16, v10
    v_and_b32 v3, 0xffff0000, v10
    v_lshlrev_b32 v10, 16, v247
    v_and_b32 v11, 0xffff0000, v247
    v_add_f32 v2, v2, v10
    v_add_f32 v3, v3, v11
    v_cvt_pk_bf16_f32 v10, v2, v3
    v_lshlrev_b32 v2, 16, v10
    v_and_b32 v3, 0xffff0000, v10
    v_mul_f32 v10, v2, v2
    v_fma_f32 v10, v10, v244, s56
    v_mul_f32 v10, v10, v2
    v_exp_f32 v10, v10
    v_mul_f32 v11, v3, v3
    v_fma_f32 v11, v11, v244, s56
    v_mul_f32 v11, v11, v3
    v_exp_f32 v11, v11
    v_add_f32 v10, 1.0, v10
    v_add_f32 v11, 1.0, v11
    v_rcp_f32 v10, v10
    v_rcp_f32 v11, v11
    s_nop 0
    v_mul_f32 v2, v2, v10
    v_mul_f32 v3, v3, v11
    v_cvt_pk_bf16_f32 v129, v2, v3
    ds_read_b128 v[64:67], v242 offset:2048
    ds_read_b128 v[68:71], v242 offset:22528
    ds_read_b128 v[72:75], v242 offset:43008
    ds_read_b128 v[76:79], v242 offset:63488
    ds_read_b128 v[80:83], v243 offset:2048
    ds_read_b128 v[84:87], v243 offset:22528
    ds_read_b128 v[88:91], v243 offset:43008
    s_waitcnt lgkmcnt(7)
    ds_read_b128 v[92:95], v243 offset:63488
    v_add_f32 v32, v32, v48
    v_add_f32 v33, v33, v49
    v_add_f32 v34, v34, v50
    v_add_f32 v35, v35, v51
    v_add_f32 v36, v36, v52
    v_add_f32 v37, v37, v53
    v_add_f32 v38, v38, v54
    v_add_f32 v39, v39, v55
    v_add_f32 v40, v40, v56
    v_add_f32 v41, v41, v57
    v_add_f32 v42, v42, v58
    v_add_f32 v43, v43, v59
    v_add_f32 v44, v44, v60
    v_add_f32 v45, v45, v61
    v_add_f32 v46, v46, v62
    v_add_f32 v47, v47, v63
    v_add_f32 v32, v32, v40
    v_add_f32 v33, v33, v41
    v_add_f32 v34, v34, v42
    v_add_f32 v35, v35, v43
    v_add_f32 v36, v36, v44
    v_add_f32 v37, v37, v45
    v_add_f32 v38, v38, v46
    v_add_f32 v39, v39, v47
    v_add_f32 v32, v32, v36
    v_add_f32 v33, v33, v37
    v_add_f32 v34, v34, v38
    v_add_f32 v35, v35, v39
    v_cvt_pk_bf16_f32 v40, v32, v33
    v_lshlrev_b32 v32, 16, v40
    v_and_b32 v33, 0xffff0000, v40
    v_lshlrev_b32 v40, 16, v248
    v_and_b32 v41, 0xffff0000, v248
    v_add_f32 v32, v32, v40
    v_add_f32 v33, v33, v41
    v_cvt_pk_bf16_f32 v40, v32, v33
    v_lshlrev_b32 v32, 16, v40
    v_and_b32 v33, 0xffff0000, v40
    v_mul_f32 v40, v32, v32
    v_fma_f32 v40, v40, v244, s56
    v_mul_f32 v40, v40, v32
    v_exp_f32 v40, v40
    v_mul_f32 v41, v33, v33
    v_fma_f32 v41, v41, v244, s56
    v_mul_f32 v41, v41, v33
    v_exp_f32 v41, v41
    v_add_f32 v40, 1.0, v40
    v_add_f32 v41, 1.0, v41
    v_rcp_f32 v40, v40
    v_rcp_f32 v41, v41
    s_nop 0
    v_mul_f32 v32, v32, v40
    v_mul_f32 v33, v33, v41
    v_cvt_pk_bf16_f32 v130, v32, v33
    v_cvt_pk_bf16_f32 v42, v34, v35
    v_lshlrev_b32 v34, 16, v42
    v_and_b32 v35, 0xffff0000, v42
    v_lshlrev_b32 v42, 16, v249
    v_and_b32 v43, 0xffff0000, v249
    v_add_f32 v34, v34, v42
    v_add_f32 v35, v35, v43
    v_cvt_pk_bf16_f32 v42, v34, v35
    v_lshlrev_b32 v34, 16, v42
    v_and_b32 v35, 0xffff0000, v42
    v_mul_f32 v42, v34, v34
    v_fma_f32 v42, v42, v244, s56
    v_mul_f32 v42, v42, v34
    v_exp_f32 v42, v42
    v_mul_f32 v43, v35, v35
    v_fma_f32 v43, v43, v244, s56
    v_mul_f32 v43, v43, v35
    v_exp_f32 v43, v43
    v_add_f32 v42, 1.0, v42
    v_add_f32 v43, 1.0, v43
    v_rcp_f32 v42, v42
    v_rcp_f32 v43, v43
    s_nop 0
    v_mul_f32 v34, v34, v42
    v_mul_f32 v35, v35, v43
    v_cvt_pk_bf16_f32 v131, v34, v35
    buffer_store_dwordx4 v[128:131], v240, s[28:31], s57 offen offset:0 sc1
    ds_read_b128 v[96:99], v242 offset:3072
    ds_read_b128 v[100:103], v242 offset:23552
    ds_read_b128 v[104:107], v242 offset:44032
    ds_read_b128 v[108:111], v242 offset:64512
    ds_read_b128 v[112:115], v243 offset:3072
    ds_read_b128 v[116:119], v243 offset:23552
    ds_read_b128 v[120:123], v243 offset:44032
    s_waitcnt lgkmcnt(7)
    ds_read_b128 v[124:127], v243 offset:64512
    v_add_f32 v64, v64, v80
    v_add_f32 v65, v65, v81
    v_add_f32 v66, v66, v82
    v_add_f32 v67, v67, v83
    v_add_f32 v68, v68, v84
    v_add_f32 v69, v69, v85
    v_add_f32 v70, v70, v86
    v_add_f32 v71, v71, v87
    v_add_f32 v72, v72, v88
    v_add_f32 v73, v73, v89
    v_add_f32 v74, v74, v90
    v_add_f32 v75, v75, v91
    v_add_f32 v76, v76, v92
    v_add_f32 v77, v77, v93
    v_add_f32 v78, v78, v94
    v_add_f32 v79, v79, v95
    v_add_f32 v64, v64, v72
    v_add_f32 v65, v65, v73
    v_add_f32 v66, v66, v74
    v_add_f32 v67, v67, v75
    v_add_f32 v68, v68, v76
    v_add_f32 v69, v69, v77
    v_add_f32 v70, v70, v78
    v_add_f32 v71, v71, v79
    v_add_f32 v64, v64, v68
    v_add_f32 v65, v65, v69
    v_add_f32 v66, v66, v70
    v_add_f32 v67, v67, v71
    v_cvt_pk_bf16_f32 v72, v64, v65
    v_lshlrev_b32 v64, 16, v72
    v_and_b32 v65, 0xffff0000, v72
    v_lshlrev_b32 v72, 16, v250
    v_and_b32 v73, 0xffff0000, v250
    v_add_f32 v64, v64, v72
    v_add_f32 v65, v65, v73
    v_cvt_pk_bf16_f32 v72, v64, v65
    v_lshlrev_b32 v64, 16, v72
    v_and_b32 v65, 0xffff0000, v72
    v_mul_f32 v72, v64, v64
    v_fma_f32 v72, v72, v244, s56
    v_mul_f32 v72, v72, v64
    v_exp_f32 v72, v72
    v_mul_f32 v73, v65, v65
    v_fma_f32 v73, v73, v244, s56
    v_mul_f32 v73, v73, v65
    v_exp_f32 v73, v73
    v_add_f32 v72, 1.0, v72
    v_add_f32 v73, 1.0, v73
    v_rcp_f32 v72, v72
    v_rcp_f32 v73, v73
    s_nop 0
    v_mul_f32 v64, v64, v72
    v_mul_f32 v65, v65, v73
    v_cvt_pk_bf16_f32 v132, v64, v65
    v_cvt_pk_bf16_f32 v74, v66, v67
    v_lshlrev_b32 v66, 16, v74
    v_and_b32 v67, 0xffff0000, v74
    v_lshlrev_b32 v74, 16, v251
    v_and_b32 v75, 0xffff0000, v251
    v_add_f32 v66, v66, v74
    v_add_f32 v67, v67, v75
    v_cvt_pk_bf16_f32 v74, v66, v67
    v_lshlrev_b32 v66, 16, v74
    v_and_b32 v67, 0xffff0000, v74
    v_mul_f32 v74, v66, v66
    v_fma_f32 v74, v74, v244, s56
    v_mul_f32 v74, v74, v66
    v_exp_f32 v74, v74
    v_mul_f32 v75, v67, v67
    v_fma_f32 v75, v75, v244, s56
    v_mul_f32 v75, v75, v67
    v_exp_f32 v75, v75
    v_add_f32 v74, 1.0, v74
    v_add_f32 v75, 1.0, v75
    v_rcp_f32 v74, v74
    v_rcp_f32 v75, v75
    s_nop 0
    v_mul_f32 v66, v66, v74
    v_mul_f32 v67, v67, v75
    v_cvt_pk_bf16_f32 v133, v66, v67
    s_waitcnt lgkmcnt(0)
    v_add_f32 v96, v96, v112
    v_add_f32 v97, v97, v113
    v_add_f32 v98, v98, v114
    v_add_f32 v99, v99, v115
    v_add_f32 v100, v100, v116
    v_add_f32 v101, v101, v117
    v_add_f32 v102, v102, v118
    v_add_f32 v103, v103, v119
    v_add_f32 v104, v104, v120
    v_add_f32 v105, v105, v121
    v_add_f32 v106, v106, v122
    v_add_f32 v107, v107, v123
    v_add_f32 v108, v108, v124
    v_add_f32 v109, v109, v125
    v_add_f32 v110, v110, v126
    v_add_f32 v111, v111, v127
    v_add_f32 v96, v96, v104
    v_add_f32 v97, v97, v105
    v_add_f32 v98, v98, v106
    v_add_f32 v99, v99, v107
    v_add_f32 v100, v100, v108
    v_add_f32 v101, v101, v109
    v_add_f32 v102, v102, v110
    v_add_f32 v103, v103, v111
    v_add_f32 v96, v96, v100
    v_add_f32 v97, v97, v101
    v_add_f32 v98, v98, v102
    v_add_f32 v99, v99, v103
    v_cvt_pk_bf16_f32 v104, v96, v97
    v_lshlrev_b32 v96, 16, v104
    v_and_b32 v97, 0xffff0000, v104
    v_lshlrev_b32 v104, 16, v252
    v_and_b32 v105, 0xffff0000, v252
    v_add_f32 v96, v96, v104
    v_add_f32 v97, v97, v105
    v_cvt_pk_bf16_f32 v104, v96, v97
    v_lshlrev_b32 v96, 16, v104
    v_and_b32 v97, 0xffff0000, v104
    v_mul_f32 v104, v96, v96
    v_fma_f32 v104, v104, v244, s56
    v_mul_f32 v104, v104, v96
    v_exp_f32 v104, v104
    v_mul_f32 v105, v97, v97
    v_fma_f32 v105, v105, v244, s56
    v_mul_f32 v105, v105, v97
    v_exp_f32 v105, v105
    v_add_f32 v104, 1.0, v104
    v_add_f32 v105, 1.0, v105
    v_rcp_f32 v104, v104
    v_rcp_f32 v105, v105
    s_nop 0
    v_mul_f32 v96, v96, v104
    v_mul_f32 v97, v97, v105
    v_cvt_pk_bf16_f32 v134, v96, v97
    v_cvt_pk_bf16_f32 v106, v98, v99
    v_lshlrev_b32 v98, 16, v106
    v_and_b32 v99, 0xffff0000, v106
    v_lshlrev_b32 v106, 16, v253
    v_and_b32 v107, 0xffff0000, v253
    v_add_f32 v98, v98, v106
    v_add_f32 v99, v99, v107
    v_cvt_pk_bf16_f32 v106, v98, v99
    v_lshlrev_b32 v98, 16, v106
    v_and_b32 v99, 0xffff0000, v106
    v_mul_f32 v106, v98, v98
    v_fma_f32 v106, v106, v244, s56
    v_mul_f32 v106, v106, v98
    v_exp_f32 v106, v106
    v_mul_f32 v107, v99, v99
    v_fma_f32 v107, v107, v244, s56
    v_mul_f32 v107, v107, v99
    v_exp_f32 v107, v107
    v_add_f32 v106, 1.0, v106
    v_add_f32 v107, 1.0, v107
    v_rcp_f32 v106, v106
    v_rcp_f32 v107, v107
    s_nop 0
    v_mul_f32 v98, v98, v106
    v_mul_f32 v99, v99, v107
    v_cvt_pk_bf16_f32 v135, v98, v99
    buffer_store_dwordx4 v[132:135], v240, s[28:31], s57 offen offset:1024 sc1
K5_END:
    s_endpgm
k5_kernel_end:
.globl k6_kernel
.p2align 8
.type k6_kernel,@function
k6_kernel:
    s_cmp_ge_u32 s2, 256
    s_cbranch_scc1 K6_END
    s_load_dwordx4 s[4:7], s[0:1], 72
    s_load_dwordx2 s[8:9], s[0:1], 104
    s_load_dwordx2 s[10:11], s[0:1], 88
    v_mov_b32 v245, v0
    v_and_b32 v241, 63, v0
    v_lshrrev_b32 v242, 6, v0
    s_nop 0
    v_readfirstlane_b32 s14, v242
    s_and_b32 s15, s2, 7
    s_mul_i32 s15, s15, 32
    s_lshr_b32 s16, s2, 3
    s_add_u32 s16, s16, s15
    s_lshr_b32 s15, s16, 3
    s_and_b32 s16, s16, 7
    v_lshlrev_b32 v240, 4, v241
    v_lshrrev_b32 v242, 3, v241
    s_movk_i32 s17, 4096
    v_mul_u32_u24 v242, s17, v242
    s_lshl_b32 s18, s15, 7
    v_add_u32 v242, s18, v242
    v_bfe_u32 v243, v241, 4, 2
    v_lshlrev_b32 v243, 1, v243
    v_and_b32 v244, 7, v241
    v_xor_b32 v243, v243, v244
    v_lshl_add_u32 v232, v243, 4, v242
    v_lshl_add_u32 v233, v243, 4, v242
    v_add_u32 v233, 31744, v233
    v_lshl_add_u32 v234, v243, 4, v242
    v_add_u32 v234, 63488, v234
    v_lshl_add_u32 v235, v243, 4, v242
    v_add_u32 v235, 95232, v235
    s_mul_i32 s19, s14, 917504
    s_mul_i32 s50, s14, 20480
    s_mul_i32 s51, s16, 276480
    s_mul_i32 s52, s14, 7168
    s_add_u32 s51, s51, s52
    s_add_u32 s40, s51, 0
    s_add_u32 s45, s51, 4096
    s_add_u32 s41, s51, 55296
    s_add_u32 s46, s51, 59392
    s_add_u32 s42, s51, 110592
    s_add_u32 s47, s51, 114688
    s_add_u32 s43, s51, 165888
    s_add_u32 s48, s51, 169984
    s_add_u32 s44, s51, 221184
    s_add_u32 s49, s51, 225280
    s_waitcnt lgkmcnt(0)
    s_mov_b32 s20, s4
    s_and_b32 s21, s5, 0xffff
    s_mov_b32 s22, 7077888
    s_mov_b32 s23, 0x00020000
    s_add_u32 s24, s8, 109051904
    s_addc_u32 s25, s9, 0
    s_and_b32 s25, s25, 0xffff
    s_mov_b32 s26, 2211840
    s_mov_b32 s27, 0x00020000
    s_mov_b32 s28, s10
    s_and_b32 s29, s11, 0xffff
    s_mov_b32 s30, 2621440
    s_mov_b32 s31, 0x00020000
    s_mov_b32 s32, s6
    s_and_b32 s33, s7, 0xffff
    s_mov_b32 s34, 4096
    s_mov_b32 s35, 0x00020000
    s_add_u32 s36, s8, 100663296
    s_addc_u32 s37, s9, 0
    s_and_b32 s37, s37, 0xffff
    s_mov_b32 s38, 2621440
    s_mov_b32 s39, 0x00020000
    s_add_u32 m0, s50, 0
    s_add_u32 s53, s19, 0
    buffer_load_dwordx4 v232, s[20:23], s53 offen offset:0 lds
    buffer_load_dwordx4 v233, s[20:23], s53 offen offset:1024 lds
    buffer_load_dwordx4 v234, s[20:23], s53 offen offset:2048 lds
    buffer_load_dwordx4 v235, s[20:23], s53 offen offset:3072 lds
    buffer_load_dwordx4 v[0:3], v240, s[24:27], s40 offen offset:0
    buffer_load_dwordx4 v[4:7], v240, s[24:27], s41 offen offset:0
    buffer_load_dwordx4 v[8:11], v240, s[24:27], s42 offen offset:0
    buffer_load_dwordx4 v[12:15], v240, s[24:27], s43 offen offset:0
    buffer_load_dwordx4 v[16:19], v240, s[24:27], s44 offen offset:0
    s_add_u32 m0, s50, 4096
    s_add_u32 s53, s19, 131072
    buffer_load_dwordx4 v232, s[20:23], s53 offen offset:0 lds
    buffer_load_dwordx4 v233, s[20:23], s53 offen offset:1024 lds
    buffer_load_dwordx4 v234, s[20:23], s53 offen offset:2048 lds
    buffer_load_dwordx4 v235, s[20:23], s53 offen offset:3072 lds
    buffer_load_dwordx4 v[20:23], v240, s[24:27], s40 offen offset:1024
    buffer_load_dwordx4 v[24:27], v240, s[24:27], s41 offen offset:1024
    buffer_load_dwordx4 v[28:31], v240, s[24:27], s42 offen offset:1024
    buffer_load_dwordx4 v[32:35], v240, s[24:27], s43 offen offset:1024
    buffer_load_dwordx4 v[36:39], v240, s[24:27], s44 offen offset:1024
    v_bfe_u32 v242, v241, 2, 2
    v_lshrrev_b32 v243, 4, v241
    v_lshl_add_u32 v244, v243, 2, v242
    v_lshlrev_b32 v244, 7, v244
    v_add_u32 v244, s50, v244
    v_and_b32 v236, 3, v241
    v_lshl_add_u32 v244, v236, 3, v244
    v_lshrrev_b32 v242, 1, v242
    v_and_b32 v243, 1, v243
    v_lshl_add_u32 v242, v243, 1, v242
    v_xor_b32 v243, 0, v242
    v_lshl_add_u32 v236, v243, 5, v244
    v_xor_b32 v243, 1, v242
    v_lshl_add_u32 v237, v243, 5, v244
    v_xor_b32 v243, 2, v242
    v_lshl_add_u32 v238, v243, 5, v244
    v_xor_b32 v243, 3, v242
    v_lshl_add_u32 v239, v243, 5, v244
    s_movk_i32 s54, 6554
    s_movk_i32 s55, 1280
    s_mul_i32 s56, s15, 64*1280
    s_mul_i32 s57, s16, 160
    s_add_u32 s56, s56, s57
    v_add_u32 v242, 0, v245
    v_mul_u32_u24 v243, s54, v242
    v_lshrrev_b32 v243, 16, v243
    v_mul_u32_u24 v244, 10, v243
    v_sub_u32 v242, v242, v244
    v_mul_u32_u24 v244, s55, v243
    v_lshl_add_u32 v246, v242, 4, v244
    v_lshlrev_b32 v250, 1, v243
    v_lshlrev_b32 v244, 1, v242
    v_xor_b32 v244, v244, v243
    v_and_b32 v244, 15, v244
    v_lshlrev_b32 v244, 4, v244
    v_lshrrev_b32 v243, 4, v243
    v_lshl_add_u32 v244, v243, 10, v244
    v_and_b32 v243, 1, v242
    v_lshl_add_u32 v244, v243, 9, v244
    v_lshrrev_b32 v243, 1, v242
    v_lshl_add_u32 v248, v243, 12, v244
    v_add_u32 v242, 512, v245
    v_mul_u32_u24 v243, s54, v242
    v_lshrrev_b32 v243, 16, v243
    v_mul_u32_u24 v244, 10, v243
    v_sub_u32 v242, v242, v244
    v_mul_u32_u24 v244, s55, v243
    v_lshl_add_u32 v247, v242, 4, v244
    v_lshlrev_b32 v251, 1, v243
    v_lshlrev_b32 v244, 1, v242
    v_xor_b32 v244, v244, v243
    v_and_b32 v244, 15, v244
    v_lshlrev_b32 v244, 4, v244
    v_lshrrev_b32 v243, 4, v243
    v_lshl_add_u32 v244, v243, 10, v244
    v_and_b32 v243, 1, v242
    v_lshl_add_u32 v244, v243, 9, v244
    v_lshrrev_b32 v243, 1, v242
    v_lshl_add_u32 v249, v243, 12, v244
    s_waitcnt vmcnt(14) lgkmcnt(0)
    ds_read_b64_tr_b16 v[200:201], v236 offset:0
    ds_read_b64_tr_b16 v[202:203], v236 offset:2048
    ds_read_b64_tr_b16 v[204:205], v237 offset:0
    ds_read_b64_tr_b16 v[206:207], v237 offset:2048
    ds_read_b64_tr_b16 v[208:209], v238 offset:0
    ds_read_b64_tr_b16 v[210:211], v238 offset:2048
    ds_read_b64_tr_b16 v[212:213], v239 offset:0
    ds_read_b64_tr_b16 v[214:215], v239 offset:2048
    s_add_u32 m0, s50, 8192
    s_add_u32 s53, s19, 262144
    buffer_load_dwordx4 v232, s[20:23], s53 offen offset:0 lds
    buffer_load_dwordx4 v233, s[20:23], s53 offen offset:1024 lds
    buffer_load_dwordx4 v234, s[20:23], s53 offen offset:2048 lds
    buffer_load_dwordx4 v235, s[20:23], s53 offen offset:3072 lds
    buffer_load_dwordx4 v[40:43], v240, s[24:27], s40 offen offset:2048
    buffer_load_dwordx4 v[44:47], v240, s[24:27], s41 offen offset:2048
    buffer_load_dwordx4 v[48:51], v240, s[24:27], s42 offen offset:2048
    buffer_load_dwordx4 v[52:55], v240, s[24:27], s43 offen offset:2048
    buffer_load_dwordx4 v[56:59], v240, s[24:27], s44 offen offset:2048
    s_waitcnt vmcnt(14) lgkmcnt(0)
    v_mfma_f32_16x16x32_bf16 v[120:123], v[0:3], v[200:203], 0
    ds_read_b64_tr_b16 v[216:217], v236 offset:4096
    v_mfma_f32_16x16x32_bf16 v[136:139], v[4:7], v[200:203], 0
    ds_read_b64_tr_b16 v[218:219], v236 offset:6144
    v_mfma_f32_16x16x32_bf16 v[152:155], v[8:11], v[200:203], 0
    ds_read_b64_tr_b16 v[220:221], v237 offset:4096
    v_mfma_f32_16x16x32_bf16 v[168:171], v[12:15], v[200:203], 0
    ds_read_b64_tr_b16 v[222:223], v237 offset:6144
    v_mfma_f32_16x16x32_bf16 v[184:187], v[16:19], v[200:203], 0
    ds_read_b64_tr_b16 v[224:225], v238 offset:4096
    v_mfma_f32_16x16x32_bf16 v[124:127], v[0:3], v[204:207], 0
    ds_read_b64_tr_b16 v[226:227], v238 offset:6144
    v_mfma_f32_16x16x32_bf16 v[140:143], v[4:7], v[204:207], 0
    ds_read_b64_tr_b16 v[228:229], v239 offset:4096
    v_mfma_f32_16x16x32_bf16 v[156:159], v[8:11], v[204:207], 0
    ds_read_b64_tr_b16 v[230:231], v239 offset:6144
    v_mfma_f32_16x16x32_bf16 v[172:175], v[12:15], v[204:207], 0
    s_add_u32 m0, s50, 12288
    s_add_u32 s53, s19, 393216
    buffer_load_dwordx4 v232, s[20:23], s53 offen offset:0 lds
    buffer_load_dwordx4 v233, s[20:23], s53 offen offset:1024 lds
    buffer_load_dwordx4 v234, s[20:23], s53 offen offset:2048 lds
    buffer_load_dwordx4 v235, s[20:23], s53 offen offset:3072 lds
    v_mfma_f32_16x16x32_bf16 v[188:191], v[16:19], v[204:207], 0
    buffer_load_dwordx4 v[60:63], v240, s[24:27], s40 offen offset:3072
    v_mfma_f32_16x16x32_bf16 v[128:131], v[0:3], v[208:211], 0
    buffer_load_dwordx4 v[64:67], v240, s[24:27], s41 offen offset:3072
    v_mfma_f32_16x16x32_bf16 v[144:147], v[4:7], v[208:211], 0
    buffer_load_dwordx4 v[68:71], v240, s[24:27], s42 offen offset:3072
    v_mfma_f32_16x16x32_bf16 v[160:163], v[8:11], v[208:211], 0
    buffer_load_dwordx4 v[72:75], v240, s[24:27], s43 offen offset:3072
    v_mfma_f32_16x16x32_bf16 v[176:179], v[12:15], v[208:211], 0
    buffer_load_dwordx4 v[76:79], v240, s[24:27], s44 offen offset:3072
    v_mfma_f32_16x16x32_bf16 v[192:195], v[16:19], v[208:211], 0
    v_mfma_f32_16x16x32_bf16 v[132:135], v[0:3], v[212:215], 0
    v_mfma_f32_16x16x32_bf16 v[148:151], v[4:7], v[212:215], 0
    v_mfma_f32_16x16x32_bf16 v[164:167], v[8:11], v[212:215], 0
    v_mfma_f32_16x16x32_bf16 v[180:183], v[12:15], v[212:215], 0
    v_mfma_f32_16x16x32_bf16 v[196:199], v[16:19], v[212:215], 0
    s_waitcnt vmcnt(14) lgkmcnt(0)
    v_mfma_f32_16x16x32_bf16 v[120:123], v[20:23], v[216:219], v[120:123]
    ds_read_b64_tr_b16 v[200:201], v236 offset:8192
    v_mfma_f32_16x16x32_bf16 v[136:139], v[24:27], v[216:219], v[136:139]
    ds_read_b64_tr_b16 v[202:203], v236 offset:10240
    v_mfma_f32_16x16x32_bf16 v[152:155], v[28:31], v[216:219], v[152:155]
    ds_read_b64_tr_b16 v[204:205], v237 offset:8192
    v_mfma_f32_16x16x32_bf16 v[168:171], v[32:35], v[216:219], v[168:171]
    ds_read_b64_tr_b16 v[206:207], v237 offset:10240
    v_mfma_f32_16x16x32_bf16 v[184:187], v[36:39], v[216:219], v[184:187]
    ds_read_b64_tr_b16 v[208:209], v238 offset:8192
    v_mfma_f32_16x16x32_bf16 v[124:127], v[20:23], v[220:223], v[124:127]
    ds_read_b64_tr_b16 v[210:211], v238 offset:10240
    v_mfma_f32_16x16x32_bf16 v[140:143], v[24:27], v[220:223], v[140:143]
    ds_read_b64_tr_b16 v[212:213], v239 offset:8192
    v_mfma_f32_16x16x32_bf16 v[156:159], v[28:31], v[220:223], v[156:159]
    ds_read_b64_tr_b16 v[214:215], v239 offset:10240
    v_mfma_f32_16x16x32_bf16 v[172:175], v[32:35], v[220:223], v[172:175]
    s_add_u32 m0, s50, 16384
    s_add_u32 s53, s19, 524288
    buffer_load_dwordx4 v232, s[20:23], s53 offen offset:0 lds
    buffer_load_dwordx4 v233, s[20:23], s53 offen offset:1024 lds
    buffer_load_dwordx4 v234, s[20:23], s53 offen offset:2048 lds
    buffer_load_dwordx4 v235, s[20:23], s53 offen offset:3072 lds
    v_mfma_f32_16x16x32_bf16 v[188:191], v[36:39], v[220:223], v[188:191]
    buffer_load_dwordx4 v[80:83], v240, s[24:27], s45 offen offset:0
    v_mfma_f32_16x16x32_bf16 v[128:131], v[20:23], v[224:227], v[128:131]
    buffer_load_dwordx4 v[84:87], v240, s[24:27], s46 offen offset:0
    v_mfma_f32_16x16x32_bf16 v[144:147], v[24:27], v[224:227], v[144:147]
    buffer_load_dwordx4 v[88:91], v240, s[24:27], s47 offen offset:0
    v_mfma_f32_16x16x32_bf16 v[160:163], v[28:31], v[224:227], v[160:163]
    buffer_load_dwordx4 v[92:95], v240, s[24:27], s48 offen offset:0
    v_mfma_f32_16x16x32_bf16 v[176:179], v[32:35], v[224:227], v[176:179]
    buffer_load_dwordx4 v[96:99], v240, s[24:27], s49 offen offset:0
    v_mfma_f32_16x16x32_bf16 v[192:195], v[36:39], v[224:227], v[192:195]
    v_mfma_f32_16x16x32_bf16 v[132:135], v[20:23], v[228:231], v[132:135]
    v_mfma_f32_16x16x32_bf16 v[148:151], v[24:27], v[228:231], v[148:151]
    v_mfma_f32_16x16x32_bf16 v[164:167], v[28:31], v[228:231], v[164:167]
    v_mfma_f32_16x16x32_bf16 v[180:183], v[32:35], v[228:231], v[180:183]
    v_mfma_f32_16x16x32_bf16 v[196:199], v[36:39], v[228:231], v[196:199]
    s_waitcnt vmcnt(14) lgkmcnt(0)
    v_mfma_f32_16x16x32_bf16 v[120:123], v[40:43], v[200:203], v[120:123]
    ds_read_b64_tr_b16 v[216:217], v236 offset:12288
    v_mfma_f32_16x16x32_bf16 v[136:139], v[44:47], v[200:203], v[136:139]
    ds_read_b64_tr_b16 v[218:219], v236 offset:14336
    v_mfma_f32_16x16x32_bf16 v[152:155], v[48:51], v[200:203], v[152:155]
    ds_read_b64_tr_b16 v[220:221], v237 offset:12288
    v_mfma_f32_16x16x32_bf16 v[168:171], v[52:55], v[200:203], v[168:171]
    ds_read_b64_tr_b16 v[222:223], v237 offset:14336
    v_mfma_f32_16x16x32_bf16 v[184:187], v[56:59], v[200:203], v[184:187]
    ds_read_b64_tr_b16 v[224:225], v238 offset:12288
    v_mfma_f32_16x16x32_bf16 v[124:127], v[40:43], v[204:207], v[124:127]
    ds_read_b64_tr_b16 v[226:227], v238 offset:14336
    v_mfma_f32_16x16x32_bf16 v[140:143], v[44:47], v[204:207], v[140:143]
    ds_read_b64_tr_b16 v[228:229], v239 offset:12288
    v_mfma_f32_16x16x32_bf16 v[156:159], v[48:51], v[204:207], v[156:159]
    ds_read_b64_tr_b16 v[230:231], v239 offset:14336
    v_mfma_f32_16x16x32_bf16 v[172:175], v[52:55], v[204:207], v[172:175]
    s_add_u32 m0, s50, 0
    s_add_u32 s53, s19, 655360
    buffer_load_dwordx4 v232, s[20:23], s53 offen offset:0 lds
    buffer_load_dwordx4 v233, s[20:23], s53 offen offset:1024 lds
    buffer_load_dwordx4 v234, s[20:23], s53 offen offset:2048 lds
    buffer_load_dwordx4 v235, s[20:23], s53 offen offset:3072 lds
    v_mfma_f32_16x16x32_bf16 v[188:191], v[56:59], v[204:207], v[188:191]
    buffer_load_dwordx4 v[100:103], v240, s[24:27], s45 offen offset:1024
    v_mfma_f32_16x16x32_bf16 v[128:131], v[40:43], v[208:211], v[128:131]
    buffer_load_dwordx4 v[104:107], v240, s[24:27], s46 offen offset:1024
    v_mfma_f32_16x16x32_bf16 v[144:147], v[44:47], v[208:211], v[144:147]
    buffer_load_dwordx4 v[108:111], v240, s[24:27], s47 offen offset:1024
    v_mfma_f32_16x16x32_bf16 v[160:163], v[48:51], v[208:211], v[160:163]
    buffer_load_dwordx4 v[112:115], v240, s[24:27], s48 offen offset:1024
    v_mfma_f32_16x16x32_bf16 v[176:179], v[52:55], v[208:211], v[176:179]
    buffer_load_dwordx4 v[116:119], v240, s[24:27], s49 offen offset:1024
    v_mfma_f32_16x16x32_bf16 v[192:195], v[56:59], v[208:211], v[192:195]
    v_mfma_f32_16x16x32_bf16 v[132:135], v[40:43], v[212:215], v[132:135]
    v_mfma_f32_16x16x32_bf16 v[148:151], v[44:47], v[212:215], v[148:151]
    v_mfma_f32_16x16x32_bf16 v[164:167], v[48:51], v[212:215], v[164:167]
    v_mfma_f32_16x16x32_bf16 v[180:183], v[52:55], v[212:215], v[180:183]
    v_mfma_f32_16x16x32_bf16 v[196:199], v[56:59], v[212:215], v[196:199]
    s_waitcnt vmcnt(14) lgkmcnt(0)
    v_mfma_f32_16x16x32_bf16 v[120:123], v[60:63], v[216:219], v[120:123]
    ds_read_b64_tr_b16 v[200:201], v236 offset:16384
    v_mfma_f32_16x16x32_bf16 v[136:139], v[64:67], v[216:219], v[136:139]
    ds_read_b64_tr_b16 v[202:203], v236 offset:18432
    v_mfma_f32_16x16x32_bf16 v[152:155], v[68:71], v[216:219], v[152:155]
    ds_read_b64_tr_b16 v[204:205], v237 offset:16384
    v_mfma_f32_16x16x32_bf16 v[168:171], v[72:75], v[216:219], v[168:171]
    ds_read_b64_tr_b16 v[206:207], v237 offset:18432
    v_mfma_f32_16x16x32_bf16 v[184:187], v[76:79], v[216:219], v[184:187]
    ds_read_b64_tr_b16 v[208:209], v238 offset:16384
    v_mfma_f32_16x16x32_bf16 v[124:127], v[60:63], v[220:223], v[124:127]
    ds_read_b64_tr_b16 v[210:211], v238 offset:18432
    v_mfma_f32_16x16x32_bf16 v[140:143], v[64:67], v[220:223], v[140:143]
    ds_read_b64_tr_b16 v[212:213], v239 offset:16384
    v_mfma_f32_16x16x32_bf16 v[156:159], v[68:71], v[220:223], v[156:159]
    ds_read_b64_tr_b16 v[214:215], v239 offset:18432
    v_mfma_f32_16x16x32_bf16 v[172:175], v[72:75], v[220:223], v[172:175]
    s_add_u32 m0, s50, 4096
    s_add_u32 s53, s19, 786432
    buffer_load_dwordx4 v232, s[20:23], s53 offen offset:0 lds
    buffer_load_dwordx4 v233, s[20:23], s53 offen offset:1024 lds
    buffer_load_dwordx4 v234, s[20:23], s53 offen offset:2048 lds
    buffer_load_dwordx4 v235, s[20:23], s53 offen offset:3072 lds
    v_mfma_f32_16x16x32_bf16 v[188:191], v[76:79], v[220:223], v[188:191]
    buffer_load_dwordx4 v[0:3], v240, s[24:27], s45 offen offset:2048
    v_mfma_f32_16x16x32_bf16 v[128:131], v[60:63], v[224:227], v[128:131]
    buffer_load_dwordx4 v[4:7], v240, s[24:27], s46 offen offset:2048
    v_mfma_f32_16x16x32_bf16 v[144:147], v[64:67], v[224:227], v[144:147]
    buffer_load_dwordx4 v[8:11], v240, s[24:27], s47 offen offset:2048
    v_mfma_f32_16x16x32_bf16 v[160:163], v[68:71], v[224:227], v[160:163]
    buffer_load_dwordx4 v[12:15], v240, s[24:27], s48 offen offset:2048
    v_mfma_f32_16x16x32_bf16 v[176:179], v[72:75], v[224:227], v[176:179]
    buffer_load_dwordx4 v[16:19], v240, s[24:27], s49 offen offset:2048
    v_mfma_f32_16x16x32_bf16 v[192:195], v[76:79], v[224:227], v[192:195]
    v_mfma_f32_16x16x32_bf16 v[132:135], v[60:63], v[228:231], v[132:135]
    v_mfma_f32_16x16x32_bf16 v[148:151], v[64:67], v[228:231], v[148:151]
    v_mfma_f32_16x16x32_bf16 v[164:167], v[68:71], v[228:231], v[164:167]
    v_mfma_f32_16x16x32_bf16 v[180:183], v[72:75], v[228:231], v[180:183]
    v_mfma_f32_16x16x32_bf16 v[196:199], v[76:79], v[228:231], v[196:199]
    s_waitcnt vmcnt(14) lgkmcnt(0)
    v_mfma_f32_16x16x32_bf16 v[120:123], v[80:83], v[200:203], v[120:123]
    ds_read_b64_tr_b16 v[216:217], v236 offset:0
    v_mfma_f32_16x16x32_bf16 v[136:139], v[84:87], v[200:203], v[136:139]
    ds_read_b64_tr_b16 v[218:219], v236 offset:2048
    v_mfma_f32_16x16x32_bf16 v[152:155], v[88:91], v[200:203], v[152:155]
    ds_read_b64_tr_b16 v[220:221], v237 offset:0
    v_mfma_f32_16x16x32_bf16 v[168:171], v[92:95], v[200:203], v[168:171]
    ds_read_b64_tr_b16 v[222:223], v237 offset:2048
    v_mfma_f32_16x16x32_bf16 v[184:187], v[96:99], v[200:203], v[184:187]
    ds_read_b64_tr_b16 v[224:225], v238 offset:0
    v_mfma_f32_16x16x32_bf16 v[124:127], v[80:83], v[204:207], v[124:127]
    ds_read_b64_tr_b16 v[226:227], v238 offset:2048
    v_mfma_f32_16x16x32_bf16 v[140:143], v[84:87], v[204:207], v[140:143]
    ds_read_b64_tr_b16 v[228:229], v239 offset:0
    v_mfma_f32_16x16x32_bf16 v[156:159], v[88:91], v[204:207], v[156:159]
    ds_read_b64_tr_b16 v[230:231], v239 offset:2048
    v_mfma_f32_16x16x32_bf16 v[172:175], v[92:95], v[204:207], v[172:175]
    buffer_load_dwordx4 v[20:23], v246, s[36:39], s56 offen
    buffer_load_ushort v28, v250, s[32:35], s18 offen
    s_cmp_ge_u32 s14, 2
    s_cselect_b32 s58, 0x7fffffff, s56
    s_cselect_b32 s59, 0x7fffffff, s18
    buffer_load_dwordx4 v[24:27], v247, s[36:39], s58 offen
    buffer_load_ushort v29, v251, s[32:35], s59 offen
    v_mfma_f32_16x16x32_bf16 v[188:191], v[96:99], v[204:207], v[188:191]
    v_mfma_f32_16x16x32_bf16 v[128:131], v[80:83], v[208:211], v[128:131]
    v_mfma_f32_16x16x32_bf16 v[144:147], v[84:87], v[208:211], v[144:147]
    v_mfma_f32_16x16x32_bf16 v[160:163], v[88:91], v[208:211], v[160:163]
    v_mfma_f32_16x16x32_bf16 v[176:179], v[92:95], v[208:211], v[176:179]
    v_mfma_f32_16x16x32_bf16 v[192:195], v[96:99], v[208:211], v[192:195]
    v_mfma_f32_16x16x32_bf16 v[132:135], v[80:83], v[212:215], v[132:135]
    v_mfma_f32_16x16x32_bf16 v[148:151], v[84:87], v[212:215], v[148:151]
    v_mfma_f32_16x16x32_bf16 v[164:167], v[88:91], v[212:215], v[164:167]
    v_mfma_f32_16x16x32_bf16 v[180:183], v[92:95], v[212:215], v[180:183]
    v_mfma_f32_16x16x32_bf16 v[196:199], v[96:99], v[212:215], v[196:199]
    s_waitcnt vmcnt(9) lgkmcnt(0)
    v_mfma_f32_16x16x32_bf16 v[120:123], v[100:103], v[216:219], v[120:123]
    ds_read_b64_tr_b16 v[200:201], v236 offset:4096
    v_mfma_f32_16x16x32_bf16 v[136:139], v[104:107], v[216:219], v[136:139]
    ds_read_b64_tr_b16 v[202:203], v236 offset:6144
    v_mfma_f32_16x16x32_bf16 v[152:155], v[108:111], v[216:219], v[152:155]
    ds_read_b64_tr_b16 v[204:205], v237 offset:4096
    v_mfma_f32_16x16x32_bf16 v[168:171], v[112:115], v[216:219], v[168:171]
    ds_read_b64_tr_b16 v[206:207], v237 offset:6144
    v_mfma_f32_16x16x32_bf16 v[184:187], v[116:119], v[216:219], v[184:187]
    ds_read_b64_tr_b16 v[208:209], v238 offset:4096
    v_mfma_f32_16x16x32_bf16 v[124:127], v[100:103], v[220:223], v[124:127]
    ds_read_b64_tr_b16 v[210:211], v238 offset:6144
    v_mfma_f32_16x16x32_bf16 v[140:143], v[104:107], v[220:223], v[140:143]
    ds_read_b64_tr_b16 v[212:213], v239 offset:4096
    v_mfma_f32_16x16x32_bf16 v[156:159], v[108:111], v[220:223], v[156:159]
    ds_read_b64_tr_b16 v[214:215], v239 offset:6144
    v_mfma_f32_16x16x32_bf16 v[172:175], v[112:115], v[220:223], v[172:175]
    v_mfma_f32_16x16x32_bf16 v[188:191], v[116:119], v[220:223], v[188:191]
    v_mfma_f32_16x16x32_bf16 v[128:131], v[100:103], v[224:227], v[128:131]
    v_mfma_f32_16x16x32_bf16 v[144:147], v[104:107], v[224:227], v[144:147]
    v_mfma_f32_16x16x32_bf16 v[160:163], v[108:111], v[224:227], v[160:163]
    v_mfma_f32_16x16x32_bf16 v[176:179], v[112:115], v[224:227], v[176:179]
    v_mfma_f32_16x16x32_bf16 v[192:195], v[116:119], v[224:227], v[192:195]
    v_mfma_f32_16x16x32_bf16 v[132:135], v[100:103], v[228:231], v[132:135]
    v_mfma_f32_16x16x32_bf16 v[148:151], v[104:107], v[228:231], v[148:151]
    v_mfma_f32_16x16x32_bf16 v[164:167], v[108:111], v[228:231], v[164:167]
    v_mfma_f32_16x16x32_bf16 v[180:183], v[112:115], v[228:231], v[180:183]
    v_mfma_f32_16x16x32_bf16 v[196:199], v[116:119], v[228:231], v[196:199]
    s_waitcnt vmcnt(4) lgkmcnt(0)
    v_mfma_f32_16x16x32_bf16 v[120:123], v[0:3], v[200:203], v[120:123]
    v_mfma_f32_16x16x32_bf16 v[136:139], v[4:7], v[200:203], v[136:139]
    v_mfma_f32_16x16x32_bf16 v[152:155], v[8:11], v[200:203], v[152:155]
    v_mfma_f32_16x16x32_bf16 v[168:171], v[12:15], v[200:203], v[168:171]
    v_mfma_f32_16x16x32_bf16 v[184:187], v[16:19], v[200:203], v[184:187]
    v_mfma_f32_16x16x32_bf16 v[124:127], v[0:3], v[204:207], v[124:127]
    v_mfma_f32_16x16x32_bf16 v[140:143], v[4:7], v[204:207], v[140:143]
    v_mfma_f32_16x16x32_bf16 v[156:159], v[8:11], v[204:207], v[156:159]
    v_mfma_f32_16x16x32_bf16 v[172:175], v[12:15], v[204:207], v[172:175]
    v_mfma_f32_16x16x32_bf16 v[188:191], v[16:19], v[204:207], v[188:191]
    v_mfma_f32_16x16x32_bf16 v[128:131], v[0:3], v[208:211], v[128:131]
    v_mfma_f32_16x16x32_bf16 v[144:147], v[4:7], v[208:211], v[144:147]
    v_mfma_f32_16x16x32_bf16 v[160:163], v[8:11], v[208:211], v[160:163]
    v_mfma_f32_16x16x32_bf16 v[176:179], v[12:15], v[208:211], v[176:179]
    v_mfma_f32_16x16x32_bf16 v[192:195], v[16:19], v[208:211], v[192:195]
    v_mfma_f32_16x16x32_bf16 v[132:135], v[0:3], v[212:215], v[132:135]
    v_mfma_f32_16x16x32_bf16 v[148:151], v[4:7], v[212:215], v[148:151]
    v_mfma_f32_16x16x32_bf16 v[164:167], v[8:11], v[212:215], v[164:167]
    v_mfma_f32_16x16x32_bf16 v[180:183], v[12:15], v[212:215], v[180:183]
    v_mfma_f32_16x16x32_bf16 v[196:199], v[16:19], v[212:215], v[196:199]
    v_lshrrev_b32 v243, 4, v241
    v_lshlrev_b32 v243, 4, v243
    v_xor_b32 v243, v243, v240
    v_add_u32 v243, s50, v243
    v_xor_b32 v216, 0, v243
    v_xor_b32 v220, 64, v243
    v_xor_b32 v224, 128, v243
    v_xor_b32 v228, 192, v243
    s_nop 7
    ds_write_b128 v216, v[120:123] offset:0
    ds_write_b128 v220, v[136:139] offset:4096
    ds_write_b128 v224, v[152:155] offset:8192
    ds_write_b128 v228, v[168:171] offset:12288
    ds_write_b128 v216, v[184:187] offset:16384
    ds_write_b128 v216, v[124:127] offset:1024
    ds_write_b128 v220, v[140:143] offset:5120
    ds_write_b128 v224, v[156:159] offset:9216
    ds_write_b128 v228, v[172:175] offset:13312
    ds_write_b128 v216, v[188:191] offset:17408
    ds_write_b128 v216, v[128:131] offset:2048
    ds_write_b128 v220, v[144:147] offset:6144
    ds_write_b128 v224, v[160:163] offset:10240
    ds_write_b128 v228, v[176:179] offset:14336
    ds_write_b128 v216, v[192:195] offset:18432
    ds_write_b128 v216, v[132:135] offset:3072
    ds_write_b128 v220, v[148:151] offset:7168
    ds_write_b128 v224, v[164:167] offset:11264
    ds_write_b128 v228, v[180:183] offset:15360
    ds_write_b128 v216, v[196:199] offset:19456
    v_xor_b32 v232, 16, v248
    v_add_u32 v234, 81920, v248
    v_add_u32 v236, 81920, v232
    v_xor_b32 v233, 16, v249
    v_add_u32 v235, 81920, v249
    v_add_u32 v237, 81920, v233
    s_waitcnt vmcnt(0) lgkmcnt(0)
    s_barrier
    ds_read_b128 v[32:35], v248 offset:0
    ds_read_b128 v[36:39], v248 offset:20480
    ds_read_b128 v[40:43], v248 offset:40960
    ds_read_b128 v[44:47], v248 offset:61440
    ds_read_b128 v[48:51], v234 offset:0
    ds_read_b128 v[52:55], v234 offset:20480
    ds_read_b128 v[56:59], v234 offset:40960
    ds_read_b128 v[60:63], v234 offset:61440
    ds_read_b128 v[64:67], v232 offset:256
    ds_read_b128 v[68:71], v232 offset:20736
    ds_read_b128 v[72:75], v232 offset:41216
    ds_read_b128 v[76:79], v232 offset:61696
    ds_read_b128 v[80:83], v236 offset:256
    ds_read_b128 v[84:87], v236 offset:20736
    ds_read_b128 v[88:91], v236 offset:41216
    v_lshlrev_b32 v28, 16, v28
    s_waitcnt lgkmcnt(7)
    ds_read_b128 v[92:95], v236 offset:61696
    v_add_f32 v32, v32, v48
    v_add_f32 v33, v33, v49
    v_add_f32 v34, v34, v50
    v_add_f32 v35, v35, v51
    v_add_f32 v36, v36, v52
    v_add_f32 v37, v37, v53
    v_add_f32 v38, v38, v54
    v_add_f32 v39, v39, v55
    v_add_f32 v40, v40, v56
    v_add_f32 v41, v41, v57
    v_add_f32 v42, v42, v58
    v_add_f32 v43, v43, v59
    v_add_f32 v44, v44, v60
    v_add_f32 v45, v45, v61
    v_add_f32 v46, v46, v62
    v_add_f32 v47, v47, v63
    v_add_f32 v32, v32, v40
    v_add_f32 v33, v33, v41
    v_add_f32 v34, v34, v42
    v_add_f32 v35, v35, v43
    v_add_f32 v36, v36, v44
    v_add_f32 v37, v37, v45
    v_add_f32 v38, v38, v46
    v_add_f32 v39, v39, v47
    v_add_f32 v32, v32, v36
    v_add_f32 v33, v33, v37
    v_add_f32 v34, v34, v38
    v_add_f32 v35, v35, v39
    v_cvt_pk_bf16_f32 v40, v32, v33
    v_lshlrev_b32 v32, 16, v40
    v_and_b32 v33, 0xffff0000, v40
    v_add_f32 v32, v32, v28
    v_add_f32 v33, v33, v28
    v_cvt_pk_bf16_f32 v40, v32, v33
    v_lshlrev_b32 v32, 16, v40
    v_and_b32 v33, 0xffff0000, v40
    v_lshlrev_b32 v40, 16, v20
    v_and_b32 v41, 0xffff0000, v20
    v_add_f32 v32, v32, v40
    v_add_f32 v33, v33, v41
    v_cvt_pk_bf16_f32 v20, v32, v33
    v_cvt_pk_bf16_f32 v42, v34, v35
    v_lshlrev_b32 v34, 16, v42
    v_and_b32 v35, 0xffff0000, v42
    v_add_f32 v34, v34, v28
    v_add_f32 v35, v35, v28
    v_cvt_pk_bf16_f32 v42, v34, v35
    v_lshlrev_b32 v34, 16, v42
    v_and_b32 v35, 0xffff0000, v42
    v_lshlrev_b32 v42, 16, v21
    v_and_b32 v43, 0xffff0000, v21
    v_add_f32 v34, v34, v42
    v_add_f32 v35, v35, v43
    v_cvt_pk_bf16_f32 v21, v34, v35
    s_waitcnt lgkmcnt(0)
    v_add_f32 v64, v64, v80
    v_add_f32 v65, v65, v81
    v_add_f32 v66, v66, v82
    v_add_f32 v67, v67, v83
    v_add_f32 v68, v68, v84
    v_add_f32 v69, v69, v85
    v_add_f32 v70, v70, v86
    v_add_f32 v71, v71, v87
    v_add_f32 v72, v72, v88
    v_add_f32 v73, v73, v89
    v_add_f32 v74, v74, v90
    v_add_f32 v75, v75, v91
    v_add_f32 v76, v76, v92
    v_add_f32 v77, v77, v93
    v_add_f32 v78, v78, v94
    v_add_f32 v79, v79, v95
    v_add_f32 v64, v64, v72
    v_add_f32 v65, v65, v73
    v_add_f32 v66, v66, v74
    v_add_f32 v67, v67, v75
    v_add_f32 v68, v68, v76
    v_add_f32 v69, v69, v77
    v_add_f32 v70, v70, v78
    v_add_f32 v71, v71, v79
    v_add_f32 v64, v64, v68
    v_add_f32 v65, v65, v69
    v_add_f32 v66, v66, v70
    v_add_f32 v67, v67, v71
    v_cvt_pk_bf16_f32 v72, v64, v65
    v_lshlrev_b32 v64, 16, v72
    v_and_b32 v65, 0xffff0000, v72
    v_add_f32 v64, v64, v28
    v_add_f32 v65, v65, v28
    v_cvt_pk_bf16_f32 v72, v64, v65
    v_lshlrev_b32 v64, 16, v72
    v_and_b32 v65, 0xffff0000, v72
    v_lshlrev_b32 v72, 16, v22
    v_and_b32 v73, 0xffff0000, v22
    v_add_f32 v64, v64, v72
    v_add_f32 v65, v65, v73
    v_cvt_pk_bf16_f32 v22, v64, v65
    v_cvt_pk_bf16_f32 v74, v66, v67
    v_lshlrev_b32 v66, 16, v74
    v_and_b32 v67, 0xffff0000, v74
    v_add_f32 v66, v66, v28
    v_add_f32 v67, v67, v28
    v_cvt_pk_bf16_f32 v74, v66, v67
    v_lshlrev_b32 v66, 16, v74
    v_and_b32 v67, 0xffff0000, v74
    v_lshlrev_b32 v74, 16, v23
    v_and_b32 v75, 0xffff0000, v23
    v_add_f32 v66, v66, v74
    v_add_f32 v67, v67, v75
    v_cvt_pk_bf16_f32 v23, v66, v67
    buffer_store_dwordx4 v[20:23], v246, s[28:31], s56 offen sc1
    s_cmp_ge_u32 s14, 2
    s_cbranch_scc1 K6_END
    ds_read_b128 v[96:99], v249 offset:0
    ds_read_b128 v[100:103], v249 offset:20480
    ds_read_b128 v[104:107], v249 offset:40960
    ds_read_b128 v[108:111], v249 offset:61440
    ds_read_b128 v[112:115], v235 offset:0
    ds_read_b128 v[116:119], v235 offset:20480
    ds_read_b128 v[120:123], v235 offset:40960
    ds_read_b128 v[124:127], v235 offset:61440
    ds_read_b128 v[128:131], v233 offset:256
    ds_read_b128 v[132:135], v233 offset:20736
    ds_read_b128 v[136:139], v233 offset:41216
    ds_read_b128 v[140:143], v233 offset:61696
    ds_read_b128 v[144:147], v237 offset:256
    ds_read_b128 v[148:151], v237 offset:20736
    ds_read_b128 v[152:155], v237 offset:41216
    v_lshlrev_b32 v29, 16, v29
    s_waitcnt lgkmcnt(7)
    ds_read_b128 v[156:159], v237 offset:61696
    v_add_f32 v96, v96, v112
    v_add_f32 v97, v97, v113
    v_add_f32 v98, v98, v114
    v_add_f32 v99, v99, v115
    v_add_f32 v100, v100, v116
    v_add_f32 v101, v101, v117
    v_add_f32 v102, v102, v118
    v_add_f32 v103, v103, v119
    v_add_f32 v104, v104, v120
    v_add_f32 v105, v105, v121
    v_add_f32 v106, v106, v122
    v_add_f32 v107, v107, v123
    v_add_f32 v108, v108, v124
    v_add_f32 v109, v109, v125
    v_add_f32 v110, v110, v126
    v_add_f32 v111, v111, v127
    v_add_f32 v96, v96, v104
    v_add_f32 v97, v97, v105
    v_add_f32 v98, v98, v106
    v_add_f32 v99, v99, v107
    v_add_f32 v100, v100, v108
    v_add_f32 v101, v101, v109
    v_add_f32 v102, v102, v110
    v_add_f32 v103, v103, v111
    v_add_f32 v96, v96, v100
    v_add_f32 v97, v97, v101
    v_add_f32 v98, v98, v102
    v_add_f32 v99, v99, v103
    v_cvt_pk_bf16_f32 v104, v96, v97
    v_lshlrev_b32 v96, 16, v104
    v_and_b32 v97, 0xffff0000, v104
    v_add_f32 v96, v96, v29
    v_add_f32 v97, v97, v29
    v_cvt_pk_bf16_f32 v104, v96, v97
    v_lshlrev_b32 v96, 16, v104
    v_and_b32 v97, 0xffff0000, v104
    v_lshlrev_b32 v104, 16, v24
    v_and_b32 v105, 0xffff0000, v24
    v_add_f32 v96, v96, v104
    v_add_f32 v97, v97, v105
    v_cvt_pk_bf16_f32 v24, v96, v97
    v_cvt_pk_bf16_f32 v106, v98, v99
    v_lshlrev_b32 v98, 16, v106
    v_and_b32 v99, 0xffff0000, v106
    v_add_f32 v98, v98, v29
    v_add_f32 v99, v99, v29
    v_cvt_pk_bf16_f32 v106, v98, v99
    v_lshlrev_b32 v98, 16, v106
    v_and_b32 v99, 0xffff0000, v106
    v_lshlrev_b32 v106, 16, v25
    v_and_b32 v107, 0xffff0000, v25
    v_add_f32 v98, v98, v106
    v_add_f32 v99, v99, v107
    v_cvt_pk_bf16_f32 v25, v98, v99
    s_waitcnt lgkmcnt(0)
    v_add_f32 v128, v128, v144
    v_add_f32 v129, v129, v145
    v_add_f32 v130, v130, v146
    v_add_f32 v131, v131, v147
    v_add_f32 v132, v132, v148
    v_add_f32 v133, v133, v149
    v_add_f32 v134, v134, v150
    v_add_f32 v135, v135, v151
    v_add_f32 v136, v136, v152
    v_add_f32 v137, v137, v153
    v_add_f32 v138, v138, v154
    v_add_f32 v139, v139, v155
    v_add_f32 v140, v140, v156
    v_add_f32 v141, v141, v157
    v_add_f32 v142, v142, v158
    v_add_f32 v143, v143, v159
    v_add_f32 v128, v128, v136
    v_add_f32 v129, v129, v137
    v_add_f32 v130, v130, v138
    v_add_f32 v131, v131, v139
    v_add_f32 v132, v132, v140
    v_add_f32 v133, v133, v141
    v_add_f32 v134, v134, v142
    v_add_f32 v135, v135, v143
    v_add_f32 v128, v128, v132
    v_add_f32 v129, v129, v133
    v_add_f32 v130, v130, v134
    v_add_f32 v131, v131, v135
    v_cvt_pk_bf16_f32 v136, v128, v129
    v_lshlrev_b32 v128, 16, v136
    v_and_b32 v129, 0xffff0000, v136
    v_add_f32 v128, v128, v29
    v_add_f32 v129, v129, v29
    v_cvt_pk_bf16_f32 v136, v128, v129
    v_lshlrev_b32 v128, 16, v136
    v_and_b32 v129, 0xffff0000, v136
    v_lshlrev_b32 v136, 16, v26
    v_and_b32 v137, 0xffff0000, v26
    v_add_f32 v128, v128, v136
    v_add_f32 v129, v129, v137
    v_cvt_pk_bf16_f32 v26, v128, v129
    v_cvt_pk_bf16_f32 v138, v130, v131
    v_lshlrev_b32 v130, 16, v138
    v_and_b32 v131, 0xffff0000, v138
    v_add_f32 v130, v130, v29
    v_add_f32 v131, v131, v29
    v_cvt_pk_bf16_f32 v138, v130, v131
    v_lshlrev_b32 v130, 16, v138
    v_and_b32 v131, 0xffff0000, v138
    v_lshlrev_b32 v138, 16, v27
    v_and_b32 v139, 0xffff0000, v27
    v_add_f32 v130, v130, v138
    v_add_f32 v131, v131, v139
    v_cvt_pk_bf16_f32 v27, v130, v131
    buffer_store_dwordx4 v[24:27], v247, s[28:31], s56 offen sc1
K6_END:
    s_endpgm
k6_kernel_end:
code_end:
.section .rodata,"a"
.p2align 6
.amdhsa_kernel k1_kernel
  .amdhsa_next_free_vgpr 256
  .amdhsa_next_free_sgpr 102
  .amdhsa_accum_offset 256
  .amdhsa_group_segment_fixed_size 0
  .amdhsa_kernarg_size 112
  .amdhsa_user_sgpr_count 2
  .amdhsa_user_sgpr_kernarg_segment_ptr 1
  .amdhsa_system_sgpr_workgroup_id_x 1
  .amdhsa_float_denorm_mode_32 3
.end_amdhsa_kernel
.p2align 6
.amdhsa_kernel k2_kernel
  .amdhsa_next_free_vgpr 256
  .amdhsa_next_free_sgpr 102
  .amdhsa_accum_offset 256
  .amdhsa_group_segment_fixed_size 0
  .amdhsa_kernarg_size 112
  .amdhsa_user_sgpr_count 2
  .amdhsa_user_sgpr_kernarg_segment_ptr 1
  .amdhsa_system_sgpr_workgroup_id_x 1
  .amdhsa_float_denorm_mode_32 3
.end_amdhsa_kernel
.p2align 6
.amdhsa_kernel k3_kernel
  .amdhsa_next_free_vgpr 256
  .amdhsa_next_free_sgpr 102
  .amdhsa_accum_offset 256
  .amdhsa_group_segment_fixed_size 0
  .amdhsa_kernarg_size 112
  .amdhsa_user_sgpr_count 2
  .amdhsa_user_sgpr_kernarg_segment_ptr 1
  .amdhsa_system_sgpr_workgroup_id_x 1
  .amdhsa_float_denorm_mode_32 3
.end_amdhsa_kernel
.p2align 6
.amdhsa_kernel k4_kernel
  .amdhsa_next_free_vgpr 104
  .amdhsa_next_free_sgpr 102
  .amdhsa_accum_offset 104
  .amdhsa_group_segment_fixed_size 0
  .amdhsa_kernarg_size 112
  .amdhsa_user_sgpr_count 2
  .amdhsa_user_sgpr_kernarg_segment_ptr 1
  .amdhsa_system_sgpr_workgroup_id_x 1
  .amdhsa_float_denorm_mode_32 3
.end_amdhsa_kernel
.p2align 6
.amdhsa_kernel k5_kernel
  .amdhsa_next_free_vgpr 256
  .amdhsa_next_free_sgpr 102
  .amdhsa_accum_offset 256
  .amdhsa_group_segment_fixed_size 0
  .amdhsa_kernarg_size 112
  .amdhsa_user_sgpr_count 2
  .amdhsa_user_sgpr_kernarg_segment_ptr 1
  .amdhsa_system_sgpr_workgroup_id_x 1
  .amdhsa_float_denorm_mode_32 3
.end_amdhsa_kernel
.p2align 6
.amdhsa_kernel k6_kernel
  .amdhsa_next_free_vgpr 256
  .amdhsa_next_free_sgpr 102
  .amdhsa_accum_offset 256
  .amdhsa_group_segment_fixed_size 0
  .amdhsa_kernarg_size 112
  .amdhsa_user_sgpr_count 2
  .amdhsa_user_sgpr_kernarg_segment_ptr 1
  .amdhsa_system_sgpr_workgroup_id_x 1
  .amdhsa_float_denorm_mode_32 3
.end_amdhsa_kernel
```
